```python
import torch

def _softmax(x, axis=-1):
    return torch.softmax(x, dim=axis)

def _gelu(x):
    return torch.nn.functional.gelu(x, approximate='tanh')

def _silu(x):
    return torch.nn.functional.silu(x)

def _sigmoid(x):
    return torch.sigmoid(x)

def _layernorm(x, axis=-1, eps=1e-05):
    m = x.mean(dim=axis, keepdim=True)
    v = x.var(dim=axis, keepdim=True, unbiased=False)
    return (x - m) / torch.sqrt(v + eps)

def _scatter_add(tgt, idx, src, axis=0):
    return tgt.clone().index_add_(axis, idx, src)

def _segment_sum(src, seg, n):
    out = torch.zeros((n,) + src.shape[1:], dtype=src.dtype)
    return out.index_add_(0, seg, src)

def _pad(x, pw):
    flat = tuple((v for pair in reversed(pw) for v in pair))
    return torch.nn.functional.pad(x, flat)
kernel_name = 'adaLN_cond__ssm_conv_h3__glu_gated_geglu__prompt'

def setup_inputs():

    _w = lambda a: (lambda t: t.to(torch.bfloat16) if t.is_floating_point() else t)(torch.as_tensor(a))

    def _A_setup():
        B, S, D = (1, 2048, 576)
        ks = 4
        return {'q': _w((lambda *s: torch.randn(*s, dtype=torch.bfloat16) * 0.05)(B, S, D)), 'k': _w((lambda *s: torch.randn(*s, dtype=torch.bfloat16) * 0.8)(B, S, D)), 'v': _w((lambda *s: torch.randn(*s, dtype=torch.bfloat16) * 0.8)(B, S, D)), 'shift_k': _w((lambda *s: torch.randn(*s, dtype=torch.bfloat16) * 0.8)(D, ks) * 0.5), 'ssm_k': _w((lambda *s: torch.randn(*s, dtype=torch.bfloat16) * 0.8)(D, S) * (1.0 / S ** 0.5)), 'ssm_D': _w((lambda *s: torch.randn(*s, dtype=torch.bfloat16) * 0.8)(D))}
    _A_in = _A_setup()

    def _B_setup():
        B, S, Dm, Df = (1, 2048, 576, 4608)
        return {'x': _w((lambda *s: torch.randn(*s, dtype=torch.bfloat16) * 0.05)(B, S, Dm)), 'w_gate': _w((lambda *s: torch.randn(*s, dtype=torch.bfloat16) * 1.6)(Dm, Df) * Dm ** (-0.5)), 'w_up': _w((lambda *s: torch.randn(*s, dtype=torch.bfloat16) * 1.6)(Dm, Df) * Dm ** (-0.5)), 'w_down': _w((lambda *s: torch.randn(*s, dtype=torch.bfloat16) * 1.6)(Df, Dm) * Df ** (-0.5))}
    _B_in = _B_setup()
    return {'A_q': _A_in['q'], 'A_k': _A_in['k'], 'A_v': _A_in['v'], 'A_shift_k': _A_in['shift_k'], 'A_ssm_k': _A_in['ssm_k'], 'A_ssm_D': _A_in['ssm_D'], 'B_x': _B_in['x'], 'B_w_gate': _B_in['w_gate'], 'B_w_up': _B_in['w_up'], 'B_w_down': _B_in['w_down'], 'c': _w((lambda *s: torch.randn(*s, dtype=torch.bfloat16) * 0.1)(1, 576) * 8.0), 'w_mod': _w((lambda *s: torch.randn(*s, dtype=torch.bfloat16) * 0.1)(576, 6 * 576) * 576 ** (-0.5) * 8.0)}

def reference(A_q, A_k, A_v, A_shift_k, A_ssm_k, A_ssm_D, B_x, B_w_gate, B_w_up, B_w_down, c, w_mod):

    def _A_ref(q, k, v, shift_k, ssm_k, ssm_D):
        B, S, D = q.shape
        ks = shift_k.shape[-1]
        k_pad = _pad(k, ((0, 0), (ks - 1, 0), (0, 0)))
        k_shift = torch.zeros_like(k)
        for t in range(ks):
            k_shift = k_shift + k_pad[:, t:t + S, :] * shift_k[:, ks - 1 - t][None, None, :]
        kv = k_shift * v
        L = 2 * S
        kv_pad = _pad(kv, ((0, 0), (0, S), (0, 0)))
        kf_pad = _pad(ssm_k, ((0, 0), (0, S)))
        kv_f = (lambda x, axes=(-2, -1): torch.fft.rfft2(x.float(), dim=axes))(kv_pad[:, None, :, :], axes=(1, 2))
        kf_f = (lambda x, axes=(-2, -1): torch.fft.rfft2(x.float(), dim=axes))(kf_pad[:, None, :], axes=(1, 2))
        kf_f = (lambda x, *d: x.permute(*d))(kf_f, 1, 2, 0)
        y_f = kv_f * kf_f[None, :, :, :]
        y = (lambda x, s, axes=(-2, -1): torch.fft.irfft2(x, s=s, dim=axes).to(torch.bfloat16))(y_f, (1, L), axes=(1, 2))[:, 0, :S, :]
        y = y + kv * ssm_D[None, None, :]
        return q * y

    def _B_ref(x, w_gate, w_up, w_down):
        g = torch.einsum('bsd,df->bsf', x, w_gate)
        u = torch.einsum('bsd,df->bsf', x, w_up)
        h = _gelu(g) * u
        return torch.einsum('bsf,fd->bsd', h, w_down)
    x = A_q
    mod = (_silu(c) @ w_mod).reshape(c.shape[0], 6, 1, -1)
    sa, ca, ga, sb, cb, gb = (mod[:, 0].clone(), mod[:, 1].clone(), mod[:, 2].clone(), mod[:, 3].clone(), mod[:, 4].clone(), mod[:, 5].clone())
    h = _layernorm(x, axis=-1) * (1 + ca) + sa
    x = x + ga * _A_ref(h, A_k, A_v, A_shift_k, A_ssm_k, A_ssm_D)
    h = _layernorm(x, axis=-1) * (1 + cb) + sb
    x = x + gb * _B_ref(h, B_w_gate, B_w_up, B_w_down)
    return x
```

```asm
; @launch grid=(256,1,1) block=(256,1,1) lds=163840
.amdgcn_target "amdgcn-amd-amdhsa--gfx950"
.text
.globl adaLN_cond__ssm_conv_h3__glu_gated_geglu__prompt_kernel
.p2align 8
.type adaLN_cond__ssm_conv_h3__glu_gated_geglu__prompt_kernel,@function
adaLN_cond__ssm_conv_h3__glu_gated_geglu__prompt_kernel:
    s_cmp_ge_u32 s2, 256
    s_cbranch_scc1 adaLN_cond__ssm_conv_h3__glu_gated_geglu__prompt_kernel_end
    s_load_dwordx4 s[40:43], s[0:1], 8
    s_load_dwordx2 s[44:45], s[0:1], 24
    s_load_dwordx2 s[16:17], s[0:1], 112
    s_load_dwordx2 s[20:21], s[0:1], 0
    s_cmp_ge_u32 s2, 144
    s_cselect_b32 s3, 80, 32
    s_load_dwordx4 s[52:55], s[0:1], s3
    s_load_dwordx2 s[4:5], s[0:1], 56
    s_load_dwordx2 s[8:9], s[0:1], 64
    s_load_dwordx2 s[12:13], s[0:1], 72
    s_load_dwordx2 s[60:61], s[0:1], 96
    s_and_b32 s25, s2, 7
    s_lshr_b32 s26, s2, 3
    s_getpc_b64 s[46:47]
adaLN_cond__ssm_conv_h3__glu_gated_geglu__prompt_kernel_pc:
    v_lshrrev_b32 v1, 6, v0
    s_nop 0
    v_readfirstlane_b32 s24, v1
    s_and_b32 s33, s26, 3
    s_lshl_b32 s3, s25, 2
    s_add_u32 s3, s3, s33
    s_lshr_b32 s49, s26, 2
    s_lshl_b32 s49, s49, 5
    s_add_u32 s73, s3, s49
    s_mul_i32 s66, s73, 9216
    s_cmp_ge_u32 s2, 144
    s_cselect_b32 s84, 147456, 0
    v_and_b32 v205, 63, v0
    v_lshlrev_b32 v9, 4, v205
    s_cmp_eq_u32 s24, 3
    s_cbranch_scc1 adaLN_cond__ssm_conv_h3__glu_gated_geglu__prompt_kernel_e3
    v_cmp_gt_u32 vcc, 0x90, v0
    v_mov_b32 v2, 0x7ff00000
    v_lshl_add_u32 v5, v0, 3, s66
    v_lshl_add_u32 v8, v0, 6, s66
    v_cndmask_b32 v5, v2, v5, vcc
    v_cndmask_b32 v8, v2, v8, vcc
    v_subrev_u32 v6, 3456, v5
    v_lshlrev_b32 v7, 5, v0
    v_and_b32 v200, 7, v0
    v_lshrrev_b32 v201, 3, v0
    v_mul_u32_u24 v202, 1152, v200
    v_lshl_add_u32 v202, v201, 4, v202
    s_mov_b32 s46, 4608
    s_waitcnt lgkmcnt(0)
    s_mov_b32 s76, s40
    s_mov_b32 s77, s41
    s_and_b32 s77, s77, 0xffff
    s_mov_b32 s78, 2359296
    s_mov_b32 s79, 0x00020000
    buffer_load_dwordx2 v[12:13], v6, s[76:79], 0 offen offset:0
    buffer_load_dwordx2 v[14:15], v6, s[76:79], 0 offen offset:1152
    buffer_load_dwordx2 v[16:17], v6, s[76:79], 0 offen offset:2304
    buffer_load_dwordx2 v[18:19], v5, s[76:79], 0 offen offset:0
    buffer_load_dwordx2 v[20:21], v5, s[76:79], 0 offen offset:1152
    buffer_load_dwordx2 v[22:23], v5, s[76:79], 0 offen offset:2304
    buffer_load_dwordx2 v[24:25], v5, s[76:79], 0 offen offset:3456
    buffer_load_dwordx2 v[26:27], v5, s[76:79], s46 offen offset:0
    buffer_load_dwordx2 v[28:29], v5, s[76:79], s46 offen offset:1152
    buffer_load_dwordx2 v[30:31], v5, s[76:79], s46 offen offset:2304
    buffer_load_dwordx2 v[32:33], v5, s[76:79], s46 offen offset:3456
    s_mov_b32 s80, s44
    s_mov_b32 s81, s45
    s_and_b32 s81, s81, 0xffff
    s_mov_b32 s82, 4608
    s_mov_b32 s83, 0x00020000
    buffer_load_dwordx4 v[52:55], v7, s[80:83], 0 offen
    buffer_load_dwordx4 v[56:59], v7, s[80:83], 0 offen offset:16
    s_mov_b32 s40, s42
    s_mov_b32 s41, s43
    s_and_b32 s41, s41, 0xffff
    s_mov_b32 s42, 2359296
    s_mov_b32 s43, 0x00020000
    buffer_load_dwordx2 v[34:35], v5, s[40:43], 0 offen offset:0
    buffer_load_dwordx2 v[36:37], v5, s[40:43], 0 offen offset:1152
    buffer_load_dwordx2 v[38:39], v5, s[40:43], 0 offen offset:2304
    buffer_load_dwordx2 v[40:41], v5, s[40:43], 0 offen offset:3456
    buffer_load_dwordx2 v[42:43], v5, s[40:43], s46 offen offset:0
    buffer_load_dwordx2 v[44:45], v5, s[40:43], s46 offen offset:1152
    buffer_load_dwordx2 v[46:47], v5, s[40:43], s46 offen offset:2304
    buffer_load_dwordx2 v[48:49], v5, s[40:43], s46 offen offset:3456
    s_and_b32 s17, s17, 0xffff
    s_mov_b32 s18, 46465024
    s_mov_b32 s19, 0x00020000
    s_and_b32 s21, s21, 0xffff
    s_mov_b32 s22, 2359296
    s_mov_b32 s23, 0x00020000
    s_mov_b32 s3, 4956160
    buffer_load_dword v199, off, s[16:19], s3 sc1
    buffer_load_dwordx4 v[208:211], v202, s[20:23], s66 offen offset:0
    buffer_load_dwordx4 v[212:215], v202, s[20:23], s66 offen offset:384
    buffer_load_dwordx4 v[216:219], v202, s[20:23], s66 offen offset:768
    s_and_b32 s5, s5, 0xffff
    s_mov_b32 s6, 5308416
    s_mov_b32 s7, 0x00020000
    s_and_b32 s9, s9, 0xffff
    s_mov_b32 s10, 5308416
    s_mov_b32 s11, 0x00020000
    s_and_b32 s13, s13, 0xffff
    s_mov_b32 s14, 5308416
    s_mov_b32 s15, 0x00020000
    v_add_u32 v9, 16, v8
    v_add_u32 v10, 32, v8
    v_add_u32 v11, 48, v8
    s_mov_b32 s66, 0xffff0000
    s_waitcnt vmcnt(12)
    v_lshlrev_b32 v82, 16, v52
    v_lshlrev_b32 v83, 16, v54
    v_and_b32 v84, s66, v52
    v_and_b32 v85, s66, v54
    v_lshlrev_b32 v86, 16, v53
    v_lshlrev_b32 v87, 16, v55
    v_and_b32 v88, s66, v53
    v_and_b32 v89, s66, v55
    v_lshlrev_b32 v60, 16, v12
    v_and_b32 v61, s66, v12
    v_lshlrev_b32 v62, 16, v14
    v_and_b32 v63, s66, v14
    v_lshlrev_b32 v64, 16, v16
    v_and_b32 v65, s66, v16
    v_lshlrev_b32 v66, 16, v18
    v_and_b32 v67, s66, v18
    v_lshlrev_b32 v68, 16, v20
    v_and_b32 v69, s66, v20
    v_lshlrev_b32 v70, 16, v22
    v_and_b32 v71, s66, v22
    v_lshlrev_b32 v72, 16, v24
    v_and_b32 v73, s66, v24
    v_lshlrev_b32 v74, 16, v26
    v_and_b32 v75, s66, v26
    v_lshlrev_b32 v76, 16, v28
    v_and_b32 v77, s66, v28
    v_lshlrev_b32 v78, 16, v30
    v_and_b32 v79, s66, v30
    v_lshlrev_b32 v80, 16, v32
    v_and_b32 v81, s66, v32
    v_pk_mul_f32 v[90:91], v[60:61], v[88:89]
    v_pk_mul_f32 v[92:93], v[62:63], v[88:89]
    v_pk_mul_f32 v[94:95], v[64:65], v[88:89]
    v_pk_mul_f32 v[96:97], v[66:67], v[88:89]
    v_pk_mul_f32 v[98:99], v[68:69], v[88:89]
    v_pk_mul_f32 v[100:101], v[70:71], v[88:89]
    v_pk_mul_f32 v[102:103], v[72:73], v[88:89]
    v_pk_mul_f32 v[104:105], v[74:75], v[88:89]
    v_pk_fma_f32 v[90:91], v[62:63], v[86:87], v[90:91]
    v_pk_fma_f32 v[92:93], v[64:65], v[86:87], v[92:93]
    v_pk_fma_f32 v[94:95], v[66:67], v[86:87], v[94:95]
    v_pk_fma_f32 v[96:97], v[68:69], v[86:87], v[96:97]
    v_pk_fma_f32 v[98:99], v[70:71], v[86:87], v[98:99]
    v_pk_fma_f32 v[100:101], v[72:73], v[86:87], v[100:101]
    v_pk_fma_f32 v[102:103], v[74:75], v[86:87], v[102:103]
    v_pk_fma_f32 v[104:105], v[76:77], v[86:87], v[104:105]
    v_pk_fma_f32 v[90:91], v[64:65], v[84:85], v[90:91]
    v_pk_fma_f32 v[92:93], v[66:67], v[84:85], v[92:93]
    v_pk_fma_f32 v[94:95], v[68:69], v[84:85], v[94:95]
    v_pk_fma_f32 v[96:97], v[70:71], v[84:85], v[96:97]
    v_pk_fma_f32 v[98:99], v[72:73], v[84:85], v[98:99]
    v_pk_fma_f32 v[100:101], v[74:75], v[84:85], v[100:101]
    v_pk_fma_f32 v[102:103], v[76:77], v[84:85], v[102:103]
    v_pk_fma_f32 v[104:105], v[78:79], v[84:85], v[104:105]
    v_pk_fma_f32 v[90:91], v[66:67], v[82:83], v[90:91]
    v_pk_fma_f32 v[92:93], v[68:69], v[82:83], v[92:93]
    v_pk_fma_f32 v[94:95], v[70:71], v[82:83], v[94:95]
    v_pk_fma_f32 v[96:97], v[72:73], v[82:83], v[96:97]
    v_pk_fma_f32 v[98:99], v[74:75], v[82:83], v[98:99]
    v_pk_fma_f32 v[100:101], v[76:77], v[82:83], v[100:101]
    v_pk_fma_f32 v[102:103], v[78:79], v[82:83], v[102:103]
    v_pk_fma_f32 v[104:105], v[80:81], v[82:83], v[104:105]
    s_waitcnt vmcnt(4)
    v_lshlrev_b32 v106, 16, v34
    v_and_b32 v107, s66, v34
    v_lshlrev_b32 v108, 16, v36
    v_and_b32 v109, s66, v36
    v_lshlrev_b32 v110, 16, v38
    v_and_b32 v111, s66, v38
    v_lshlrev_b32 v112, 16, v40
    v_and_b32 v113, s66, v40
    v_lshlrev_b32 v114, 16, v42
    v_and_b32 v115, s66, v42
    v_lshlrev_b32 v116, 16, v44
    v_and_b32 v117, s66, v44
    v_lshlrev_b32 v118, 16, v46
    v_and_b32 v119, s66, v46
    v_lshlrev_b32 v120, 16, v48
    v_and_b32 v121, s66, v48
    v_pk_mul_f32 v[90:91], v[90:91], v[106:107]
    v_pk_mul_f32 v[92:93], v[92:93], v[108:109]
    v_pk_mul_f32 v[94:95], v[94:95], v[110:111]
    v_pk_mul_f32 v[96:97], v[96:97], v[112:113]
    v_pk_mul_f32 v[98:99], v[98:99], v[114:115]
    v_pk_mul_f32 v[100:101], v[100:101], v[116:117]
    v_pk_mul_f32 v[102:103], v[102:103], v[118:119]
    v_pk_mul_f32 v[104:105], v[104:105], v[120:121]
    v_cvt_pk_bf16_f32 v140, v104, v102
    v_cvt_pk_bf16_f32 v141, v100, v98
    v_cvt_pk_bf16_f32 v142, v96, v94
    v_cvt_pk_bf16_f32 v143, v92, v90
    v_cvt_pk_bf16_f32 v144, v105, v103
    v_cvt_pk_bf16_f32 v145, v101, v99
    v_cvt_pk_bf16_f32 v146, v97, v95
    v_cvt_pk_bf16_f32 v147, v93, v91
    v_lshlrev_b32 v82, 16, v56
    v_lshlrev_b32 v83, 16, v58
    v_and_b32 v84, s66, v56
    v_and_b32 v85, s66, v58
    v_lshlrev_b32 v86, 16, v57
    v_lshlrev_b32 v87, 16, v59
    v_and_b32 v88, s66, v57
    v_and_b32 v89, s66, v59
    v_lshlrev_b32 v60, 16, v13
    v_and_b32 v61, s66, v13
    v_lshlrev_b32 v62, 16, v15
    v_and_b32 v63, s66, v15
    v_lshlrev_b32 v64, 16, v17
    v_and_b32 v65, s66, v17
    v_lshlrev_b32 v66, 16, v19
    v_and_b32 v67, s66, v19
    v_lshlrev_b32 v68, 16, v21
    v_and_b32 v69, s66, v21
    v_lshlrev_b32 v70, 16, v23
    v_and_b32 v71, s66, v23
    v_lshlrev_b32 v72, 16, v25
    v_and_b32 v73, s66, v25
    v_lshlrev_b32 v74, 16, v27
    v_and_b32 v75, s66, v27
    v_lshlrev_b32 v76, 16, v29
    v_and_b32 v77, s66, v29
    v_lshlrev_b32 v78, 16, v31
    v_and_b32 v79, s66, v31
    v_lshlrev_b32 v80, 16, v33
    v_and_b32 v81, s66, v33
    v_pk_mul_f32 v[90:91], v[60:61], v[88:89]
    v_pk_mul_f32 v[92:93], v[62:63], v[88:89]
    v_pk_mul_f32 v[94:95], v[64:65], v[88:89]
    v_pk_mul_f32 v[96:97], v[66:67], v[88:89]
    v_pk_mul_f32 v[98:99], v[68:69], v[88:89]
    v_pk_mul_f32 v[100:101], v[70:71], v[88:89]
    v_pk_mul_f32 v[102:103], v[72:73], v[88:89]
    v_pk_mul_f32 v[104:105], v[74:75], v[88:89]
    v_pk_fma_f32 v[90:91], v[62:63], v[86:87], v[90:91]
    v_pk_fma_f32 v[92:93], v[64:65], v[86:87], v[92:93]
    v_pk_fma_f32 v[94:95], v[66:67], v[86:87], v[94:95]
    v_pk_fma_f32 v[96:97], v[68:69], v[86:87], v[96:97]
    v_pk_fma_f32 v[98:99], v[70:71], v[86:87], v[98:99]
    v_pk_fma_f32 v[100:101], v[72:73], v[86:87], v[100:101]
    v_pk_fma_f32 v[102:103], v[74:75], v[86:87], v[102:103]
    v_pk_fma_f32 v[104:105], v[76:77], v[86:87], v[104:105]
    v_pk_fma_f32 v[90:91], v[64:65], v[84:85], v[90:91]
    v_pk_fma_f32 v[92:93], v[66:67], v[84:85], v[92:93]
    v_pk_fma_f32 v[94:95], v[68:69], v[84:85], v[94:95]
    v_pk_fma_f32 v[96:97], v[70:71], v[84:85], v[96:97]
    v_pk_fma_f32 v[98:99], v[72:73], v[84:85], v[98:99]
    v_pk_fma_f32 v[100:101], v[74:75], v[84:85], v[100:101]
    v_pk_fma_f32 v[102:103], v[76:77], v[84:85], v[102:103]
    v_pk_fma_f32 v[104:105], v[78:79], v[84:85], v[104:105]
    v_pk_fma_f32 v[90:91], v[66:67], v[82:83], v[90:91]
    v_pk_fma_f32 v[92:93], v[68:69], v[82:83], v[92:93]
    v_pk_fma_f32 v[94:95], v[70:71], v[82:83], v[94:95]
    v_pk_fma_f32 v[96:97], v[72:73], v[82:83], v[96:97]
    v_pk_fma_f32 v[98:99], v[74:75], v[82:83], v[98:99]
    v_pk_fma_f32 v[100:101], v[76:77], v[82:83], v[100:101]
    v_pk_fma_f32 v[102:103], v[78:79], v[82:83], v[102:103]
    v_pk_fma_f32 v[104:105], v[80:81], v[82:83], v[104:105]
    v_lshlrev_b32 v106, 16, v35
    v_and_b32 v107, s66, v35
    v_lshlrev_b32 v108, 16, v37
    v_and_b32 v109, s66, v37
    v_lshlrev_b32 v110, 16, v39
    v_and_b32 v111, s66, v39
    v_lshlrev_b32 v112, 16, v41
    v_and_b32 v113, s66, v41
    v_lshlrev_b32 v114, 16, v43
    v_and_b32 v115, s66, v43
    v_lshlrev_b32 v116, 16, v45
    v_and_b32 v117, s66, v45
    v_lshlrev_b32 v118, 16, v47
    v_and_b32 v119, s66, v47
    v_lshlrev_b32 v120, 16, v49
    v_and_b32 v121, s66, v49
    v_pk_mul_f32 v[90:91], v[90:91], v[106:107]
    v_pk_mul_f32 v[92:93], v[92:93], v[108:109]
    v_pk_mul_f32 v[94:95], v[94:95], v[110:111]
    v_pk_mul_f32 v[96:97], v[96:97], v[112:113]
    v_pk_mul_f32 v[98:99], v[98:99], v[114:115]
    v_pk_mul_f32 v[100:101], v[100:101], v[116:117]
    v_pk_mul_f32 v[102:103], v[102:103], v[118:119]
    v_pk_mul_f32 v[104:105], v[104:105], v[120:121]
    v_cvt_pk_bf16_f32 v148, v104, v102
    v_cvt_pk_bf16_f32 v149, v100, v98
    v_cvt_pk_bf16_f32 v150, v96, v94
    v_cvt_pk_bf16_f32 v151, v92, v90
    v_cvt_pk_bf16_f32 v152, v105, v103
    v_cvt_pk_bf16_f32 v153, v101, v99
    v_cvt_pk_bf16_f32 v154, v97, v95
    v_cvt_pk_bf16_f32 v155, v93, v91
    v_permlane32_swap_b32 v140, v148
    v_permlane32_swap_b32 v141, v149
    v_permlane32_swap_b32 v142, v150
    v_permlane32_swap_b32 v143, v151
    v_permlane32_swap_b32 v8, v10
    v_permlane32_swap_b32 v144, v152
    v_permlane32_swap_b32 v145, v153
    v_permlane32_swap_b32 v146, v154
    v_permlane32_swap_b32 v147, v155
    v_permlane32_swap_b32 v9, v11
    v_permlane16_swap_b32 v140, v144
    v_permlane16_swap_b32 v141, v145
    v_permlane16_swap_b32 v142, v146
    v_permlane16_swap_b32 v143, v147
    v_permlane16_swap_b32 v8, v9
    v_permlane16_swap_b32 v148, v152
    v_permlane16_swap_b32 v149, v153
    v_permlane16_swap_b32 v150, v154
    v_permlane16_swap_b32 v151, v155
    v_permlane16_swap_b32 v10, v11
    buffer_store_dwordx4 v[140:143], v8, s[16:19], 0 offen sc1
    buffer_store_dwordx4 v[144:147], v9, s[16:19], 0 offen sc1
    buffer_store_dwordx4 v[148:151], v10, s[16:19], 0 offen sc1
    buffer_store_dwordx4 v[152:155], v11, s[16:19], 0 offen sc1
    v_lshlrev_b32 v9, 4, v205
    s_lshl_b32 s3, s24, 6
    s_add_u32 s3, s3, s84
    v_lshl_add_u32 v196, v200, 3, s3
    s_waitcnt vmcnt(4)
    v_lshlrev_b32 v132, 16, v208
    v_and_b32 v133, s66, v208
    v_lshlrev_b32 v134, 16, v209
    v_and_b32 v135, s66, v209
    v_lshlrev_b32 v136, 16, v210
    v_and_b32 v137, s66, v210
    v_lshlrev_b32 v138, 16, v211
    v_and_b32 v139, s66, v211
    v_lshlrev_b32 v140, 16, v212
    v_and_b32 v141, s66, v212
    v_lshlrev_b32 v142, 16, v213
    v_and_b32 v143, s66, v213
    v_lshlrev_b32 v144, 16, v214
    v_and_b32 v145, s66, v214
    v_lshlrev_b32 v146, 16, v215
    v_and_b32 v147, s66, v215
    v_lshlrev_b32 v148, 16, v216
    v_and_b32 v149, s66, v216
    v_lshlrev_b32 v150, 16, v217
    v_and_b32 v151, s66, v217
    v_lshlrev_b32 v152, 16, v218
    v_and_b32 v153, s66, v218
    v_lshlrev_b32 v154, 16, v219
    v_and_b32 v155, s66, v219
    v_pk_add_f32 v[180:181], v[132:133], v[134:135]
    v_pk_mul_f32 v[182:183], v[132:133], v[132:133]
    v_pk_mul_f32 v[184:185], v[134:135], v[134:135]
    v_pk_add_f32 v[180:181], v[180:181], v[136:137]
    v_pk_fma_f32 v[182:183], v[136:137], v[136:137], v[182:183]
    v_pk_add_f32 v[180:181], v[180:181], v[138:139]
    v_pk_fma_f32 v[184:185], v[138:139], v[138:139], v[184:185]
    v_pk_add_f32 v[180:181], v[180:181], v[140:141]
    v_pk_fma_f32 v[182:183], v[140:141], v[140:141], v[182:183]
    v_pk_add_f32 v[180:181], v[180:181], v[142:143]
    v_pk_fma_f32 v[184:185], v[142:143], v[142:143], v[184:185]
    v_pk_add_f32 v[180:181], v[180:181], v[144:145]
    v_pk_fma_f32 v[182:183], v[144:145], v[144:145], v[182:183]
    v_pk_add_f32 v[180:181], v[180:181], v[146:147]
    v_pk_fma_f32 v[184:185], v[146:147], v[146:147], v[184:185]
    v_pk_add_f32 v[180:181], v[180:181], v[148:149]
    v_pk_fma_f32 v[182:183], v[148:149], v[148:149], v[182:183]
    v_pk_add_f32 v[180:181], v[180:181], v[150:151]
    v_pk_fma_f32 v[184:185], v[150:151], v[150:151], v[184:185]
    v_pk_add_f32 v[180:181], v[180:181], v[152:153]
    v_pk_fma_f32 v[182:183], v[152:153], v[152:153], v[182:183]
    v_pk_add_f32 v[180:181], v[180:181], v[154:155]
    v_pk_fma_f32 v[184:185], v[154:155], v[154:155], v[184:185]
    v_pk_add_f32 v[182:183], v[182:183], v[184:185]
    v_add_f32 v180, v180, v181
    v_add_f32 v181, v182, v183
    s_nop 0
    v_add_f32 v180, v180, v180 row_ror:8
    v_add_f32 v181, v181, v181 row_ror:8
    v_mov_b32 v182, v180
    v_mov_b32 v183, v181
    s_nop 0
    v_permlane16_swap_b32 v180, v182
    v_permlane16_swap_b32 v181, v183
    v_pk_add_f32 v[180:181], v[180:181], v[182:183]
    v_mov_b32 v182, v180
    v_mov_b32 v183, v181
    s_nop 0
    v_permlane32_swap_b32 v180, v182
    v_permlane32_swap_b32 v181, v183
    v_pk_add_f32 v[180:181], v[180:181], v[182:183]
    ds_write_b64 v196, v[180:181]
    s_branch adaLN_cond__ssm_conv_h3__glu_gated_geglu__prompt_kernel_ej
adaLN_cond__ssm_conv_h3__glu_gated_geglu__prompt_kernel_e3:
    v_lshl_add_u32 v2, v205, 5, s26
    v_lshlrev_b32 v2, 7, v2
    v_min_u32 v2, adaLN_cond__ssm_conv_h3__glu_gated_geglu__prompt_kernel_end-adaLN_cond__ssm_conv_h3__glu_gated_geglu__prompt_kernel_pc, v2
    v_mov_b32 v3, s47
    v_add_co_u32 v2, vcc, s46, v2
    s_nop 1
    v_addc_co_u32 v3, vcc, 0, v3, vcc
    global_load_dword v192, v[2:3], off
    v_mov_b32 v12, -1
    v_mov_b32 v13, -1
    v_mov_b32 v14, -1
    v_mov_b32 v15, -1
    v_and_b32 v200, 7, v0
    v_lshrrev_b32 v201, 3, v0
    s_add_u32 s66, s66, 2359296
    s_waitcnt lgkmcnt(0)
    s_and_b32 s17, s17, 0xffff
    s_mov_b32 s18, 46465024
    s_mov_b32 s19, 0x00020000
    s_mov_b32 s3, 4956160
    buffer_load_dword v199, off, s[16:19], s3 sc1
    s_add_u32 s3, s66, 0
    buffer_store_dwordx4 v[12:15], v9, s[16:19], s3 offen offset:0 sc1
    buffer_store_dwordx4 v[12:15], v9, s[16:19], s3 offen offset:1024 sc1
    buffer_store_dwordx4 v[12:15], v9, s[16:19], s3 offen offset:2048 sc1
    buffer_store_dwordx4 v[12:15], v9, s[16:19], s3 offen offset:3072 sc1
    s_add_u32 s3, s3, 4096
    buffer_store_dwordx4 v[12:15], v9, s[16:19], s3 offen offset:0 sc1
    buffer_store_dwordx4 v[12:15], v9, s[16:19], s3 offen offset:1024 sc1
    buffer_store_dwordx4 v[12:15], v9, s[16:19], s3 offen offset:2048 sc1
    buffer_store_dwordx4 v[12:15], v9, s[16:19], s3 offen offset:3072 sc1
    s_add_u32 s3, s3, 4096
    buffer_store_dwordx4 v[12:15], v9, s[16:19], s3 offen offset:0 sc1
    s_and_b32 s21, s21, 0xffff
    s_mov_b32 s22, 2359296
    s_mov_b32 s23, 0x00020000
    s_and_b32 s5, s5, 0xffff
    s_mov_b32 s6, 5308416
    s_mov_b32 s7, 0x00020000
    s_and_b32 s9, s9, 0xffff
    s_mov_b32 s10, 5308416
    s_mov_b32 s11, 0x00020000
    s_and_b32 s13, s13, 0xffff
    s_mov_b32 s14, 5308416
    s_mov_b32 s15, 0x00020000
    s_load_dwordx2 s[40:41], s[0:1], 88
    s_lshl_b32 s3, s26, 7
    v_add_u32 v3, s3, v205
    v_mul_u32_u24 v4, 7282, v3
    v_lshrrev_b32 v4, 22, v4
    v_mul_u32_u24 v5, 576, v4
    v_sub_u32 v5, v3, v5
    v_mul_u32_u24 v5, 6912, v5
    v_lshl_add_u32 v4, v4, 3, s25
    v_min_u32 v4, 53, v4
    v_lshl_add_u32 v6, v4, 7, v5
    v_add_u32 v3, 64, v3
    v_mul_u32_u24 v4, 7282, v3
    v_lshrrev_b32 v4, 22, v4
    v_mul_u32_u24 v5, 576, v4
    v_sub_u32 v5, v3, v5
    v_mul_u32_u24 v5, 6912, v5
    v_lshl_add_u32 v4, v4, 3, s25
    v_min_u32 v4, 53, v4
    v_lshl_add_u32 v7, v4, 7, v5
    s_sub_u32 s72, s2, 144
    s_cmp_ge_u32 s72, 54
    s_cbranch_scc1 adaLN_cond__ssm_conv_h3__glu_gated_geglu__prompt_kernel_e3x
    s_mov_b32 s76, s52
    s_mov_b32 s77, s53
    s_and_b32 s77, s77, 0xffff
    s_mov_b32 s78, 1152
    s_mov_b32 s79, 0x00020000
    v_lshlrev_b32 v2, 2, v205
    buffer_load_dword v16, v2, s[76:79], 0 offen offset:0
    buffer_load_dword v17, v2, s[76:79], 0 offen offset:256
    buffer_load_dword v18, v2, s[76:79], 0 offen offset:512
    buffer_load_dword v19, v2, s[76:79], 0 offen offset:768
    buffer_load_dword v20, v2, s[76:79], 0 offen offset:1024
    s_waitcnt vmcnt(0)
    s_mov_b32 s66, 0xffff0000
    s_mov_b32 s49, 0xbfb8aa3b
    v_add_u32 v21, 148480, v2
    v_lshlrev_b32 v22, 16, v16
    v_and_b32 v23, s66, v16
    v_lshlrev_b32 v24, 16, v17
    v_and_b32 v25, s66, v17
    v_lshlrev_b32 v26, 16, v18
    v_and_b32 v27, s66, v18
    v_lshlrev_b32 v28, 16, v19
    v_and_b32 v29, s66, v19
    v_lshlrev_b32 v30, 16, v20
    v_and_b32 v31, s66, v20
    v_mul_f32 v32, s49, v22
    v_mul_f32 v33, s49, v23
    v_mul_f32 v34, s49, v24
    v_mul_f32 v35, s49, v25
    v_mul_f32 v36, s49, v26
    v_mul_f32 v37, s49, v27
    v_mul_f32 v38, s49, v28
    v_mul_f32 v39, s49, v29
    v_mul_f32 v40, s49, v30
    v_mul_f32 v41, s49, v31
    v_exp_f32 v32, v32
    v_exp_f32 v33, v33
    v_exp_f32 v34, v34
    v_exp_f32 v35, v35
    v_exp_f32 v36, v36
    v_exp_f32 v37, v37
    v_exp_f32 v38, v38
    v_exp_f32 v39, v39
    v_exp_f32 v40, v40
    v_exp_f32 v41, v41
    v_add_f32 v32, 1.0, v32
    v_add_f32 v33, 1.0, v33
    v_add_f32 v34, 1.0, v34
    v_add_f32 v35, 1.0, v35
    v_add_f32 v36, 1.0, v36
    v_add_f32 v37, 1.0, v37
    v_add_f32 v38, 1.0, v38
    v_add_f32 v39, 1.0, v39
    v_add_f32 v40, 1.0, v40
    v_add_f32 v41, 1.0, v41
    v_rcp_f32 v32, v32
    v_rcp_f32 v33, v33
    v_rcp_f32 v34, v34
    v_rcp_f32 v35, v35
    v_rcp_f32 v36, v36
    v_rcp_f32 v37, v37
    v_rcp_f32 v38, v38
    v_rcp_f32 v39, v39
    v_rcp_f32 v40, v40
    v_rcp_f32 v41, v41
    v_mul_f32 v22, v22, v32
    v_mul_f32 v23, v23, v33
    v_mul_f32 v24, v24, v34
    v_mul_f32 v25, v25, v35
    v_mul_f32 v26, v26, v36
    v_mul_f32 v27, v27, v37
    v_mul_f32 v28, v28, v38
    v_mul_f32 v29, v29, v39
    v_mul_f32 v30, v30, v40
    v_mul_f32 v31, v31, v41
    v_cvt_pk_bf16_f32 v16, v22, v23
    ds_write_b32 v21, v16 offset:0
    v_cvt_pk_bf16_f32 v17, v24, v25
    ds_write_b32 v21, v17 offset:256
    v_cvt_pk_bf16_f32 v18, v26, v27
    ds_write_b32 v21, v18 offset:512
    v_cvt_pk_bf16_f32 v19, v28, v29
    ds_write_b32 v21, v19 offset:768
    v_cvt_pk_bf16_f32 v20, v30, v31
    ds_write_b32 v21, v20 offset:1024
adaLN_cond__ssm_conv_h3__glu_gated_geglu__prompt_kernel_e3x:
    s_waitcnt vmcnt(0) lgkmcnt(0)
    s_and_b32 s41, s41, 0xffff
    s_mov_b32 s42, 3981312
    s_mov_b32 s43, 0x00020000
    buffer_load_dword v194, v6, s[40:43], 0 offen
    buffer_load_dword v195, v7, s[40:43], 0 offen
    s_branch adaLN_cond__ssm_conv_h3__glu_gated_geglu__prompt_kernel_ej2
adaLN_cond__ssm_conv_h3__glu_gated_geglu__prompt_kernel_ej:
    s_waitcnt vmcnt(0)
adaLN_cond__ssm_conv_h3__glu_gated_geglu__prompt_kernel_ej2:
    v_readfirstlane_b32 s71, v199
    s_lshr_b32 s3, s73, 1
    s_mul_i32 s3, s3, 18432
    s_add_u32 s36, s3, 2359296
    s_add_u32 s37, s3, 2365440
    s_add_u32 s38, s3, 2371584
    s_and_b32 s3, s73, 1
    s_lshl_b32 s3, s3, 3
    v_add_u32 v244, s3, v200
    v_lshlrev_b32 v245, 8, v201
    v_lshl_add_u32 v204, v244, 4, v245
    v_lshl_add_u32 v203, v244, 3, v245
    v_lshlrev_b32 v198, 5, v201
    v_lshl_add_u32 v197, v200, 3, s84
    s_lshl_b32 s3, s2, 2
    s_add_u32 s3, s3, s24
    s_mul_i32 s67, s3, 32
    s_mul_i32 s58, s3, 12288
    s_add_u32 s58, s58, 28573696
    s_waitcnt lgkmcnt(0)
    s_barrier
    s_mul_i32 s70, s71, 0x9E3779B1
    s_add_u32 s70, s70, 0x7F4A7C15
    s_bfe_u32 s72, s73, 0x20004
    s_lshl_b32 s72, s72, 2
    s_lshr_b32 s3, s73, 6
    s_add_u32 s72, s72, s3
    s_lshl_b32 s72, s72, 4
    s_and_b32 s3, s73, 15
    s_add_u32 s72, s72, s3
    s_lshl_b32 s72, s72, 5
    s_cmp_lg_u32 s24, 0
    s_cbranch_scc1 adaLN_cond__ssm_conv_h3__glu_gated_geglu__prompt_kernel_nf
    s_add_u32 s49, s72, 4915200
    v_mov_b32 v13, s70
    s_mov_b64 exec, 1
    buffer_store_dword v13, off, s[16:19], s49 sc1
    s_mov_b64 exec, -1
adaLN_cond__ssm_conv_h3__glu_gated_geglu__prompt_kernel_nf:
    s_cmp_ge_u32 s2, 144
    s_cbranch_scc1 adaLN_cond__ssm_conv_h3__glu_gated_geglu__prompt_kernel_oth
    s_mul_i32 s72, s25, 18
    s_add_u32 s72, s72, s26
    s_lshl_b32 s3, s72, 2
    s_mul_i32 s49, s25, 18
    s_add_u32 s49, s49, s26
    s_lshl_b32 s49, s49, 2
    s_add_u32 s74, s49, s24
    s_lshl_b32 s49, s74, 12
    s_add_u32 s76, s52, s49
    s_addc_u32 s77, s53, 0
    s_and_b32 s77, s77, 0xffff
    s_mov_b32 s78, 4096
    s_mov_b32 s79, 0x00020000
    v_lshlrev_b32 v250, 4, v205
    v_subrev_u32 v251, 16, v250
    buffer_load_dwordx4 v[220:223], v250, s[76:79], 0 offen offset:0
    buffer_load_dword v224, v250, s[76:79], 0 offen offset:16
    buffer_load_dwordx4 v[226:229], v250, s[76:79], 0 offen offset:1024
    buffer_load_dword v230, v250, s[76:79], 0 offen offset:1040
    buffer_load_dwordx4 v[232:235], v250, s[76:79], 0 offen offset:2048
    buffer_load_dword v236, v250, s[76:79], 0 offen offset:2064
    buffer_load_dwordx4 v[238:241], v250, s[76:79], 0 offen offset:3072
    buffer_load_dword v242, v250, s[76:79], 0 offen offset:3088
    buffer_load_dword v248, v251, s[76:79], 0 offen
    s_mov_b32 s80, s54
    s_mov_b32 s81, s55
    s_and_b32 s81, s81, 0xffff
    s_mov_b32 s82, 1152
    s_mov_b32 s83, 0x00020000
    s_lshl_b32 s49, s74, 1
    buffer_load_ushort v249, off, s[80:83], s49
adaLN_cond__ssm_conv_h3__glu_gated_geglu__prompt_kernel_nh_0_1:
    v_mov_b32 v156, -1
    v_mov_b32 v157, -1
    v_mov_b32 v158, -1
    v_mov_b32 v159, -1
    v_lshrrev_b32 v160, 3, v205
    v_and_b32 v161, 7, v205
    v_lshlrev_b32 v161, 4, v161
    s_and_b32 s49, s73, 1
    s_lshl_b32 s49, s49, 7
    s_mul_i32 s66, s24, 4608
    s_add_u32 s49, s49, s66
    s_add_u32 s49, s49, s36
    s_add_u32 s49, s49, 2621440
    v_add_u32 v162, 0, v160
    v_min_u32 v162, 17, v162
    v_lshl_add_u32 v162, v162, 8, v161
    buffer_store_dwordx4 v[156:159], v162, s[16:19], s49 offen sc1
    v_add_u32 v162, 8, v160
    v_min_u32 v162, 17, v162
    v_lshl_add_u32 v162, v162, 8, v161
    buffer_store_dwordx4 v[156:159], v162, s[16:19], s49 offen sc1
    v_add_u32 v162, 16, v160
    v_min_u32 v162, 17, v162
    v_lshl_add_u32 v162, v162, 8, v161
    buffer_store_dwordx4 v[156:159], v162, s[16:19], s49 offen sc1
    v_lshrrev_b32 v3, 2, v0
    v_and_b32 v4, 3, v0
    v_mul_u32_u24 v5, 9216, v3
    v_add_u32 v8, s3, v4
    v_lshl_add_u32 v5, v8, 4, v5
    v_mul_u32_u24 v8, 4640, v4
    v_lshl_add_u32 v8, v3, 4, v8
    v_add_u32 v8, 145792, v8
    v_and_b32 v2, 15, v205
    v_lshrrev_b32 v15, 4, v205
    v_lshlrev_b32 v10, 5, v0
    ds_read_b64 v[184:185], v197 offset:0
    ds_read_b64 v[186:187], v197 offset:64
    ds_read_b64 v[188:189], v197 offset:128
    s_mov_b32 s3, 0x3ae38e39
    s_waitcnt lgkmcnt(0)
    v_pk_add_f32 v[184:185], v[184:185], v[186:187]
    v_pk_add_f32 v[184:185], v[184:185], v[188:189]
    v_mul_f32 v206, s3, v184
    v_mul_f32 v207, s3, v185
    v_fma_f32 v207, -v206, v206, v207
    v_max_f32 v207, 0, v207
    v_add_f32 v207, 0x3727c5ac, v207
    v_rsq_f32 v207, v207
    v_mul_f32 v206, -1.0, v206
    v_mul_f32 v206, v206, v207
    s_and_b32 s27, s33, 1
    s_lshr_b32 s3, s33, 1
    s_mul_i32 s3, s3, 9
    s_mul_i32 s49, s25, 18
    s_add_u32 s3, s3, s49
    s_add_u32 s28, s3, 4
    s_lshl_b32 s3, s33, 3
    s_or_b32 s3, s3, 0x80000
    s_bfe_u32 s29, 235537920, s3
    s_add_u32 s29, s29, s49
    v_lshrrev_b32 v244, 2, v205
    s_mul_i32 s3, s24, 144
    v_add_u32 v244, s3, v244
    v_mul_u32_u24 v244, 9216, v244
    v_lshrrev_b32 v245, 4, v205
    v_and_b32 v245, 2, v245
    v_and_b32 v247, 3, v205
    v_xor_b32 v245, v245, v247
    v_lshl_add_u32 v6, v245, 4, v244
    s_lshl_b32 s3, s28, 6
    v_add_u32 v7, s3, v6
    s_mov_b32 s40, 0
    s_mov_b32 s41, 146432
    s_mov_b32 s42, 292864
    s_mov_b32 s43, 439296
    s_mov_b32 s44, 589824
    s_mov_b32 s45, 736256
    s_mov_b32 s46, 882688
    s_mov_b32 s47, 1029120
    s_mov_b32 s48, 1179648
    s_mul_i32 s34, s24, 9216
    v_mov_b32 v244, 0
    v_mov_b32 v245, 0
    v_mov_b32 v246, 0
    v_mov_b32 v247, 0
    s_mul_i32 s3, s24, 4640
    s_add_u32 s3, s3, 145280
    v_add_u32 v12, s3, v9
    s_mov_b32 exec_hi, 0
    ds_write_b128 v12, v[244:247]
    s_mov_b64 exec, -1
    s_mul_i32 s49, s24, 8320
    s_add_u32 s49, s49, 112000
    v_add_u32 v13, s49, v9
    v_lshlrev_b32 v3, 1, v2
    v_sub_u32 v3, v3, v15
    v_add_u32 v3, 5, v3
    v_lshl_add_u32 v250, v3, 4, s3
    v_add_u32 v4, 1, v2
    v_and_b32 v3, 1, v4
    v_sub_u32 v4, v4, v3
    v_lshl_add_u32 v4, v15, 3, v4
    v_lshlrev_b32 v4, 1, v4
    v_mul_u32_u24 v3, 4160, v3
    v_add3_u32 v251, v4, v3, s49
    v_add_u32 v252, 1024, v251
    v_add_u32 v253, 2048, v251
    v_add_u32 v254, 3072, v251
    v_lshlrev_b32 v12, 9, v15
    v_lshl_add_u32 v12, v2, 3, v12
    s_lshl_b32 s3, s24, 1
    s_add_u32 s3, s3, 112000
    v_add_u32 v255, s3, v12
    v_lshl_add_u32 v3, v15, 3, v2
    v_sub_u32 v3, 15, v3
    v_and_b32 v1, 1, v3
    v_lshlrev_b32 v1, 4, v1
    v_ashrrev_i32 v3, 1, v3
    v_cmp_eq_u32 s[50:51], 0, v3
    v_cmp_eq_u32 s[52:53], 1, v3
    v_cmp_eq_u32 s[54:55], 2, v3
    v_cmp_eq_u32 s[56:57], 3, v3
    s_waitcnt vmcnt(11)
    ds_write_b128 v13, v[220:223] offset:32
    v_alignbit_b32 v72, v221, v220, 16
    v_alignbit_b32 v73, v222, v221, 16
    v_alignbit_b32 v74, v223, v222, 16
    v_alignbit_b32 v75, v224, v223, 16
    ds_write_b128 v13, v[72:75] offset:4192
    s_waitcnt vmcnt(9)
    ds_write_b128 v13, v[226:229] offset:1056
    v_alignbit_b32 v76, v227, v226, 16
    v_alignbit_b32 v77, v228, v227, 16
    v_alignbit_b32 v78, v229, v228, 16
    v_alignbit_b32 v79, v230, v229, 16
    ds_write_b128 v13, v[76:79] offset:5216
    s_waitcnt vmcnt(7)
    ds_write_b128 v13, v[232:235] offset:2080
    v_alignbit_b32 v80, v233, v232, 16
    v_alignbit_b32 v81, v234, v233, 16
    v_alignbit_b32 v82, v235, v234, 16
    v_alignbit_b32 v83, v236, v235, 16
    ds_write_b128 v13, v[80:83] offset:6240
    s_waitcnt vmcnt(5)
    ds_write_b128 v13, v[238:241] offset:3104
    v_alignbit_b32 v84, v239, v238, 16
    v_alignbit_b32 v85, v240, v239, 16
    v_alignbit_b32 v86, v241, v240, 16
    v_alignbit_b32 v87, v242, v241, 16
    ds_write_b128 v13, v[84:87] offset:7264
    s_waitcnt vmcnt(3)
    s_mov_b64 exec, 3
    ds_write_b128 v13, v[244:247] offset:0
    v_alignbit_b32 v88, v245, v244, 16
    v_alignbit_b32 v89, v246, v245, 16
    v_alignbit_b32 v90, v247, v246, 16
    v_alignbit_b32 v91, v248, v247, 16
    ds_write_b128 v13, v[88:91] offset:4160
    s_mov_b64 exec, -1
    v_lshlrev_b32 v1, v1, v249
    v_cndmask_b32 v96, 0, v1, s[50:51]
    v_cndmask_b32 v97, 0, v1, s[52:53]
    v_cndmask_b32 v98, 0, v1, s[54:55]
    v_cndmask_b32 v99, 0, v1, s[56:57]
    s_mov_b32 s49, 4915200
    s_mov_b32 s69, 0
    buffer_load_dword v192, v10, s[16:19], s49 offen sc1
    s_sleep 2
adaLN_cond__ssm_conv_h3__glu_gated_geglu__prompt_kernel_p1:
    buffer_load_dword v193, v10, s[16:19], s49 offen sc1
    s_add_u32 s69, s69, 1
    s_waitcnt vmcnt(1)
    v_subrev_u32 v192, s70, v192
    v_cmp_lt_u32 vcc, 5, v192
    s_cmp_ge_u32 s69, 400000
    s_cbranch_scc1 adaLN_cond__ssm_conv_h3__glu_gated_geglu__prompt_kernel_p1x
    s_cbranch_vccz adaLN_cond__ssm_conv_h3__glu_gated_geglu__prompt_kernel_p1x
    buffer_load_dword v192, v10, s[16:19], s49 offen sc1
    s_add_u32 s69, s69, 1
    s_waitcnt vmcnt(1)
    v_subrev_u32 v193, s70, v193
    v_cmp_lt_u32 vcc, 5, v193
    s_cmp_ge_u32 s69, 400000
    s_cbranch_scc1 adaLN_cond__ssm_conv_h3__glu_gated_geglu__prompt_kernel_p1x
    s_cbranch_vccz adaLN_cond__ssm_conv_h3__glu_gated_geglu__prompt_kernel_p1x
    s_branch adaLN_cond__ssm_conv_h3__glu_gated_geglu__prompt_kernel_p1
adaLN_cond__ssm_conv_h3__glu_gated_geglu__prompt_kernel_p1x:
    s_mov_b32 s3, 0
    buffer_load_dwordx4 v[16:19], v5, s[16:19], s3 offen sc1
    s_mov_b32 s3, 589824
    buffer_load_dwordx4 v[20:23], v5, s[16:19], s3 offen sc1
    s_mov_b32 s3, 1179648
    buffer_load_dwordx4 v[24:27], v5, s[16:19], s3 offen sc1
    s_mov_b32 s3, 1769472
    buffer_load_dwordx4 v[28:31], v5, s[16:19], s3 offen sc1
    s_add_u32 s49, s67, 4849664
    v_mov_b32 v13, s70
    s_mov_b64 exec, 1
    buffer_store_dword v13, off, s[16:19], s49 sc1
    s_mov_b64 exec, -1
    s_waitcnt vmcnt(4)
    ds_write_b128 v8, v[16:19] offset:0
    s_waitcnt vmcnt(3)
    ds_write_b128 v8, v[20:23] offset:1024
    s_waitcnt vmcnt(2)
    ds_write_b128 v8, v[24:27] offset:2048
    s_waitcnt vmcnt(1)
    ds_write_b128 v8, v[28:31] offset:3072
    s_waitcnt lgkmcnt(0)
    s_barrier
    ds_read_b128 a[28:31], v250 offset:4032
    ds_read2_b32 a[32:33], v251 offset0:0 offset1:1
    ds_read2_b32 a[34:35], v251 offset0:2 offset1:3
    ds_read_b128 a[24:27], v250 offset:3520
    ds_read2_b32 a[36:37], v251 offset0:128 offset1:129
    ds_read2_b32 a[38:39], v251 offset0:130 offset1:131
    ds_read_b128 a[20:23], v250 offset:3008
    ds_read2_b32 a[40:41], v252 offset0:0 offset1:1
    ds_read2_b32 a[42:43], v252 offset0:2 offset1:3
    ds_read_b128 a[16:19], v250 offset:2496
    ds_read2_b32 a[44:45], v252 offset0:128 offset1:129
    ds_read2_b32 a[46:47], v252 offset0:130 offset1:131
    ds_read_b128 a[12:15], v250 offset:1984
    ds_read2_b32 a[48:49], v253 offset0:0 offset1:1
    ds_read2_b32 a[50:51], v253 offset0:2 offset1:3
    ds_read_b128 a[8:11], v250 offset:1472
    ds_read2_b32 a[52:53], v253 offset0:128 offset1:129
    ds_read2_b32 a[54:55], v253 offset0:130 offset1:131
    ds_read_b128 a[4:7], v250 offset:960
    ds_read2_b32 a[56:57], v254 offset0:0 offset1:1
    ds_read2_b32 a[58:59], v254 offset0:2 offset1:3
    ds_read_b128 a[0:3], v250 offset:448
    ds_read2_b32 a[60:61], v254 offset0:128 offset1:129
    ds_read2_b32 a[62:63], v254 offset0:130 offset1:131
    s_or_b32 s3, s2, s24
    s_cmp_lg_u32 s3, 0
    s_cbranch_scc1 adaLN_cond__ssm_conv_h3__glu_gated_geglu__prompt_kernel_ne
    s_add_u32 s3, s71, 1
    v_mov_b32 v13, s3
    s_mov_b32 s3, 4956160
    s_mov_b64 exec, 1
    buffer_store_dword v13, off, s[16:19], s3 sc1
    s_mov_b64 exec, -1
adaLN_cond__ssm_conv_h3__glu_gated_geglu__prompt_kernel_ne:
    s_waitcnt lgkmcnt(0)
    v_mfma_f32_16x16x32_bf16 v[100:103], a[0:3], v[96:99], 0
    s_add_u32 m0, s34, 0
    ds_read_b128 a[92:95], v250 offset:3968
    v_mfma_f32_16x16x32_bf16 v[104:107], a[4:7], v[96:99], 0
    ds_read2_b32 a[96:97], v251 offset0:16 offset1:17
    v_mfma_f32_16x16x32_bf16 v[108:111], a[8:11], v[96:99], 0
    buffer_load_dwordx4 v7, s[4:7], s40 offen offset:0  lds
    v_mfma_f32_16x16x32_bf16 v[112:115], a[12:15], v[96:99], 0
    ds_read2_b32 a[98:99], v251 offset0:18 offset1:19
    v_mfma_f32_16x16x32_bf16 v[116:119], a[16:19], v[96:99], 0
    v_mfma_f32_16x16x32_bf16 v[120:123], a[20:23], v[96:99], 0
    ds_read_b128 a[88:91], v250 offset:3456
    v_mfma_f32_16x16x32_bf16 v[124:127], a[24:27], v[96:99], 0
    v_mfma_f32_16x16x32_bf16 v[128:131], a[28:31], v[96:99], 0
    ds_read2_b32 a[100:101], v251 offset0:144 offset1:145
    v_mfma_f32_16x16x32_bf16 v[128:131], a[28:31], a[32:35], v[128:131]
    ds_read2_b32 a[102:103], v251 offset0:146 offset1:147
    v_mfma_f32_16x16x32_bf16 v[128:131], a[24:27], a[36:39], v[128:131]
    v_mfma_f32_16x16x32_bf16 v[128:131], a[20:23], a[40:43], v[128:131]
    ds_read_b128 a[84:87], v250 offset:2944
    v_mfma_f32_16x16x32_bf16 v[128:131], a[16:19], a[44:47], v[128:131]
    buffer_load_dwordx4 v7, s[4:7], s41 offen offset:1024  lds
    v_mfma_f32_16x16x32_bf16 v[128:131], a[12:15], a[48:51], v[128:131]
    ds_read2_b32 a[104:105], v252 offset0:16 offset1:17
    v_mfma_f32_16x16x32_bf16 v[128:131], a[8:11], a[52:55], v[128:131]
    v_mfma_f32_16x16x32_bf16 v[128:131], a[4:7], a[56:59], v[128:131]
    ds_read2_b32 a[106:107], v252 offset0:18 offset1:19
    v_mfma_f32_16x16x32_bf16 v[128:131], a[0:3], a[60:63], v[128:131]
    ds_read_b128 a[80:83], v250 offset:2432
    v_mfma_f32_16x16x32_bf16 v[124:127], a[24:27], a[32:35], v[124:127]
    v_mfma_f32_16x16x32_bf16 v[124:127], a[20:23], a[36:39], v[124:127]
    ds_read2_b32 a[108:109], v252 offset0:144 offset1:145
    v_mfma_f32_16x16x32_bf16 v[124:127], a[16:19], a[40:43], v[124:127]
    v_mfma_f32_16x16x32_bf16 v[124:127], a[12:15], a[44:47], v[124:127]
    ds_read2_b32 a[110:111], v252 offset0:146 offset1:147
    v_mfma_f32_16x16x32_bf16 v[124:127], a[8:11], a[48:51], v[124:127]
    buffer_load_dwordx4 v7, s[4:7], s42 offen offset:2048  lds
    v_mfma_f32_16x16x32_bf16 v[124:127], a[4:7], a[52:55], v[124:127]
    ds_read_b128 a[76:79], v250 offset:1920
    v_mfma_f32_16x16x32_bf16 v[124:127], a[0:3], a[56:59], v[124:127]
    ds_read2_b32 a[112:113], v253 offset0:16 offset1:17
    v_mfma_f32_16x16x32_bf16 v[120:123], a[20:23], a[32:35], v[120:123]
    v_mfma_f32_16x16x32_bf16 v[120:123], a[16:19], a[36:39], v[120:123]
    ds_read2_b32 a[114:115], v253 offset0:18 offset1:19
    v_mfma_f32_16x16x32_bf16 v[120:123], a[12:15], a[40:43], v[120:123]
    v_mfma_f32_16x16x32_bf16 v[120:123], a[8:11], a[44:47], v[120:123]
    ds_read_b128 a[72:75], v250 offset:1408
    v_mfma_f32_16x16x32_bf16 v[120:123], a[4:7], a[48:51], v[120:123]
    v_mfma_f32_16x16x32_bf16 v[120:123], a[0:3], a[52:55], v[120:123]
    ds_read2_b32 a[116:117], v253 offset0:144 offset1:145
    v_mfma_f32_16x16x32_bf16 v[116:119], a[16:19], a[32:35], v[116:119]
    ds_read2_b32 a[118:119], v253 offset0:146 offset1:147
    v_mfma_f32_16x16x32_bf16 v[116:119], a[12:15], a[36:39], v[116:119]
    buffer_load_dwordx4 v7, s[4:7], s43 offen offset:3072  lds
    v_mfma_f32_16x16x32_bf16 v[116:119], a[8:11], a[40:43], v[116:119]
    ds_read_b128 a[68:71], v250 offset:896
    v_mfma_f32_16x16x32_bf16 v[116:119], a[4:7], a[44:47], v[116:119]
    v_mfma_f32_16x16x32_bf16 v[116:119], a[0:3], a[48:51], v[116:119]
    ds_read2_b32 a[120:121], v254 offset0:16 offset1:17
    v_mfma_f32_16x16x32_bf16 v[112:115], a[12:15], a[32:35], v[112:115]
    v_mfma_f32_16x16x32_bf16 v[112:115], a[8:11], a[36:39], v[112:115]
    ds_read2_b32 a[122:123], v254 offset0:18 offset1:19
    v_mfma_f32_16x16x32_bf16 v[112:115], a[4:7], a[40:43], v[112:115]
    ds_read_b128 a[64:67], v250 offset:384
    v_mfma_f32_16x16x32_bf16 v[112:115], a[0:3], a[44:47], v[112:115]
    v_mfma_f32_16x16x32_bf16 v[108:111], a[8:11], a[32:35], v[108:111]
    ds_read2_b32 a[124:125], v254 offset0:144 offset1:145
    v_mfma_f32_16x16x32_bf16 v[108:111], a[4:7], a[36:39], v[108:111]
    v_mfma_f32_16x16x32_bf16 v[108:111], a[0:3], a[40:43], v[108:111]
    s_add_u32 m0, s34, 4096
    ds_read2_b32 a[126:127], v254 offset0:146 offset1:147
    v_mfma_f32_16x16x32_bf16 v[104:107], a[4:7], a[32:35], v[104:107]
    buffer_load_dwordx4 v7, s[4:7], s44 offen offset:0  lds
    v_mfma_f32_16x16x32_bf16 v[104:107], a[0:3], a[36:39], v[104:107]
    v_mfma_f32_16x16x32_bf16 v[100:103], a[0:3], a[32:35], v[100:103]
    s_waitcnt lgkmcnt(15)
    v_mfma_f32_16x16x32_bf16 v[128:131], a[92:95], a[96:99], v[128:131]
    s_waitcnt lgkmcnt(15)
    ds_read_b128 a[28:31], v250 offset:3904
    v_mfma_f32_16x16x32_bf16 v[128:131], a[88:91], a[100:103], v[128:131]
    s_waitcnt lgkmcnt(15)
    ds_read2_b32 a[32:33], v251 offset0:32 offset1:33
    v_mfma_f32_16x16x32_bf16 v[128:131], a[84:87], a[104:107], v[128:131]
    s_waitcnt lgkmcnt(14)
    ds_read2_b32 a[34:35], v251 offset0:34 offset1:35
    v_mfma_f32_16x16x32_bf16 v[128:131], a[80:83], a[108:111], v[128:131]
    s_waitcnt lgkmcnt(12)
    v_mfma_f32_16x16x32_bf16 v[128:131], a[76:79], a[112:115], v[128:131]
    s_waitcnt lgkmcnt(9)
    ds_read_b128 a[24:27], v250 offset:3392
    v_mfma_f32_16x16x32_bf16 v[128:131], a[72:75], a[116:119], v[128:131]
    s_waitcnt lgkmcnt(7)
    ds_read2_b32 a[36:37], v251 offset0:160 offset1:161
    v_mfma_f32_16x16x32_bf16 v[128:131], a[68:71], a[120:123], v[128:131]
    s_waitcnt lgkmcnt(5)
    buffer_load_dwordx4 v7, s[4:7], s45 offen offset:1024  lds
    v_mfma_f32_16x16x32_bf16 v[128:131], a[64:67], a[124:127], v[128:131]
    ds_read2_b32 a[38:39], v251 offset0:162 offset1:163
    v_mfma_f32_16x16x32_bf16 v[124:127], a[88:91], a[96:99], v[124:127]
    ds_read_b128 a[20:23], v250 offset:2880
    v_mfma_f32_16x16x32_bf16 v[124:127], a[84:87], a[100:103], v[124:127]
    ds_read2_b32 a[40:41], v252 offset0:32 offset1:33
    v_mfma_f32_16x16x32_bf16 v[124:127], a[80:83], a[104:107], v[124:127]
    v_mfma_f32_16x16x32_bf16 v[124:127], a[76:79], a[108:111], v[124:127]
    ds_read2_b32 a[42:43], v252 offset0:34 offset1:35
    v_mfma_f32_16x16x32_bf16 v[124:127], a[72:75], a[112:115], v[124:127]
    ds_read_b128 a[16:19], v250 offset:2368
    v_mfma_f32_16x16x32_bf16 v[124:127], a[68:71], a[116:119], v[124:127]
    v_mfma_f32_16x16x32_bf16 v[124:127], a[64:67], a[120:123], v[124:127]
    ds_read2_b32 a[44:45], v252 offset0:160 offset1:161
    v_mfma_f32_16x16x32_bf16 v[120:123], a[84:87], a[96:99], v[120:123]
    ds_read2_b32 a[46:47], v252 offset0:162 offset1:163
    v_mfma_f32_16x16x32_bf16 v[120:123], a[80:83], a[100:103], v[120:123]
    buffer_load_dwordx4 v7, s[4:7], s46 offen offset:2048  lds
    v_mfma_f32_16x16x32_bf16 v[120:123], a[76:79], a[104:107], v[120:123]
    ds_read_b128 a[12:15], v250 offset:1856
    v_mfma_f32_16x16x32_bf16 v[120:123], a[72:75], a[108:111], v[120:123]
    ds_read2_b32 a[48:49], v253 offset0:32 offset1:33
    v_mfma_f32_16x16x32_bf16 v[120:123], a[68:71], a[112:115], v[120:123]
    ds_read2_b32 a[50:51], v253 offset0:34 offset1:35
    v_mfma_f32_16x16x32_bf16 v[120:123], a[64:67], a[116:119], v[120:123]
    v_mfma_f32_16x16x32_bf16 v[116:119], a[80:83], a[96:99], v[116:119]
    ds_read_b128 a[8:11], v250 offset:1344
    v_mfma_f32_16x16x32_bf16 v[116:119], a[76:79], a[100:103], v[116:119]
    ds_read2_b32 a[52:53], v253 offset0:160 offset1:161
    v_mfma_f32_16x16x32_bf16 v[116:119], a[72:75], a[104:107], v[116:119]
    v_mfma_f32_16x16x32_bf16 v[116:119], a[68:71], a[108:111], v[116:119]
    ds_read2_b32 a[54:55], v253 offset0:162 offset1:163
    v_mfma_f32_16x16x32_bf16 v[116:119], a[64:67], a[112:115], v[116:119]
    ds_read_b128 a[4:7], v250 offset:832
    v_mfma_f32_16x16x32_bf16 v[112:115], a[76:79], a[96:99], v[112:115]
    ds_read2_b32 a[56:57], v254 offset0:32 offset1:33
    v_mfma_f32_16x16x32_bf16 v[112:115], a[72:75], a[100:103], v[112:115]
    buffer_load_dwordx4 v7, s[4:7], s47 offen offset:3072  lds
    v_mfma_f32_16x16x32_bf16 v[112:115], a[68:71], a[104:107], v[112:115]
    ds_read2_b32 a[58:59], v254 offset0:34 offset1:35
    v_mfma_f32_16x16x32_bf16 v[112:115], a[64:67], a[108:111], v[112:115]
    ds_read_b128 a[0:3], v250 offset:320
    v_mfma_f32_16x16x32_bf16 v[108:111], a[72:75], a[96:99], v[108:111]
    v_mfma_f32_16x16x32_bf16 v[108:111], a[68:71], a[100:103], v[108:111]
    ds_read2_b32 a[60:61], v254 offset0:160 offset1:161
    v_mfma_f32_16x16x32_bf16 v[108:111], a[64:67], a[104:107], v[108:111]
    ds_read2_b32 a[62:63], v254 offset0:162 offset1:163
    v_mfma_f32_16x16x32_bf16 v[104:107], a[68:71], a[96:99], v[104:107]
    v_mfma_f32_16x16x32_bf16 v[104:107], a[64:67], a[100:103], v[104:107]
    v_mfma_f32_16x16x32_bf16 v[100:103], a[64:67], a[96:99], v[100:103]
    s_waitcnt lgkmcnt(15)
    v_mfma_f32_16x16x32_bf16 v[128:131], a[28:31], a[32:35], v[128:131]
    s_waitcnt lgkmcnt(15)
    ds_read_b128 a[92:95], v250 offset:3840
    s_add_u32 m0, s34, 8192
    v_mfma_f32_16x16x32_bf16 v[128:131], a[24:27], a[36:39], v[128:131]
    s_waitcnt lgkmcnt(15)
    ds_read2_b32 a[96:97], v251 offset0:48 offset1:49
    v_mfma_f32_16x16x32_bf16 v[128:131], a[20:23], a[40:43], v[128:131]
    s_waitcnt lgkmcnt(14)
    ds_read2_b32 a[98:99], v251 offset0:50 offset1:51
    v_mfma_f32_16x16x32_bf16 v[128:131], a[16:19], a[44:47], v[128:131]
    s_waitcnt lgkmcnt(12)
    buffer_load_dwordx4 v7, s[4:7], s48 offen offset:0  lds
    v_mfma_f32_16x16x32_bf16 v[128:131], a[12:15], a[48:51], v[128:131]
    s_waitcnt lgkmcnt(9)
    ds_read_b128 a[88:91], v250 offset:3328
    v_mfma_f32_16x16x32_bf16 v[128:131], a[8:11], a[52:55], v[128:131]
    s_waitcnt lgkmcnt(7)
    ds_read2_b32 a[100:101], v251 offset0:176 offset1:177
    v_mfma_f32_16x16x32_bf16 v[128:131], a[4:7], a[56:59], v[128:131]
    s_waitcnt lgkmcnt(5)
    v_mfma_f32_16x16x32_bf16 v[128:131], a[0:3], a[60:63], v[128:131]
    ds_read2_b32 a[102:103], v251 offset0:178 offset1:179
    v_mfma_f32_16x16x32_bf16 v[124:127], a[24:27], a[32:35], v[124:127]
    ds_read_b128 a[84:87], v250 offset:2816
    v_mfma_f32_16x16x32_bf16 v[124:127], a[20:23], a[36:39], v[124:127]
    ds_read2_b32 a[104:105], v252 offset0:48 offset1:49
    v_mfma_f32_16x16x32_bf16 v[124:127], a[16:19], a[40:43], v[124:127]
    s_add_u32 m0, s34, 36864
    s_nop 0
    buffer_load_dwordx4 v7, s[8:11], s40 offen offset:0  lds
    v_mfma_f32_16x16x32_bf16 v[124:127], a[12:15], a[44:47], v[124:127]
    ds_read2_b32 a[106:107], v252 offset0:50 offset1:51
    v_mfma_f32_16x16x32_bf16 v[124:127], a[8:11], a[48:51], v[124:127]
    ds_read_b128 a[80:83], v250 offset:2304
    v_mfma_f32_16x16x32_bf16 v[124:127], a[4:7], a[52:55], v[124:127]
    v_mfma_f32_16x16x32_bf16 v[124:127], a[0:3], a[56:59], v[124:127]
    ds_read2_b32 a[108:109], v252 offset0:176 offset1:177
    v_mfma_f32_16x16x32_bf16 v[120:123], a[20:23], a[32:35], v[120:123]
    ds_read2_b32 a[110:111], v252 offset0:178 offset1:179
    v_mfma_f32_16x16x32_bf16 v[120:123], a[16:19], a[36:39], v[120:123]
    v_mfma_f32_16x16x32_bf16 v[120:123], a[12:15], a[40:43], v[120:123]
    ds_read_b128 a[76:79], v250 offset:1792
    v_mfma_f32_16x16x32_bf16 v[120:123], a[8:11], a[44:47], v[120:123]
    ds_read2_b32 a[112:113], v253 offset0:48 offset1:49
    v_mfma_f32_16x16x32_bf16 v[120:123], a[4:7], a[48:51], v[120:123]
    ds_read2_b32 a[114:115], v253 offset0:50 offset1:51
    v_mfma_f32_16x16x32_bf16 v[120:123], a[0:3], a[52:55], v[120:123]
    buffer_load_dwordx4 v7, s[8:11], s41 offen offset:1024  lds
    v_mfma_f32_16x16x32_bf16 v[116:119], a[16:19], a[32:35], v[116:119]
    ds_read_b128 a[72:75], v250 offset:1280
    v_mfma_f32_16x16x32_bf16 v[116:119], a[12:15], a[36:39], v[116:119]
    ds_read2_b32 a[116:117], v253 offset0:176 offset1:177
    v_mfma_f32_16x16x32_bf16 v[116:119], a[8:11], a[40:43], v[116:119]
    v_mfma_f32_16x16x32_bf16 v[116:119], a[4:7], a[44:47], v[116:119]
    ds_read2_b32 a[118:119], v253 offset0:178 offset1:179
    v_mfma_f32_16x16x32_bf16 v[116:119], a[0:3], a[48:51], v[116:119]
    ds_read_b128 a[68:71], v250 offset:768
    v_mfma_f32_16x16x32_bf16 v[112:115], a[12:15], a[32:35], v[112:115]
    ds_read2_b32 a[120:121], v254 offset0:48 offset1:49
    v_mfma_f32_16x16x32_bf16 v[112:115], a[8:11], a[36:39], v[112:115]
    v_mfma_f32_16x16x32_bf16 v[112:115], a[4:7], a[40:43], v[112:115]
    ds_read2_b32 a[122:123], v254 offset0:50 offset1:51
    v_mfma_f32_16x16x32_bf16 v[112:115], a[0:3], a[44:47], v[112:115]
    ds_read_b128 a[64:67], v250 offset:256
    v_mfma_f32_16x16x32_bf16 v[108:111], a[8:11], a[32:35], v[108:111]
    buffer_load_dwordx4 v7, s[8:11], s42 offen offset:2048  lds
    v_mfma_f32_16x16x32_bf16 v[108:111], a[4:7], a[36:39], v[108:111]
    ds_read2_b32 a[124:125], v254 offset0:176 offset1:177
    v_mfma_f32_16x16x32_bf16 v[108:111], a[0:3], a[40:43], v[108:111]
    ds_read2_b32 a[126:127], v254 offset0:178 offset1:179
    v_mfma_f32_16x16x32_bf16 v[104:107], a[4:7], a[32:35], v[104:107]
    v_mfma_f32_16x16x32_bf16 v[104:107], a[0:3], a[36:39], v[104:107]
    v_mfma_f32_16x16x32_bf16 v[100:103], a[0:3], a[32:35], v[100:103]
    s_waitcnt lgkmcnt(15)
    v_mfma_f32_16x16x32_bf16 v[128:131], a[92:95], a[96:99], v[128:131]
    s_waitcnt lgkmcnt(15)
    ds_read_b128 a[28:31], v250 offset:3776
    v_mfma_f32_16x16x32_bf16 v[128:131], a[88:91], a[100:103], v[128:131]
    s_waitcnt lgkmcnt(15)
    ds_read2_b32 a[32:33], v251 offset0:64 offset1:65
    v_mfma_f32_16x16x32_bf16 v[128:131], a[84:87], a[104:107], v[128:131]
    s_waitcnt lgkmcnt(14)
    ds_read2_b32 a[34:35], v251 offset0:66 offset1:67
    v_mfma_f32_16x16x32_bf16 v[128:131], a[80:83], a[108:111], v[128:131]
    s_waitcnt lgkmcnt(12)
    v_mfma_f32_16x16x32_bf16 v[128:131], a[76:79], a[112:115], v[128:131]
    s_waitcnt lgkmcnt(9)
    ds_read_b128 a[24:27], v250 offset:3264
    v_mfma_f32_16x16x32_bf16 v[128:131], a[72:75], a[116:119], v[128:131]
    s_waitcnt lgkmcnt(7)
    ds_read2_b32 a[36:37], v251 offset0:192 offset1:193
    v_mfma_f32_16x16x32_bf16 v[128:131], a[68:71], a[120:123], v[128:131]
    s_waitcnt lgkmcnt(5)
    buffer_load_dwordx4 v7, s[8:11], s43 offen offset:3072  lds
    v_mfma_f32_16x16x32_bf16 v[128:131], a[64:67], a[124:127], v[128:131]
    ds_read2_b32 a[38:39], v251 offset0:194 offset1:195
    v_mfma_f32_16x16x32_bf16 v[124:127], a[88:91], a[96:99], v[124:127]
    ds_read_b128 a[20:23], v250 offset:2752
    v_mfma_f32_16x16x32_bf16 v[124:127], a[84:87], a[100:103], v[124:127]
    ds_read2_b32 a[40:41], v252 offset0:64 offset1:65
    v_mfma_f32_16x16x32_bf16 v[124:127], a[80:83], a[104:107], v[124:127]
    v_mfma_f32_16x16x32_bf16 v[124:127], a[76:79], a[108:111], v[124:127]
    ds_read2_b32 a[42:43], v252 offset0:66 offset1:67
    v_mfma_f32_16x16x32_bf16 v[124:127], a[72:75], a[112:115], v[124:127]
    ds_read_b128 a[16:19], v250 offset:2240
    v_mfma_f32_16x16x32_bf16 v[124:127], a[68:71], a[116:119], v[124:127]
    v_mfma_f32_16x16x32_bf16 v[124:127], a[64:67], a[120:123], v[124:127]
    s_add_u32 m0, s34, 40960
    ds_read2_b32 a[44:45], v252 offset0:192 offset1:193
    v_mfma_f32_16x16x32_bf16 v[120:123], a[84:87], a[96:99], v[120:123]
    ds_read2_b32 a[46:47], v252 offset0:194 offset1:195
    v_mfma_f32_16x16x32_bf16 v[120:123], a[80:83], a[100:103], v[120:123]
    buffer_load_dwordx4 v7, s[8:11], s44 offen offset:0  lds
    v_mfma_f32_16x16x32_bf16 v[120:123], a[76:79], a[104:107], v[120:123]
    ds_read_b128 a[12:15], v250 offset:1728
    v_mfma_f32_16x16x32_bf16 v[120:123], a[72:75], a[108:111], v[120:123]
    ds_read2_b32 a[48:49], v253 offset0:64 offset1:65
    v_mfma_f32_16x16x32_bf16 v[120:123], a[68:71], a[112:115], v[120:123]
    ds_read2_b32 a[50:51], v253 offset0:66 offset1:67
    v_mfma_f32_16x16x32_bf16 v[120:123], a[64:67], a[116:119], v[120:123]
    v_mfma_f32_16x16x32_bf16 v[116:119], a[80:83], a[96:99], v[116:119]
    ds_read_b128 a[8:11], v250 offset:1216
    v_mfma_f32_16x16x32_bf16 v[116:119], a[76:79], a[100:103], v[116:119]
    ds_read2_b32 a[52:53], v253 offset0:192 offset1:193
    v_mfma_f32_16x16x32_bf16 v[116:119], a[72:75], a[104:107], v[116:119]
    v_mfma_f32_16x16x32_bf16 v[116:119], a[68:71], a[108:111], v[116:119]
    ds_read2_b32 a[54:55], v253 offset0:194 offset1:195
    v_mfma_f32_16x16x32_bf16 v[116:119], a[64:67], a[112:115], v[116:119]
    ds_read_b128 a[4:7], v250 offset:704
    v_mfma_f32_16x16x32_bf16 v[112:115], a[76:79], a[96:99], v[112:115]
    ds_read2_b32 a[56:57], v254 offset0:64 offset1:65
    v_mfma_f32_16x16x32_bf16 v[112:115], a[72:75], a[100:103], v[112:115]
    buffer_load_dwordx4 v7, s[8:11], s45 offen offset:1024  lds
    v_mfma_f32_16x16x32_bf16 v[112:115], a[68:71], a[104:107], v[112:115]
    ds_read2_b32 a[58:59], v254 offset0:66 offset1:67
    v_mfma_f32_16x16x32_bf16 v[112:115], a[64:67], a[108:111], v[112:115]
    ds_read_b128 a[0:3], v250 offset:192
    v_mfma_f32_16x16x32_bf16 v[108:111], a[72:75], a[96:99], v[108:111]
    v_mfma_f32_16x16x32_bf16 v[108:111], a[68:71], a[100:103], v[108:111]
    ds_read2_b32 a[60:61], v254 offset0:192 offset1:193
    v_mfma_f32_16x16x32_bf16 v[108:111], a[64:67], a[104:107], v[108:111]
    ds_read2_b32 a[62:63], v254 offset0:194 offset1:195
    v_mfma_f32_16x16x32_bf16 v[104:107], a[68:71], a[96:99], v[104:107]
    v_mfma_f32_16x16x32_bf16 v[104:107], a[64:67], a[100:103], v[104:107]
    buffer_load_dwordx4 v7, s[8:11], s46 offen offset:2048  lds
    v_mfma_f32_16x16x32_bf16 v[100:103], a[64:67], a[96:99], v[100:103]
    s_waitcnt lgkmcnt(15)
    v_mfma_f32_16x16x32_bf16 v[128:131], a[28:31], a[32:35], v[128:131]
    s_waitcnt lgkmcnt(15)
    ds_read_b128 a[92:95], v250 offset:3712
    v_mfma_f32_16x16x32_bf16 v[128:131], a[24:27], a[36:39], v[128:131]
    s_waitcnt lgkmcnt(15)
    ds_read2_b32 a[96:97], v251 offset0:80 offset1:81
    v_mfma_f32_16x16x32_bf16 v[128:131], a[20:23], a[40:43], v[128:131]
    s_waitcnt lgkmcnt(14)
    ds_read2_b32 a[98:99], v251 offset0:82 offset1:83
    v_mfma_f32_16x16x32_bf16 v[128:131], a[16:19], a[44:47], v[128:131]
    s_waitcnt lgkmcnt(12)
    v_mfma_f32_16x16x32_bf16 v[128:131], a[12:15], a[48:51], v[128:131]
    s_waitcnt lgkmcnt(9)
    ds_read_b128 a[88:91], v250 offset:3200
    v_mfma_f32_16x16x32_bf16 v[128:131], a[8:11], a[52:55], v[128:131]
    s_waitcnt lgkmcnt(7)
    ds_read2_b32 a[100:101], v251 offset0:208 offset1:209
    v_mfma_f32_16x16x32_bf16 v[128:131], a[4:7], a[56:59], v[128:131]
    s_waitcnt lgkmcnt(5)
    v_mfma_f32_16x16x32_bf16 v[128:131], a[0:3], a[60:63], v[128:131]
    ds_read2_b32 a[102:103], v251 offset0:210 offset1:211
    v_mfma_f32_16x16x32_bf16 v[124:127], a[24:27], a[32:35], v[124:127]
    ds_read_b128 a[84:87], v250 offset:2688
    v_mfma_f32_16x16x32_bf16 v[124:127], a[20:23], a[36:39], v[124:127]
    ds_read2_b32 a[104:105], v252 offset0:80 offset1:81
    v_mfma_f32_16x16x32_bf16 v[124:127], a[16:19], a[40:43], v[124:127]
    buffer_load_dwordx4 v7, s[8:11], s47 offen offset:3072  lds
    v_mfma_f32_16x16x32_bf16 v[124:127], a[12:15], a[44:47], v[124:127]
    ds_read2_b32 a[106:107], v252 offset0:82 offset1:83
    v_mfma_f32_16x16x32_bf16 v[124:127], a[8:11], a[48:51], v[124:127]
    ds_read_b128 a[80:83], v250 offset:2176
    v_mfma_f32_16x16x32_bf16 v[124:127], a[4:7], a[52:55], v[124:127]
    v_mfma_f32_16x16x32_bf16 v[124:127], a[0:3], a[56:59], v[124:127]
    ds_read2_b32 a[108:109], v252 offset0:208 offset1:209
    v_mfma_f32_16x16x32_bf16 v[120:123], a[20:23], a[32:35], v[120:123]
    ds_read2_b32 a[110:111], v252 offset0:210 offset1:211
    v_mfma_f32_16x16x32_bf16 v[120:123], a[16:19], a[36:39], v[120:123]
    v_mfma_f32_16x16x32_bf16 v[120:123], a[12:15], a[40:43], v[120:123]
    ds_read_b128 a[76:79], v250 offset:1664
    v_mfma_f32_16x16x32_bf16 v[120:123], a[8:11], a[44:47], v[120:123]
    s_add_u32 m0, s34, 45056
    ds_read2_b32 a[112:113], v253 offset0:80 offset1:81
    v_mfma_f32_16x16x32_bf16 v[120:123], a[4:7], a[48:51], v[120:123]
    ds_read2_b32 a[114:115], v253 offset0:82 offset1:83
    v_mfma_f32_16x16x32_bf16 v[120:123], a[0:3], a[52:55], v[120:123]
    buffer_load_dwordx4 v7, s[8:11], s48 offen offset:0  lds
    v_mfma_f32_16x16x32_bf16 v[116:119], a[16:19], a[32:35], v[116:119]
    ds_read_b128 a[72:75], v250 offset:1152
    v_mfma_f32_16x16x32_bf16 v[116:119], a[12:15], a[36:39], v[116:119]
    ds_read2_b32 a[116:117], v253 offset0:208 offset1:209
    v_mfma_f32_16x16x32_bf16 v[116:119], a[8:11], a[40:43], v[116:119]
    v_mfma_f32_16x16x32_bf16 v[116:119], a[4:7], a[44:47], v[116:119]
    s_lshl_b32 s3, s29, 6
    ds_read2_b32 a[118:119], v253 offset0:210 offset1:211
    v_add_u32 v7, s3, v6
    v_mfma_f32_16x16x32_bf16 v[116:119], a[0:3], a[48:51], v[116:119]
    ds_read_b128 a[68:71], v250 offset:640
    v_mfma_f32_16x16x32_bf16 v[112:115], a[12:15], a[32:35], v[112:115]
    ds_read2_b32 a[120:121], v254 offset0:80 offset1:81
    v_mfma_f32_16x16x32_bf16 v[112:115], a[8:11], a[36:39], v[112:115]
    v_mfma_f32_16x16x32_bf16 v[112:115], a[4:7], a[40:43], v[112:115]
    s_add_u32 m0, s34, 73728
    ds_read2_b32 a[122:123], v254 offset0:82 offset1:83
    v_mfma_f32_16x16x32_bf16 v[112:115], a[0:3], a[44:47], v[112:115]
    ds_read_b128 a[64:67], v250 offset:128
    v_mfma_f32_16x16x32_bf16 v[108:111], a[8:11], a[32:35], v[108:111]
    buffer_load_dwordx4 v7, s[4:7], s40 offen offset:0  lds
    v_mfma_f32_16x16x32_bf16 v[108:111], a[4:7], a[36:39], v[108:111]
    ds_read2_b32 a[124:125], v254 offset0:208 offset1:209
    v_mfma_f32_16x16x32_bf16 v[108:111], a[0:3], a[40:43], v[108:111]
    ds_read2_b32 a[126:127], v254 offset0:210 offset1:211
    v_mfma_f32_16x16x32_bf16 v[104:107], a[4:7], a[32:35], v[104:107]
    v_mfma_f32_16x16x32_bf16 v[104:107], a[0:3], a[36:39], v[104:107]
    v_mfma_f32_16x16x32_bf16 v[100:103], a[0:3], a[32:35], v[100:103]
    s_waitcnt lgkmcnt(15)
    v_mfma_f32_16x16x32_bf16 v[128:131], a[92:95], a[96:99], v[128:131]
    s_waitcnt lgkmcnt(15)
    ds_read_b128 a[28:31], v250 offset:3648
    v_mfma_f32_16x16x32_bf16 v[128:131], a[88:91], a[100:103], v[128:131]
    s_waitcnt lgkmcnt(15)
    ds_read2_b32 a[32:33], v251 offset0:96 offset1:97
    v_mfma_f32_16x16x32_bf16 v[128:131], a[84:87], a[104:107], v[128:131]
    s_waitcnt lgkmcnt(14)
    ds_read2_b32 a[34:35], v251 offset0:98 offset1:99
    v_mfma_f32_16x16x32_bf16 v[128:131], a[80:83], a[108:111], v[128:131]
    s_waitcnt lgkmcnt(12)
    buffer_load_dwordx4 v7, s[4:7], s41 offen offset:1024  lds
    v_mfma_f32_16x16x32_bf16 v[128:131], a[76:79], a[112:115], v[128:131]
    s_waitcnt lgkmcnt(9)
    ds_read_b128 a[24:27], v250 offset:3136
    v_mfma_f32_16x16x32_bf16 v[128:131], a[72:75], a[116:119], v[128:131]
    s_waitcnt lgkmcnt(7)
    ds_read2_b32 a[36:37], v251 offset0:224 offset1:225
    v_mfma_f32_16x16x32_bf16 v[128:131], a[68:71], a[120:123], v[128:131]
    s_waitcnt lgkmcnt(5)
    v_mfma_f32_16x16x32_bf16 v[128:131], a[64:67], a[124:127], v[128:131]
    ds_read2_b32 a[38:39], v251 offset0:226 offset1:227
    v_mfma_f32_16x16x32_bf16 v[124:127], a[88:91], a[96:99], v[124:127]
    ds_read_b128 a[20:23], v250 offset:2624
    v_mfma_f32_16x16x32_bf16 v[124:127], a[84:87], a[100:103], v[124:127]
    ds_read2_b32 a[40:41], v252 offset0:96 offset1:97
    v_mfma_f32_16x16x32_bf16 v[124:127], a[80:83], a[104:107], v[124:127]
    v_mfma_f32_16x16x32_bf16 v[124:127], a[76:79], a[108:111], v[124:127]
    ds_read2_b32 a[42:43], v252 offset0:98 offset1:99
    v_mfma_f32_16x16x32_bf16 v[124:127], a[72:75], a[112:115], v[124:127]
    ds_read_b128 a[16:19], v250 offset:2112
    v_mfma_f32_16x16x32_bf16 v[124:127], a[68:71], a[116:119], v[124:127]
    buffer_load_dwordx4 v7, s[4:7], s42 offen offset:2048  lds
    v_mfma_f32_16x16x32_bf16 v[124:127], a[64:67], a[120:123], v[124:127]
    ds_read2_b32 a[44:45], v252 offset0:224 offset1:225
    v_mfma_f32_16x16x32_bf16 v[120:123], a[84:87], a[96:99], v[120:123]
    ds_read2_b32 a[46:47], v252 offset0:226 offset1:227
    v_mfma_f32_16x16x32_bf16 v[120:123], a[80:83], a[100:103], v[120:123]
    v_mfma_f32_16x16x32_bf16 v[120:123], a[76:79], a[104:107], v[120:123]
    ds_read_b128 a[12:15], v250 offset:1600
    v_mfma_f32_16x16x32_bf16 v[120:123], a[72:75], a[108:111], v[120:123]
    ds_read2_b32 a[48:49], v253 offset0:96 offset1:97
    v_mfma_f32_16x16x32_bf16 v[120:123], a[68:71], a[112:115], v[120:123]
    ds_read2_b32 a[50:51], v253 offset0:98 offset1:99
    v_mfma_f32_16x16x32_bf16 v[120:123], a[64:67], a[116:119], v[120:123]
    v_mfma_f32_16x16x32_bf16 v[116:119], a[80:83], a[96:99], v[116:119]
    ds_read_b128 a[8:11], v250 offset:1088
    v_mfma_f32_16x16x32_bf16 v[116:119], a[76:79], a[100:103], v[116:119]
    ds_read2_b32 a[52:53], v253 offset0:224 offset1:225
    v_mfma_f32_16x16x32_bf16 v[116:119], a[72:75], a[104:107], v[116:119]
    buffer_load_dwordx4 v7, s[4:7], s43 offen offset:3072  lds
    v_mfma_f32_16x16x32_bf16 v[116:119], a[68:71], a[108:111], v[116:119]
    ds_read2_b32 a[54:55], v253 offset0:226 offset1:227
    v_mfma_f32_16x16x32_bf16 v[116:119], a[64:67], a[112:115], v[116:119]
    ds_read_b128 a[4:7], v250 offset:576
    v_mfma_f32_16x16x32_bf16 v[112:115], a[76:79], a[96:99], v[112:115]
    ds_read2_b32 a[56:57], v254 offset0:96 offset1:97
    v_mfma_f32_16x16x32_bf16 v[112:115], a[72:75], a[100:103], v[112:115]
    v_mfma_f32_16x16x32_bf16 v[112:115], a[68:71], a[104:107], v[112:115]
    ds_read2_b32 a[58:59], v254 offset0:98 offset1:99
    v_mfma_f32_16x16x32_bf16 v[112:115], a[64:67], a[108:111], v[112:115]
    ds_read_b128 a[0:3], v250 offset:64
    v_mfma_f32_16x16x32_bf16 v[108:111], a[72:75], a[96:99], v[108:111]
    v_mfma_f32_16x16x32_bf16 v[108:111], a[68:71], a[100:103], v[108:111]
    ds_read2_b32 a[60:61], v254 offset0:224 offset1:225
    v_mfma_f32_16x16x32_bf16 v[108:111], a[64:67], a[104:107], v[108:111]
    s_add_u32 m0, s34, 77824
    ds_read2_b32 a[62:63], v254 offset0:226 offset1:227
    v_mfma_f32_16x16x32_bf16 v[104:107], a[68:71], a[96:99], v[104:107]
    buffer_load_dwordx4 v7, s[4:7], s44 offen offset:0  lds
    v_mfma_f32_16x16x32_bf16 v[104:107], a[64:67], a[100:103], v[104:107]
    v_mfma_f32_16x16x32_bf16 v[100:103], a[64:67], a[96:99], v[100:103]
    s_waitcnt lgkmcnt(15)
    v_mfma_f32_16x16x32_bf16 v[128:131], a[28:31], a[32:35], v[128:131]
    s_waitcnt lgkmcnt(15)
    ds_read_b128 a[92:95], v250 offset:3584
    v_mfma_f32_16x16x32_bf16 v[128:131], a[24:27], a[36:39], v[128:131]
    s_waitcnt lgkmcnt(15)
    ds_read2_b32 a[96:97], v251 offset0:112 offset1:113
    v_mfma_f32_16x16x32_bf16 v[128:131], a[20:23], a[40:43], v[128:131]
    s_waitcnt lgkmcnt(14)
    ds_read2_b32 a[98:99], v251 offset0:114 offset1:115
    v_mfma_f32_16x16x32_bf16 v[128:131], a[16:19], a[44:47], v[128:131]
    s_waitcnt lgkmcnt(12)
    ds_read_b128 a[88:91], v250 offset:3072
    v_mfma_f32_16x16x32_bf16 v[128:131], a[12:15], a[48:51], v[128:131]
    s_waitcnt lgkmcnt(10)
    ds_read2_b32 a[100:101], v251 offset0:240 offset1:241
    v_mfma_f32_16x16x32_bf16 v[128:131], a[8:11], a[52:55], v[128:131]
    s_waitcnt lgkmcnt(8)
    v_mfma_f32_16x16x32_bf16 v[128:131], a[4:7], a[56:59], v[128:131]
    s_waitcnt lgkmcnt(5)
    ds_read2_b32 a[102:103], v251 offset0:242 offset1:243
    v_mfma_f32_16x16x32_bf16 v[128:131], a[0:3], a[60:63], v[128:131]
    ds_read_b128 a[84:87], v250 offset:2560
    v_mfma_f32_16x16x32_bf16 v[124:127], a[24:27], a[32:35], v[124:127]
    ds_read2_b32 a[104:105], v252 offset0:112 offset1:113
    v_mfma_f32_16x16x32_bf16 v[124:127], a[20:23], a[36:39], v[124:127]
    ds_read2_b32 a[106:107], v252 offset0:114 offset1:115
    v_mfma_f32_16x16x32_bf16 v[124:127], a[16:19], a[40:43], v[124:127]
    ds_read_b128 a[80:83], v250 offset:2048
    v_mfma_f32_16x16x32_bf16 v[124:127], a[12:15], a[44:47], v[124:127]
    buffer_load_dwordx4 v7, s[4:7], s45 offen offset:1024  lds
    v_mfma_f32_16x16x32_bf16 v[124:127], a[8:11], a[48:51], v[124:127]
    ds_read2_b32 a[108:109], v252 offset0:240 offset1:241
    v_mfma_f32_16x16x32_bf16 v[124:127], a[4:7], a[52:55], v[124:127]
    ds_read2_b32 a[110:111], v252 offset0:242 offset1:243
    v_mfma_f32_16x16x32_bf16 v[124:127], a[0:3], a[56:59], v[124:127]
    ds_read_b128 a[76:79], v250 offset:1536
    v_mfma_f32_16x16x32_bf16 v[120:123], a[20:23], a[32:35], v[120:123]
    ds_read2_b32 a[112:113], v253 offset0:112 offset1:113
    v_mfma_f32_16x16x32_bf16 v[120:123], a[16:19], a[36:39], v[120:123]
    ds_read2_b32 a[114:115], v253 offset0:114 offset1:115
    v_mfma_f32_16x16x32_bf16 v[120:123], a[12:15], a[40:43], v[120:123]
    buffer_load_dwordx4 v7, s[4:7], s46 offen offset:2048  lds
    v_mfma_f32_16x16x32_bf16 v[120:123], a[8:11], a[44:47], v[120:123]
    ds_read_b128 a[72:75], v250 offset:1024
    v_mfma_f32_16x16x32_bf16 v[120:123], a[4:7], a[48:51], v[120:123]
    ds_read2_b32 a[116:117], v253 offset0:240 offset1:241
    v_mfma_f32_16x16x32_bf16 v[120:123], a[0:3], a[52:55], v[120:123]
    ds_read2_b32 a[118:119], v253 offset0:242 offset1:243
    v_mfma_f32_16x16x32_bf16 v[116:119], a[16:19], a[32:35], v[116:119]
    ds_read_b128 a[68:71], v250 offset:512
    v_mfma_f32_16x16x32_bf16 v[116:119], a[12:15], a[36:39], v[116:119]
    ds_read2_b32 a[120:121], v254 offset0:112 offset1:113
    v_mfma_f32_16x16x32_bf16 v[116:119], a[8:11], a[40:43], v[116:119]
    v_mfma_f32_16x16x32_bf16 v[116:119], a[4:7], a[44:47], v[116:119]
    ds_read2_b32 a[122:123], v254 offset0:114 offset1:115
    v_mfma_f32_16x16x32_bf16 v[116:119], a[0:3], a[48:51], v[116:119]
    ds_read_b128 a[64:67], v250 offset:0
    v_mfma_f32_16x16x32_bf16 v[112:115], a[12:15], a[32:35], v[112:115]
    ds_read2_b32 a[124:125], v254 offset0:240 offset1:241
    v_mfma_f32_16x16x32_bf16 v[112:115], a[8:11], a[36:39], v[112:115]
    ds_read2_b32 a[126:127], v254 offset0:242 offset1:243
    v_mfma_f32_16x16x32_bf16 v[112:115], a[4:7], a[40:43], v[112:115]
    buffer_load_dwordx4 v7, s[4:7], s47 offen offset:3072  lds
    v_min_u32 v244, 53, v205
    v_mfma_f32_16x16x32_bf16 v[112:115], a[0:3], a[44:47], v[112:115]
    v_lshlrev_b32 v246, 7, v244
    s_mov_b32 s59, 4947968
    v_mfma_f32_16x16x32_bf16 v[108:111], a[8:11], a[32:35], v[108:111]
    buffer_load_dword v11, v246, s[16:19], s59 offen sc1
    v_mfma_f32_16x16x32_bf16 v[108:111], a[4:7], a[36:39], v[108:111]
    v_mfma_f32_16x16x32_bf16 v[108:111], a[0:3], a[40:43], v[108:111]
    v_mfma_f32_16x16x32_bf16 v[104:107], a[4:7], a[32:35], v[104:107]
    v_mfma_f32_16x16x32_bf16 v[104:107], a[0:3], a[36:39], v[104:107]
    v_mfma_f32_16x16x32_bf16 v[100:103], a[0:3], a[32:35], v[100:103]
    s_waitcnt lgkmcnt(0)
    s_barrier
    v_mfma_f32_16x16x32_bf16 v[128:131], a[92:95], a[96:99], v[128:131]
    s_add_u32 m0, s34, 81920
    s_nop 0
    buffer_load_dwordx4 v7, s[4:7], s48 offen offset:0  lds
    v_mfma_f32_16x16x32_bf16 v[128:131], a[88:91], a[100:103], v[128:131]
    v_mfma_f32_16x16x32_bf16 v[128:131], a[84:87], a[104:107], v[128:131]
    v_mfma_f32_16x16x32_bf16 v[128:131], a[80:83], a[108:111], v[128:131]
    v_mfma_f32_16x16x32_bf16 v[128:131], a[76:79], a[112:115], v[128:131]
    v_mfma_f32_16x16x32_bf16 v[128:131], a[72:75], a[116:119], v[128:131]
    v_mfma_f32_16x16x32_bf16 v[128:131], a[68:71], a[120:123], v[128:131]
    v_mfma_f32_16x16x32_bf16 v[128:131], a[64:67], a[124:127], v[128:131]
    v_mfma_f32_16x16x32_bf16 v[124:127], a[88:91], a[96:99], v[124:127]
    v_mfma_f32_16x16x32_bf16 v[124:127], a[84:87], a[100:103], v[124:127]
    v_mfma_f32_16x16x32_bf16 v[124:127], a[80:83], a[104:107], v[124:127]
    v_mfma_f32_16x16x32_bf16 v[124:127], a[76:79], a[108:111], v[124:127]
    v_mfma_f32_16x16x32_bf16 v[124:127], a[72:75], a[112:115], v[124:127]
    s_nop 2
    v_cvt_pk_bf16_f32 v194, v128, v129
    v_cvt_pk_bf16_f32 v195, v130, v131
    v_mfma_f32_16x16x32_bf16 v[124:127], a[68:71], a[116:119], v[124:127]
    ds_write_b16 v255, v194 offset:14336
    ds_write_b16_d16_hi v255, v194 offset:14464
    v_mfma_f32_16x16x32_bf16 v[124:127], a[64:67], a[120:123], v[124:127]
    ds_write_b16 v255, v195 offset:14592
    ds_write_b16_d16_hi v255, v195 offset:14720
    v_mfma_f32_16x16x32_bf16 v[120:123], a[84:87], a[96:99], v[120:123]
    v_mfma_f32_16x16x32_bf16 v[120:123], a[80:83], a[100:103], v[120:123]
    v_mfma_f32_16x16x32_bf16 v[120:123], a[76:79], a[104:107], v[120:123]
    v_mfma_f32_16x16x32_bf16 v[120:123], a[72:75], a[108:111], v[120:123]
    v_mfma_f32_16x16x32_bf16 v[120:123], a[68:71], a[112:115], v[120:123]
    s_nop 0
    v_cvt_pk_bf16_f32 v192, v124, v125
    v_cvt_pk_bf16_f32 v193, v126, v127
    v_mfma_f32_16x16x32_bf16 v[120:123], a[64:67], a[116:119], v[120:123]
    ds_write_b16 v255, v192 offset:12288
    ds_write_b16_d16_hi v255, v192 offset:12416
    v_mfma_f32_16x16x32_bf16 v[116:119], a[80:83], a[96:99], v[116:119]
    ds_write_b16 v255, v193 offset:12544
    ds_write_b16_d16_hi v255, v193 offset:12672
    v_mfma_f32_16x16x32_bf16 v[116:119], a[76:79], a[100:103], v[116:119]
    v_mfma_f32_16x16x32_bf16 v[116:119], a[72:75], a[104:107], v[116:119]
    v_mfma_f32_16x16x32_bf16 v[116:119], a[68:71], a[108:111], v[116:119]
    v_mfma_f32_16x16x32_bf16 v[116:119], a[64:67], a[112:115], v[116:119]
    v_cvt_pk_bf16_f32 v190, v120, v121
    v_cvt_pk_bf16_f32 v191, v122, v123
    v_mfma_f32_16x16x32_bf16 v[112:115], a[76:79], a[96:99], v[112:115]
    ds_write_b16 v255, v190 offset:10240
    ds_write_b16_d16_hi v255, v190 offset:10368
    v_mfma_f32_16x16x32_bf16 v[112:115], a[72:75], a[100:103], v[112:115]
    ds_write_b16 v255, v191 offset:10496
    ds_write_b16_d16_hi v255, v191 offset:10624
    v_mfma_f32_16x16x32_bf16 v[112:115], a[68:71], a[104:107], v[112:115]
    v_mfma_f32_16x16x32_bf16 v[112:115], a[64:67], a[108:111], v[112:115]
    v_mfma_f32_16x16x32_bf16 v[108:111], a[72:75], a[96:99], v[108:111]
    v_cvt_pk_bf16_f32 v188, v116, v117
    v_cvt_pk_bf16_f32 v189, v118, v119
    v_mfma_f32_16x16x32_bf16 v[108:111], a[68:71], a[100:103], v[108:111]
    ds_write_b16 v255, v188 offset:8192
    ds_write_b16_d16_hi v255, v188 offset:8320
    v_mfma_f32_16x16x32_bf16 v[108:111], a[64:67], a[104:107], v[108:111]
    ds_write_b16 v255, v189 offset:8448
    ds_write_b16_d16_hi v255, v189 offset:8576
    v_mfma_f32_16x16x32_bf16 v[104:107], a[68:71], a[96:99], v[104:107]
    v_mfma_f32_16x16x32_bf16 v[104:107], a[64:67], a[100:103], v[104:107]
    v_cvt_pk_bf16_f32 v186, v112, v113
    v_cvt_pk_bf16_f32 v187, v114, v115
    v_mfma_f32_16x16x32_bf16 v[100:103], a[64:67], a[96:99], v[100:103]
    ds_write_b16 v255, v186 offset:6144
    ds_write_b16_d16_hi v255, v186 offset:6272
    ds_write_b16 v255, v187 offset:6400
    ds_write_b16_d16_hi v255, v187 offset:6528
    v_cvt_pk_bf16_f32 v184, v108, v109
    v_cvt_pk_bf16_f32 v185, v110, v111
    ds_write_b16 v255, v184 offset:4096
    ds_write_b16_d16_hi v255, v184 offset:4224
    ds_write_b16 v255, v185 offset:4352
    ds_write_b16_d16_hi v255, v185 offset:4480
    v_cvt_pk_bf16_f32 v182, v104, v105
    v_cvt_pk_bf16_f32 v183, v106, v107
    ds_write_b16 v255, v182 offset:2048
    ds_write_b16_d16_hi v255, v182 offset:2176
    ds_write_b16 v255, v183 offset:2304
    ds_write_b16_d16_hi v255, v183 offset:2432
    v_cvt_pk_bf16_f32 v180, v100, v101
    v_cvt_pk_bf16_f32 v181, v102, v103
    ds_write_b16 v255, v180 offset:0
    ds_write_b16_d16_hi v255, v180 offset:128
    ds_write_b16 v255, v181 offset:256
    ds_write_b16_d16_hi v255, v181 offset:384
    v_lshlrev_b32 v244, 4, v0
    v_add_u32 v244, 112000, v244
    v_mul_u32_u24 v245, 18432, v201
    v_lshl_add_u32 v245, v200, 4, v245
    s_lshl_b32 s3, s72, 7
    v_add_u32 v245, s3, v245
    s_waitcnt lgkmcnt(0)
    s_barrier
    ds_read_b128 v[100:103], v244 offset:0
    ds_read_b128 v[104:107], v244 offset:4096
    ds_read_b128 v[108:111], v244 offset:8192
    ds_read_b128 v[112:115], v244 offset:12288
    s_mov_b32 s3, 2359296
    s_waitcnt lgkmcnt(3)
    v_min_u32 v100, 0xfffffffe, v100
    v_min_u32 v101, 0xfffffffe, v101
    v_min_u32 v102, 0xfffffffe, v102
    v_min_u32 v103, 0xfffffffe, v103
    buffer_store_dwordx4 v[100:103], v245, s[16:19], s3 offen sc1
    s_mov_b32 s3, 2949120
    s_waitcnt lgkmcnt(2)
    v_min_u32 v104, 0xfffffffe, v104
    v_min_u32 v105, 0xfffffffe, v105
    v_min_u32 v106, 0xfffffffe, v106
    v_min_u32 v107, 0xfffffffe, v107
    buffer_store_dwordx4 v[104:107], v245, s[16:19], s3 offen sc1
    s_mov_b32 s3, 3538944
    s_waitcnt lgkmcnt(1)
    v_min_u32 v108, 0xfffffffe, v108
    v_min_u32 v109, 0xfffffffe, v109
    v_min_u32 v110, 0xfffffffe, v110
    v_min_u32 v111, 0xfffffffe, v111
    buffer_store_dwordx4 v[108:111], v245, s[16:19], s3 offen sc1
    s_mov_b32 s3, 4128768
    s_waitcnt lgkmcnt(0)
    v_min_u32 v112, 0xfffffffe, v112
    v_min_u32 v113, 0xfffffffe, v113
    v_min_u32 v114, 0xfffffffe, v114
    v_min_u32 v115, 0xfffffffe, v115
    buffer_store_dwordx4 v[112:115], v245, s[16:19], s3 offen sc1
    v_pk_fma_f32 v[156:157], v[132:133], v[206:207], v[206:207] op_sel:[0,1,0] op_sel_hi:[1,1,0]
    v_pk_fma_f32 v[158:159], v[134:135], v[206:207], v[206:207] op_sel:[0,1,0] op_sel_hi:[1,1,0]
    v_pk_fma_f32 v[160:161], v[136:137], v[206:207], v[206:207] op_sel:[0,1,0] op_sel_hi:[1,1,0]
    v_pk_fma_f32 v[162:163], v[138:139], v[206:207], v[206:207] op_sel:[0,1,0] op_sel_hi:[1,1,0]
    v_pk_fma_f32 v[164:165], v[140:141], v[206:207], v[206:207] op_sel:[0,1,0] op_sel_hi:[1,1,0]
    v_pk_fma_f32 v[166:167], v[142:143], v[206:207], v[206:207] op_sel:[0,1,0] op_sel_hi:[1,1,0]
    v_pk_fma_f32 v[168:169], v[144:145], v[206:207], v[206:207] op_sel:[0,1,0] op_sel_hi:[1,1,0]
    v_pk_fma_f32 v[170:171], v[146:147], v[206:207], v[206:207] op_sel:[0,1,0] op_sel_hi:[1,1,0]
    v_pk_fma_f32 v[172:173], v[148:149], v[206:207], v[206:207] op_sel:[0,1,0] op_sel_hi:[1,1,0]
    v_pk_fma_f32 v[174:175], v[150:151], v[206:207], v[206:207] op_sel:[0,1,0] op_sel_hi:[1,1,0]
    v_pk_fma_f32 v[176:177], v[152:153], v[206:207], v[206:207] op_sel:[0,1,0] op_sel_hi:[1,1,0]
    v_pk_fma_f32 v[178:179], v[154:155], v[206:207], v[206:207] op_sel:[0,1,0] op_sel_hi:[1,1,0]
    s_waitcnt vmcnt(5)
    v_subrev_u32 v11, s70, v11
    v_cmp_lt_u32 vcc, 5, v11
    s_nop 1
    s_cbranch_vccnz adaLN_cond__ssm_conv_h3__glu_gated_geglu__prompt_kernel_slm
adaLN_cond__ssm_conv_h3__glu_gated_geglu__prompt_kernel_slmb:
    s_mov_b32 s49, 4720896
    buffer_load_dwordx4 v[64:67], v198, s[16:19], s49 offen offset:0 sc1
    buffer_load_dwordx4 v[68:71], v198, s[16:19], s49 offen offset:16 sc1
    buffer_load_dwordx4 v[72:75], v198, s[16:19], s49 offen offset:768 sc1
    buffer_load_dwordx4 v[76:79], v198, s[16:19], s49 offen offset:784 sc1
    buffer_load_dwordx4 v[80:83], v198, s[16:19], s49 offen offset:1536 sc1
    buffer_load_dwordx4 v[84:87], v198, s[16:19], s49 offen offset:1552 sc1
    s_mov_b32 s49, 4718592
    buffer_load_dwordx4 v[32:35], v198, s[16:19], s49 offen offset:0 sc1
    buffer_load_dwordx4 v[36:39], v198, s[16:19], s49 offen offset:16 sc1
    buffer_load_dwordx4 v[40:43], v198, s[16:19], s49 offen offset:768 sc1
    buffer_load_dwordx4 v[44:47], v198, s[16:19], s49 offen offset:784 sc1
    buffer_load_dwordx4 v[48:51], v198, s[16:19], s49 offen offset:1536 sc1
    buffer_load_dwordx4 v[52:55], v198, s[16:19], s49 offen offset:1552 sc1
    s_mov_b32 s49, 4723200
    buffer_load_dwordx4 v[220:223], v198, s[16:19], s49 offen offset:0 sc1
    buffer_load_dwordx4 v[224:227], v198, s[16:19], s49 offen offset:16 sc1
    buffer_load_dwordx4 v[228:231], v198, s[16:19], s49 offen offset:768 sc1
    buffer_load_dwordx4 v[232:235], v198, s[16:19], s49 offen offset:784 sc1
    buffer_load_dwordx4 v[236:239], v198, s[16:19], s49 offen offset:1536 sc1
    buffer_load_dwordx4 v[240:243], v198, s[16:19], s49 offen offset:1552 sc1
    s_waitcnt vmcnt(6)
    v_pk_fma_f32 v[156:157], v[156:157], v[64:65], v[32:33]
    v_pk_fma_f32 v[158:159], v[158:159], v[66:67], v[34:35]
    v_pk_fma_f32 v[160:161], v[160:161], v[68:69], v[36:37]
    v_pk_fma_f32 v[162:163], v[162:163], v[70:71], v[38:39]
    v_pk_fma_f32 v[164:165], v[164:165], v[72:73], v[40:41]
    v_pk_fma_f32 v[166:167], v[166:167], v[74:75], v[42:43]
    v_pk_fma_f32 v[168:169], v[168:169], v[76:77], v[44:45]
    v_pk_fma_f32 v[170:171], v[170:171], v[78:79], v[46:47]
    v_pk_fma_f32 v[172:173], v[172:173], v[80:81], v[48:49]
    v_pk_fma_f32 v[174:175], v[174:175], v[82:83], v[50:51]
    v_pk_fma_f32 v[176:177], v[176:177], v[84:85], v[52:53]
    v_pk_fma_f32 v[178:179], v[178:179], v[86:87], v[54:55]
    s_mov_b32 s49, 4727808
    buffer_load_dwordx4 v[64:67], v198, s[16:19], s49 offen offset:0 sc1
    buffer_load_dwordx4 v[68:71], v198, s[16:19], s49 offen offset:16 sc1
    buffer_load_dwordx4 v[72:75], v198, s[16:19], s49 offen offset:768 sc1
    buffer_load_dwordx4 v[76:79], v198, s[16:19], s49 offen offset:784 sc1
    buffer_load_dwordx4 v[80:83], v198, s[16:19], s49 offen offset:1536 sc1
    buffer_load_dwordx4 v[84:87], v198, s[16:19], s49 offen offset:1552 sc1
    s_mov_b32 s49, 4725504
    buffer_load_dwordx4 v[32:35], v198, s[16:19], s49 offen offset:0 sc1
    buffer_load_dwordx4 v[36:39], v198, s[16:19], s49 offen offset:16 sc1
    buffer_load_dwordx4 v[40:43], v198, s[16:19], s49 offen offset:768 sc1
    buffer_load_dwordx4 v[44:47], v198, s[16:19], s49 offen offset:784 sc1
    buffer_load_dwordx4 v[48:51], v198, s[16:19], s49 offen offset:1536 sc1
    buffer_load_dwordx4 v[52:55], v198, s[16:19], s49 offen offset:1552 sc1
    s_waitcnt vmcnt(12)
    v_pk_mul_f32 v[156:157], v[156:157], v[220:221]
    v_pk_mul_f32 v[158:159], v[158:159], v[222:223]
    v_pk_mul_f32 v[160:161], v[160:161], v[224:225]
    v_pk_mul_f32 v[162:163], v[162:163], v[226:227]
    v_pk_mul_f32 v[164:165], v[164:165], v[228:229]
    v_pk_mul_f32 v[166:167], v[166:167], v[230:231]
    v_pk_mul_f32 v[168:169], v[168:169], v[232:233]
    v_pk_mul_f32 v[170:171], v[170:171], v[234:235]
    v_pk_mul_f32 v[172:173], v[172:173], v[236:237]
    v_pk_mul_f32 v[174:175], v[174:175], v[238:239]
    v_pk_mul_f32 v[176:177], v[176:177], v[240:241]
    v_pk_mul_f32 v[178:179], v[178:179], v[242:243]
    s_branch adaLN_cond__ssm_conv_h3__glu_gated_geglu__prompt_kernel_ln
adaLN_cond__ssm_conv_h3__glu_gated_geglu__prompt_kernel_oth:
    v_mov_b32 v156, -1
    v_mov_b32 v157, -1
    v_mov_b32 v158, -1
    v_mov_b32 v159, -1
    v_lshrrev_b32 v160, 3, v205
    v_and_b32 v161, 7, v205
    v_lshlrev_b32 v161, 4, v161
    s_and_b32 s49, s73, 1
    s_lshl_b32 s49, s49, 7
    s_mul_i32 s66, s24, 4608
    s_add_u32 s49, s49, s66
    s_add_u32 s49, s49, s36
    s_add_u32 s49, s49, 2621440
    v_add_u32 v162, 0, v160
    v_min_u32 v162, 17, v162
    v_lshl_add_u32 v162, v162, 8, v161
    buffer_store_dwordx4 v[156:159], v162, s[16:19], s49 offen sc1
    v_add_u32 v162, 8, v160
    v_min_u32 v162, 17, v162
    v_lshl_add_u32 v162, v162, 8, v161
    buffer_store_dwordx4 v[156:159], v162, s[16:19], s49 offen sc1
    v_add_u32 v162, 16, v160
    v_min_u32 v162, 17, v162
    v_lshl_add_u32 v162, v162, 8, v161
    buffer_store_dwordx4 v[156:159], v162, s[16:19], s49 offen sc1
    s_cmp_ge_u32 s2, 198
    s_cbranch_scc1 adaLN_cond__ssm_conv_h3__glu_gated_geglu__prompt_kernel_spare
    s_mov_b32 s80, s54
    s_mov_b32 s81, s55
    s_and_b32 s81, s81, 0xffff
    s_mov_b32 s82, 3981312
    s_mov_b32 s83, 0x00020000
    v_lshrrev_b32 v3, 3, v205
    s_mul_i32 s3, s24, 144
    v_add_u32 v4, s3, v3
    v_mul_u32_u24 v4, 6912, v4
    v_and_b32 v3, 2, v3
    v_and_b32 v5, 7, v205
    v_xor_b32 v3, v3, v5
    s_sub_u32 s3, s2, 144
    s_lshl_b32 s3, s3, 7
    v_lshl_add_u32 v5, v3, 4, v4
    v_add_u32 v5, s3, v5
    v_xor_b32 v3, 4, v3
    v_lshl_add_u32 v4, v3, 4, v4
    v_add_u32 v4, s3, v4
    s_mul_i32 s49, s24, 18432
    s_add_u32 m0, s49, 73728
    s_mov_b32 s3, 0
    buffer_load_dwordx4 v5, s[80:83], s3 offen  lds
    s_add_u32 m0, s49, 74752
    s_mov_b32 s3, 55296
    buffer_load_dwordx4 v4, s[80:83], s3 offen  lds
    s_add_u32 m0, s49, 75776
    s_mov_b32 s3, 110592
    buffer_load_dwordx4 v5, s[80:83], s3 offen  lds
    s_add_u32 m0, s49, 76800
    s_mov_b32 s3, 165888
    buffer_load_dwordx4 v4, s[80:83], s3 offen  lds
    s_add_u32 m0, s49, 77824
    s_mov_b32 s3, 221184
    buffer_load_dwordx4 v5, s[80:83], s3 offen  lds
    s_add_u32 m0, s49, 78848
    s_mov_b32 s3, 276480
    buffer_load_dwordx4 v4, s[80:83], s3 offen  lds
    s_add_u32 m0, s49, 79872
    s_mov_b32 s3, 331776
    buffer_load_dwordx4 v5, s[80:83], s3 offen  lds
    s_add_u32 m0, s49, 80896
    s_mov_b32 s3, 387072
    buffer_load_dwordx4 v4, s[80:83], s3 offen  lds
    s_add_u32 m0, s49, 81920
    s_mov_b32 s3, 442368
    buffer_load_dwordx4 v5, s[80:83], s3 offen  lds
    s_add_u32 m0, s49, 82944
    s_mov_b32 s3, 497664
    buffer_load_dwordx4 v4, s[80:83], s3 offen  lds
    s_add_u32 m0, s49, 83968
    s_mov_b32 s3, 552960
    buffer_load_dwordx4 v5, s[80:83], s3 offen  lds
    s_add_u32 m0, s49, 84992
    s_mov_b32 s3, 608256
    buffer_load_dwordx4 v4, s[80:83], s3 offen  lds
    s_add_u32 m0, s49, 86016
    s_mov_b32 s3, 663552
    buffer_load_dwordx4 v5, s[80:83], s3 offen  lds
    s_add_u32 m0, s49, 87040
    s_mov_b32 s3, 718848
    buffer_load_dwordx4 v4, s[80:83], s3 offen  lds
    s_add_u32 m0, s49, 88064
    s_mov_b32 s3, 774144
    buffer_load_dwordx4 v5, s[80:83], s3 offen  lds
    s_add_u32 m0, s49, 89088
    s_mov_b32 s3, 829440
    buffer_load_dwordx4 v4, s[80:83], s3 offen  lds
    s_add_u32 m0, s49, 90112
    s_mov_b32 s3, 884736
    buffer_load_dwordx4 v5, s[80:83], s3 offen  lds
    s_add_u32 m0, s49, 91136
    s_mov_b32 s3, 940032
    buffer_load_dwordx4 v4, s[80:83], s3 offen  lds
    s_and_b32 s27, s33, 1
    s_lshr_b32 s3, s33, 1
    s_mul_i32 s3, s3, 9
    s_mul_i32 s49, s25, 18
    s_add_u32 s3, s3, s49
    s_add_u32 s28, s3, 4
    s_lshl_b32 s3, s33, 3
    s_or_b32 s3, s3, 0x80000
    s_bfe_u32 s29, 235537920, s3
    s_add_u32 s29, s29, s49
    v_lshrrev_b32 v244, 2, v205
    s_mul_i32 s3, s24, 144
    v_add_u32 v244, s3, v244
    v_mul_u32_u24 v244, 9216, v244
    v_lshrrev_b32 v245, 4, v205
    v_and_b32 v245, 2, v245
    v_and_b32 v247, 3, v205
    v_xor_b32 v245, v245, v247
    v_lshl_add_u32 v6, v245, 4, v244
    s_lshl_b32 s3, s28, 6
    v_add_u32 v7, s3, v6
    s_mov_b32 s40, 0
    s_mov_b32 s41, 146432
    s_mov_b32 s42, 292864
    s_mov_b32 s43, 439296
    s_mov_b32 s44, 589824
    s_mov_b32 s45, 736256
    s_mov_b32 s46, 882688
    s_mov_b32 s47, 1029120
    s_mov_b32 s48, 1179648
    s_mul_i32 s34, s24, 9216
    ds_read_b64 v[184:185], v197 offset:0
    ds_read_b64 v[186:187], v197 offset:64
    ds_read_b64 v[188:189], v197 offset:128
    s_mov_b32 s3, 0x3ae38e39
    s_waitcnt lgkmcnt(0)
    v_pk_add_f32 v[184:185], v[184:185], v[186:187]
    v_pk_add_f32 v[184:185], v[184:185], v[188:189]
    v_mul_f32 v206, s3, v184
    v_mul_f32 v207, s3, v185
    v_fma_f32 v207, -v206, v206, v207
    v_max_f32 v207, 0, v207
    v_add_f32 v207, 0x3727c5ac, v207
    v_rsq_f32 v207, v207
    v_mul_f32 v206, -1.0, v206
    v_mul_f32 v206, v206, v207
    v_lshrrev_b32 v2, 4, v205
    v_bfe_u32 v3, v205, 2, 2
    v_lshl_add_u32 v4, v2, 3, v3
    v_lshlrev_b32 v4, 7, v4
    v_lshrrev_b32 v3, 1, v3
    v_and_b32 v5, 1, v2
    v_lshl_add_u32 v3, v5, 1, v3
    v_xor_b32 v3, s24, v3
    v_lshl_add_u32 v4, v3, 5, v4
    v_and_b32 v3, 3, v205
    v_lshl_add_u32 v4, v3, 3, v4
    v_add_u32 v4, 73728, v4
    v_add_u32 v5, 36864, v4
    v_lshlrev_b32 v8, 4, v2
    v_add_u32 v8, 148480, v8
    s_waitcnt vmcnt(0)
    s_add_u32 s49, s67, 4849664
    v_mov_b32 v13, s70
    s_mov_b64 exec, 1
    buffer_store_dword v13, off, s[16:19], s49 sc1
    s_mov_b64 exec, -1
    s_barrier
    ds_read_b128 v[32:35], v8 offset:0
    ds_read_b64_tr_b16 a[0:1], v4 offset:0
    ds_read_b64_tr_b16 a[2:3], v4 offset:512
    ds_read_b128 v[36:39], v8 offset:64
    ds_read_b64_tr_b16 a[4:5], v4 offset:4096
    ds_read_b64_tr_b16 a[6:7], v4 offset:4608
    ds_read_b128 v[40:43], v8 offset:128
    ds_read_b64_tr_b16 a[8:9], v4 offset:8192
    ds_read_b64_tr_b16 a[10:11], v4 offset:8704
    ds_read_b128 v[44:47], v8 offset:192
    ds_read_b64_tr_b16 a[12:13], v4 offset:12288
    ds_read_b64_tr_b16 a[14:15], v4 offset:12800
    s_waitcnt lgkmcnt(9)
    v_mfma_f32_16x16x32_bf16 v[12:15], a[0:3], v[32:35], 0
    ds_read_b128 v[48:51], v8 offset:256
    ds_read_b64_tr_b16 a[16:17], v4 offset:16384
    ds_read_b64_tr_b16 a[18:19], v4 offset:16896
    s_waitcnt lgkmcnt(9)
    v_mfma_f32_16x16x32_bf16 v[12:15], a[4:7], v[36:39], v[12:15]
    ds_read_b128 v[52:55], v8 offset:320
    ds_read_b64_tr_b16 a[20:21], v4 offset:20480
    ds_read_b64_tr_b16 a[22:23], v4 offset:20992
    s_waitcnt lgkmcnt(9)
    v_mfma_f32_16x16x32_bf16 v[12:15], a[8:11], v[40:43], v[12:15]
    ds_read_b128 v[56:59], v8 offset:384
    ds_read_b64_tr_b16 a[24:25], v4 offset:24576
    ds_read_b64_tr_b16 a[26:27], v4 offset:25088
    s_waitcnt lgkmcnt(9)
    v_mfma_f32_16x16x32_bf16 v[12:15], a[12:15], v[44:47], v[12:15]
    ds_read_b128 v[60:63], v8 offset:448
    ds_read_b64_tr_b16 a[28:29], v4 offset:28672
    ds_read_b64_tr_b16 a[30:31], v4 offset:29184
    s_waitcnt lgkmcnt(9)
    v_mfma_f32_16x16x32_bf16 v[12:15], a[16:19], v[48:51], v[12:15]
    ds_read_b128 v[64:67], v8 offset:512
    ds_read_b64_tr_b16 a[32:33], v4 offset:32768
    ds_read_b64_tr_b16 a[34:35], v4 offset:33280
    s_waitcnt lgkmcnt(9)
    v_mfma_f32_16x16x32_bf16 v[12:15], a[20:23], v[52:55], v[12:15]
    ds_read_b128 v[68:71], v8 offset:576
    ds_read_b64_tr_b16 a[36:37], v5 offset:0
    ds_read_b64_tr_b16 a[38:39], v5 offset:512
    s_waitcnt lgkmcnt(9)
    v_mfma_f32_16x16x32_bf16 v[12:15], a[24:27], v[56:59], v[12:15]
    ds_read_b128 v[72:75], v8 offset:640
    ds_read_b64_tr_b16 a[40:41], v5 offset:4096
    ds_read_b64_tr_b16 a[42:43], v5 offset:4608
    s_waitcnt lgkmcnt(9)
    v_mfma_f32_16x16x32_bf16 v[12:15], a[28:31], v[60:63], v[12:15]
    ds_read_b128 v[76:79], v8 offset:704
    ds_read_b64_tr_b16 a[44:45], v5 offset:8192
    ds_read_b64_tr_b16 a[46:47], v5 offset:8704
    s_waitcnt lgkmcnt(9)
    v_mfma_f32_16x16x32_bf16 v[12:15], a[32:35], v[64:67], v[12:15]
    ds_read_b128 v[80:83], v8 offset:768
    ds_read_b64_tr_b16 a[48:49], v5 offset:12288
    ds_read_b64_tr_b16 a[50:51], v5 offset:12800
    s_waitcnt lgkmcnt(9)
    v_mfma_f32_16x16x32_bf16 v[12:15], a[36:39], v[68:71], v[12:15]
    ds_read_b128 v[84:87], v8 offset:832
    ds_read_b64_tr_b16 a[52:53], v5 offset:16384
    ds_read_b64_tr_b16 a[54:55], v5 offset:16896
    s_waitcnt lgkmcnt(9)
    v_mfma_f32_16x16x32_bf16 v[12:15], a[40:43], v[72:75], v[12:15]
    ds_read_b128 v[88:91], v8 offset:896
    ds_read_b64_tr_b16 a[56:57], v5 offset:20480
    ds_read_b64_tr_b16 a[58:59], v5 offset:20992
    s_waitcnt lgkmcnt(9)
    v_mfma_f32_16x16x32_bf16 v[12:15], a[44:47], v[76:79], v[12:15]
    ds_read_b128 v[92:95], v8 offset:960
    ds_read_b64_tr_b16 a[60:61], v5 offset:24576
    ds_read_b64_tr_b16 a[62:63], v5 offset:25088
    s_waitcnt lgkmcnt(9)
    v_mfma_f32_16x16x32_bf16 v[12:15], a[48:51], v[80:83], v[12:15]
    ds_read_b128 v[96:99], v8 offset:1024
    ds_read_b64_tr_b16 a[64:65], v5 offset:28672
    ds_read_b64_tr_b16 a[66:67], v5 offset:29184
    s_waitcnt lgkmcnt(9)
    v_mfma_f32_16x16x32_bf16 v[12:15], a[52:55], v[84:87], v[12:15]
    ds_read_b128 v[100:103], v8 offset:1088
    ds_read_b64_tr_b16 a[68:69], v5 offset:32768
    ds_read_b64_tr_b16 a[70:71], v5 offset:33280
    s_waitcnt lgkmcnt(9)
    v_mfma_f32_16x16x32_bf16 v[12:15], a[56:59], v[88:91], v[12:15]
    s_waitcnt lgkmcnt(6)
    v_mfma_f32_16x16x32_bf16 v[12:15], a[60:63], v[92:95], v[12:15]
    s_waitcnt lgkmcnt(3)
    v_mfma_f32_16x16x32_bf16 v[12:15], a[64:67], v[96:99], v[12:15]
    s_waitcnt lgkmcnt(0)
    v_mfma_f32_16x16x32_bf16 v[12:15], a[68:71], v[100:103], v[12:15]
    s_sub_u32 s72, s2, 144
    s_sub_u32 s3, s72, 9
    s_cmp_lt_u32 s3, 9
    s_cselect_b32 s49, 1.0, 0
    s_sub_u32 s3, s72, 36
    s_cmp_lt_u32 s3, 9
    s_cselect_b32 s49, 1.0, s49
    s_lshl_b32 s3, s72, 8
    s_lshl_b32 s66, s24, 6
    s_add_u32 s3, s3, s66
    s_add_u32 s3, s3, 4718592
    v_lshlrev_b32 v4, 4, v2
    v_cvt_pk_bf16_f32 v12, v12, v12
    v_cvt_pk_bf16_f32 v13, v13, v13
    v_cvt_pk_bf16_f32 v14, v14, v14
    v_cvt_pk_bf16_f32 v15, v15, v15
    v_lshlrev_b32 v12, 16, v12
    v_lshlrev_b32 v13, 16, v13
    v_lshlrev_b32 v14, 16, v14
    v_lshlrev_b32 v15, 16, v15
    v_add_f32 v12, s49, v12
    v_add_f32 v13, s49, v13
    v_add_f32 v14, s49, v14
    v_add_f32 v15, s49, v15
    v_cvt_pk_bf16_f32 v12, v12, v12
    v_cvt_pk_bf16_f32 v13, v13, v13
    v_cvt_pk_bf16_f32 v14, v14, v14
    v_cvt_pk_bf16_f32 v15, v15, v15
    v_lshlrev_b32 v12, 16, v12
    v_lshlrev_b32 v13, 16, v13
    v_lshlrev_b32 v14, 16, v14
    v_lshlrev_b32 v15, 16, v15
    s_mov_b32 exec_lo, 0x00010001
    s_mov_b32 exec_hi, 0x00010001
    buffer_store_dwordx4 v[12:15], v4, s[16:19], s3 offen sc1
    s_mov_b64 exec, -1
    s_lshl_b32 s72, s72, 7
    s_waitcnt vmcnt(0)
    s_barrier
    s_cmp_lg_u32 s24, 0
    s_cbranch_scc1 adaLN_cond__ssm_conv_h3__glu_gated_geglu__prompt_kernel_mx
    s_add_u32 s49, s72, 4947968
    v_mov_b32 v13, s70
    s_mov_b64 exec, 1
    buffer_store_dword v13, off, s[16:19], s49 sc1
    s_mov_b64 exec, -1
adaLN_cond__ssm_conv_h3__glu_gated_geglu__prompt_kernel_mx:
    s_add_u32 m0, s34, 0
    s_nop 0
    buffer_load_dwordx4 v7, s[4:7], s40 offen offset:0  lds
    buffer_load_dwordx4 v7, s[4:7], s41 offen offset:1024  lds
    buffer_load_dwordx4 v7, s[4:7], s42 offen offset:2048  lds
    buffer_load_dwordx4 v7, s[4:7], s43 offen offset:3072  lds
    s_add_u32 m0, s34, 4096
    s_nop 0
    buffer_load_dwordx4 v7, s[4:7], s44 offen offset:0  lds
    buffer_load_dwordx4 v7, s[4:7], s45 offen offset:1024  lds
    buffer_load_dwordx4 v7, s[4:7], s46 offen offset:2048  lds
    buffer_load_dwordx4 v7, s[4:7], s47 offen offset:3072  lds
    s_add_u32 m0, s34, 8192
    s_nop 0
    buffer_load_dwordx4 v7, s[4:7], s48 offen offset:0  lds
    s_add_u32 m0, s34, 36864
    s_nop 0
    buffer_load_dwordx4 v7, s[8:11], s40 offen offset:0  lds
    buffer_load_dwordx4 v7, s[8:11], s41 offen offset:1024  lds
    buffer_load_dwordx4 v7, s[8:11], s42 offen offset:2048  lds
    buffer_load_dwordx4 v7, s[8:11], s43 offen offset:3072  lds
    s_add_u32 m0, s34, 40960
    s_nop 0
    buffer_load_dwordx4 v7, s[8:11], s44 offen offset:0  lds
    buffer_load_dwordx4 v7, s[8:11], s45 offen offset:1024  lds
    buffer_load_dwordx4 v7, s[8:11], s46 offen offset:2048  lds
    buffer_load_dwordx4 v7, s[8:11], s47 offen offset:3072  lds
    s_add_u32 m0, s34, 45056
    s_nop 0
    buffer_load_dwordx4 v7, s[8:11], s48 offen offset:0  lds
    s_sub_u32 s3, s26, 18
    v_mul_u32_u24 v244, 14, v0
    v_add_u32 v244, s3, v244
    s_mul_i32 s3, s25, 1152
    v_lshrrev_b32 v245, 2, v244
    v_and_b32 v244, 3, v244
    v_min_u32 v247, 1, v244
    v_lshl_add_u32 v244, v244, 1, v247
    v_mul_u32_u24 v245, 9216, v245
    v_lshl_add_u32 v244, v244, 7, v245
    buffer_load_dword v248, v244, s[4:7], s3 offen
    buffer_load_dword v249, v244, s[8:11], s3 offen
    s_branch adaLN_cond__ssm_conv_h3__glu_gated_geglu__prompt_kernel_oj
adaLN_cond__ssm_conv_h3__glu_gated_geglu__prompt_kernel_spare:
    s_sub_u32 s3, s2, 198
    s_lshr_b32 s3, s3, 3
    v_mul_u32_u24 v244, 7, v0
    v_add_u32 v244, s3, v244
    s_mul_i32 s3, s25, 1152
    v_lshrrev_b32 v245, 1, v244
    v_and_b32 v244, 1, v244
    v_lshl_add_u32 v244, v244, 2, 2
    v_mul_u32_u24 v245, 9216, v245
    v_lshl_add_u32 v244, v244, 7, v245
    buffer_load_dword v248, v244, s[4:7], s3 offen
    buffer_load_dword v249, v244, s[8:11], s3 offen
    ds_read_b64 v[184:185], v197 offset:0
    ds_read_b64 v[186:187], v197 offset:64
    ds_read_b64 v[188:189], v197 offset:128
    s_mov_b32 s3, 0x3ae38e39
    s_waitcnt lgkmcnt(0)
    v_pk_add_f32 v[184:185], v[184:185], v[186:187]
    v_pk_add_f32 v[184:185], v[184:185], v[188:189]
    v_mul_f32 v206, s3, v184
    v_mul_f32 v207, s3, v185
    v_fma_f32 v207, -v206, v206, v207
    v_max_f32 v207, 0, v207
    v_add_f32 v207, 0x3727c5ac, v207
    v_rsq_f32 v207, v207
    v_mul_f32 v206, -1.0, v206
    v_mul_f32 v206, v206, v207
    s_and_b32 s27, s33, 1
    s_lshr_b32 s3, s33, 1
    s_mul_i32 s3, s3, 9
    s_mul_i32 s49, s25, 18
    s_add_u32 s3, s3, s49
    s_add_u32 s28, s3, 4
    s_lshl_b32 s3, s33, 3
    s_or_b32 s3, s3, 0x80000
    s_bfe_u32 s29, 235537920, s3
    s_add_u32 s29, s29, s49
    v_lshrrev_b32 v244, 2, v205
    s_mul_i32 s3, s24, 144
    v_add_u32 v244, s3, v244
    v_mul_u32_u24 v244, 9216, v244
    v_lshrrev_b32 v245, 4, v205
    v_and_b32 v245, 2, v245
    v_and_b32 v247, 3, v205
    v_xor_b32 v245, v245, v247
    v_lshl_add_u32 v6, v245, 4, v244
    s_lshl_b32 s3, s28, 6
    v_add_u32 v7, s3, v6
    s_mov_b32 s40, 0
    s_mov_b32 s41, 146432
    s_mov_b32 s42, 292864
    s_mov_b32 s43, 439296
    s_mov_b32 s44, 589824
    s_mov_b32 s45, 736256
    s_mov_b32 s46, 882688
    s_mov_b32 s47, 1029120
    s_mov_b32 s48, 1179648
    s_mul_i32 s34, s24, 9216
    s_add_u32 m0, s34, 0
    s_nop 0
    buffer_load_dwordx4 v7, s[4:7], s40 offen offset:0  lds
    buffer_load_dwordx4 v7, s[4:7], s41 offen offset:1024  lds
    buffer_load_dwordx4 v7, s[4:7], s42 offen offset:2048  lds
    buffer_load_dwordx4 v7, s[4:7], s43 offen offset:3072  lds
    s_add_u32 m0, s34, 4096
    s_nop 0
    buffer_load_dwordx4 v7, s[4:7], s44 offen offset:0  lds
    buffer_load_dwordx4 v7, s[4:7], s45 offen offset:1024  lds
    buffer_load_dwordx4 v7, s[4:7], s46 offen offset:2048  lds
    buffer_load_dwordx4 v7, s[4:7], s47 offen offset:3072  lds
    s_add_u32 m0, s34, 8192
    s_nop 0
    buffer_load_dwordx4 v7, s[4:7], s48 offen offset:0  lds
    s_add_u32 m0, s34, 36864
    s_nop 0
    buffer_load_dwordx4 v7, s[8:11], s40 offen offset:0  lds
    buffer_load_dwordx4 v7, s[8:11], s41 offen offset:1024  lds
    buffer_load_dwordx4 v7, s[8:11], s42 offen offset:2048  lds
    buffer_load_dwordx4 v7, s[8:11], s43 offen offset:3072  lds
    s_add_u32 m0, s34, 40960
    s_nop 0
    buffer_load_dwordx4 v7, s[8:11], s44 offen offset:0  lds
    buffer_load_dwordx4 v7, s[8:11], s45 offen offset:1024  lds
    buffer_load_dwordx4 v7, s[8:11], s46 offen offset:2048  lds
    buffer_load_dwordx4 v7, s[8:11], s47 offen offset:3072  lds
    s_add_u32 m0, s34, 45056
    s_nop 0
    buffer_load_dwordx4 v7, s[8:11], s48 offen offset:0  lds
    v_lshlrev_b32 v10, 5, v0
    s_mov_b32 s49, 4915200
    s_mov_b32 s69, 0
adaLN_cond__ssm_conv_h3__glu_gated_geglu__prompt_kernel_ps:
    buffer_load_dword v11, v10, s[16:19], s49 offen sc1
    s_add_u32 s69, s69, 1
    s_waitcnt vmcnt(0)
    v_subrev_u32 v11, s70, v11
    v_cmp_lt_u32 vcc, 5, v11
    s_cmp_ge_u32 s69, 400000
    s_cbranch_scc1 adaLN_cond__ssm_conv_h3__glu_gated_geglu__prompt_kernel_psx
    s_cbranch_vccz adaLN_cond__ssm_conv_h3__glu_gated_geglu__prompt_kernel_psx
    s_sleep 2
    s_branch adaLN_cond__ssm_conv_h3__glu_gated_geglu__prompt_kernel_ps
adaLN_cond__ssm_conv_h3__glu_gated_geglu__prompt_kernel_psx:
    s_add_u32 s49, s67, 4849664
    v_mov_b32 v13, s70
    s_mov_b64 exec, 1
    buffer_store_dword v13, off, s[16:19], s49 sc1
    s_mov_b64 exec, -1
    s_sub_u32 s3, s26, 18
    v_mul_u32_u24 v244, 14, v0
    v_add_u32 v244, s3, v244
    s_mul_i32 s3, s25, 1152
    v_lshrrev_b32 v245, 2, v244
    v_and_b32 v244, 3, v244
    v_min_u32 v247, 1, v244
    v_lshl_add_u32 v244, v244, 1, v247
    v_mul_u32_u24 v245, 9216, v245
    v_lshl_add_u32 v244, v244, 7, v245
    buffer_load_dword v248, v244, s[4:7], s3 offen
    buffer_load_dword v249, v244, s[8:11], s3 offen
adaLN_cond__ssm_conv_h3__glu_gated_geglu__prompt_kernel_oj:
    v_min_u32 v244, 53, v205
    v_lshlrev_b32 v246, 7, v244
    s_mov_b32 s59, 4947968
    buffer_load_dword v11, v246, s[16:19], s59 offen sc1
    v_pk_fma_f32 v[156:157], v[132:133], v[206:207], v[206:207] op_sel:[0,1,0] op_sel_hi:[1,1,0]
    v_pk_fma_f32 v[158:159], v[134:135], v[206:207], v[206:207] op_sel:[0,1,0] op_sel_hi:[1,1,0]
    v_pk_fma_f32 v[160:161], v[136:137], v[206:207], v[206:207] op_sel:[0,1,0] op_sel_hi:[1,1,0]
    v_pk_fma_f32 v[162:163], v[138:139], v[206:207], v[206:207] op_sel:[0,1,0] op_sel_hi:[1,1,0]
    v_pk_fma_f32 v[164:165], v[140:141], v[206:207], v[206:207] op_sel:[0,1,0] op_sel_hi:[1,1,0]
    v_pk_fma_f32 v[166:167], v[142:143], v[206:207], v[206:207] op_sel:[0,1,0] op_sel_hi:[1,1,0]
    v_pk_fma_f32 v[168:169], v[144:145], v[206:207], v[206:207] op_sel:[0,1,0] op_sel_hi:[1,1,0]
    v_pk_fma_f32 v[170:171], v[146:147], v[206:207], v[206:207] op_sel:[0,1,0] op_sel_hi:[1,1,0]
    v_pk_fma_f32 v[172:173], v[148:149], v[206:207], v[206:207] op_sel:[0,1,0] op_sel_hi:[1,1,0]
    v_pk_fma_f32 v[174:175], v[150:151], v[206:207], v[206:207] op_sel:[0,1,0] op_sel_hi:[1,1,0]
    v_pk_fma_f32 v[176:177], v[152:153], v[206:207], v[206:207] op_sel:[0,1,0] op_sel_hi:[1,1,0]
    v_pk_fma_f32 v[178:179], v[154:155], v[206:207], v[206:207] op_sel:[0,1,0] op_sel_hi:[1,1,0]
    s_waitcnt vmcnt(0)
    v_subrev_u32 v11, s70, v11
    v_cmp_lt_u32 vcc, 5, v11
    s_nop 1
    s_cbranch_vccnz adaLN_cond__ssm_conv_h3__glu_gated_geglu__prompt_kernel_slo
adaLN_cond__ssm_conv_h3__glu_gated_geglu__prompt_kernel_slob:
    s_mov_b32 s49, 4720896
    buffer_load_dwordx4 v[64:67], v198, s[16:19], s49 offen offset:0 sc1
    buffer_load_dwordx4 v[68:71], v198, s[16:19], s49 offen offset:16 sc1
    buffer_load_dwordx4 v[72:75], v198, s[16:19], s49 offen offset:768 sc1
    buffer_load_dwordx4 v[76:79], v198, s[16:19], s49 offen offset:784 sc1
    buffer_load_dwordx4 v[80:83], v198, s[16:19], s49 offen offset:1536 sc1
    buffer_load_dwordx4 v[84:87], v198, s[16:19], s49 offen offset:1552 sc1
    s_mov_b32 s49, 4718592
    buffer_load_dwordx4 v[32:35], v198, s[16:19], s49 offen offset:0 sc1
    buffer_load_dwordx4 v[36:39], v198, s[16:19], s49 offen offset:16 sc1
    buffer_load_dwordx4 v[40:43], v198, s[16:19], s49 offen offset:768 sc1
    buffer_load_dwordx4 v[44:47], v198, s[16:19], s49 offen offset:784 sc1
    buffer_load_dwordx4 v[48:51], v198, s[16:19], s49 offen offset:1536 sc1
    buffer_load_dwordx4 v[52:55], v198, s[16:19], s49 offen offset:1552 sc1
    s_mov_b32 s49, 4723200
    buffer_load_dwordx4 v[220:223], v198, s[16:19], s49 offen offset:0 sc1
    buffer_load_dwordx4 v[224:227], v198, s[16:19], s49 offen offset:16 sc1
    buffer_load_dwordx4 v[228:231], v198, s[16:19], s49 offen offset:768 sc1
    buffer_load_dwordx4 v[232:235], v198, s[16:19], s49 offen offset:784 sc1
    buffer_load_dwordx4 v[236:239], v198, s[16:19], s49 offen offset:1536 sc1
    buffer_load_dwordx4 v[240:243], v198, s[16:19], s49 offen offset:1552 sc1
    s_waitcnt vmcnt(6)
    v_pk_fma_f32 v[156:157], v[156:157], v[64:65], v[32:33]
    v_pk_fma_f32 v[158:159], v[158:159], v[66:67], v[34:35]
    v_pk_fma_f32 v[160:161], v[160:161], v[68:69], v[36:37]
    v_pk_fma_f32 v[162:163], v[162:163], v[70:71], v[38:39]
    v_pk_fma_f32 v[164:165], v[164:165], v[72:73], v[40:41]
    v_pk_fma_f32 v[166:167], v[166:167], v[74:75], v[42:43]
    v_pk_fma_f32 v[168:169], v[168:169], v[76:77], v[44:45]
    v_pk_fma_f32 v[170:171], v[170:171], v[78:79], v[46:47]
    v_pk_fma_f32 v[172:173], v[172:173], v[80:81], v[48:49]
    v_pk_fma_f32 v[174:175], v[174:175], v[82:83], v[50:51]
    v_pk_fma_f32 v[176:177], v[176:177], v[84:85], v[52:53]
    v_pk_fma_f32 v[178:179], v[178:179], v[86:87], v[54:55]
    s_mov_b32 s49, 4727808
    buffer_load_dwordx4 v[64:67], v198, s[16:19], s49 offen offset:0 sc1
    buffer_load_dwordx4 v[68:71], v198, s[16:19], s49 offen offset:16 sc1
    buffer_load_dwordx4 v[72:75], v198, s[16:19], s49 offen offset:768 sc1
    buffer_load_dwordx4 v[76:79], v198, s[16:19], s49 offen offset:784 sc1
    buffer_load_dwordx4 v[80:83], v198, s[16:19], s49 offen offset:1536 sc1
    buffer_load_dwordx4 v[84:87], v198, s[16:19], s49 offen offset:1552 sc1
    s_mov_b32 s49, 4725504
    buffer_load_dwordx4 v[32:35], v198, s[16:19], s49 offen offset:0 sc1
    buffer_load_dwordx4 v[36:39], v198, s[16:19], s49 offen offset:16 sc1
    buffer_load_dwordx4 v[40:43], v198, s[16:19], s49 offen offset:768 sc1
    buffer_load_dwordx4 v[44:47], v198, s[16:19], s49 offen offset:784 sc1
    buffer_load_dwordx4 v[48:51], v198, s[16:19], s49 offen offset:1536 sc1
    buffer_load_dwordx4 v[52:55], v198, s[16:19], s49 offen offset:1552 sc1
    s_waitcnt vmcnt(12)
    v_pk_mul_f32 v[156:157], v[156:157], v[220:221]
    v_pk_mul_f32 v[158:159], v[158:159], v[222:223]
    v_pk_mul_f32 v[160:161], v[160:161], v[224:225]
    v_pk_mul_f32 v[162:163], v[162:163], v[226:227]
    v_pk_mul_f32 v[164:165], v[164:165], v[228:229]
    v_pk_mul_f32 v[166:167], v[166:167], v[230:231]
    v_pk_mul_f32 v[168:169], v[168:169], v[232:233]
    v_pk_mul_f32 v[170:171], v[170:171], v[234:235]
    v_pk_mul_f32 v[172:173], v[172:173], v[236:237]
    v_pk_mul_f32 v[174:175], v[174:175], v[238:239]
    v_pk_mul_f32 v[176:177], v[176:177], v[240:241]
    v_pk_mul_f32 v[178:179], v[178:179], v[242:243]
    s_lshl_b32 s3, s29, 6
    v_add_u32 v7, s3, v6
    s_waitcnt vmcnt(30)
    s_add_u32 m0, s34, 73728
    s_nop 0
    buffer_load_dwordx4 v7, s[4:7], s40 offen offset:0  lds
    buffer_load_dwordx4 v7, s[4:7], s41 offen offset:1024  lds
    buffer_load_dwordx4 v7, s[4:7], s42 offen offset:2048  lds
    buffer_load_dwordx4 v7, s[4:7], s43 offen offset:3072  lds
    s_add_u32 m0, s34, 77824
    s_nop 0
    buffer_load_dwordx4 v7, s[4:7], s44 offen offset:0  lds
    buffer_load_dwordx4 v7, s[4:7], s45 offen offset:1024  lds
    buffer_load_dwordx4 v7, s[4:7], s46 offen offset:2048  lds
    buffer_load_dwordx4 v7, s[4:7], s47 offen offset:3072  lds
    s_add_u32 m0, s34, 81920
    s_nop 0
    buffer_load_dwordx4 v7, s[4:7], s48 offen offset:0  lds
    s_add_u32 m0, s34, 110592
    s_nop 0
    buffer_load_dwordx4 v7, s[8:11], s40 offen offset:0  lds
    buffer_load_dwordx4 v7, s[8:11], s41 offen offset:1024  lds
    buffer_load_dwordx4 v7, s[8:11], s42 offen offset:2048  lds
    buffer_load_dwordx4 v7, s[8:11], s43 offen offset:3072  lds
    s_add_u32 m0, s34, 114688
    s_nop 0
    buffer_load_dwordx4 v7, s[8:11], s44 offen offset:0  lds
    buffer_load_dwordx4 v7, s[8:11], s45 offen offset:1024  lds
    buffer_load_dwordx4 v7, s[8:11], s46 offen offset:2048  lds
    buffer_load_dwordx4 v7, s[8:11], s47 offen offset:3072  lds
    s_add_u32 m0, s34, 118784
    s_nop 0
    buffer_load_dwordx4 v7, s[8:11], s48 offen offset:0  lds
    s_mov_b32 s69, 0
adaLN_cond__ssm_conv_h3__glu_gated_geglu__prompt_kernel_yc:
    buffer_load_dwordx2 v[88:89], v203, s[16:19], s36 offen sc1
    s_add_u32 s69, s69, 1
    s_waitcnt vmcnt(0)
    v_cmp_eq_u32 vcc, -1, v88
    s_cmp_ge_u32 s69, 400000
    s_cbranch_scc1 adaLN_cond__ssm_conv_h3__glu_gated_geglu__prompt_kernel_ycx
    s_cbranch_vccz adaLN_cond__ssm_conv_h3__glu_gated_geglu__prompt_kernel_ycx
    s_sleep 1
    s_branch adaLN_cond__ssm_conv_h3__glu_gated_geglu__prompt_kernel_yc
adaLN_cond__ssm_conv_h3__glu_gated_geglu__prompt_kernel_ycx:
adaLN_cond__ssm_conv_h3__glu_gated_geglu__prompt_kernel_ln:
    s_cmp_eq_u32 s24, 3
    s_cbranch_scc1 adaLN_cond__ssm_conv_h3__glu_gated_geglu__prompt_kernel_w3
    s_sub_u32 s3, 147712, s84
    v_add_u32 v196, s3, v196
    v_add_u32 v197, s3, v197
    s_mov_b32 s66, 0xffff0000
    s_mov_b32 s69, 0
adaLN_cond__ssm_conv_h3__glu_gated_geglu__prompt_kernel_ya:
    buffer_load_dwordx2 v[88:89], v203, s[16:19], s36 offen sc1
    buffer_load_dwordx2 v[90:91], v203, s[16:19], s36 offen offset:128 sc1
    buffer_load_dwordx2 v[92:93], v203, s[16:19], s37 offen sc1
    buffer_load_dwordx2 v[94:95], v203, s[16:19], s37 offen offset:128 sc1
    buffer_load_dwordx2 v[96:97], v203, s[16:19], s38 offen sc1
    buffer_load_dwordx2 v[98:99], v203, s[16:19], s38 offen offset:128 sc1
    s_add_u32 s69, s69, 1
    s_waitcnt vmcnt(0)
    v_max3_u32 v180, v88, v89, v90
    v_max3_u32 v181, v91, v92, v93
    v_max3_u32 v180, v180, v94, v95
    v_max3_u32 v181, v181, v96, v97
    v_max3_u32 v180, v180, v98, v99
    v_max_u32 v180, v180, v181
    v_cmp_eq_u32 vcc, -1, v180
    s_cmp_ge_u32 s69, 400000
    s_cbranch_scc1 adaLN_cond__ssm_conv_h3__glu_gated_geglu__prompt_kernel_yax
    s_nop 1
    s_cbranch_vccnz adaLN_cond__ssm_conv_h3__glu_gated_geglu__prompt_kernel_ya
adaLN_cond__ssm_conv_h3__glu_gated_geglu__prompt_kernel_yax:
    v_lshlrev_b32 v100, 16, v88
    v_and_b32 v101, s66, v88
    v_lshlrev_b32 v102, 16, v89
    v_and_b32 v103, s66, v89
    v_lshlrev_b32 v104, 16, v90
    v_and_b32 v105, s66, v90
    v_lshlrev_b32 v106, 16, v91
    v_and_b32 v107, s66, v91
    v_lshlrev_b32 v108, 16, v92
    v_and_b32 v109, s66, v92
    v_lshlrev_b32 v110, 16, v93
    v_and_b32 v111, s66, v93
    v_lshlrev_b32 v112, 16, v94
    v_and_b32 v113, s66, v94
    v_lshlrev_b32 v114, 16, v95
    v_and_b32 v115, s66, v95
    v_lshlrev_b32 v116, 16, v96
    v_and_b32 v117, s66, v96
    v_lshlrev_b32 v118, 16, v97
    v_and_b32 v119, s66, v97
    v_lshlrev_b32 v120, 16, v98
    v_and_b32 v121, s66, v98
    v_lshlrev_b32 v122, 16, v99
    v_and_b32 v123, s66, v99
    v_pk_fma_f32 v[156:157], v[156:157], v[100:101], v[132:133]
    v_pk_fma_f32 v[158:159], v[158:159], v[102:103], v[134:135]
    v_pk_fma_f32 v[160:161], v[160:161], v[104:105], v[136:137]
    v_pk_fma_f32 v[162:163], v[162:163], v[106:107], v[138:139]
    v_pk_fma_f32 v[164:165], v[164:165], v[108:109], v[140:141]
    v_pk_fma_f32 v[166:167], v[166:167], v[110:111], v[142:143]
    v_pk_fma_f32 v[168:169], v[168:169], v[112:113], v[144:145]
    v_pk_fma_f32 v[170:171], v[170:171], v[114:115], v[146:147]
    v_pk_fma_f32 v[172:173], v[172:173], v[116:117], v[148:149]
    v_pk_fma_f32 v[174:175], v[174:175], v[118:119], v[150:151]
    v_pk_fma_f32 v[176:177], v[176:177], v[120:121], v[152:153]
    v_pk_fma_f32 v[178:179], v[178:179], v[122:123], v[154:155]
    v_cvt_pk_bf16_f32 v208, v156, v157
    v_cvt_pk_bf16_f32 v209, v158, v159
    v_cvt_pk_bf16_f32 v210, v160, v161
    v_cvt_pk_bf16_f32 v211, v162, v163
    v_cvt_pk_bf16_f32 v212, v164, v165
    v_cvt_pk_bf16_f32 v213, v166, v167
    v_cvt_pk_bf16_f32 v214, v168, v169
    v_cvt_pk_bf16_f32 v215, v170, v171
    v_cvt_pk_bf16_f32 v216, v172, v173
    v_cvt_pk_bf16_f32 v217, v174, v175
    v_cvt_pk_bf16_f32 v218, v176, v177
    v_cvt_pk_bf16_f32 v219, v178, v179
    v_lshlrev_b32 v132, 16, v208
    v_and_b32 v133, s66, v208
    v_lshlrev_b32 v134, 16, v209
    v_and_b32 v135, s66, v209
    v_lshlrev_b32 v136, 16, v210
    v_and_b32 v137, s66, v210
    v_lshlrev_b32 v138, 16, v211
    v_and_b32 v139, s66, v211
    v_lshlrev_b32 v140, 16, v212
    v_and_b32 v141, s66, v212
    v_lshlrev_b32 v142, 16, v213
    v_and_b32 v143, s66, v213
    v_lshlrev_b32 v144, 16, v214
    v_and_b32 v145, s66, v214
    v_lshlrev_b32 v146, 16, v215
    v_and_b32 v147, s66, v215
    v_lshlrev_b32 v148, 16, v216
    v_and_b32 v149, s66, v216
    v_lshlrev_b32 v150, 16, v217
    v_and_b32 v151, s66, v217
    v_lshlrev_b32 v152, 16, v218
    v_and_b32 v153, s66, v218
    v_lshlrev_b32 v154, 16, v219
    v_and_b32 v155, s66, v219
    v_pk_add_f32 v[180:181], v[132:133], v[134:135]
    v_pk_mul_f32 v[182:183], v[132:133], v[132:133]
    v_pk_mul_f32 v[184:185], v[134:135], v[134:135]
    v_pk_add_f32 v[180:181], v[180:181], v[136:137]
    v_pk_fma_f32 v[182:183], v[136:137], v[136:137], v[182:183]
    v_pk_add_f32 v[180:181], v[180:181], v[138:139]
    v_pk_fma_f32 v[184:185], v[138:139], v[138:139], v[184:185]
    v_pk_add_f32 v[180:181], v[180:181], v[140:141]
    v_pk_fma_f32 v[182:183], v[140:141], v[140:141], v[182:183]
    v_pk_add_f32 v[180:181], v[180:181], v[142:143]
    v_pk_fma_f32 v[184:185], v[142:143], v[142:143], v[184:185]
    v_pk_add_f32 v[180:181], v[180:181], v[144:145]
    v_pk_fma_f32 v[182:183], v[144:145], v[144:145], v[182:183]
    v_pk_add_f32 v[180:181], v[180:181], v[146:147]
    v_pk_fma_f32 v[184:185], v[146:147], v[146:147], v[184:185]
    v_pk_add_f32 v[180:181], v[180:181], v[148:149]
    v_pk_fma_f32 v[182:183], v[148:149], v[148:149], v[182:183]
    v_pk_add_f32 v[180:181], v[180:181], v[150:151]
    v_pk_fma_f32 v[184:185], v[150:151], v[150:151], v[184:185]
    v_pk_add_f32 v[180:181], v[180:181], v[152:153]
    v_pk_fma_f32 v[182:183], v[152:153], v[152:153], v[182:183]
    v_pk_add_f32 v[180:181], v[180:181], v[154:155]
    v_pk_fma_f32 v[184:185], v[154:155], v[154:155], v[184:185]
    v_pk_add_f32 v[182:183], v[182:183], v[184:185]
    v_add_f32 v180, v180, v181
    v_add_f32 v181, v182, v183
    s_nop 0
    v_add_f32 v180, v180, v180 row_ror:8
    v_add_f32 v181, v181, v181 row_ror:8
    v_mov_b32 v182, v180
    v_mov_b32 v183, v181
    s_nop 0
    v_permlane16_swap_b32 v180, v182
    v_permlane16_swap_b32 v181, v183
    v_pk_add_f32 v[180:181], v[180:181], v[182:183]
    v_mov_b32 v182, v180
    v_mov_b32 v183, v181
    s_nop 0
    v_permlane32_swap_b32 v180, v182
    v_permlane32_swap_b32 v181, v183
    v_pk_add_f32 v[180:181], v[180:181], v[182:183]
    ds_write_b64 v196, v[180:181]
    s_waitcnt lgkmcnt(0)
    s_barrier
    ds_read_b64 v[184:185], v197 offset:0
    ds_read_b64 v[186:187], v197 offset:64
    ds_read_b64 v[188:189], v197 offset:128
    s_mov_b32 s3, 0x3ae38e39
    s_waitcnt lgkmcnt(0)
    v_pk_add_f32 v[184:185], v[184:185], v[186:187]
    v_pk_add_f32 v[184:185], v[184:185], v[188:189]
    v_mul_f32 v206, s3, v184
    v_mul_f32 v207, s3, v185
    v_fma_f32 v207, -v206, v206, v207
    v_max_f32 v207, 0, v207
    v_add_f32 v207, 0x3727c5ac, v207
    v_rsq_f32 v207, v207
    v_mul_f32 v206, -1.0, v206
    v_mul_f32 v206, v206, v207
    v_pk_fma_f32 v[156:157], v[132:133], v[206:207], v[206:207] op_sel:[0,1,0] op_sel_hi:[1,1,0]
    v_pk_fma_f32 v[158:159], v[134:135], v[206:207], v[206:207] op_sel:[0,1,0] op_sel_hi:[1,1,0]
    v_pk_fma_f32 v[160:161], v[136:137], v[206:207], v[206:207] op_sel:[0,1,0] op_sel_hi:[1,1,0]
    v_pk_fma_f32 v[162:163], v[138:139], v[206:207], v[206:207] op_sel:[0,1,0] op_sel_hi:[1,1,0]
    v_pk_fma_f32 v[156:157], v[156:157], v[64:65], v[32:33]
    v_pk_fma_f32 v[158:159], v[158:159], v[66:67], v[34:35]
    v_pk_fma_f32 v[160:161], v[160:161], v[68:69], v[36:37]
    v_pk_fma_f32 v[162:163], v[162:163], v[70:71], v[38:39]
    v_cvt_pk_bf16_f32 v88, v156, v157
    v_cvt_pk_bf16_f32 v89, v158, v159
    v_cvt_pk_bf16_f32 v90, v160, v161
    v_cvt_pk_bf16_f32 v91, v162, v163
    v_min_u32 v88, 0xfffffffe, v88
    s_add_u32 s3, s36, 2621440
    buffer_store_dwordx4 v[88:91], v204, s[16:19], s3 offen sc1
    v_pk_fma_f32 v[164:165], v[140:141], v[206:207], v[206:207] op_sel:[0,1,0] op_sel_hi:[1,1,0]
    v_pk_fma_f32 v[166:167], v[142:143], v[206:207], v[206:207] op_sel:[0,1,0] op_sel_hi:[1,1,0]
    v_pk_fma_f32 v[168:169], v[144:145], v[206:207], v[206:207] op_sel:[0,1,0] op_sel_hi:[1,1,0]
    v_pk_fma_f32 v[170:171], v[146:147], v[206:207], v[206:207] op_sel:[0,1,0] op_sel_hi:[1,1,0]
    v_pk_fma_f32 v[164:165], v[164:165], v[72:73], v[40:41]
    v_pk_fma_f32 v[166:167], v[166:167], v[74:75], v[42:43]
    v_pk_fma_f32 v[168:169], v[168:169], v[76:77], v[44:45]
    v_pk_fma_f32 v[170:171], v[170:171], v[78:79], v[46:47]
    v_cvt_pk_bf16_f32 v92, v164, v165
    v_cvt_pk_bf16_f32 v93, v166, v167
    v_cvt_pk_bf16_f32 v94, v168, v169
    v_cvt_pk_bf16_f32 v95, v170, v171
    v_min_u32 v92, 0xfffffffe, v92
    s_add_u32 s3, s37, 2621440
    buffer_store_dwordx4 v[92:95], v204, s[16:19], s3 offen sc1
    v_pk_fma_f32 v[172:173], v[148:149], v[206:207], v[206:207] op_sel:[0,1,0] op_sel_hi:[1,1,0]
    v_pk_fma_f32 v[174:175], v[150:151], v[206:207], v[206:207] op_sel:[0,1,0] op_sel_hi:[1,1,0]
    v_pk_fma_f32 v[176:177], v[152:153], v[206:207], v[206:207] op_sel:[0,1,0] op_sel_hi:[1,1,0]
    v_pk_fma_f32 v[178:179], v[154:155], v[206:207], v[206:207] op_sel:[0,1,0] op_sel_hi:[1,1,0]
    v_pk_fma_f32 v[172:173], v[172:173], v[80:81], v[48:49]
    v_pk_fma_f32 v[174:175], v[174:175], v[82:83], v[50:51]
    v_pk_fma_f32 v[176:177], v[176:177], v[84:85], v[52:53]
    v_pk_fma_f32 v[178:179], v[178:179], v[86:87], v[54:55]
    v_cvt_pk_bf16_f32 v96, v172, v173
    v_cvt_pk_bf16_f32 v97, v174, v175
    v_cvt_pk_bf16_f32 v98, v176, v177
    v_cvt_pk_bf16_f32 v99, v178, v179
    v_min_u32 v96, 0xfffffffe, v96
    s_add_u32 s3, s38, 2621440
    buffer_store_dwordx4 v[96:99], v204, s[16:19], s3 offen sc1
    s_add_u32 s3, s36, 4980736
    buffer_store_dwordx2 v[208:209], v203, s[16:19], s3 offen sc1
    buffer_store_dwordx2 v[210:211], v203, s[16:19], s3 offen offset:128 sc1
    s_add_u32 s3, s37, 4980736
    buffer_store_dwordx2 v[212:213], v203, s[16:19], s3 offen sc1
    buffer_store_dwordx2 v[214:215], v203, s[16:19], s3 offen offset:128 sc1
    s_add_u32 s3, s38, 4980736
    buffer_store_dwordx2 v[216:217], v203, s[16:19], s3 offen sc1
    buffer_store_dwordx2 v[218:219], v203, s[16:19], s3 offen offset:128 sc1
    s_barrier
    v_min_u32 v244, 23, v205
    v_mul_u32_u24 v245, 43691, v244
    v_lshrrev_b32 v245, 17, v245
    v_mul_u32_u24 v247, 3, v245
    v_sub_u32 v244, v244, v247
    s_lshl_b32 s3, s24, 3
    v_add_u32 v245, s3, v245
    v_and_b32 v247, 3, v245
    v_lshrrev_b32 v245, 2, v245
    s_and_b32 s3, s26, 28
    v_add_u32 v247, s3, v247
    v_lshl_add_u32 v245, v247, 3, v245
    v_lshl_add_u32 v245, v245, 2, v244
    v_mul_u32_u24 v12, 32, v245
    s_lshr_b32 s3, s26, 2
    s_lshl_b32 s3, s3, 4
    s_lshl_b32 s49, s24, 2
    s_add_u32 s3, s3, s49
    s_lshl_b32 s49, s27, 1
    s_xor_b32 s66, s49, 0
    s_add_u32 s66, s66, s3
    s_mul_i32 s50, s66, 18432
    s_add_u32 s50, s50, 4980736
    s_mul_i32 s54, s66, 147456
    s_add_u32 s54, s54, 9699328
    s_xor_b32 s66, s49, 1
    s_add_u32 s66, s66, s3
    s_mul_i32 s51, s66, 18432
    s_add_u32 s51, s51, 4980736
    s_mul_i32 s55, s66, 147456
    s_add_u32 s55, s55, 9699328
    s_xor_b32 s66, s49, 2
    s_add_u32 s66, s66, s3
    s_mul_i32 s52, s66, 18432
    s_add_u32 s52, s52, 4980736
    s_mul_i32 s56, s66, 147456
    s_add_u32 s56, s56, 9699328
    s_xor_b32 s66, s49, 3
    s_add_u32 s66, s66, s3
    s_mul_i32 s53, s66, 18432
    s_add_u32 s53, s53, 4980736
    s_mul_i32 s57, s66, 147456
    s_add_u32 s57, s57, 9699328
    v_lshrrev_b32 v244, 4, v205
    v_bfe_u32 v245, v205, 2, 2
    v_lshl_add_u32 v245, v244, 3, v245
    v_lshlrev_b32 v245, 6, v245
    v_and_b32 v247, 3, v205
    v_lshl_add_u32 v245, v247, 3, v245
    v_and_b32 v244, 1, v244
    v_lshl_add_u32 v2, v244, 5, v245
    v_xor_b32 v3, 32, v2
    v_add_u32 v4, 36864, v2
    v_add_u32 v5, 36864, v3
    v_add_u32 v56, 73728, v2
    v_add_u32 v57, 73728, v3
    v_add_u32 v58, 110592, v2
    v_add_u32 v59, 110592, v3
    v_mov_b32 v10, 0xbdd2d3e8
    s_mov_b32 s35, 0xc0135761
    v_add_u32 v24, 4096, v9
    v_add_u32 v25, 8192, v9
    v_add_u32 v26, 12288, v9
    v_add_u32 v27, 16384, v9
    s_lshl_b32 s3, s28, 10
    v_add_u32 v8, s3, v9
    s_lshl_b32 s3, s33, 3
    s_or_b32 s3, s3, 0x80000
    s_mul_i32 s49, s25, 18
    s_bfe_u32 s74, 252380929, s3
    s_add_u32 s74, s74, s49
    s_bfe_u32 s82, 269223170, s3
    s_add_u32 s82, s82, s49
    s_bfe_u32 s83, 285804547, s3
    s_add_u32 s83, s83, s49
    s_lshl_b32 s3, s74, 6
    v_add_u32 v7, s3, v6
    s_branch adaLN_cond__ssm_conv_h3__glu_gated_geglu__prompt_kernel_lnj
adaLN_cond__ssm_conv_h3__glu_gated_geglu__prompt_kernel_w3:
    s_mul_i32 s3, s24, 1327104
    v_subrev_u32 v196, s3, v6
    s_lshl_b32 s3, s29, 6
    v_add_u32 v196, s3, v196
    v_min_u32 v244, 23, v205
    v_mul_u32_u24 v245, 43691, v244
    v_lshrrev_b32 v245, 17, v245
    v_mul_u32_u24 v247, 3, v245
    v_sub_u32 v244, v244, v247
    s_lshl_b32 s3, s24, 3
    v_add_u32 v245, s3, v245
    v_and_b32 v247, 3, v245
    v_lshrrev_b32 v245, 2, v245
    s_and_b32 s3, s26, 28
    v_add_u32 v247, s3, v247
    v_lshl_add_u32 v245, v247, 3, v245
    v_lshl_add_u32 v245, v245, 2, v244
    v_mul_u32_u24 v12, 32, v245
    s_lshr_b32 s3, s26, 2
    s_lshl_b32 s3, s3, 4
    s_lshl_b32 s49, s24, 2
    s_add_u32 s3, s3, s49
    s_lshl_b32 s49, s27, 1
    s_xor_b32 s66, s49, 0
    s_add_u32 s66, s66, s3
    s_mul_i32 s50, s66, 18432
    s_add_u32 s50, s50, 4980736
    s_mul_i32 s54, s66, 147456
    s_add_u32 s54, s54, 9699328
    s_xor_b32 s66, s49, 1
    s_add_u32 s66, s66, s3
    s_mul_i32 s51, s66, 18432
    s_add_u32 s51, s51, 4980736
    s_mul_i32 s55, s66, 147456
    s_add_u32 s55, s55, 9699328
    s_xor_b32 s66, s49, 2
    s_add_u32 s66, s66, s3
    s_mul_i32 s52, s66, 18432
    s_add_u32 s52, s52, 4980736
    s_mul_i32 s56, s66, 147456
    s_add_u32 s56, s56, 9699328
    s_xor_b32 s66, s49, 3
    s_add_u32 s66, s66, s3
    s_mul_i32 s53, s66, 18432
    s_add_u32 s53, s53, 4980736
    s_mul_i32 s57, s66, 147456
    s_add_u32 s57, s57, 9699328
    v_lshrrev_b32 v244, 4, v205
    v_bfe_u32 v245, v205, 2, 2
    v_lshl_add_u32 v245, v244, 3, v245
    v_lshlrev_b32 v245, 6, v245
    v_and_b32 v247, 3, v205
    v_lshl_add_u32 v245, v247, 3, v245
    v_and_b32 v244, 1, v244
    v_lshl_add_u32 v2, v244, 5, v245
    v_xor_b32 v3, 32, v2
    v_add_u32 v4, 36864, v2
    v_add_u32 v5, 36864, v3
    v_add_u32 v56, 73728, v2
    v_add_u32 v57, 73728, v3
    v_add_u32 v58, 110592, v2
    v_add_u32 v59, 110592, v3
    v_mov_b32 v10, 0xbdd2d3e8
    s_mov_b32 s35, 0xc0135761
    v_add_u32 v24, 4096, v9
    v_add_u32 v25, 8192, v9
    v_add_u32 v26, 12288, v9
    v_add_u32 v27, 16384, v9
    s_lshl_b32 s3, s28, 10
    v_add_u32 v8, s3, v9
    s_lshl_b32 s3, s33, 3
    s_or_b32 s3, s3, 0x80000
    s_mul_i32 s49, s25, 18
    s_bfe_u32 s74, 252380929, s3
    s_add_u32 s74, s74, s49
    s_bfe_u32 s82, 269223170, s3
    s_add_u32 s82, s82, s49
    s_bfe_u32 s83, 285804547, s3
    s_add_u32 s83, s83, s49
    s_lshl_b32 s3, s74, 6
    v_add_u32 v7, s3, v6
    s_cmp_lt_u32 s2, 144
    s_cbranch_scc1 adaLN_cond__ssm_conv_h3__glu_gated_geglu__prompt_kernel_w3c
    s_barrier
    s_barrier
    s_branch adaLN_cond__ssm_conv_h3__glu_gated_geglu__prompt_kernel_lnj
adaLN_cond__ssm_conv_h3__glu_gated_geglu__prompt_kernel_w3c:
    s_barrier
    s_mov_b32 m0, 110592
    s_mov_b32 s3, 0
    buffer_load_dwordx4 v196, s[8:11], s3 offen  lds
    s_mov_b32 m0, 111616
    s_mov_b32 s3, 147456
    buffer_load_dwordx4 v196, s[8:11], s3 offen  lds
    s_mov_b32 m0, 112640
    s_mov_b32 s3, 294912
    buffer_load_dwordx4 v196, s[8:11], s3 offen  lds
    s_mov_b32 m0, 113664
    s_mov_b32 s3, 442368
    buffer_load_dwordx4 v196, s[8:11], s3 offen  lds
    s_mov_b32 m0, 114688
    s_mov_b32 s3, 589824
    buffer_load_dwordx4 v196, s[8:11], s3 offen  lds
    s_mov_b32 m0, 115712
    s_mov_b32 s3, 737280
    buffer_load_dwordx4 v196, s[8:11], s3 offen  lds
    s_mov_b32 m0, 116736
    s_mov_b32 s3, 884736
    buffer_load_dwordx4 v196, s[8:11], s3 offen  lds
    s_mov_b32 m0, 117760
    s_mov_b32 s3, 1032192
    buffer_load_dwordx4 v196, s[8:11], s3 offen  lds
    s_mov_b32 m0, 118784
    s_mov_b32 s3, 1179648
    buffer_load_dwordx4 v196, s[8:11], s3 offen  lds
    s_mov_b32 m0, 119808
    s_mov_b32 s3, 1327104
    buffer_load_dwordx4 v196, s[8:11], s3 offen  lds
    s_mov_b32 m0, 120832
    s_mov_b32 s3, 1474560
    buffer_load_dwordx4 v196, s[8:11], s3 offen  lds
    s_mov_b32 m0, 121856
    s_mov_b32 s3, 1622016
    buffer_load_dwordx4 v196, s[8:11], s3 offen  lds
    s_barrier
    s_mov_b32 m0, 122880
    s_mov_b32 s3, 1769472
    buffer_load_dwordx4 v196, s[8:11], s3 offen  lds
    s_mov_b32 m0, 123904
    s_mov_b32 s3, 1916928
    buffer_load_dwordx4 v196, s[8:11], s3 offen  lds
    s_mov_b32 m0, 124928
    s_mov_b32 s3, 2064384
    buffer_load_dwordx4 v196, s[8:11], s3 offen  lds
    s_mov_b32 m0, 125952
    s_mov_b32 s3, 2211840
    buffer_load_dwordx4 v196, s[8:11], s3 offen  lds
    s_mov_b32 m0, 126976
    s_mov_b32 s3, 2359296
    buffer_load_dwordx4 v196, s[8:11], s3 offen  lds
    s_mov_b32 m0, 128000
    s_mov_b32 s3, 2506752
    buffer_load_dwordx4 v196, s[8:11], s3 offen  lds
    s_mov_b32 m0, 129024
    s_mov_b32 s3, 2654208
    buffer_load_dwordx4 v196, s[8:11], s3 offen  lds
    s_mov_b32 m0, 130048
    s_mov_b32 s3, 2801664
    buffer_load_dwordx4 v196, s[8:11], s3 offen  lds
    s_mov_b32 m0, 131072
    s_mov_b32 s3, 2949120
    buffer_load_dwordx4 v196, s[8:11], s3 offen  lds
    s_mov_b32 m0, 132096
    s_mov_b32 s3, 3096576
    buffer_load_dwordx4 v196, s[8:11], s3 offen  lds
    s_mov_b32 m0, 133120
    s_mov_b32 s3, 3244032
    buffer_load_dwordx4 v196, s[8:11], s3 offen  lds
    s_mov_b32 m0, 134144
    s_mov_b32 s3, 3391488
    buffer_load_dwordx4 v196, s[8:11], s3 offen  lds
    s_mov_b32 m0, 135168
    s_mov_b32 s3, 3538944
    buffer_load_dwordx4 v196, s[8:11], s3 offen  lds
    s_mov_b32 m0, 136192
    s_mov_b32 s3, 3686400
    buffer_load_dwordx4 v196, s[8:11], s3 offen  lds
    s_mov_b32 m0, 137216
    s_mov_b32 s3, 3833856
    buffer_load_dwordx4 v196, s[8:11], s3 offen  lds
    s_mov_b32 m0, 138240
    s_mov_b32 s3, 3981312
    buffer_load_dwordx4 v196, s[8:11], s3 offen  lds
    s_mov_b32 m0, 139264
    s_mov_b32 s3, 4128768
    buffer_load_dwordx4 v196, s[8:11], s3 offen  lds
    s_mov_b32 m0, 140288
    s_mov_b32 s3, 4276224
    buffer_load_dwordx4 v196, s[8:11], s3 offen  lds
    s_mov_b32 m0, 141312
    s_mov_b32 s3, 4423680
    buffer_load_dwordx4 v196, s[8:11], s3 offen  lds
    s_mov_b32 m0, 142336
    s_mov_b32 s3, 4571136
    buffer_load_dwordx4 v196, s[8:11], s3 offen  lds
    s_waitcnt vmcnt(36)
    s_mov_b32 m0, 143360
    s_mov_b32 s3, 4718592
    buffer_load_dwordx4 v196, s[8:11], s3 offen  lds
    s_mov_b32 m0, 144384
    s_mov_b32 s3, 4866048
    buffer_load_dwordx4 v196, s[8:11], s3 offen  lds
    s_mov_b32 m0, 145408
    s_mov_b32 s3, 5013504
    buffer_load_dwordx4 v196, s[8:11], s3 offen  lds
    s_mov_b32 m0, 146432
    s_mov_b32 s3, 5160960
    buffer_load_dwordx4 v196, s[8:11], s3 offen  lds
adaLN_cond__ssm_conv_h3__glu_gated_geglu__prompt_kernel_lnj:
    s_and_b32 s3, s26, 28
    s_add_u32 s3, s3, s24
    s_mul_i32 s3, s3, 54
    v_min_u32 v247, 53, v205
    v_add_u32 v247, s3, v247
    v_mul_u32_u24 v244, 43691, v247
    v_lshrrev_b32 v244, 17, v244
    v_mul_u32_u24 v245, 3, v244
    v_sub_u32 v247, v247, v245
    v_mul_u32_u24 v244, 9216, v244
    v_lshl_add_u32 v247, v247, 7, v244
    s_lshl_b32 s3, s27, 2
    s_add_u32 s3, s3, s28
    s_sub_u32 s3, s3, 4
    s_lshr_b32 s3, s3, 1
    s_lshl_b32 s3, s3, 7
    v_add_u32 v149, s3, v247
    s_lshr_b32 s30, s25, 1
    s_lshr_b32 s32, s24, 1
    s_and_b32 s3, s25, 1
    s_lshl_b32 s3, s3, 3
    s_lshr_b32 s49, s26, 2
    s_add_u32 s68, s3, s49
    s_lshl_b32 s3, s68, 3
    s_lshl_b32 s49, s24, 1
    s_add_u32 s31, s3, s49
    s_mul_i32 s3, s31, 147456
    s_mul_i32 s49, s30, 36864
    s_add_u32 s3, s3, s49
    s_add_u32 s62, s3, 9699328
    s_add_u32 s63, s3, 9846784
    s_add_u32 s64, s3, 9717760
    s_add_u32 s65, s3, 9865216
    s_mul_i32 s39, s30, 1327104
    s_mul_i32 s3, s32, 663552
    s_add_u32 s75, s39, s3
    s_mov_b32 s49, 238609295
    s_mul_i32 s66, s33, 288
    s_lshl_b32 s3, s30, 2
    v_add_u32 v244, 0, v205
    v_mul_hi_u32 v245, v244, s49
    v_mul_u32_u24 v246, 18, v245
    v_sub_u32 v244, v244, v246
    v_xor_b32 v246, s3, v244
    v_cmp_gt_u32 vcc, 16, v244
    v_mul_u32_u24 v245, 1152, v245
    s_nop 0
    v_cndmask_b32 v244, v244, v246, vcc
    v_lshl_add_u32 v245, v244, 4, v245
    v_add_u32 v150, s66, v245
    v_add_u32 v244, 64, v205
    v_mul_hi_u32 v245, v244, s49
    v_mul_u32_u24 v246, 18, v245
    v_sub_u32 v244, v244, v246
    v_xor_b32 v246, s3, v244
    v_cmp_gt_u32 vcc, 16, v244
    v_mul_u32_u24 v245, 1152, v245
    s_nop 0
    v_cndmask_b32 v244, v244, v246, vcc
    v_lshl_add_u32 v245, v244, 4, v245
    v_add_u32 v151, s66, v245
    v_add_u32 v244, 128, v205
    v_mul_hi_u32 v245, v244, s49
    v_mul_u32_u24 v246, 18, v245
    v_sub_u32 v244, v244, v246
    v_xor_b32 v246, s3, v244
    v_cmp_gt_u32 vcc, 16, v244
    v_mul_u32_u24 v245, 1152, v245
    s_nop 0
    v_cndmask_b32 v244, v244, v246, vcc
    v_lshl_add_u32 v245, v244, 4, v245
    v_add_u32 v152, s66, v245
    v_add_u32 v244, 192, v205
    v_mul_hi_u32 v245, v244, s49
    v_mul_u32_u24 v246, 18, v245
    v_sub_u32 v244, v244, v246
    v_xor_b32 v246, s3, v244
    v_cmp_gt_u32 vcc, 16, v244
    v_mul_u32_u24 v245, 1152, v245
    s_nop 0
    v_cndmask_b32 v244, v244, v246, vcc
    v_lshl_add_u32 v245, v244, 4, v245
    v_add_u32 v153, s66, v245
    v_add_u32 v244, 256, v205
    v_mul_hi_u32 v245, v244, s49
    v_mul_u32_u24 v246, 18, v245
    v_sub_u32 v244, v244, v246
    v_xor_b32 v246, s3, v244
    v_cmp_gt_u32 vcc, 16, v244
    v_mul_u32_u24 v245, 1152, v245
    s_nop 0
    v_cndmask_b32 v244, v244, v246, vcc
    v_lshl_add_u32 v245, v244, 4, v245
    v_add_u32 v154, s66, v245
    v_add_u32 v244, 320, v205
    v_mul_hi_u32 v245, v244, s49
    v_mul_u32_u24 v246, 18, v245
    v_sub_u32 v244, v244, v246
    v_xor_b32 v246, s3, v244
    v_cmp_gt_u32 vcc, 16, v244
    v_mul_u32_u24 v245, 1152, v245
    s_nop 0
    v_cndmask_b32 v244, v244, v246, vcc
    v_lshl_add_u32 v245, v244, 4, v245
    v_add_u32 v155, s66, v245
    v_add_u32 v244, 384, v205
    v_mul_hi_u32 v245, v244, s49
    v_mul_u32_u24 v246, 18, v245
    v_sub_u32 v244, v244, v246
    v_xor_b32 v246, s3, v244
    v_cmp_gt_u32 vcc, 16, v244
    v_mul_u32_u24 v245, 1152, v245
    s_nop 0
    v_cndmask_b32 v244, v244, v246, vcc
    v_lshl_add_u32 v245, v244, 4, v245
    v_add_u32 v156, s66, v245
    v_add_u32 v244, 448, v205
    v_mul_hi_u32 v245, v244, s49
    v_mul_u32_u24 v246, 18, v245
    v_sub_u32 v244, v244, v246
    v_xor_b32 v246, s3, v244
    v_cmp_gt_u32 vcc, 16, v244
    v_mul_u32_u24 v245, 1152, v245
    s_nop 0
    v_cndmask_b32 v244, v244, v246, vcc
    v_lshl_add_u32 v245, v244, 4, v245
    v_add_u32 v157, s66, v245
    v_add_u32 v244, 512, v205
    v_mul_hi_u32 v245, v244, s49
    v_mul_u32_u24 v246, 18, v245
    v_sub_u32 v244, v244, v246
    v_xor_b32 v246, s3, v244
    v_cmp_gt_u32 vcc, 16, v244
    v_mul_u32_u24 v245, 1152, v245
    s_nop 0
    v_cndmask_b32 v244, v244, v246, vcc
    v_lshl_add_u32 v245, v244, 4, v245
    v_add_u32 v158, s66, v245
    s_lshl_b32 s3, s26, 2
    s_add_u32 s3, s3, s24
    s_mul_i32 s3, s3, 3456
    s_add_u32 s3, s3, s39
    v_min_u32 v244, 26, v205
    v_lshl_add_u32 v62, v244, 7, s3
    v_lshrrev_b32 v244, 2, v205
    v_mul_u32_u24 v244, 288, v244
    v_and_b32 v245, 3, v205
    v_lshl_add_u32 v244, v245, 3, v244
    v_add_u32 v14, 0, v244
    v_add_u32 v15, 36864, v244
    v_add_u32 v144, 73728, v244
    v_add_u32 v145, 110592, v244
    v_and_b32 v244, 3, v205
    s_lshr_b32 s3, s68, 1
    s_lshl_b32 s3, s3, 2
    v_add_u32 v245, s3, v244
    v_bfe_u32 v244, v205, 2, 1
    s_lshl_b32 s3, s30, 1
    v_add_u32 v244, s3, v244
    v_lshl_add_u32 v245, v245, 3, v244
    s_and_b32 s3, s68, 1
    s_lshl_b32 s3, s3, 1
    s_add_u32 s3, s3, s32
    v_lshl_add_u32 v245, v245, 2, s3
    s_mov_b32 s59, 4816896
    v_mul_u32_u24 v60, 32, v245
    s_and_b32 s3, s26, 28
    s_add_u32 s3, s3, s24
    s_mul_i32 s3, s3, 18
    v_min_u32 v244, 17, v205
    v_add_u32 v244, s3, v244
    v_mul_u32_u24 v244, 9216, v244
    v_mov_b32 v146, v244
    s_lshl_b32 s78, s82, 6
    s_lshl_b32 s79, s83, 6
    v_mov_b32 v148, s70
    v_min_u32 v159, 47, v205
    v_lshlrev_b32 v159, 8, v159
    s_mov_b32 s49, 4784128
    v_min_u32 v244, 11, v205
    v_mul_u32_u24 v245, 43691, v244
    v_lshrrev_b32 v245, 17, v245
    v_mul_u32_u24 v246, 3, v245
    v_sub_u32 v244, v244, v246
    v_lshlrev_b32 v244, 11, v244
    v_and_b32 v246, 1, v245
    v_lshl_add_u32 v244, v246, 7, v244
    v_lshrrev_b32 v245, 1, v245
    v_mul_u32_u24 v245, 18432, v245
    v_add_u32 v244, v244, v245
    s_min_u32 s49, s50, s50
    s_add_u32 s49, s49, 14080
    v_add_u32 v244, s49, v244
    v_bfe_u32 v245, v205, 2, 3
    s_lshl_b32 s3, s24, 3
    v_add_u32 v245, s3, v245
    v_and_b32 v246, 3, v245
    v_lshrrev_b32 v245, 2, v245
    s_and_b32 s3, s26, 28
    v_add_u32 v246, s3, v246
    v_lshl_add_u32 v245, v246, 3, v245
    v_and_b32 v246, 3, v205
    v_lshl_add_u32 v245, v245, 2, v246
    v_mul_u32_u24 v245, 32, v245
    v_add_u32 v245, 4849664, v245
    v_cmp_gt_u32 vcc, 32, v205
    s_not_b32 s3, s70
    v_mov_b32 v246, s3
    v_cndmask_b32 v244, v245, v244, vcc
    v_mov_b32 v247, 0
    v_cndmask_b32 v246, v246, v247, vcc
    s_mov_b32 s76, 0
    s_mov_b32 s77, -1
    s_mov_b32 s69, 0
adaLN_cond__ssm_conv_h3__glu_gated_geglu__prompt_kernel_p3:
    buffer_load_dword v11, v244, s[16:19], 0 offen sc1
    s_add_u32 s69, s69, 1
    s_waitcnt vmcnt(0)
    v_xor_b32 v11, v11, v246
    v_cmp_eq_u32 vcc, -1, v11
    s_nop 1
    s_xor_b64 vcc, vcc, s[76:77]
    s_cmp_ge_u32 s69, 400000
    s_cbranch_scc1 adaLN_cond__ssm_conv_h3__glu_gated_geglu__prompt_kernel_p3x
    s_nop 1
    s_cbranch_vccnz adaLN_cond__ssm_conv_h3__glu_gated_geglu__prompt_kernel_p3
adaLN_cond__ssm_conv_h3__glu_gated_geglu__prompt_kernel_p3x:
    buffer_load_dwordx4 a[0:3], v9, s[16:19], s50 offen offset:0 sc1
    buffer_load_dwordx4 a[4:7], v9, s[16:19], s51 offen offset:0 sc1
    buffer_load_dwordx4 a[16:19], v9, s[16:19], s50 offen offset:1024 sc1
    buffer_load_dwordx4 a[20:23], v9, s[16:19], s51 offen offset:1024 sc1
    buffer_load_dwordx4 a[32:35], v9, s[16:19], s50 offen offset:2048 sc1
    buffer_load_dwordx4 a[36:39], v9, s[16:19], s51 offen offset:2048 sc1
    buffer_load_dwordx4 a[48:51], v9, s[16:19], s50 offen offset:3072 sc1
    buffer_load_dwordx4 a[52:55], v9, s[16:19], s51 offen offset:3072 sc1
    buffer_load_dwordx4 a[64:67], v24, s[16:19], s50 offen offset:0 sc1
    buffer_load_dwordx4 a[68:71], v24, s[16:19], s51 offen offset:0 sc1
    buffer_load_dwordx4 a[80:83], v24, s[16:19], s50 offen offset:1024 sc1
    buffer_load_dwordx4 a[84:87], v24, s[16:19], s51 offen offset:1024 sc1
    s_barrier
    ds_read_b64_tr_b16 v[32:33], v2 offset:0
    ds_read_b64_tr_b16 v[34:35], v2 offset:256
    ds_read_b64_tr_b16 v[36:37], v2 offset:2048
    ds_read_b64_tr_b16 v[38:39], v2 offset:2304
    ds_read_b64_tr_b16 v[40:41], v4 offset:0
    ds_read_b64_tr_b16 v[42:43], v4 offset:256
    ds_read_b64_tr_b16 v[44:45], v4 offset:2048
    ds_read_b64_tr_b16 v[46:47], v4 offset:2304
    s_waitcnt vmcnt(8) lgkmcnt(4)
    v_accvgpr_read_b32 v176, a0
    v_accvgpr_read_b32 v177, a4
    v_accvgpr_read_b32 v178, a16
    v_accvgpr_read_b32 v179, a20
    v_max3_u32 v176, v176, v177, v178
    v_max_u32 v176, v176, v179
    v_cmp_eq_u32 vcc, -1, v176
    s_nop 1
    s_cbranch_vccnz adaLN_cond__ssm_conv_h3__glu_gated_geglu__prompt_kernel_bc0_0
adaLN_cond__ssm_conv_h3__glu_gated_geglu__prompt_kernel_bc0_0b:
    v_mfma_f32_16x16x32_bf16 v[64:67], v[32:35], a[0:3], 0
    ds_read_b64_tr_b16 v[48:49], v56 offset:0
    v_mfma_f32_16x16x32_bf16 v[64:67], v[36:39], a[16:19], v[64:67]
    buffer_load_dwordx4 a[96:99], v24, s[16:19], s50 offen offset:2048 sc1
    ds_read_b64_tr_b16 v[50:51], v56 offset:256
    v_mfma_f32_16x16x32_bf16 v[68:71], v[32:35], a[4:7], 0
    ds_read_b64_tr_b16 v[52:53], v56 offset:2048
    v_mfma_f32_16x16x32_bf16 v[68:71], v[36:39], a[20:23], v[68:71]
    s_waitcnt lgkmcnt(3)
    ds_read_b64_tr_b16 v[54:55], v56 offset:2304
    v_mfma_f32_16x16x32_bf16 v[80:83], v[40:43], a[0:3], 0
    ds_read_b64_tr_b16 v[32:33], v58 offset:0
    v_mfma_f32_16x16x32_bf16 v[80:83], v[44:47], a[16:19], v[80:83]
    buffer_load_dwordx4 a[100:103], v24, s[16:19], s51 offen offset:2048 sc1
    ds_read_b64_tr_b16 v[34:35], v58 offset:256
    v_mfma_f32_16x16x32_bf16 v[84:87], v[40:43], a[4:7], 0
    ds_read_b64_tr_b16 v[36:37], v58 offset:2048
    v_mfma_f32_16x16x32_bf16 v[84:87], v[44:47], a[20:23], v[84:87]
    s_waitcnt lgkmcnt(3)
    ds_read_b64_tr_b16 v[38:39], v58 offset:2304
    v_mfma_f32_16x16x32_bf16 v[160:163], v[48:51], a[0:3], 0
    ds_read_b64_tr_b16 v[40:41], v2 offset:4096
    v_mfma_f32_16x16x32_bf16 v[160:163], v[52:55], a[16:19], v[160:163]
    buffer_load_dwordx4 a[112:115], v24, s[16:19], s50 offen offset:3072 sc1
    ds_read_b64_tr_b16 v[42:43], v2 offset:4352
    v_mfma_f32_16x16x32_bf16 v[164:167], v[48:51], a[4:7], 0
    ds_read_b64_tr_b16 v[44:45], v2 offset:6144
    v_mfma_f32_16x16x32_bf16 v[164:167], v[52:55], a[20:23], v[164:167]
    s_waitcnt lgkmcnt(3)
    ds_read_b64_tr_b16 v[46:47], v2 offset:6400
    v_mfma_f32_16x16x32_bf16 v[168:171], v[32:35], a[0:3], 0
    ds_read_b64_tr_b16 v[48:49], v4 offset:4096
    v_mfma_f32_16x16x32_bf16 v[168:171], v[36:39], a[16:19], v[168:171]
    buffer_load_dwordx4 a[116:119], v24, s[16:19], s51 offen offset:3072 sc1
    ds_read_b64_tr_b16 v[50:51], v4 offset:4352
    v_mfma_f32_16x16x32_bf16 v[172:175], v[32:35], a[4:7], 0
    ds_read_b64_tr_b16 v[52:53], v4 offset:6144
    v_mfma_f32_16x16x32_bf16 v[172:175], v[36:39], a[20:23], v[172:175]
    s_waitcnt vmcnt(8) lgkmcnt(3)
    v_accvgpr_read_b32 v176, a32
    v_accvgpr_read_b32 v177, a36
    v_accvgpr_read_b32 v178, a48
    v_accvgpr_read_b32 v179, a52
    v_max3_u32 v176, v176, v177, v178
    v_max_u32 v176, v176, v179
    v_cmp_eq_u32 vcc, -1, v176
    s_nop 1
    s_cbranch_vccnz adaLN_cond__ssm_conv_h3__glu_gated_geglu__prompt_kernel_bc0_1
adaLN_cond__ssm_conv_h3__glu_gated_geglu__prompt_kernel_bc0_1b:
    ds_read_b64_tr_b16 v[54:55], v4 offset:6400
    v_mfma_f32_16x16x32_bf16 v[64:67], v[40:43], a[32:35], v[64:67]
    ds_read_b64_tr_b16 v[32:33], v56 offset:4096
    v_mfma_f32_16x16x32_bf16 v[64:67], v[44:47], a[48:51], v[64:67]
    buffer_load_dwordx4 a[128:131], v25, s[16:19], s50 offen offset:0 sc1
    ds_read_b64_tr_b16 v[34:35], v56 offset:4352
    v_mfma_f32_16x16x32_bf16 v[68:71], v[40:43], a[36:39], v[68:71]
    ds_read_b64_tr_b16 v[36:37], v56 offset:6144
    v_mfma_f32_16x16x32_bf16 v[68:71], v[44:47], a[52:55], v[68:71]
    s_waitcnt lgkmcnt(3)
    ds_read_b64_tr_b16 v[38:39], v56 offset:6400
    v_mfma_f32_16x16x32_bf16 v[80:83], v[48:51], a[32:35], v[80:83]
    ds_read_b64_tr_b16 v[40:41], v58 offset:4096
    v_mfma_f32_16x16x32_bf16 v[80:83], v[52:55], a[48:51], v[80:83]
    buffer_load_dwordx4 a[132:135], v25, s[16:19], s51 offen offset:0 sc1
    ds_read_b64_tr_b16 v[42:43], v58 offset:4352
    v_mfma_f32_16x16x32_bf16 v[84:87], v[48:51], a[36:39], v[84:87]
    ds_read_b64_tr_b16 v[44:45], v58 offset:6144
    v_mfma_f32_16x16x32_bf16 v[84:87], v[52:55], a[52:55], v[84:87]
    s_waitcnt lgkmcnt(3)
    ds_read_b64_tr_b16 v[46:47], v58 offset:6400
    v_mfma_f32_16x16x32_bf16 v[160:163], v[32:35], a[32:35], v[160:163]
    ds_read_b64_tr_b16 v[48:49], v2 offset:8192
    v_mfma_f32_16x16x32_bf16 v[160:163], v[36:39], a[48:51], v[160:163]
    buffer_load_dwordx4 a[144:147], v25, s[16:19], s50 offen offset:1024 sc1
    ds_read_b64_tr_b16 v[50:51], v2 offset:8448
    v_mfma_f32_16x16x32_bf16 v[164:167], v[32:35], a[36:39], v[164:167]
    ds_read_b64_tr_b16 v[52:53], v2 offset:10240
    v_mfma_f32_16x16x32_bf16 v[164:167], v[36:39], a[52:55], v[164:167]
    s_waitcnt lgkmcnt(3)
    ds_read_b64_tr_b16 v[54:55], v2 offset:10496
    v_mfma_f32_16x16x32_bf16 v[168:171], v[40:43], a[32:35], v[168:171]
    ds_read_b64_tr_b16 v[32:33], v4 offset:8192
    v_mfma_f32_16x16x32_bf16 v[168:171], v[44:47], a[48:51], v[168:171]
    buffer_load_dwordx4 a[148:151], v25, s[16:19], s51 offen offset:1024 sc1
    ds_read_b64_tr_b16 v[34:35], v4 offset:8448
    v_mfma_f32_16x16x32_bf16 v[172:175], v[40:43], a[36:39], v[172:175]
    ds_read_b64_tr_b16 v[36:37], v4 offset:10240
    v_mfma_f32_16x16x32_bf16 v[172:175], v[44:47], a[52:55], v[172:175]
    s_waitcnt vmcnt(8) lgkmcnt(3)
    v_accvgpr_read_b32 v176, a64
    v_accvgpr_read_b32 v177, a68
    v_accvgpr_read_b32 v178, a80
    v_accvgpr_read_b32 v179, a84
    v_max3_u32 v176, v176, v177, v178
    v_max_u32 v176, v176, v179
    v_cmp_eq_u32 vcc, -1, v176
    s_nop 1
    s_cbranch_vccnz adaLN_cond__ssm_conv_h3__glu_gated_geglu__prompt_kernel_bc0_2
adaLN_cond__ssm_conv_h3__glu_gated_geglu__prompt_kernel_bc0_2b:
    ds_read_b64_tr_b16 v[38:39], v4 offset:10496
    v_mfma_f32_16x16x32_bf16 v[64:67], v[48:51], a[64:67], v[64:67]
    ds_read_b64_tr_b16 v[40:41], v56 offset:8192
    v_mfma_f32_16x16x32_bf16 v[64:67], v[52:55], a[80:83], v[64:67]
    buffer_load_dwordx4 a[160:163], v25, s[16:19], s50 offen offset:2048 sc1
    ds_read_b64_tr_b16 v[42:43], v56 offset:8448
    v_mfma_f32_16x16x32_bf16 v[68:71], v[48:51], a[68:71], v[68:71]
    ds_read_b64_tr_b16 v[44:45], v56 offset:10240
    v_mfma_f32_16x16x32_bf16 v[68:71], v[52:55], a[84:87], v[68:71]
    s_waitcnt lgkmcnt(3)
    ds_read_b64_tr_b16 v[46:47], v56 offset:10496
    v_mfma_f32_16x16x32_bf16 v[80:83], v[32:35], a[64:67], v[80:83]
    ds_read_b64_tr_b16 v[48:49], v58 offset:8192
    v_mfma_f32_16x16x32_bf16 v[80:83], v[36:39], a[80:83], v[80:83]
    buffer_load_dwordx4 a[164:167], v25, s[16:19], s51 offen offset:2048 sc1
    ds_read_b64_tr_b16 v[50:51], v58 offset:8448
    v_mfma_f32_16x16x32_bf16 v[84:87], v[32:35], a[68:71], v[84:87]
    ds_read_b64_tr_b16 v[52:53], v58 offset:10240
    v_mfma_f32_16x16x32_bf16 v[84:87], v[36:39], a[84:87], v[84:87]
    s_waitcnt lgkmcnt(3)
    ds_read_b64_tr_b16 v[54:55], v58 offset:10496
    v_mfma_f32_16x16x32_bf16 v[160:163], v[40:43], a[64:67], v[160:163]
    ds_read_b64_tr_b16 v[32:33], v2 offset:12288
    v_mfma_f32_16x16x32_bf16 v[160:163], v[44:47], a[80:83], v[160:163]
    buffer_load_dwordx4 a[176:179], v25, s[16:19], s50 offen offset:3072 sc1
    ds_read_b64_tr_b16 v[34:35], v2 offset:12544
    v_mfma_f32_16x16x32_bf16 v[164:167], v[40:43], a[68:71], v[164:167]
    ds_read_b64_tr_b16 v[36:37], v2 offset:14336
    v_mfma_f32_16x16x32_bf16 v[164:167], v[44:47], a[84:87], v[164:167]
    s_waitcnt lgkmcnt(3)
    ds_read_b64_tr_b16 v[38:39], v2 offset:14592
    v_mfma_f32_16x16x32_bf16 v[168:171], v[48:51], a[64:67], v[168:171]
    ds_read_b64_tr_b16 v[40:41], v4 offset:12288
    v_mfma_f32_16x16x32_bf16 v[168:171], v[52:55], a[80:83], v[168:171]
    buffer_load_dwordx4 a[180:183], v25, s[16:19], s51 offen offset:3072 sc1
    ds_read_b64_tr_b16 v[42:43], v4 offset:12544
    v_mfma_f32_16x16x32_bf16 v[172:175], v[48:51], a[68:71], v[172:175]
    ds_read_b64_tr_b16 v[44:45], v4 offset:14336
    v_mfma_f32_16x16x32_bf16 v[172:175], v[52:55], a[84:87], v[172:175]
    s_waitcnt vmcnt(8) lgkmcnt(3)
    v_accvgpr_read_b32 v176, a96
    v_accvgpr_read_b32 v177, a100
    v_accvgpr_read_b32 v178, a112
    v_accvgpr_read_b32 v179, a116
    v_max3_u32 v176, v176, v177, v178
    v_max_u32 v176, v176, v179
    v_cmp_eq_u32 vcc, -1, v176
    s_nop 1
    s_cbranch_vccnz adaLN_cond__ssm_conv_h3__glu_gated_geglu__prompt_kernel_bc0_3
adaLN_cond__ssm_conv_h3__glu_gated_geglu__prompt_kernel_bc0_3b:
    ds_read_b64_tr_b16 v[46:47], v4 offset:14592
    v_mfma_f32_16x16x32_bf16 v[64:67], v[32:35], a[96:99], v[64:67]
    ds_read_b64_tr_b16 v[48:49], v56 offset:12288
    v_mfma_f32_16x16x32_bf16 v[64:67], v[36:39], a[112:115], v[64:67]
    buffer_load_dwordx4 a[192:195], v26, s[16:19], s50 offen offset:0 sc1
    ds_read_b64_tr_b16 v[50:51], v56 offset:12544
    v_mfma_f32_16x16x32_bf16 v[68:71], v[32:35], a[100:103], v[68:71]
    ds_read_b64_tr_b16 v[52:53], v56 offset:14336
    v_mfma_f32_16x16x32_bf16 v[68:71], v[36:39], a[116:119], v[68:71]
    s_waitcnt lgkmcnt(3)
    ds_read_b64_tr_b16 v[54:55], v56 offset:14592
    v_mfma_f32_16x16x32_bf16 v[80:83], v[40:43], a[96:99], v[80:83]
    ds_read_b64_tr_b16 v[32:33], v58 offset:12288
    v_mfma_f32_16x16x32_bf16 v[80:83], v[44:47], a[112:115], v[80:83]
    buffer_load_dwordx4 a[196:199], v26, s[16:19], s51 offen offset:0 sc1
    ds_read_b64_tr_b16 v[34:35], v58 offset:12544
    v_mfma_f32_16x16x32_bf16 v[84:87], v[40:43], a[100:103], v[84:87]
    ds_read_b64_tr_b16 v[36:37], v58 offset:14336
    v_mfma_f32_16x16x32_bf16 v[84:87], v[44:47], a[116:119], v[84:87]
    s_waitcnt lgkmcnt(3)
    ds_read_b64_tr_b16 v[38:39], v58 offset:14592
    v_mfma_f32_16x16x32_bf16 v[160:163], v[48:51], a[96:99], v[160:163]
    ds_read_b64_tr_b16 v[40:41], v2 offset:16384
    v_mfma_f32_16x16x32_bf16 v[160:163], v[52:55], a[112:115], v[160:163]
    buffer_load_dwordx4 a[208:211], v26, s[16:19], s50 offen offset:1024 sc1
    ds_read_b64_tr_b16 v[42:43], v2 offset:16640
    v_mfma_f32_16x16x32_bf16 v[164:167], v[48:51], a[100:103], v[164:167]
    ds_read_b64_tr_b16 v[44:45], v2 offset:18432
    v_mfma_f32_16x16x32_bf16 v[164:167], v[52:55], a[116:119], v[164:167]
    s_waitcnt lgkmcnt(3)
    ds_read_b64_tr_b16 v[46:47], v2 offset:18688
    v_mfma_f32_16x16x32_bf16 v[168:171], v[32:35], a[96:99], v[168:171]
    ds_read_b64_tr_b16 v[48:49], v4 offset:16384
    v_mfma_f32_16x16x32_bf16 v[168:171], v[36:39], a[112:115], v[168:171]
    buffer_load_dwordx4 a[212:215], v26, s[16:19], s51 offen offset:1024 sc1
    ds_read_b64_tr_b16 v[50:51], v4 offset:16640
    v_mfma_f32_16x16x32_bf16 v[172:175], v[32:35], a[100:103], v[172:175]
    ds_read_b64_tr_b16 v[52:53], v4 offset:18432
    v_mfma_f32_16x16x32_bf16 v[172:175], v[36:39], a[116:119], v[172:175]
    s_waitcnt vmcnt(8) lgkmcnt(3)
    v_accvgpr_read_b32 v176, a128
    v_accvgpr_read_b32 v177, a132
    v_accvgpr_read_b32 v178, a144
    v_accvgpr_read_b32 v179, a148
    v_max3_u32 v176, v176, v177, v178
    v_max_u32 v176, v176, v179
    v_cmp_eq_u32 vcc, -1, v176
    s_nop 1
    s_cbranch_vccnz adaLN_cond__ssm_conv_h3__glu_gated_geglu__prompt_kernel_bc0_4
adaLN_cond__ssm_conv_h3__glu_gated_geglu__prompt_kernel_bc0_4b:
    ds_read_b64_tr_b16 v[54:55], v4 offset:18688
    v_mfma_f32_16x16x32_bf16 v[64:67], v[40:43], a[128:131], v[64:67]
    ds_read_b64_tr_b16 v[32:33], v56 offset:16384
    v_mfma_f32_16x16x32_bf16 v[64:67], v[44:47], a[144:147], v[64:67]
    buffer_load_dwordx4 a[224:227], v26, s[16:19], s50 offen offset:2048 sc1
    ds_read_b64_tr_b16 v[34:35], v56 offset:16640
    v_mfma_f32_16x16x32_bf16 v[68:71], v[40:43], a[132:135], v[68:71]
    ds_read_b64_tr_b16 v[36:37], v56 offset:18432
    v_mfma_f32_16x16x32_bf16 v[68:71], v[44:47], a[148:151], v[68:71]
    s_waitcnt lgkmcnt(3)
    ds_read_b64_tr_b16 v[38:39], v56 offset:18688
    v_mfma_f32_16x16x32_bf16 v[80:83], v[48:51], a[128:131], v[80:83]
    ds_read_b64_tr_b16 v[40:41], v58 offset:16384
    v_mfma_f32_16x16x32_bf16 v[80:83], v[52:55], a[144:147], v[80:83]
    buffer_load_dwordx4 a[228:231], v26, s[16:19], s51 offen offset:2048 sc1
    ds_read_b64_tr_b16 v[42:43], v58 offset:16640
    v_mfma_f32_16x16x32_bf16 v[84:87], v[48:51], a[132:135], v[84:87]
    ds_read_b64_tr_b16 v[44:45], v58 offset:18432
    v_mfma_f32_16x16x32_bf16 v[84:87], v[52:55], a[148:151], v[84:87]
    s_waitcnt lgkmcnt(3)
    ds_read_b64_tr_b16 v[46:47], v58 offset:18688
    v_mfma_f32_16x16x32_bf16 v[160:163], v[32:35], a[128:131], v[160:163]
    ds_read_b64_tr_b16 v[48:49], v2 offset:20480
    v_mfma_f32_16x16x32_bf16 v[160:163], v[36:39], a[144:147], v[160:163]
    buffer_load_dwordx4 a[240:243], v26, s[16:19], s50 offen offset:3072 sc1
    ds_read_b64_tr_b16 v[50:51], v2 offset:20736
    v_mfma_f32_16x16x32_bf16 v[164:167], v[32:35], a[132:135], v[164:167]
    ds_read_b64_tr_b16 v[52:53], v2 offset:22528
    v_mfma_f32_16x16x32_bf16 v[164:167], v[36:39], a[148:151], v[164:167]
    s_waitcnt lgkmcnt(3)
    ds_read_b64_tr_b16 v[54:55], v2 offset:22784
    v_mfma_f32_16x16x32_bf16 v[168:171], v[40:43], a[128:131], v[168:171]
    ds_read_b64_tr_b16 v[32:33], v4 offset:20480
    v_mfma_f32_16x16x32_bf16 v[168:171], v[44:47], a[144:147], v[168:171]
    buffer_load_dwordx4 a[244:247], v26, s[16:19], s51 offen offset:3072 sc1
    ds_read_b64_tr_b16 v[34:35], v4 offset:20736
    v_mfma_f32_16x16x32_bf16 v[172:175], v[40:43], a[132:135], v[172:175]
    ds_read_b64_tr_b16 v[36:37], v4 offset:22528
    v_mfma_f32_16x16x32_bf16 v[172:175], v[44:47], a[148:151], v[172:175]
    s_waitcnt vmcnt(8) lgkmcnt(3)
    v_accvgpr_read_b32 v176, a160
    v_accvgpr_read_b32 v177, a164
    v_accvgpr_read_b32 v178, a176
    v_accvgpr_read_b32 v179, a180
    v_max3_u32 v176, v176, v177, v178
    v_max_u32 v176, v176, v179
    v_cmp_eq_u32 vcc, -1, v176
    s_nop 1
    s_cbranch_vccnz adaLN_cond__ssm_conv_h3__glu_gated_geglu__prompt_kernel_bc0_5
adaLN_cond__ssm_conv_h3__glu_gated_geglu__prompt_kernel_bc0_5b:
    ds_read_b64_tr_b16 v[38:39], v4 offset:22784
    v_mfma_f32_16x16x32_bf16 v[64:67], v[48:51], a[160:163], v[64:67]
    ds_read_b64_tr_b16 v[40:41], v56 offset:20480
    v_mfma_f32_16x16x32_bf16 v[64:67], v[52:55], a[176:179], v[64:67]
    buffer_load_dwordx4 v[224:227], v27, s[16:19], s50 offen offset:0 sc1
    ds_read_b64_tr_b16 v[42:43], v56 offset:20736
    v_mfma_f32_16x16x32_bf16 v[68:71], v[48:51], a[164:167], v[68:71]
    ds_read_b64_tr_b16 v[44:45], v56 offset:22528
    v_mfma_f32_16x16x32_bf16 v[68:71], v[52:55], a[180:183], v[68:71]
    s_waitcnt lgkmcnt(3)
    ds_read_b64_tr_b16 v[46:47], v56 offset:22784
    v_mfma_f32_16x16x32_bf16 v[80:83], v[32:35], a[160:163], v[80:83]
    ds_read_b64_tr_b16 v[48:49], v58 offset:20480
    v_mfma_f32_16x16x32_bf16 v[80:83], v[36:39], a[176:179], v[80:83]
    buffer_load_dwordx4 v[228:231], v27, s[16:19], s51 offen offset:0 sc1
    ds_read_b64_tr_b16 v[50:51], v58 offset:20736
    v_mfma_f32_16x16x32_bf16 v[84:87], v[32:35], a[164:167], v[84:87]
    ds_read_b64_tr_b16 v[52:53], v58 offset:22528
    v_mfma_f32_16x16x32_bf16 v[84:87], v[36:39], a[180:183], v[84:87]
    s_waitcnt lgkmcnt(3)
    ds_read_b64_tr_b16 v[54:55], v58 offset:22784
    v_mfma_f32_16x16x32_bf16 v[160:163], v[40:43], a[160:163], v[160:163]
    ds_read_b64_tr_b16 v[32:33], v2 offset:24576
    v_mfma_f32_16x16x32_bf16 v[160:163], v[44:47], a[176:179], v[160:163]
    buffer_load_dwordx4 v[240:243], v27, s[16:19], s50 offen offset:1024 sc1
    ds_read_b64_tr_b16 v[34:35], v2 offset:24832
    v_mfma_f32_16x16x32_bf16 v[164:167], v[40:43], a[164:167], v[164:167]
    ds_read_b64_tr_b16 v[36:37], v2 offset:26624
    v_mfma_f32_16x16x32_bf16 v[164:167], v[44:47], a[180:183], v[164:167]
    s_waitcnt lgkmcnt(3)
    ds_read_b64_tr_b16 v[38:39], v2 offset:26880
    v_mfma_f32_16x16x32_bf16 v[168:171], v[48:51], a[160:163], v[168:171]
    ds_read_b64_tr_b16 v[40:41], v4 offset:24576
    v_mfma_f32_16x16x32_bf16 v[168:171], v[52:55], a[176:179], v[168:171]
    buffer_load_dwordx4 v[244:247], v27, s[16:19], s51 offen offset:1024 sc1
    ds_read_b64_tr_b16 v[42:43], v4 offset:24832
    v_mfma_f32_16x16x32_bf16 v[172:175], v[48:51], a[164:167], v[172:175]
    ds_read_b64_tr_b16 v[44:45], v4 offset:26624
    v_mfma_f32_16x16x32_bf16 v[172:175], v[52:55], a[180:183], v[172:175]
    s_waitcnt vmcnt(8) lgkmcnt(3)
    v_accvgpr_read_b32 v176, a192
    v_accvgpr_read_b32 v177, a196
    v_accvgpr_read_b32 v178, a208
    v_accvgpr_read_b32 v179, a212
    v_max3_u32 v176, v176, v177, v178
    v_max_u32 v176, v176, v179
    v_cmp_eq_u32 vcc, -1, v176
    s_nop 1
    s_cbranch_vccnz adaLN_cond__ssm_conv_h3__glu_gated_geglu__prompt_kernel_bc0_6
adaLN_cond__ssm_conv_h3__glu_gated_geglu__prompt_kernel_bc0_6b:
    ds_read_b64_tr_b16 v[46:47], v4 offset:26880
    v_mfma_f32_16x16x32_bf16 v[64:67], v[32:35], a[192:195], v[64:67]
    ds_read_b64_tr_b16 v[48:49], v56 offset:24576
    v_mfma_f32_16x16x32_bf16 v[64:67], v[36:39], a[208:211], v[64:67]
    buffer_load_dwordx4 a[8:11], v9, s[16:19], s52 offen offset:0 sc1
    ds_read_b64_tr_b16 v[50:51], v56 offset:24832
    v_mfma_f32_16x16x32_bf16 v[68:71], v[32:35], a[196:199], v[68:71]
    ds_read_b64_tr_b16 v[52:53], v56 offset:26624
    v_mfma_f32_16x16x32_bf16 v[68:71], v[36:39], a[212:215], v[68:71]
    s_waitcnt lgkmcnt(3)
    ds_read_b64_tr_b16 v[54:55], v56 offset:26880
    v_mfma_f32_16x16x32_bf16 v[80:83], v[40:43], a[192:195], v[80:83]
    ds_read_b64_tr_b16 v[32:33], v58 offset:24576
    v_mfma_f32_16x16x32_bf16 v[80:83], v[44:47], a[208:211], v[80:83]
    buffer_load_dwordx4 a[12:15], v9, s[16:19], s53 offen offset:0 sc1
    ds_read_b64_tr_b16 v[34:35], v58 offset:24832
    v_mfma_f32_16x16x32_bf16 v[84:87], v[40:43], a[196:199], v[84:87]
    ds_read_b64_tr_b16 v[36:37], v58 offset:26624
    v_mfma_f32_16x16x32_bf16 v[84:87], v[44:47], a[212:215], v[84:87]
    s_waitcnt lgkmcnt(3)
    ds_read_b64_tr_b16 v[38:39], v58 offset:26880
    v_mfma_f32_16x16x32_bf16 v[160:163], v[48:51], a[192:195], v[160:163]
    ds_read_b64_tr_b16 v[40:41], v2 offset:28672
    v_mfma_f32_16x16x32_bf16 v[160:163], v[52:55], a[208:211], v[160:163]
    buffer_load_dwordx4 a[24:27], v9, s[16:19], s52 offen offset:1024 sc1
    ds_read_b64_tr_b16 v[42:43], v2 offset:28928
    v_mfma_f32_16x16x32_bf16 v[164:167], v[48:51], a[196:199], v[164:167]
    ds_read_b64_tr_b16 v[44:45], v2 offset:30720
    v_mfma_f32_16x16x32_bf16 v[164:167], v[52:55], a[212:215], v[164:167]
    s_waitcnt lgkmcnt(3)
    ds_read_b64_tr_b16 v[46:47], v2 offset:30976
    v_mfma_f32_16x16x32_bf16 v[168:171], v[32:35], a[192:195], v[168:171]
    ds_read_b64_tr_b16 v[48:49], v4 offset:28672
    v_mfma_f32_16x16x32_bf16 v[168:171], v[36:39], a[208:211], v[168:171]
    buffer_load_dwordx4 a[28:31], v9, s[16:19], s53 offen offset:1024 sc1
    ds_read_b64_tr_b16 v[50:51], v4 offset:28928
    v_mfma_f32_16x16x32_bf16 v[172:175], v[32:35], a[196:199], v[172:175]
    ds_read_b64_tr_b16 v[52:53], v4 offset:30720
    v_mfma_f32_16x16x32_bf16 v[172:175], v[36:39], a[212:215], v[172:175]
    s_waitcnt vmcnt(8) lgkmcnt(3)
    v_accvgpr_read_b32 v176, a224
    v_accvgpr_read_b32 v177, a228
    v_accvgpr_read_b32 v178, a240
    v_accvgpr_read_b32 v179, a244
    v_max3_u32 v176, v176, v177, v178
    v_max_u32 v176, v176, v179
    v_cmp_eq_u32 vcc, -1, v176
    s_nop 1
    s_cbranch_vccnz adaLN_cond__ssm_conv_h3__glu_gated_geglu__prompt_kernel_bc0_7
adaLN_cond__ssm_conv_h3__glu_gated_geglu__prompt_kernel_bc0_7b:
    ds_read_b64_tr_b16 v[54:55], v4 offset:30976
    v_mfma_f32_16x16x32_bf16 v[64:67], v[40:43], a[224:227], v[64:67]
    ds_read_b64_tr_b16 v[32:33], v56 offset:28672
    v_mfma_f32_16x16x32_bf16 v[64:67], v[44:47], a[240:243], v[64:67]
    buffer_load_dwordx4 a[40:43], v9, s[16:19], s52 offen offset:2048 sc1
    ds_read_b64_tr_b16 v[34:35], v56 offset:28928
    v_mfma_f32_16x16x32_bf16 v[68:71], v[40:43], a[228:231], v[68:71]
    ds_read_b64_tr_b16 v[36:37], v56 offset:30720
    v_mfma_f32_16x16x32_bf16 v[68:71], v[44:47], a[244:247], v[68:71]
    s_waitcnt lgkmcnt(3)
    ds_read_b64_tr_b16 v[38:39], v56 offset:30976
    v_mfma_f32_16x16x32_bf16 v[80:83], v[48:51], a[224:227], v[80:83]
    ds_read_b64_tr_b16 v[40:41], v58 offset:28672
    v_mfma_f32_16x16x32_bf16 v[80:83], v[52:55], a[240:243], v[80:83]
    buffer_load_dwordx4 a[44:47], v9, s[16:19], s53 offen offset:2048 sc1
    ds_read_b64_tr_b16 v[42:43], v58 offset:28928
    v_mfma_f32_16x16x32_bf16 v[84:87], v[48:51], a[228:231], v[84:87]
    ds_read_b64_tr_b16 v[44:45], v58 offset:30720
    v_mfma_f32_16x16x32_bf16 v[84:87], v[52:55], a[244:247], v[84:87]
    s_waitcnt lgkmcnt(3)
    ds_read_b64_tr_b16 v[46:47], v58 offset:30976
    v_mfma_f32_16x16x32_bf16 v[160:163], v[32:35], a[224:227], v[160:163]
    ds_read_b64_tr_b16 v[48:49], v2 offset:32768
    v_mfma_f32_16x16x32_bf16 v[160:163], v[36:39], a[240:243], v[160:163]
    buffer_load_dwordx4 a[56:59], v9, s[16:19], s52 offen offset:3072 sc1
    ds_read_b64_tr_b16 v[50:51], v2 offset:33024
    v_mfma_f32_16x16x32_bf16 v[164:167], v[32:35], a[228:231], v[164:167]
    ds_read_b64_tr_b16 v[52:53], v2 offset:34816
    v_mfma_f32_16x16x32_bf16 v[164:167], v[36:39], a[244:247], v[164:167]
    s_waitcnt lgkmcnt(3)
    ds_read_b64_tr_b16 v[54:55], v2 offset:35072
    v_mfma_f32_16x16x32_bf16 v[168:171], v[40:43], a[224:227], v[168:171]
    ds_read_b64_tr_b16 v[32:33], v4 offset:32768
    v_mfma_f32_16x16x32_bf16 v[168:171], v[44:47], a[240:243], v[168:171]
    buffer_load_dwordx4 a[60:63], v9, s[16:19], s53 offen offset:3072 sc1
    ds_read_b64_tr_b16 v[34:35], v4 offset:33024
    v_mfma_f32_16x16x32_bf16 v[172:175], v[40:43], a[228:231], v[172:175]
    ds_read_b64_tr_b16 v[36:37], v4 offset:34816
    v_mfma_f32_16x16x32_bf16 v[172:175], v[44:47], a[244:247], v[172:175]
    s_waitcnt vmcnt(8) lgkmcnt(3)
    v_max3_u32 v176, v224, v228, v240
    v_max_u32 v176, v176, v244
    v_cmp_eq_u32 vcc, -1, v176
    s_nop 1
    s_cbranch_vccnz adaLN_cond__ssm_conv_h3__glu_gated_geglu__prompt_kernel_bc0_8
adaLN_cond__ssm_conv_h3__glu_gated_geglu__prompt_kernel_bc0_8b:
    ds_read_b64_tr_b16 v[38:39], v4 offset:35072
    v_mfma_f32_16x16x32_bf16 v[64:67], v[48:51], v[224:227], v[64:67]
    ds_read_b64_tr_b16 v[40:41], v56 offset:32768
    v_mfma_f32_16x16x32_bf16 v[64:67], v[52:55], v[240:243], v[64:67]
    buffer_load_dwordx4 a[72:75], v24, s[16:19], s52 offen offset:0 sc1
    ds_read_b64_tr_b16 v[42:43], v56 offset:33024
    v_mfma_f32_16x16x32_bf16 v[68:71], v[48:51], v[228:231], v[68:71]
    ds_read_b64_tr_b16 v[44:45], v56 offset:34816
    v_mfma_f32_16x16x32_bf16 v[68:71], v[52:55], v[244:247], v[68:71]
    s_waitcnt lgkmcnt(3)
    ds_read_b64_tr_b16 v[46:47], v56 offset:35072
    v_mfma_f32_16x16x32_bf16 v[80:83], v[32:35], v[224:227], v[80:83]
    ds_read_b64_tr_b16 v[48:49], v58 offset:32768
    v_mfma_f32_16x16x32_bf16 v[80:83], v[36:39], v[240:243], v[80:83]
    buffer_load_dwordx4 a[76:79], v24, s[16:19], s53 offen offset:0 sc1
    ds_read_b64_tr_b16 v[50:51], v58 offset:33024
    v_mfma_f32_16x16x32_bf16 v[84:87], v[32:35], v[228:231], v[84:87]
    ds_read_b64_tr_b16 v[52:53], v58 offset:34816
    v_mfma_f32_16x16x32_bf16 v[84:87], v[36:39], v[244:247], v[84:87]
    s_waitcnt lgkmcnt(3)
    ds_read_b64_tr_b16 v[54:55], v58 offset:35072
    v_mfma_f32_16x16x32_bf16 v[160:163], v[40:43], v[224:227], v[160:163]
    ds_read_b64_tr_b16 v[32:33], v3 offset:0
    v_mfma_f32_16x16x32_bf16 v[160:163], v[44:47], v[240:243], v[160:163]
    buffer_load_dwordx4 a[88:91], v24, s[16:19], s52 offen offset:1024 sc1
    ds_read_b64_tr_b16 v[34:35], v3 offset:256
    v_mfma_f32_16x16x32_bf16 v[164:167], v[40:43], v[228:231], v[164:167]
    ds_read_b64_tr_b16 v[36:37], v3 offset:2048
    v_mfma_f32_16x16x32_bf16 v[164:167], v[44:47], v[244:247], v[164:167]
    s_waitcnt lgkmcnt(3)
    ds_read_b64_tr_b16 v[38:39], v3 offset:2304
    v_mfma_f32_16x16x32_bf16 v[168:171], v[48:51], v[224:227], v[168:171]
    ds_read_b64_tr_b16 v[40:41], v5 offset:0
    v_mfma_f32_16x16x32_bf16 v[168:171], v[52:55], v[240:243], v[168:171]
    buffer_load_dwordx4 a[92:95], v24, s[16:19], s53 offen offset:1024 sc1
    ds_read_b64_tr_b16 v[42:43], v5 offset:256
    v_mfma_f32_16x16x32_bf16 v[172:175], v[48:51], v[228:231], v[172:175]
    ds_read_b64_tr_b16 v[44:45], v5 offset:2048
    v_mfma_f32_16x16x32_bf16 v[172:175], v[52:55], v[244:247], v[172:175]
    s_waitcnt lgkmcnt(3)
    ds_read_b64_tr_b16 v[46:47], v5 offset:2304
    s_add_u32 s49, s67, 4784128
    v_mov_b32 v13, s70
    s_mov_b64 exec, 1
    buffer_store_dword v13, off, s[16:19], s49 sc1
    s_mov_b64 exec, -1
    v_mfma_f32_16x16x32_bf16 v[96:99], v[32:35], a[0:3], 0
    ds_read_b64_tr_b16 v[48:49], v3 offset:4096
    v_mfma_f32_16x16x32_bf16 v[96:99], v[36:39], a[16:19], v[96:99]
    buffer_load_dwordx4 a[104:107], v24, s[16:19], s52 offen offset:2048 sc1
    ds_read_b64_tr_b16 v[50:51], v3 offset:4352
    v_mfma_f32_16x16x32_bf16 v[100:103], v[32:35], a[4:7], 0
    ds_read_b64_tr_b16 v[52:53], v3 offset:6144
    v_mul_f32 v16, v64, v64
    v_mfma_f32_16x16x32_bf16 v[100:103], v[36:39], a[20:23], v[100:103]
    s_waitcnt lgkmcnt(3)
    ds_read_b64_tr_b16 v[54:55], v3 offset:6400
    v_fma_f32 v16, v16, v10, s35
    v_mfma_f32_16x16x32_bf16 v[112:115], v[40:43], a[0:3], 0
    ds_read_b64_tr_b16 v[32:33], v5 offset:4096
    v_mul_f32 v16, v16, v64
    v_mfma_f32_16x16x32_bf16 v[112:115], v[44:47], a[16:19], v[112:115]
    buffer_load_dwordx4 a[108:111], v24, s[16:19], s53 offen offset:2048 sc1
    ds_read_b64_tr_b16 v[34:35], v5 offset:4352
    v_mul_f32 v80, v80, v64
    v_mfma_f32_16x16x32_bf16 v[116:119], v[40:43], a[4:7], 0
    ds_read_b64_tr_b16 v[36:37], v5 offset:6144
    v_mul_f32 v17, v65, v65
    v_mfma_f32_16x16x32_bf16 v[116:119], v[44:47], a[20:23], v[116:119]
    s_waitcnt lgkmcnt(3)
    ds_read_b64_tr_b16 v[38:39], v5 offset:6400
    v_fma_f32 v17, v17, v10, s35
    v_mfma_f32_16x16x32_bf16 v[96:99], v[48:51], a[32:35], v[96:99]
    ds_read_b64_tr_b16 v[40:41], v3 offset:8192
    v_mul_f32 v17, v17, v65
    v_mfma_f32_16x16x32_bf16 v[96:99], v[52:55], a[48:51], v[96:99]
    buffer_load_dwordx4 a[120:123], v24, s[16:19], s52 offen offset:3072 sc1
    ds_read_b64_tr_b16 v[42:43], v3 offset:8448
    v_mul_f32 v81, v81, v65
    v_mfma_f32_16x16x32_bf16 v[100:103], v[48:51], a[36:39], v[100:103]
    ds_read_b64_tr_b16 v[44:45], v3 offset:10240
    v_mul_f32 v18, v66, v66
    v_mfma_f32_16x16x32_bf16 v[100:103], v[52:55], a[52:55], v[100:103]
    s_waitcnt lgkmcnt(3)
    ds_read_b64_tr_b16 v[46:47], v3 offset:10496
    v_fma_f32 v18, v18, v10, s35
    v_mfma_f32_16x16x32_bf16 v[112:115], v[32:35], a[32:35], v[112:115]
    ds_read_b64_tr_b16 v[48:49], v5 offset:8192
    v_mul_f32 v18, v18, v66
    v_mfma_f32_16x16x32_bf16 v[112:115], v[36:39], a[48:51], v[112:115]
    ds_read_b64_tr_b16 v[50:51], v5 offset:8448
    v_mul_f32 v82, v82, v66
    v_mfma_f32_16x16x32_bf16 v[116:119], v[32:35], a[36:39], v[116:119]
    buffer_load_dwordx4 a[124:127], v24, s[16:19], s53 offen offset:3072 sc1
    ds_read_b64_tr_b16 v[52:53], v5 offset:10240
    v_mul_f32 v19, v67, v67
    v_mfma_f32_16x16x32_bf16 v[116:119], v[36:39], a[52:55], v[116:119]
    s_waitcnt lgkmcnt(3)
    ds_read_b64_tr_b16 v[54:55], v5 offset:10496
    v_fma_f32 v19, v19, v10, s35
    v_mfma_f32_16x16x32_bf16 v[96:99], v[40:43], a[64:67], v[96:99]
    ds_read_b64_tr_b16 v[32:33], v3 offset:12288
    v_mul_f32 v19, v19, v67
    v_mfma_f32_16x16x32_bf16 v[96:99], v[44:47], a[80:83], v[96:99]
    ds_read_b64_tr_b16 v[34:35], v3 offset:12544
    v_mul_f32 v83, v83, v67
    v_mfma_f32_16x16x32_bf16 v[100:103], v[40:43], a[68:71], v[100:103]
    buffer_load_dwordx4 a[136:139], v25, s[16:19], s52 offen offset:0 sc1
    ds_read_b64_tr_b16 v[36:37], v3 offset:14336
    v_mul_f32 v20, v68, v68
    v_mfma_f32_16x16x32_bf16 v[100:103], v[44:47], a[84:87], v[100:103]
    s_waitcnt lgkmcnt(3)
    ds_read_b64_tr_b16 v[38:39], v3 offset:14592
    v_fma_f32 v20, v20, v10, s35
    v_mfma_f32_16x16x32_bf16 v[112:115], v[48:51], a[64:67], v[112:115]
    ds_read_b64_tr_b16 v[40:41], v5 offset:12288
    v_mul_f32 v20, v20, v68
    v_mfma_f32_16x16x32_bf16 v[112:115], v[52:55], a[80:83], v[112:115]
    ds_read_b64_tr_b16 v[42:43], v5 offset:12544
    v_mul_f32 v84, v84, v68
    v_mfma_f32_16x16x32_bf16 v[116:119], v[48:51], a[68:71], v[116:119]
    buffer_load_dwordx4 a[140:143], v25, s[16:19], s53 offen offset:0 sc1
    ds_read_b64_tr_b16 v[44:45], v5 offset:14336
    v_mul_f32 v21, v69, v69
    v_mfma_f32_16x16x32_bf16 v[116:119], v[52:55], a[84:87], v[116:119]
    s_waitcnt lgkmcnt(3)
    ds_read_b64_tr_b16 v[46:47], v5 offset:14592
    v_fma_f32 v21, v21, v10, s35
    v_mfma_f32_16x16x32_bf16 v[96:99], v[32:35], a[96:99], v[96:99]
    ds_read_b64_tr_b16 v[48:49], v3 offset:16384
    v_mul_f32 v21, v21, v69
    v_mfma_f32_16x16x32_bf16 v[96:99], v[36:39], a[112:115], v[96:99]
    ds_read_b64_tr_b16 v[50:51], v3 offset:16640
    v_mul_f32 v85, v85, v69
    v_mfma_f32_16x16x32_bf16 v[100:103], v[32:35], a[100:103], v[100:103]
    buffer_load_dwordx4 a[152:155], v25, s[16:19], s52 offen offset:1024 sc1
    ds_read_b64_tr_b16 v[52:53], v3 offset:18432
    v_mul_f32 v22, v70, v70
    v_mfma_f32_16x16x32_bf16 v[100:103], v[36:39], a[116:119], v[100:103]
    s_waitcnt lgkmcnt(3)
    ds_read_b64_tr_b16 v[54:55], v3 offset:18688
    v_fma_f32 v22, v22, v10, s35
    v_mfma_f32_16x16x32_bf16 v[112:115], v[40:43], a[96:99], v[112:115]
    ds_read_b64_tr_b16 v[32:33], v5 offset:16384
    v_mul_f32 v22, v22, v70
    v_mfma_f32_16x16x32_bf16 v[112:115], v[44:47], a[112:115], v[112:115]
    ds_read_b64_tr_b16 v[34:35], v5 offset:16640
    v_mul_f32 v86, v86, v70
    v_mfma_f32_16x16x32_bf16 v[116:119], v[40:43], a[100:103], v[116:119]
    buffer_load_dwordx4 a[156:159], v25, s[16:19], s53 offen offset:1024 sc1
    ds_read_b64_tr_b16 v[36:37], v5 offset:18432
    v_mul_f32 v23, v71, v71
    v_mfma_f32_16x16x32_bf16 v[116:119], v[44:47], a[116:119], v[116:119]
    s_waitcnt lgkmcnt(3)
    ds_read_b64_tr_b16 v[38:39], v5 offset:18688
    v_fma_f32 v23, v23, v10, s35
    v_mfma_f32_16x16x32_bf16 v[96:99], v[48:51], a[128:131], v[96:99]
    ds_read_b64_tr_b16 v[40:41], v3 offset:20480
    v_mul_f32 v23, v23, v71
    v_mfma_f32_16x16x32_bf16 v[96:99], v[52:55], a[144:147], v[96:99]
    ds_read_b64_tr_b16 v[42:43], v3 offset:20736
    v_mul_f32 v87, v87, v71
    v_mfma_f32_16x16x32_bf16 v[100:103], v[48:51], a[132:135], v[100:103]
    ds_read_b64_tr_b16 v[44:45], v3 offset:22528
    v_exp_f32 v16, v16
    v_mfma_f32_16x16x32_bf16 v[100:103], v[52:55], a[148:151], v[100:103]
    s_waitcnt lgkmcnt(3)
    ds_read_b64_tr_b16 v[46:47], v3 offset:22784
    v_exp_f32 v17, v17
    v_mfma_f32_16x16x32_bf16 v[112:115], v[32:35], a[128:131], v[112:115]
    buffer_load_dwordx4 a[168:171], v25, s[16:19], s52 offen offset:2048 sc1
    ds_read_b64_tr_b16 v[48:49], v5 offset:20480
    v_add_f32 v16, 1.0, v16
    v_mfma_f32_16x16x32_bf16 v[112:115], v[36:39], a[144:147], v[112:115]
    ds_read_b64_tr_b16 v[50:51], v5 offset:20736
    v_add_f32 v17, 1.0, v17
    v_mfma_f32_16x16x32_bf16 v[116:119], v[32:35], a[132:135], v[116:119]
    ds_read_b64_tr_b16 v[52:53], v5 offset:22528
    v_rcp_f32 v16, v16
    v_mfma_f32_16x16x32_bf16 v[116:119], v[36:39], a[148:151], v[116:119]
    s_waitcnt lgkmcnt(3)
    ds_read_b64_tr_b16 v[54:55], v5 offset:22784
    v_rcp_f32 v17, v17
    v_mfma_f32_16x16x32_bf16 v[96:99], v[40:43], a[160:163], v[96:99]
    buffer_load_dwordx4 a[172:175], v25, s[16:19], s53 offen offset:2048 sc1
    ds_read_b64_tr_b16 v[32:33], v3 offset:24576
    v_mul_f32 v80, v80, v16
    v_mfma_f32_16x16x32_bf16 v[96:99], v[44:47], a[176:179], v[96:99]
    ds_read_b64_tr_b16 v[34:35], v3 offset:24832
    v_mul_f32 v81, v81, v17
    v_mfma_f32_16x16x32_bf16 v[100:103], v[40:43], a[164:167], v[100:103]
    ds_read_b64_tr_b16 v[36:37], v3 offset:26624
    v_cvt_pk_bf16_f32 v128, v80, v81
    v_mfma_f32_16x16x32_bf16 v[100:103], v[44:47], a[180:183], v[100:103]
    s_waitcnt lgkmcnt(3)
    ds_read_b64_tr_b16 v[38:39], v3 offset:26880
    v_exp_f32 v18, v18
    v_mfma_f32_16x16x32_bf16 v[112:115], v[48:51], a[160:163], v[112:115]
    buffer_load_dwordx4 a[184:187], v25, s[16:19], s52 offen offset:3072 sc1
    ds_read_b64_tr_b16 v[40:41], v5 offset:24576
    v_exp_f32 v19, v19
    v_mfma_f32_16x16x32_bf16 v[112:115], v[52:55], a[176:179], v[112:115]
    ds_read_b64_tr_b16 v[42:43], v5 offset:24832
    v_add_f32 v18, 1.0, v18
    v_mfma_f32_16x16x32_bf16 v[116:119], v[48:51], a[164:167], v[116:119]
    ds_read_b64_tr_b16 v[44:45], v5 offset:26624
    v_add_f32 v19, 1.0, v19
    v_mfma_f32_16x16x32_bf16 v[116:119], v[52:55], a[180:183], v[116:119]
    s_waitcnt lgkmcnt(3)
    ds_read_b64_tr_b16 v[46:47], v5 offset:26880
    v_rcp_f32 v18, v18
    v_mfma_f32_16x16x32_bf16 v[96:99], v[32:35], a[192:195], v[96:99]
    ds_read_b64_tr_b16 v[48:49], v3 offset:28672
    v_rcp_f32 v19, v19
    v_mfma_f32_16x16x32_bf16 v[96:99], v[36:39], a[208:211], v[96:99]
    buffer_load_dwordx4 a[188:191], v25, s[16:19], s53 offen offset:3072 sc1
    ds_read_b64_tr_b16 v[50:51], v3 offset:28928
    v_mul_f32 v82, v82, v18
    v_mfma_f32_16x16x32_bf16 v[100:103], v[32:35], a[196:199], v[100:103]
    ds_read_b64_tr_b16 v[52:53], v3 offset:30720
    v_mul_f32 v83, v83, v19
    v_mfma_f32_16x16x32_bf16 v[100:103], v[36:39], a[212:215], v[100:103]
    s_waitcnt lgkmcnt(3)
    ds_read_b64_tr_b16 v[54:55], v3 offset:30976
    v_cvt_pk_bf16_f32 v129, v82, v83
    v_mfma_f32_16x16x32_bf16 v[112:115], v[40:43], a[192:195], v[112:115]
    ds_read_b64_tr_b16 v[32:33], v5 offset:28672
    v_exp_f32 v20, v20
    v_mfma_f32_16x16x32_bf16 v[112:115], v[44:47], a[208:211], v[112:115]
    buffer_load_dwordx4 a[200:203], v26, s[16:19], s52 offen offset:0 sc1
    ds_read_b64_tr_b16 v[34:35], v5 offset:28928
    v_exp_f32 v21, v21
    v_mfma_f32_16x16x32_bf16 v[116:119], v[40:43], a[196:199], v[116:119]
    ds_read_b64_tr_b16 v[36:37], v5 offset:30720
    v_add_f32 v20, 1.0, v20
    v_mfma_f32_16x16x32_bf16 v[116:119], v[44:47], a[212:215], v[116:119]
    s_waitcnt lgkmcnt(3)
    ds_read_b64_tr_b16 v[38:39], v5 offset:30976
    v_add_f32 v21, 1.0, v21
    v_mfma_f32_16x16x32_bf16 v[96:99], v[48:51], a[224:227], v[96:99]
    ds_read_b64_tr_b16 v[40:41], v3 offset:32768
    v_rcp_f32 v20, v20
    v_mfma_f32_16x16x32_bf16 v[96:99], v[52:55], a[240:243], v[96:99]
    buffer_load_dwordx4 a[204:207], v26, s[16:19], s53 offen offset:0 sc1
    ds_read_b64_tr_b16 v[42:43], v3 offset:33024
    v_rcp_f32 v21, v21
    v_mfma_f32_16x16x32_bf16 v[100:103], v[48:51], a[228:231], v[100:103]
    ds_read_b64_tr_b16 v[44:45], v3 offset:34816
    v_mul_f32 v84, v84, v20
    v_mfma_f32_16x16x32_bf16 v[100:103], v[52:55], a[244:247], v[100:103]
    s_waitcnt lgkmcnt(3)
    ds_read_b64_tr_b16 v[46:47], v3 offset:35072
    v_mul_f32 v85, v85, v21
    v_mfma_f32_16x16x32_bf16 v[112:115], v[32:35], a[224:227], v[112:115]
    ds_read_b64_tr_b16 v[48:49], v5 offset:32768
    ds_read_b64_tr_b16 v[50:51], v5 offset:33024
    v_cvt_pk_bf16_f32 v132, v84, v85
    v_mfma_f32_16x16x32_bf16 v[112:115], v[36:39], a[240:243], v[112:115]
    ds_read_b64_tr_b16 v[52:53], v5 offset:34816
    ds_read_b64_tr_b16 v[54:55], v5 offset:35072
    v_exp_f32 v22, v22
    v_mfma_f32_16x16x32_bf16 v[116:119], v[32:35], a[228:231], v[116:119]
    buffer_load_dwordx4 a[216:219], v26, s[16:19], s52 offen offset:1024 sc1
    v_exp_f32 v23, v23
    v_mfma_f32_16x16x32_bf16 v[116:119], v[36:39], a[244:247], v[116:119]
    s_waitcnt lgkmcnt(0)
    s_barrier
    v_add_f32 v22, 1.0, v22
    v_mfma_f32_16x16x32_bf16 v[96:99], v[40:43], v[224:227], v[96:99]
    ds_read_b64_tr_b16 v[32:33], v56 offset:0
    v_add_f32 v23, 1.0, v23
    v_mfma_f32_16x16x32_bf16 v[96:99], v[44:47], v[240:243], v[96:99]
    ds_read_b64_tr_b16 v[34:35], v56 offset:256
    v_rcp_f32 v22, v22
    v_mfma_f32_16x16x32_bf16 v[100:103], v[40:43], v[228:231], v[100:103]
    buffer_load_dwordx4 a[220:223], v26, s[16:19], s53 offen offset:1024 sc1
    ds_read_b64_tr_b16 v[36:37], v56 offset:2048
    v_rcp_f32 v23, v23
    v_mfma_f32_16x16x32_bf16 v[100:103], v[44:47], v[244:247], v[100:103]
    s_waitcnt lgkmcnt(3)
    ds_read_b64_tr_b16 v[38:39], v56 offset:2304
    v_mul_f32 v86, v86, v22
    v_mfma_f32_16x16x32_bf16 v[112:115], v[48:51], v[224:227], v[112:115]
    ds_read_b64_tr_b16 v[40:41], v58 offset:0
    v_mul_f32 v87, v87, v23
    v_mfma_f32_16x16x32_bf16 v[112:115], v[52:55], v[240:243], v[112:115]
    ds_read_b64_tr_b16 v[42:43], v58 offset:256
    v_cvt_pk_bf16_f32 v133, v86, v87
    v_mfma_f32_16x16x32_bf16 v[116:119], v[48:51], v[228:231], v[116:119]
    ds_read_b64_tr_b16 v[44:45], v58 offset:2048
    v_mfma_f32_16x16x32_bf16 v[116:119], v[52:55], v[244:247], v[116:119]
    s_waitcnt lgkmcnt(3)
    ds_read_b64_tr_b16 v[46:47], v58 offset:2304
    s_waitcnt vmcnt(25)
    v_accvgpr_read_b32 v176, a8
    v_accvgpr_read_b32 v177, a12
    v_accvgpr_read_b32 v178, a24
    v_accvgpr_read_b32 v179, a28
    v_max3_u32 v176, v176, v177, v178
    v_max_u32 v176, v176, v179
    v_cmp_eq_u32 vcc, -1, v176
    s_nop 1
    s_cbranch_vccnz adaLN_cond__ssm_conv_h3__glu_gated_geglu__prompt_kernel_bc1_0
adaLN_cond__ssm_conv_h3__glu_gated_geglu__prompt_kernel_bc1_0b:
    s_mov_b32 s36, 0
    v_mfma_f32_16x16x32_bf16 v[72:75], v[32:35], a[8:11], 0
    s_nop 0
    ds_read_b64_tr_b16 v[48:49], v56 offset:4096
    buffer_load_dwordx4 a[232:235], v26, s[16:19], s52 offen offset:2048 sc1
    v_mfma_f32_16x16x32_bf16 v[72:75], v[36:39], a[24:27], v[72:75]
    ds_read_b64_tr_b16 v[50:51], v56 offset:4352
    v_mfma_f32_16x16x32_bf16 v[76:79], v[32:35], a[12:15], 0
    ds_read_b64_tr_b16 v[52:53], v56 offset:6144
    v_mul_f32 v16, v96, v96
    v_mul_f32 v17, v97, v97
    v_mfma_f32_16x16x32_bf16 v[76:79], v[36:39], a[28:31], v[76:79]
    s_waitcnt lgkmcnt(3)
    ds_read_b64_tr_b16 v[54:55], v56 offset:6400
    buffer_load_dwordx4 a[236:239], v26, s[16:19], s53 offen offset:2048 sc1
    v_fma_f32 v16, v16, v10, s35
    v_mfma_f32_16x16x32_bf16 v[88:91], v[40:43], a[8:11], 0
    ds_read_b64_tr_b16 v[32:33], v58 offset:4096
    v_mul_f32 v16, v16, v96
    v_fma_f32 v17, v17, v10, s35
    v_mfma_f32_16x16x32_bf16 v[88:91], v[44:47], a[24:27], v[88:91]
    ds_read_b64_tr_b16 v[34:35], v58 offset:4352
    v_exp_f32 v16, v16
    v_mfma_f32_16x16x32_bf16 v[92:95], v[40:43], a[12:15], 0
    s_nop 0
    ds_read_b64_tr_b16 v[36:37], v58 offset:6144
    buffer_load_dwordx4 a[248:251], v26, s[16:19], s52 offen offset:3072 sc1
    v_mul_f32 v112, v112, v96
    v_mfma_f32_16x16x32_bf16 v[92:95], v[44:47], a[28:31], v[92:95]
    s_waitcnt vmcnt(24) lgkmcnt(3)
    v_accvgpr_read_b32 v176, a40
    v_accvgpr_read_b32 v177, a44
    v_accvgpr_read_b32 v178, a56
    v_accvgpr_read_b32 v179, a60
    v_max3_u32 v176, v176, v177, v178
    v_max_u32 v176, v176, v179
    v_cmp_eq_u32 vcc, -1, v176
    s_nop 1
    s_cbranch_vccnz adaLN_cond__ssm_conv_h3__glu_gated_geglu__prompt_kernel_bc1_1
adaLN_cond__ssm_conv_h3__glu_gated_geglu__prompt_kernel_bc1_1b:
    ds_read_b64_tr_b16 v[38:39], v58 offset:6400
    v_add_f32 v16, 1.0, v16
    v_mul_f32 v17, v17, v97
    v_mfma_f32_16x16x32_bf16 v[72:75], v[48:51], a[40:43], v[72:75]
    ds_read_b64_tr_b16 v[40:41], v56 offset:8192
    v_rcp_f32 v16, v16
    v_mfma_f32_16x16x32_bf16 v[72:75], v[52:55], a[56:59], v[72:75]
    s_nop 0
    ds_read_b64_tr_b16 v[42:43], v56 offset:8448
    buffer_load_dwordx4 a[252:255], v26, s[16:19], s53 offen offset:3072 sc1
    v_mul_f32 v113, v113, v97
    v_mfma_f32_16x16x32_bf16 v[76:79], v[48:51], a[44:47], v[76:79]
    ds_read_b64_tr_b16 v[44:45], v56 offset:10240
    v_mul_f32 v112, v112, v16
    v_mfma_f32_16x16x32_bf16 v[76:79], v[52:55], a[60:63], v[76:79]
    s_waitcnt lgkmcnt(3)
    ds_read_b64_tr_b16 v[46:47], v56 offset:10496
    v_mul_f32 v18, v98, v98
    v_mfma_f32_16x16x32_bf16 v[88:91], v[32:35], a[40:43], v[88:91]
    s_nop 0
    ds_read_b64_tr_b16 v[48:49], v58 offset:8192
    buffer_load_dwordx4 v[232:235], v27, s[16:19], s52 offen offset:0 sc1
    v_mfma_f32_16x16x32_bf16 v[88:91], v[36:39], a[56:59], v[88:91]
    ds_read_b64_tr_b16 v[50:51], v58 offset:8448
    v_fma_f32 v18, v18, v10, s35
    v_mfma_f32_16x16x32_bf16 v[92:95], v[32:35], a[44:47], v[92:95]
    ds_read_b64_tr_b16 v[52:53], v58 offset:10240
    v_mul_f32 v18, v18, v98
    v_mfma_f32_16x16x32_bf16 v[92:95], v[36:39], a[60:63], v[92:95]
    s_waitcnt vmcnt(22) lgkmcnt(3)
    v_accvgpr_read_b32 v176, a72
    v_accvgpr_read_b32 v177, a76
    v_accvgpr_read_b32 v178, a88
    v_accvgpr_read_b32 v179, a92
    v_max3_u32 v176, v176, v177, v178
    v_max_u32 v176, v176, v179
    v_cmp_eq_u32 vcc, -1, v176
    s_nop 1
    s_cbranch_vccnz adaLN_cond__ssm_conv_h3__glu_gated_geglu__prompt_kernel_bc1_2
adaLN_cond__ssm_conv_h3__glu_gated_geglu__prompt_kernel_bc1_2b:
    ds_read_b64_tr_b16 v[54:55], v58 offset:10496
    buffer_load_dwordx4 v[236:239], v27, s[16:19], s53 offen offset:0 sc1
    v_mfma_f32_16x16x32_bf16 v[72:75], v[40:43], a[72:75], v[72:75]
    ds_read_b64_tr_b16 v[32:33], v56 offset:12288
    v_mul_f32 v114, v114, v98
    v_mfma_f32_16x16x32_bf16 v[72:75], v[44:47], a[88:91], v[72:75]
    ds_read_b64_tr_b16 v[34:35], v56 offset:12544
    v_mul_f32 v19, v99, v99
    v_mfma_f32_16x16x32_bf16 v[76:79], v[40:43], a[76:79], v[76:79]
    s_nop 0
    ds_read_b64_tr_b16 v[36:37], v56 offset:14336
    buffer_load_dwordx4 v[248:251], v27, s[16:19], s52 offen offset:1024 sc1
    v_mfma_f32_16x16x32_bf16 v[76:79], v[44:47], a[92:95], v[76:79]
    s_waitcnt lgkmcnt(3)
    ds_read_b64_tr_b16 v[38:39], v56 offset:14592
    v_fma_f32 v19, v19, v10, s35
    v_mfma_f32_16x16x32_bf16 v[88:91], v[48:51], a[72:75], v[88:91]
    ds_read_b64_tr_b16 v[40:41], v58 offset:12288
    v_mul_f32 v19, v19, v99
    v_mfma_f32_16x16x32_bf16 v[88:91], v[52:55], a[88:91], v[88:91]
    s_nop 0
    ds_read_b64_tr_b16 v[42:43], v58 offset:12544
    buffer_load_dwordx4 v[252:255], v27, s[16:19], s53 offen offset:1024 sc1
    v_mfma_f32_16x16x32_bf16 v[92:95], v[48:51], a[76:79], v[92:95]
    ds_read_b64_tr_b16 v[44:45], v58 offset:14336
    v_mul_f32 v115, v115, v99
    v_mfma_f32_16x16x32_bf16 v[92:95], v[52:55], a[92:95], v[92:95]
    s_waitcnt vmcnt(20) lgkmcnt(3)
    v_accvgpr_read_b32 v176, a104
    v_accvgpr_read_b32 v177, a108
    v_accvgpr_read_b32 v178, a120
    v_accvgpr_read_b32 v179, a124
    v_max3_u32 v176, v176, v177, v178
    v_max_u32 v176, v176, v179
    v_cmp_eq_u32 vcc, -1, v176
    s_nop 1
    s_cbranch_vccnz adaLN_cond__ssm_conv_h3__glu_gated_geglu__prompt_kernel_bc1_3
adaLN_cond__ssm_conv_h3__glu_gated_geglu__prompt_kernel_bc1_3b:
    ds_read_b64_tr_b16 v[46:47], v58 offset:14592
    v_mul_f32 v20, v100, v100
    v_mfma_f32_16x16x32_bf16 v[72:75], v[32:35], a[104:107], v[72:75]
    ds_read_b64_tr_b16 v[48:49], v56 offset:16384
    v_fma_f32 v20, v20, v10, s35
    v_mfma_f32_16x16x32_bf16 v[72:75], v[36:39], a[120:123], v[72:75]
    ds_read_b64_tr_b16 v[50:51], v56 offset:16640
    v_mul_f32 v20, v20, v100
    v_mfma_f32_16x16x32_bf16 v[76:79], v[32:35], a[108:111], v[76:79]
    ds_read_b64_tr_b16 v[52:53], v56 offset:18432
    v_mul_f32 v116, v116, v100
    v_mfma_f32_16x16x32_bf16 v[76:79], v[36:39], a[124:127], v[76:79]
    s_waitcnt lgkmcnt(3)
    ds_read_b64_tr_b16 v[54:55], v56 offset:18688
    v_mul_f32 v21, v101, v101
    v_mfma_f32_16x16x32_bf16 v[88:91], v[40:43], a[104:107], v[88:91]
    ds_read_b64_tr_b16 v[32:33], v58 offset:16384
    v_fma_f32 v21, v21, v10, s35
    v_mfma_f32_16x16x32_bf16 v[88:91], v[44:47], a[120:123], v[88:91]
    ds_read_b64_tr_b16 v[34:35], v58 offset:16640
    v_mul_f32 v21, v21, v101
    v_mfma_f32_16x16x32_bf16 v[92:95], v[40:43], a[108:111], v[92:95]
    ds_read_b64_tr_b16 v[36:37], v58 offset:18432
    v_mul_f32 v117, v117, v101
    v_mfma_f32_16x16x32_bf16 v[92:95], v[44:47], a[124:127], v[92:95]
    s_waitcnt vmcnt(16) lgkmcnt(3)
    v_accvgpr_read_b32 v176, a136
    v_accvgpr_read_b32 v177, a140
    v_accvgpr_read_b32 v178, a152
    v_accvgpr_read_b32 v179, a156
    v_max3_u32 v176, v176, v177, v178
    v_max_u32 v176, v176, v179
    v_cmp_eq_u32 vcc, -1, v176
    s_nop 1
    s_cbranch_vccnz adaLN_cond__ssm_conv_h3__glu_gated_geglu__prompt_kernel_bc1_4
adaLN_cond__ssm_conv_h3__glu_gated_geglu__prompt_kernel_bc1_4b:
    ds_read_b64_tr_b16 v[38:39], v58 offset:18688
    v_mul_f32 v22, v102, v102
    v_mfma_f32_16x16x32_bf16 v[72:75], v[48:51], a[136:139], v[72:75]
    s_add_u32 m0, s34, 0
    ds_read_b64_tr_b16 v[40:41], v56 offset:20480
    v_fma_f32 v22, v22, v10, s35
    v_mfma_f32_16x16x32_bf16 v[72:75], v[52:55], a[152:155], v[72:75]
    ds_read_b64_tr_b16 v[42:43], v56 offset:20736
    v_mul_f32 v22, v22, v102
    v_mfma_f32_16x16x32_bf16 v[76:79], v[48:51], a[140:143], v[76:79]
    s_nop 0
    ds_read_b64_tr_b16 v[44:45], v56 offset:22528
    buffer_load_dwordx4 v7, s[4:7], s40 offen offset:0  lds
    v_mfma_f32_16x16x32_bf16 v[76:79], v[52:55], a[156:159], v[76:79]
    s_waitcnt lgkmcnt(3)
    ds_read_b64_tr_b16 v[46:47], v56 offset:22784
    v_mul_f32 v118, v118, v102
    v_mfma_f32_16x16x32_bf16 v[88:91], v[32:35], a[136:139], v[88:91]
    ds_read_b64_tr_b16 v[48:49], v58 offset:20480
    v_mul_f32 v23, v103, v103
    v_mfma_f32_16x16x32_bf16 v[88:91], v[36:39], a[152:155], v[88:91]
    ds_read_b64_tr_b16 v[50:51], v58 offset:20736
    v_fma_f32 v23, v23, v10, s35
    v_mfma_f32_16x16x32_bf16 v[92:95], v[32:35], a[140:143], v[92:95]
    ds_read_b64_tr_b16 v[52:53], v58 offset:22528
    v_mul_f32 v23, v23, v103
    v_mfma_f32_16x16x32_bf16 v[92:95], v[36:39], a[156:159], v[92:95]
    s_waitcnt vmcnt(13) lgkmcnt(3)
    v_accvgpr_read_b32 v176, a168
    v_accvgpr_read_b32 v177, a172
    v_accvgpr_read_b32 v178, a184
    v_accvgpr_read_b32 v179, a188
    v_max3_u32 v176, v176, v177, v178
    v_max_u32 v176, v176, v179
    v_cmp_eq_u32 vcc, -1, v176
    s_nop 1
    s_cbranch_vccnz adaLN_cond__ssm_conv_h3__glu_gated_geglu__prompt_kernel_bc1_5
adaLN_cond__ssm_conv_h3__glu_gated_geglu__prompt_kernel_bc1_5b:
    ds_read_b64_tr_b16 v[54:55], v58 offset:22784
    v_mul_f32 v119, v119, v103
    v_mfma_f32_16x16x32_bf16 v[72:75], v[40:43], a[168:171], v[72:75]
    s_nop 0
    ds_read_b64_tr_b16 v[32:33], v56 offset:24576
    buffer_load_dwordx4 v7, s[4:7], s41 offen offset:1024  lds
    v_mfma_f32_16x16x32_bf16 v[72:75], v[44:47], a[184:187], v[72:75]
    ds_read_b64_tr_b16 v[34:35], v56 offset:24832
    v_exp_f32 v17, v17
    v_mfma_f32_16x16x32_bf16 v[76:79], v[40:43], a[172:175], v[76:79]
    ds_read_b64_tr_b16 v[36:37], v56 offset:26624
    v_exp_f32 v18, v18
    v_mfma_f32_16x16x32_bf16 v[76:79], v[44:47], a[188:191], v[76:79]
    s_waitcnt lgkmcnt(3)
    ds_read_b64_tr_b16 v[38:39], v56 offset:26880
    v_add_f32 v17, 1.0, v17
    v_mfma_f32_16x16x32_bf16 v[88:91], v[48:51], a[168:171], v[88:91]
    ds_read_b64_tr_b16 v[40:41], v58 offset:24576
    v_add_f32 v18, 1.0, v18
    v_mfma_f32_16x16x32_bf16 v[88:91], v[52:55], a[184:187], v[88:91]
    ds_read_b64_tr_b16 v[42:43], v58 offset:24832
    v_rcp_f32 v17, v17
    v_mfma_f32_16x16x32_bf16 v[92:95], v[48:51], a[172:175], v[92:95]
    ds_read_b64_tr_b16 v[44:45], v58 offset:26624
    v_rcp_f32 v18, v18
    v_mfma_f32_16x16x32_bf16 v[92:95], v[52:55], a[188:191], v[92:95]
    s_waitcnt vmcnt(10) lgkmcnt(3)
    v_accvgpr_read_b32 v176, a200
    v_accvgpr_read_b32 v177, a204
    v_accvgpr_read_b32 v178, a216
    v_accvgpr_read_b32 v179, a220
    v_max3_u32 v176, v176, v177, v178
    v_max_u32 v176, v176, v179
    v_cmp_eq_u32 vcc, -1, v176
    s_nop 1
    s_cbranch_vccnz adaLN_cond__ssm_conv_h3__glu_gated_geglu__prompt_kernel_bc1_6
adaLN_cond__ssm_conv_h3__glu_gated_geglu__prompt_kernel_bc1_6b:
    ds_read_b64_tr_b16 v[46:47], v58 offset:26880
    buffer_load_dwordx4 v7, s[4:7], s42 offen offset:2048  lds
    v_mfma_f32_16x16x32_bf16 v[72:75], v[32:35], a[200:203], v[72:75]
    ds_read_b64_tr_b16 v[48:49], v56 offset:28672
    v_mul_f32 v113, v113, v17
    v_mfma_f32_16x16x32_bf16 v[72:75], v[36:39], a[216:219], v[72:75]
    ds_read_b64_tr_b16 v[50:51], v56 offset:28928
    v_cvt_pk_bf16_f32 v130, v112, v113
    v_mfma_f32_16x16x32_bf16 v[76:79], v[32:35], a[204:207], v[76:79]
    ds_read_b64_tr_b16 v[52:53], v56 offset:30720
    v_mul_f32 v114, v114, v18
    v_mfma_f32_16x16x32_bf16 v[76:79], v[36:39], a[220:223], v[76:79]
    s_waitcnt lgkmcnt(3)
    ds_read_b64_tr_b16 v[54:55], v56 offset:30976
    v_exp_f32 v19, v19
    v_mfma_f32_16x16x32_bf16 v[88:91], v[40:43], a[200:203], v[88:91]
    ds_read_b64_tr_b16 v[32:33], v58 offset:28672
    v_exp_f32 v20, v20
    v_mfma_f32_16x16x32_bf16 v[88:91], v[44:47], a[216:219], v[88:91]
    ds_read_b64_tr_b16 v[34:35], v58 offset:28928
    v_add_f32 v19, 1.0, v19
    v_mfma_f32_16x16x32_bf16 v[92:95], v[40:43], a[204:207], v[92:95]
    s_nop 0
    ds_read_b64_tr_b16 v[36:37], v58 offset:30720
    buffer_load_dwordx4 v7, s[4:7], s43 offen offset:3072  lds
    v_mfma_f32_16x16x32_bf16 v[92:95], v[44:47], a[220:223], v[92:95]
    s_waitcnt vmcnt(8) lgkmcnt(3)
    v_accvgpr_read_b32 v176, a232
    v_accvgpr_read_b32 v177, a236
    v_accvgpr_read_b32 v178, a248
    v_accvgpr_read_b32 v179, a252
    v_max3_u32 v176, v176, v177, v178
    v_max_u32 v176, v176, v179
    v_cmp_eq_u32 vcc, -1, v176
    s_nop 1
    s_cbranch_vccnz adaLN_cond__ssm_conv_h3__glu_gated_geglu__prompt_kernel_bc1_7
adaLN_cond__ssm_conv_h3__glu_gated_geglu__prompt_kernel_bc1_7b:
    ds_read_b64_tr_b16 v[38:39], v58 offset:30976
    v_add_f32 v20, 1.0, v20
    v_mfma_f32_16x16x32_bf16 v[72:75], v[48:51], a[232:235], v[72:75]
    ds_read_b64_tr_b16 v[40:41], v56 offset:32768
    v_rcp_f32 v19, v19
    v_mfma_f32_16x16x32_bf16 v[72:75], v[52:55], a[248:251], v[72:75]
    ds_read_b64_tr_b16 v[42:43], v56 offset:33024
    v_rcp_f32 v20, v20
    v_mfma_f32_16x16x32_bf16 v[76:79], v[48:51], a[236:239], v[76:79]
    ds_read_b64_tr_b16 v[44:45], v56 offset:34816
    v_mul_f32 v115, v115, v19
    v_mfma_f32_16x16x32_bf16 v[76:79], v[52:55], a[252:255], v[76:79]
    s_waitcnt lgkmcnt(3)
    ds_read_b64_tr_b16 v[46:47], v56 offset:35072
    v_cvt_pk_bf16_f32 v131, v114, v115
    v_mfma_f32_16x16x32_bf16 v[88:91], v[32:35], a[232:235], v[88:91]
    s_add_u32 m0, s34, 4096
    ds_read_b64_tr_b16 v[48:49], v58 offset:32768
    buffer_store_dwordx4 v[128:131], v8, s[16:19], s54 offen sc1
    v_mfma_f32_16x16x32_bf16 v[88:91], v[36:39], a[248:251], v[88:91]
    s_nop 0
    ds_read_b64_tr_b16 v[50:51], v58 offset:33024
    buffer_load_dwordx4 v7, s[4:7], s44 offen offset:0  lds
    v_mfma_f32_16x16x32_bf16 v[92:95], v[32:35], a[236:239], v[92:95]
    ds_read_b64_tr_b16 v[52:53], v58 offset:34816
    v_mul_f32 v116, v116, v20
    v_mfma_f32_16x16x32_bf16 v[92:95], v[36:39], a[252:255], v[92:95]
    s_waitcnt vmcnt(6) lgkmcnt(3)
    v_max3_u32 v176, v232, v236, v248
    v_max_u32 v176, v176, v252
    v_cmp_eq_u32 vcc, -1, v176
    s_nop 1
    s_cbranch_vccnz adaLN_cond__ssm_conv_h3__glu_gated_geglu__prompt_kernel_bc1_8
adaLN_cond__ssm_conv_h3__glu_gated_geglu__prompt_kernel_bc1_8b:
    ds_read_b64_tr_b16 v[54:55], v58 offset:35072
    v_exp_f32 v21, v21
    v_mfma_f32_16x16x32_bf16 v[72:75], v[40:43], v[232:235], v[72:75]
    ds_read_b64_tr_b16 v[32:33], v57 offset:0
    v_exp_f32 v22, v22
    v_mfma_f32_16x16x32_bf16 v[72:75], v[44:47], v[248:251], v[72:75]
    ds_read_b64_tr_b16 v[34:35], v57 offset:256
    v_add_f32 v21, 1.0, v21
    v_mfma_f32_16x16x32_bf16 v[76:79], v[40:43], v[236:239], v[76:79]
    ds_read_b64_tr_b16 v[36:37], v57 offset:2048
    v_add_f32 v22, 1.0, v22
    v_mfma_f32_16x16x32_bf16 v[76:79], v[44:47], v[252:255], v[76:79]
    s_waitcnt lgkmcnt(3)
    ds_read_b64_tr_b16 v[38:39], v57 offset:2304
    v_rcp_f32 v21, v21
    v_mfma_f32_16x16x32_bf16 v[88:91], v[48:51], v[232:235], v[88:91]
    s_nop 0
    ds_read_b64_tr_b16 v[40:41], v59 offset:0
    buffer_load_dwordx4 v7, s[4:7], s45 offen offset:1024  lds
    v_mfma_f32_16x16x32_bf16 v[88:91], v[52:55], v[248:251], v[88:91]
    ds_read_b64_tr_b16 v[42:43], v59 offset:256
    v_mul_f32 v117, v117, v21
    v_mfma_f32_16x16x32_bf16 v[92:95], v[48:51], v[236:239], v[92:95]
    ds_read_b64_tr_b16 v[44:45], v59 offset:2048
    v_cvt_pk_bf16_f32 v134, v116, v117
    v_mfma_f32_16x16x32_bf16 v[92:95], v[52:55], v[252:255], v[92:95]
    s_waitcnt lgkmcnt(3)
    ds_read_b64_tr_b16 v[46:47], v59 offset:2304
    v_rcp_f32 v22, v22
    s_nop 0
    v_mul_f32 v118, v118, v22
    v_exp_f32 v23, v23
    s_nop 0
    v_add_f32 v23, 1.0, v23
    v_rcp_f32 v23, v23
    s_nop 0
    v_mul_f32 v119, v119, v23
    v_cvt_pk_bf16_f32 v135, v118, v119
    buffer_store_dwordx4 v[132:135], v8, s[16:19], s55 offen sc1
    v_mfma_f32_16x16x32_bf16 v[96:99], v[32:35], a[0:3], 0
    s_lshl_b32 s49, s29, 10
    ds_read_b64_tr_b16 v[48:49], v57 offset:4096
    v_mfma_f32_16x16x32_bf16 v[96:99], v[36:39], a[16:19], v[96:99]
    v_mfma_f32_16x16x32_bf16 v[100:103], v[32:35], a[4:7], 0
    ds_read_b64_tr_b16 v[50:51], v57 offset:4352
    v_add_u32 v8, s49, v9
    v_mfma_f32_16x16x32_bf16 v[100:103], v[36:39], a[20:23], v[100:103]
    buffer_load_dwordx4 v7, s[4:7], s46 offen offset:2048  lds
    v_mul_f32 v16, v160, v160
    v_mfma_f32_16x16x32_bf16 v[104:107], v[32:35], a[8:11], 0
    ds_read_b64_tr_b16 v[52:53], v57 offset:6144
    v_fma_f32 v16, v16, v10, s35
    v_mfma_f32_16x16x32_bf16 v[104:107], v[36:39], a[24:27], v[104:107]
    v_mul_f32 v16, v16, v160
    v_mfma_f32_16x16x32_bf16 v[108:111], v[32:35], a[12:15], 0
    ds_read_b64_tr_b16 v[54:55], v57 offset:6400
    v_mul_f32 v168, v168, v160
    v_mfma_f32_16x16x32_bf16 v[108:111], v[36:39], a[28:31], v[108:111]
    s_waitcnt lgkmcnt(4)
    v_exp_f32 v16, v16
    v_mfma_f32_16x16x32_bf16 v[112:115], v[40:43], a[0:3], 0
    ds_read_b64_tr_b16 v[32:33], v59 offset:4096
    v_mul_f32 v17, v161, v161
    v_mfma_f32_16x16x32_bf16 v[112:115], v[44:47], a[16:19], v[112:115]
    buffer_load_dwordx4 v7, s[4:7], s47 offen offset:3072  lds
    v_add_f32 v16, 1.0, v16
    v_mfma_f32_16x16x32_bf16 v[116:119], v[40:43], a[4:7], 0
    ds_read_b64_tr_b16 v[34:35], v59 offset:4352
    v_fma_f32 v17, v17, v10, s35
    v_mfma_f32_16x16x32_bf16 v[116:119], v[44:47], a[20:23], v[116:119]
    v_rcp_f32 v16, v16
    v_mfma_f32_16x16x32_bf16 v[120:123], v[40:43], a[8:11], 0
    ds_read_b64_tr_b16 v[36:37], v59 offset:6144
    v_mul_f32 v17, v17, v161
    v_mfma_f32_16x16x32_bf16 v[120:123], v[44:47], a[24:27], v[120:123]
    v_exp_f32 v17, v17
    v_mfma_f32_16x16x32_bf16 v[124:127], v[40:43], a[12:15], 0
    s_add_u32 m0, s34, 8192
    ds_read_b64_tr_b16 v[38:39], v59 offset:6400
    v_mul_f32 v168, v168, v16
    v_mfma_f32_16x16x32_bf16 v[124:127], v[44:47], a[28:31], v[124:127]
    s_waitcnt lgkmcnt(4)
    v_mul_f32 v169, v169, v161
    v_mfma_f32_16x16x32_bf16 v[96:99], v[48:51], a[32:35], v[96:99]
    ds_read_b64_tr_b16 v[40:41], v57 offset:8192
    v_add_f32 v17, 1.0, v17
    v_mfma_f32_16x16x32_bf16 v[96:99], v[52:55], a[48:51], v[96:99]
    v_rcp_f32 v17, v17
    v_mfma_f32_16x16x32_bf16 v[100:103], v[48:51], a[36:39], v[100:103]
    ds_read_b64_tr_b16 v[42:43], v57 offset:8448
    v_mul_f32 v18, v162, v162
    v_mfma_f32_16x16x32_bf16 v[100:103], v[52:55], a[52:55], v[100:103]
    buffer_load_dwordx4 v7, s[4:7], s48 offen offset:0  lds
    v_mul_f32 v169, v169, v17
    v_mfma_f32_16x16x32_bf16 v[104:107], v[48:51], a[40:43], v[104:107]
    ds_read_b64_tr_b16 v[44:45], v57 offset:10240
    v_cvt_pk_bf16_f32 v128, v168, v169
    v_mfma_f32_16x16x32_bf16 v[104:107], v[52:55], a[56:59], v[104:107]
    s_add_u32 m0, s34, 36864
    v_fma_f32 v18, v18, v10, s35
    v_mfma_f32_16x16x32_bf16 v[108:111], v[48:51], a[44:47], v[108:111]
    ds_read_b64_tr_b16 v[46:47], v57 offset:10496
    v_mul_f32 v18, v18, v162
    v_mfma_f32_16x16x32_bf16 v[108:111], v[52:55], a[60:63], v[108:111]
    s_waitcnt lgkmcnt(4)
    v_exp_f32 v18, v18
    v_mfma_f32_16x16x32_bf16 v[112:115], v[32:35], a[32:35], v[112:115]
    ds_read_b64_tr_b16 v[48:49], v59 offset:8192
    v_mul_f32 v170, v170, v162
    v_mfma_f32_16x16x32_bf16 v[112:115], v[36:39], a[48:51], v[112:115]
    buffer_load_dwordx4 v7, s[8:11], s40 offen offset:0  lds
    v_add_f32 v18, 1.0, v18
    v_mfma_f32_16x16x32_bf16 v[116:119], v[32:35], a[36:39], v[116:119]
    ds_read_b64_tr_b16 v[50:51], v59 offset:8448
    v_mul_f32 v19, v163, v163
    v_mfma_f32_16x16x32_bf16 v[116:119], v[36:39], a[52:55], v[116:119]
    v_rcp_f32 v18, v18
    v_mfma_f32_16x16x32_bf16 v[120:123], v[32:35], a[40:43], v[120:123]
    ds_read_b64_tr_b16 v[52:53], v59 offset:10240
    v_fma_f32 v19, v19, v10, s35
    v_mfma_f32_16x16x32_bf16 v[120:123], v[36:39], a[56:59], v[120:123]
    v_mul_f32 v170, v170, v18
    v_mfma_f32_16x16x32_bf16 v[124:127], v[32:35], a[44:47], v[124:127]
    ds_read_b64_tr_b16 v[54:55], v59 offset:10496
    v_mul_f32 v19, v19, v163
    v_mfma_f32_16x16x32_bf16 v[124:127], v[36:39], a[60:63], v[124:127]
    s_waitcnt lgkmcnt(4)
    v_exp_f32 v19, v19
    v_mfma_f32_16x16x32_bf16 v[96:99], v[40:43], a[64:67], v[96:99]
    ds_read_b64_tr_b16 v[32:33], v57 offset:12288
    v_mul_f32 v171, v171, v163
    v_mfma_f32_16x16x32_bf16 v[96:99], v[44:47], a[80:83], v[96:99]
    buffer_load_dwordx4 v7, s[8:11], s41 offen offset:1024  lds
    v_add_f32 v19, 1.0, v19
    v_mfma_f32_16x16x32_bf16 v[100:103], v[40:43], a[68:71], v[100:103]
    ds_read_b64_tr_b16 v[34:35], v57 offset:12544
    v_mul_f32 v20, v164, v164
    v_mfma_f32_16x16x32_bf16 v[100:103], v[44:47], a[84:87], v[100:103]
    v_rcp_f32 v19, v19
    v_mfma_f32_16x16x32_bf16 v[104:107], v[40:43], a[72:75], v[104:107]
    ds_read_b64_tr_b16 v[36:37], v57 offset:14336
    v_fma_f32 v20, v20, v10, s35
    v_mfma_f32_16x16x32_bf16 v[104:107], v[44:47], a[88:91], v[104:107]
    buffer_load_dwordx4 v7, s[8:11], s42 offen offset:2048  lds
    v_mul_f32 v171, v171, v19
    v_mfma_f32_16x16x32_bf16 v[108:111], v[40:43], a[76:79], v[108:111]
    ds_read_b64_tr_b16 v[38:39], v57 offset:14592
    v_cvt_pk_bf16_f32 v129, v170, v171
    v_mfma_f32_16x16x32_bf16 v[108:111], v[44:47], a[92:95], v[108:111]
    s_waitcnt lgkmcnt(4)
    v_mul_f32 v20, v20, v164
    v_mfma_f32_16x16x32_bf16 v[112:115], v[48:51], a[64:67], v[112:115]
    ds_read_b64_tr_b16 v[40:41], v59 offset:12288
    v_mul_f32 v172, v172, v164
    v_mfma_f32_16x16x32_bf16 v[112:115], v[52:55], a[80:83], v[112:115]
    v_exp_f32 v20, v20
    v_mfma_f32_16x16x32_bf16 v[116:119], v[48:51], a[68:71], v[116:119]
    ds_read_b64_tr_b16 v[42:43], v59 offset:12544
    v_mul_f32 v21, v165, v165
    v_mfma_f32_16x16x32_bf16 v[116:119], v[52:55], a[84:87], v[116:119]
    buffer_load_dwordx4 v7, s[8:11], s43 offen offset:3072  lds
    v_add_f32 v20, 1.0, v20
    v_mfma_f32_16x16x32_bf16 v[120:123], v[48:51], a[72:75], v[120:123]
    ds_read_b64_tr_b16 v[44:45], v59 offset:14336
    v_fma_f32 v21, v21, v10, s35
    v_mfma_f32_16x16x32_bf16 v[120:123], v[52:55], a[88:91], v[120:123]
    v_rcp_f32 v20, v20
    v_mfma_f32_16x16x32_bf16 v[124:127], v[48:51], a[76:79], v[124:127]
    ds_read_b64_tr_b16 v[46:47], v59 offset:14592
    v_mul_f32 v21, v21, v165
    v_mfma_f32_16x16x32_bf16 v[124:127], v[52:55], a[92:95], v[124:127]
    s_waitcnt lgkmcnt(4)
    v_exp_f32 v21, v21
    v_mfma_f32_16x16x32_bf16 v[96:99], v[32:35], a[96:99], v[96:99]
    s_add_u32 m0, s34, 40960
    ds_read_b64_tr_b16 v[48:49], v57 offset:16384
    v_mul_f32 v172, v172, v20
    v_mfma_f32_16x16x32_bf16 v[96:99], v[36:39], a[112:115], v[96:99]
    v_mul_f32 v173, v173, v165
    v_mfma_f32_16x16x32_bf16 v[100:103], v[32:35], a[100:103], v[100:103]
    ds_read_b64_tr_b16 v[50:51], v57 offset:16640
    v_add_f32 v21, 1.0, v21
    v_mfma_f32_16x16x32_bf16 v[100:103], v[36:39], a[116:119], v[100:103]
    v_rcp_f32 v21, v21
    v_mfma_f32_16x16x32_bf16 v[104:107], v[32:35], a[104:107], v[104:107]
    ds_read_b64_tr_b16 v[52:53], v57 offset:18432
    v_mul_f32 v22, v166, v166
    v_mfma_f32_16x16x32_bf16 v[104:107], v[36:39], a[120:123], v[104:107]
    buffer_load_dwordx4 v7, s[8:11], s44 offen offset:0  lds
    v_mul_f32 v173, v173, v21
    v_mfma_f32_16x16x32_bf16 v[108:111], v[32:35], a[108:111], v[108:111]
    ds_read_b64_tr_b16 v[54:55], v57 offset:18688
    v_cvt_pk_bf16_f32 v132, v172, v173
    v_mfma_f32_16x16x32_bf16 v[108:111], v[36:39], a[124:127], v[108:111]
    s_waitcnt lgkmcnt(4)
    v_fma_f32 v22, v22, v10, s35
    v_mfma_f32_16x16x32_bf16 v[112:115], v[40:43], a[96:99], v[112:115]
    ds_read_b64_tr_b16 v[32:33], v59 offset:16384
    v_mul_f32 v22, v22, v166
    v_mfma_f32_16x16x32_bf16 v[112:115], v[44:47], a[112:115], v[112:115]
    v_exp_f32 v22, v22
    v_mfma_f32_16x16x32_bf16 v[116:119], v[40:43], a[100:103], v[116:119]
    ds_read_b64_tr_b16 v[34:35], v59 offset:16640
    v_mul_f32 v174, v174, v166
    v_mfma_f32_16x16x32_bf16 v[116:119], v[44:47], a[116:119], v[116:119]
    buffer_load_dwordx4 v7, s[8:11], s45 offen offset:1024  lds
    v_add_f32 v22, 1.0, v22
    v_mfma_f32_16x16x32_bf16 v[120:123], v[40:43], a[104:107], v[120:123]
    ds_read_b64_tr_b16 v[36:37], v59 offset:18432
    v_mul_f32 v23, v167, v167
    v_mfma_f32_16x16x32_bf16 v[120:123], v[44:47], a[120:123], v[120:123]
    v_rcp_f32 v22, v22
    v_mfma_f32_16x16x32_bf16 v[124:127], v[40:43], a[108:111], v[124:127]
    ds_read_b64_tr_b16 v[38:39], v59 offset:18688
    v_fma_f32 v23, v23, v10, s35
    v_mfma_f32_16x16x32_bf16 v[124:127], v[44:47], a[124:127], v[124:127]
    s_waitcnt lgkmcnt(4)
    v_mul_f32 v174, v174, v22
    v_mfma_f32_16x16x32_bf16 v[96:99], v[48:51], a[128:131], v[96:99]
    ds_read_b64_tr_b16 v[40:41], v57 offset:20480
    v_mul_f32 v23, v23, v167
    v_mfma_f32_16x16x32_bf16 v[96:99], v[52:55], a[144:147], v[96:99]
    v_exp_f32 v23, v23
    v_mfma_f32_16x16x32_bf16 v[100:103], v[48:51], a[132:135], v[100:103]
    ds_read_b64_tr_b16 v[42:43], v57 offset:20736
    v_mul_f32 v175, v175, v167
    v_mfma_f32_16x16x32_bf16 v[100:103], v[52:55], a[148:151], v[100:103]
    buffer_load_dwordx4 v7, s[8:11], s46 offen offset:2048  lds
    v_add_f32 v23, 1.0, v23
    v_mfma_f32_16x16x32_bf16 v[104:107], v[48:51], a[136:139], v[104:107]
    ds_read_b64_tr_b16 v[44:45], v57 offset:22528
    v_mul_f32 v28, v72, v72
    v_mfma_f32_16x16x32_bf16 v[104:107], v[52:55], a[152:155], v[104:107]
    v_rcp_f32 v23, v23
    v_mfma_f32_16x16x32_bf16 v[108:111], v[48:51], a[140:143], v[108:111]
    ds_read_b64_tr_b16 v[46:47], v57 offset:22784
    v_fma_f32 v28, v28, v10, s35
    v_mfma_f32_16x16x32_bf16 v[108:111], v[52:55], a[156:159], v[108:111]
    s_waitcnt lgkmcnt(4)
    buffer_load_dwordx4 v7, s[8:11], s47 offen offset:3072  lds
    v_mul_f32 v175, v175, v23
    v_mfma_f32_16x16x32_bf16 v[112:115], v[32:35], a[128:131], v[112:115]
    ds_read_b64_tr_b16 v[48:49], v59 offset:20480
    v_cvt_pk_bf16_f32 v133, v174, v175
    v_mfma_f32_16x16x32_bf16 v[112:115], v[36:39], a[144:147], v[112:115]
    v_mul_f32 v28, v28, v72
    v_mfma_f32_16x16x32_bf16 v[116:119], v[32:35], a[132:135], v[116:119]
    ds_read_b64_tr_b16 v[50:51], v59 offset:20736
    v_mul_f32 v88, v88, v72
    v_mfma_f32_16x16x32_bf16 v[116:119], v[36:39], a[148:151], v[116:119]
    v_exp_f32 v28, v28
    v_mfma_f32_16x16x32_bf16 v[120:123], v[32:35], a[136:139], v[120:123]
    s_add_u32 m0, s34, 45056
    ds_read_b64_tr_b16 v[52:53], v59 offset:22528
    v_mul_f32 v29, v73, v73
    v_mfma_f32_16x16x32_bf16 v[120:123], v[36:39], a[152:155], v[120:123]
    v_add_f32 v28, 1.0, v28
    v_mfma_f32_16x16x32_bf16 v[124:127], v[32:35], a[140:143], v[124:127]
    ds_read_b64_tr_b16 v[54:55], v59 offset:22784
    v_fma_f32 v29, v29, v10, s35
    v_mfma_f32_16x16x32_bf16 v[124:127], v[36:39], a[156:159], v[124:127]
    s_waitcnt lgkmcnt(4)
    v_rcp_f32 v28, v28
    v_mfma_f32_16x16x32_bf16 v[96:99], v[40:43], a[160:163], v[96:99]
    ds_read_b64_tr_b16 v[32:33], v57 offset:24576
    v_mul_f32 v29, v29, v73
    v_mfma_f32_16x16x32_bf16 v[96:99], v[44:47], a[176:179], v[96:99]
    v_exp_f32 v29, v29
    v_mfma_f32_16x16x32_bf16 v[100:103], v[40:43], a[164:167], v[100:103]
    ds_read_b64_tr_b16 v[34:35], v57 offset:24832
    v_mul_f32 v88, v88, v28
    v_mfma_f32_16x16x32_bf16 v[100:103], v[44:47], a[180:183], v[100:103]
    buffer_load_dwordx4 v7, s[8:11], s48 offen offset:0  lds
    v_mul_f32 v89, v89, v73
    v_mfma_f32_16x16x32_bf16 v[104:107], v[40:43], a[168:171], v[104:107]
    ds_read_b64_tr_b16 v[36:37], v57 offset:26624
    v_add_f32 v29, 1.0, v29
    v_mfma_f32_16x16x32_bf16 v[104:107], v[44:47], a[184:187], v[104:107]
    v_rcp_f32 v29, v29
    v_mfma_f32_16x16x32_bf16 v[108:111], v[40:43], a[172:175], v[108:111]
    ds_read_b64_tr_b16 v[38:39], v57 offset:26880
    v_mul_f32 v30, v74, v74
    v_mfma_f32_16x16x32_bf16 v[108:111], v[44:47], a[188:191], v[108:111]
    s_waitcnt lgkmcnt(4)
    buffer_load_dword v1, v146, s[4:7], s78 offen
    v_mul_f32 v89, v89, v29
    v_mfma_f32_16x16x32_bf16 v[112:115], v[48:51], a[160:163], v[112:115]
    ds_read_b64_tr_b16 v[40:41], v59 offset:24576
    v_cvt_pk_bf16_f32 v136, v88, v89
    v_mfma_f32_16x16x32_bf16 v[112:115], v[52:55], a[176:179], v[112:115]
    buffer_load_dword v1, v146, s[8:11], s78 offen
    v_fma_f32 v30, v30, v10, s35
    v_mfma_f32_16x16x32_bf16 v[116:119], v[48:51], a[164:167], v[116:119]
    ds_read_b64_tr_b16 v[42:43], v59 offset:24832
    v_mul_f32 v30, v30, v74
    v_mfma_f32_16x16x32_bf16 v[116:119], v[52:55], a[180:183], v[116:119]
    v_exp_f32 v30, v30
    v_mfma_f32_16x16x32_bf16 v[120:123], v[48:51], a[168:171], v[120:123]
    ds_read_b64_tr_b16 v[44:45], v59 offset:26624
    v_mul_f32 v90, v90, v74
    v_mfma_f32_16x16x32_bf16 v[120:123], v[52:55], a[184:187], v[120:123]
    v_add_f32 v30, 1.0, v30
    v_mfma_f32_16x16x32_bf16 v[124:127], v[48:51], a[172:175], v[124:127]
    ds_read_b64_tr_b16 v[46:47], v59 offset:26880
    v_mul_f32 v31, v75, v75
    v_mfma_f32_16x16x32_bf16 v[124:127], v[52:55], a[188:191], v[124:127]
    s_waitcnt lgkmcnt(4)
    v_rcp_f32 v30, v30
    v_mfma_f32_16x16x32_bf16 v[96:99], v[32:35], a[192:195], v[96:99]
    ds_read_b64_tr_b16 v[48:49], v57 offset:28672
    v_fma_f32 v31, v31, v10, s35
    v_mfma_f32_16x16x32_bf16 v[96:99], v[36:39], a[208:211], v[96:99]
    v_mul_f32 v90, v90, v30
    v_mfma_f32_16x16x32_bf16 v[100:103], v[32:35], a[196:199], v[100:103]
    ds_read_b64_tr_b16 v[50:51], v57 offset:28928
    v_mul_f32 v31, v31, v75
    v_mfma_f32_16x16x32_bf16 v[100:103], v[36:39], a[212:215], v[100:103]
    v_exp_f32 v31, v31
    v_mfma_f32_16x16x32_bf16 v[104:107], v[32:35], a[200:203], v[104:107]
    ds_read_b64_tr_b16 v[52:53], v57 offset:30720
    v_mul_f32 v91, v91, v75
    v_mfma_f32_16x16x32_bf16 v[104:107], v[36:39], a[216:219], v[104:107]
    v_add_f32 v31, 1.0, v31
    v_mfma_f32_16x16x32_bf16 v[108:111], v[32:35], a[204:207], v[108:111]
    ds_read_b64_tr_b16 v[54:55], v57 offset:30976
    v_mul_f32 v16, v76, v76
    v_mfma_f32_16x16x32_bf16 v[108:111], v[36:39], a[220:223], v[108:111]
    s_waitcnt lgkmcnt(4)
    v_rcp_f32 v31, v31
    v_mfma_f32_16x16x32_bf16 v[112:115], v[40:43], a[192:195], v[112:115]
    ds_read_b64_tr_b16 v[32:33], v59 offset:28672
    v_fma_f32 v16, v16, v10, s35
    v_mfma_f32_16x16x32_bf16 v[112:115], v[44:47], a[208:211], v[112:115]
    v_mul_f32 v91, v91, v31
    v_mfma_f32_16x16x32_bf16 v[116:119], v[40:43], a[196:199], v[116:119]
    ds_read_b64_tr_b16 v[34:35], v59 offset:28928
    v_cvt_pk_bf16_f32 v137, v90, v91
    v_mfma_f32_16x16x32_bf16 v[116:119], v[44:47], a[212:215], v[116:119]
    v_mul_f32 v16, v16, v76
    v_mfma_f32_16x16x32_bf16 v[120:123], v[40:43], a[200:203], v[120:123]
    ds_read_b64_tr_b16 v[36:37], v59 offset:30720
    v_mul_f32 v92, v92, v76
    v_mfma_f32_16x16x32_bf16 v[120:123], v[44:47], a[216:219], v[120:123]
    v_exp_f32 v16, v16
    v_mfma_f32_16x16x32_bf16 v[124:127], v[40:43], a[204:207], v[124:127]
    ds_read_b64_tr_b16 v[38:39], v59 offset:30976
    v_mul_f32 v17, v77, v77
    v_mfma_f32_16x16x32_bf16 v[124:127], v[44:47], a[220:223], v[124:127]
    s_waitcnt lgkmcnt(4)
    v_add_f32 v16, 1.0, v16
    v_mfma_f32_16x16x32_bf16 v[96:99], v[48:51], a[224:227], v[96:99]
    ds_read_b64_tr_b16 v[40:41], v57 offset:32768
    v_fma_f32 v17, v17, v10, s35
    v_mfma_f32_16x16x32_bf16 v[96:99], v[52:55], a[240:243], v[96:99]
    v_rcp_f32 v16, v16
    v_mfma_f32_16x16x32_bf16 v[100:103], v[48:51], a[228:231], v[100:103]
    ds_read_b64_tr_b16 v[42:43], v57 offset:33024
    v_mul_f32 v17, v17, v77
    v_mfma_f32_16x16x32_bf16 v[100:103], v[52:55], a[244:247], v[100:103]
    v_exp_f32 v17, v17
    v_mfma_f32_16x16x32_bf16 v[104:107], v[48:51], a[232:235], v[104:107]
    ds_read_b64_tr_b16 v[44:45], v57 offset:34816
    v_mul_f32 v92, v92, v16
    v_mfma_f32_16x16x32_bf16 v[104:107], v[52:55], a[248:251], v[104:107]
    v_mul_f32 v93, v93, v77
    v_mfma_f32_16x16x32_bf16 v[108:111], v[48:51], a[236:239], v[108:111]
    ds_read_b64_tr_b16 v[46:47], v57 offset:35072
    v_add_f32 v17, 1.0, v17
    v_mfma_f32_16x16x32_bf16 v[108:111], v[52:55], a[252:255], v[108:111]
    s_waitcnt lgkmcnt(4)
    v_rcp_f32 v17, v17
    v_mfma_f32_16x16x32_bf16 v[112:115], v[32:35], a[224:227], v[112:115]
    ds_read_b64_tr_b16 v[48:49], v59 offset:32768
    v_mul_f32 v18, v78, v78
    v_mfma_f32_16x16x32_bf16 v[112:115], v[36:39], a[240:243], v[112:115]
    ds_read_b64_tr_b16 v[50:51], v59 offset:33024
    v_mul_f32 v93, v93, v17
    v_mfma_f32_16x16x32_bf16 v[116:119], v[32:35], a[228:231], v[116:119]
    ds_read_b64_tr_b16 v[52:53], v59 offset:34816
    v_cvt_pk_bf16_f32 v140, v92, v93
    v_mfma_f32_16x16x32_bf16 v[116:119], v[36:39], a[244:247], v[116:119]
    ds_read_b64_tr_b16 v[54:55], v59 offset:35072
    v_fma_f32 v18, v18, v10, s35
    v_mfma_f32_16x16x32_bf16 v[120:123], v[32:35], a[232:235], v[120:123]
    v_mul_f32 v18, v18, v78
    v_mfma_f32_16x16x32_bf16 v[120:123], v[36:39], a[248:251], v[120:123]
    v_exp_f32 v18, v18
    v_mfma_f32_16x16x32_bf16 v[124:127], v[32:35], a[236:239], v[124:127]
    v_mul_f32 v94, v94, v78
    v_mfma_f32_16x16x32_bf16 v[124:127], v[36:39], a[252:255], v[124:127]
    s_waitcnt vmcnt(2) lgkmcnt(0)
    s_barrier
    v_add_f32 v18, 1.0, v18
    v_mfma_f32_16x16x32_bf16 v[96:99], v[40:43], v[224:227], v[96:99]
    ds_read_b64_tr_b16 v[32:33], v2 offset:0
    v_mul_f32 v19, v79, v79
    v_mfma_f32_16x16x32_bf16 v[96:99], v[44:47], v[240:243], v[96:99]
    v_rcp_f32 v18, v18
    v_mfma_f32_16x16x32_bf16 v[100:103], v[40:43], v[228:231], v[100:103]
    ds_read_b64_tr_b16 v[34:35], v2 offset:256
    v_fma_f32 v19, v19, v10, s35
    v_mfma_f32_16x16x32_bf16 v[100:103], v[44:47], v[244:247], v[100:103]
    v_mul_f32 v94, v94, v18
    v_mfma_f32_16x16x32_bf16 v[104:107], v[40:43], v[232:235], v[104:107]
    ds_read_b64_tr_b16 v[36:37], v2 offset:2048
    v_mul_f32 v19, v19, v79
    v_mfma_f32_16x16x32_bf16 v[104:107], v[44:47], v[248:251], v[104:107]
    v_exp_f32 v19, v19
    v_mfma_f32_16x16x32_bf16 v[108:111], v[40:43], v[236:239], v[108:111]
    ds_read_b64_tr_b16 v[38:39], v2 offset:2304
    v_mul_f32 v95, v95, v79
    v_mfma_f32_16x16x32_bf16 v[108:111], v[44:47], v[252:255], v[108:111]
    s_waitcnt lgkmcnt(4)
    v_add_f32 v19, 1.0, v19
    v_mfma_f32_16x16x32_bf16 v[112:115], v[48:51], v[224:227], v[112:115]
    ds_read_b64_tr_b16 v[40:41], v4 offset:0
    v_mfma_f32_16x16x32_bf16 v[112:115], v[52:55], v[240:243], v[112:115]
    v_rcp_f32 v19, v19
    v_mfma_f32_16x16x32_bf16 v[116:119], v[48:51], v[228:231], v[116:119]
    ds_read_b64_tr_b16 v[42:43], v4 offset:256
    v_mfma_f32_16x16x32_bf16 v[116:119], v[52:55], v[244:247], v[116:119]
    v_mul_f32 v95, v95, v19
    v_mfma_f32_16x16x32_bf16 v[120:123], v[48:51], v[232:235], v[120:123]
    ds_read_b64_tr_b16 v[44:45], v4 offset:2048
    v_cvt_pk_bf16_f32 v141, v94, v95
    v_mfma_f32_16x16x32_bf16 v[120:123], v[52:55], v[248:251], v[120:123]
    v_mfma_f32_16x16x32_bf16 v[124:127], v[48:51], v[236:239], v[124:127]
    ds_read_b64_tr_b16 v[46:47], v4 offset:2304
    v_mfma_f32_16x16x32_bf16 v[124:127], v[52:55], v[252:255], v[124:127]
    s_waitcnt lgkmcnt(4)
    s_lshl_b32 s49, s82, 6
    v_add_u32 v7, s49, v6
    s_add_u32 s36, s36, 0x6c000
    s_add_u32 s49, s67, 4816896
    v_add_u32 v13, 1, v148
    s_mov_b64 exec, 1
    buffer_store_dword v13, off, s[16:19], s49 sc1
    s_mov_b64 exec, -1
    v_mfma_f32_16x16x32_bf16 v[64:67], v[32:35], a[0:3], 0
    s_add_u32 m0, s34, 73728
    ds_read_b64_tr_b16 v[48:49], v2 offset:4096
    v_mfma_f32_16x16x32_bf16 v[64:67], v[36:39], a[16:19], v[64:67]
    buffer_load_dwordx4 v7, s[4:7], s40 offen offset:0  lds
    v_mfma_f32_16x16x32_bf16 v[68:71], v[32:35], a[4:7], 0
    s_mov_b32 s3, 4784128
    ds_read_b64_tr_b16 v[50:51], v2 offset:4352
    v_mul_f32 v16, v96, v96
    v_mfma_f32_16x16x32_bf16 v[68:71], v[36:39], a[20:23], v[68:71]
    v_fma_f32 v16, v16, v10, s35
    v_mfma_f32_16x16x32_bf16 v[72:75], v[32:35], a[8:11], 0
    buffer_load_dword v11, v12, s[16:19], s3 offen sc1
    ds_read_b64_tr_b16 v[52:53], v2 offset:6144
    v_mul_f32 v16, v16, v96
    v_mfma_f32_16x16x32_bf16 v[72:75], v[36:39], a[24:27], v[72:75]
    v_exp_f32 v16, v16
    v_mfma_f32_16x16x32_bf16 v[76:79], v[32:35], a[12:15], 0
    ds_read_b64_tr_b16 v[54:55], v2 offset:6400
    v_mul_f32 v112, v112, v96
    v_mfma_f32_16x16x32_bf16 v[76:79], v[36:39], a[28:31], v[76:79]
    s_waitcnt lgkmcnt(4)
    v_add_f32 v16, 1.0, v16
    v_mfma_f32_16x16x32_bf16 v[80:83], v[40:43], a[0:3], 0
    ds_read_b64_tr_b16 v[32:33], v4 offset:4096
    v_mul_f32 v17, v97, v97
    v_mfma_f32_16x16x32_bf16 v[80:83], v[44:47], a[16:19], v[80:83]
    v_rcp_f32 v16, v16
    v_mfma_f32_16x16x32_bf16 v[84:87], v[40:43], a[4:7], 0
    ds_read_b64_tr_b16 v[34:35], v4 offset:4352
    v_fma_f32 v17, v17, v10, s35
    v_mfma_f32_16x16x32_bf16 v[84:87], v[44:47], a[20:23], v[84:87]
    v_mul_f32 v112, v112, v16
    v_mfma_f32_16x16x32_bf16 v[88:91], v[40:43], a[8:11], 0
    ds_read_b64_tr_b16 v[36:37], v4 offset:6144
    v_mul_f32 v17, v17, v97
    v_mfma_f32_16x16x32_bf16 v[88:91], v[44:47], a[24:27], v[88:91]
    v_exp_f32 v17, v17
    v_mfma_f32_16x16x32_bf16 v[92:95], v[40:43], a[12:15], 0
    ds_read_b64_tr_b16 v[38:39], v4 offset:6400
    v_mul_f32 v113, v113, v97
    v_mfma_f32_16x16x32_bf16 v[92:95], v[44:47], a[28:31], v[92:95]
    s_waitcnt lgkmcnt(4)
    buffer_load_dwordx4 v7, s[4:7], s41 offen offset:1024  lds
    v_add_f32 v17, 1.0, v17
    v_mfma_f32_16x16x32_bf16 v[64:67], v[48:51], a[32:35], v[64:67]
    ds_read_b64_tr_b16 v[40:41], v2 offset:8192
    v_mul_f32 v18, v98, v98
    v_mfma_f32_16x16x32_bf16 v[64:67], v[52:55], a[48:51], v[64:67]
    v_rcp_f32 v17, v17
    v_mfma_f32_16x16x32_bf16 v[68:71], v[48:51], a[36:39], v[68:71]
    ds_read_b64_tr_b16 v[42:43], v2 offset:8448
    v_fma_f32 v18, v18, v10, s35
    v_mfma_f32_16x16x32_bf16 v[68:71], v[52:55], a[52:55], v[68:71]
    v_mul_f32 v113, v113, v17
    v_mfma_f32_16x16x32_bf16 v[72:75], v[48:51], a[40:43], v[72:75]
    ds_read_b64_tr_b16 v[44:45], v2 offset:10240
    v_cvt_pk_bf16_f32 v130, v112, v113
    v_mfma_f32_16x16x32_bf16 v[72:75], v[52:55], a[56:59], v[72:75]
    v_mul_f32 v18, v18, v98
    v_mfma_f32_16x16x32_bf16 v[76:79], v[48:51], a[44:47], v[76:79]
    ds_read_b64_tr_b16 v[46:47], v2 offset:10496
    v_mul_f32 v114, v114, v98
    v_mfma_f32_16x16x32_bf16 v[76:79], v[52:55], a[60:63], v[76:79]
    s_waitcnt lgkmcnt(4)
    v_exp_f32 v18, v18
    v_mfma_f32_16x16x32_bf16 v[80:83], v[32:35], a[32:35], v[80:83]
    ds_read_b64_tr_b16 v[48:49], v4 offset:8192
    v_mul_f32 v19, v99, v99
    v_mfma_f32_16x16x32_bf16 v[80:83], v[36:39], a[48:51], v[80:83]
    buffer_load_dwordx4 v7, s[4:7], s42 offen offset:2048  lds
    v_add_f32 v18, 1.0, v18
    v_mfma_f32_16x16x32_bf16 v[84:87], v[32:35], a[36:39], v[84:87]
    ds_read_b64_tr_b16 v[50:51], v4 offset:8448
    v_fma_f32 v19, v19, v10, s35
    v_mfma_f32_16x16x32_bf16 v[84:87], v[36:39], a[52:55], v[84:87]
    v_rcp_f32 v18, v18
    v_mfma_f32_16x16x32_bf16 v[88:91], v[32:35], a[40:43], v[88:91]
    ds_read_b64_tr_b16 v[52:53], v4 offset:10240
    v_mul_f32 v19, v19, v99
    v_mfma_f32_16x16x32_bf16 v[88:91], v[36:39], a[56:59], v[88:91]
    v_exp_f32 v19, v19
    v_mfma_f32_16x16x32_bf16 v[92:95], v[32:35], a[44:47], v[92:95]
    ds_read_b64_tr_b16 v[54:55], v4 offset:10496
    v_mul_f32 v114, v114, v18
    v_mfma_f32_16x16x32_bf16 v[92:95], v[36:39], a[60:63], v[92:95]
    s_waitcnt lgkmcnt(4)
    v_mul_f32 v115, v115, v99
    v_mfma_f32_16x16x32_bf16 v[64:67], v[40:43], a[64:67], v[64:67]
    ds_read_b64_tr_b16 v[32:33], v2 offset:12288
    v_add_f32 v19, 1.0, v19
    v_mfma_f32_16x16x32_bf16 v[64:67], v[44:47], a[80:83], v[64:67]
    v_rcp_f32 v19, v19
    v_mfma_f32_16x16x32_bf16 v[68:71], v[40:43], a[68:71], v[68:71]
    ds_read_b64_tr_b16 v[34:35], v2 offset:12544
    v_mul_f32 v20, v100, v100
    v_mfma_f32_16x16x32_bf16 v[68:71], v[44:47], a[84:87], v[68:71]
    v_mul_f32 v115, v115, v19
    v_mfma_f32_16x16x32_bf16 v[72:75], v[40:43], a[72:75], v[72:75]
    ds_read_b64_tr_b16 v[36:37], v2 offset:14336
    v_cvt_pk_bf16_f32 v131, v114, v115
    v_mfma_f32_16x16x32_bf16 v[72:75], v[44:47], a[88:91], v[72:75]
    buffer_load_dwordx4 v7, s[4:7], s43 offen offset:3072  lds
    v_fma_f32 v20, v20, v10, s35
    v_mfma_f32_16x16x32_bf16 v[76:79], v[40:43], a[76:79], v[76:79]
    ds_read_b64_tr_b16 v[38:39], v2 offset:14592
    v_mul_f32 v20, v20, v100
    v_mfma_f32_16x16x32_bf16 v[76:79], v[44:47], a[92:95], v[76:79]
    s_waitcnt lgkmcnt(4)
    v_exp_f32 v20, v20
    v_mfma_f32_16x16x32_bf16 v[80:83], v[48:51], a[64:67], v[80:83]
    ds_read_b64_tr_b16 v[40:41], v4 offset:12288
    v_mul_f32 v116, v116, v100
    v_mfma_f32_16x16x32_bf16 v[80:83], v[52:55], a[80:83], v[80:83]
    buffer_store_dwordx4 v[128:131], v8, s[16:19], s54 offen sc1
    v_add_f32 v20, 1.0, v20
    v_mfma_f32_16x16x32_bf16 v[84:87], v[48:51], a[68:71], v[84:87]
    ds_read_b64_tr_b16 v[42:43], v4 offset:12544
    v_mul_f32 v21, v101, v101
    v_mfma_f32_16x16x32_bf16 v[84:87], v[52:55], a[84:87], v[84:87]
    v_rcp_f32 v20, v20
    v_mfma_f32_16x16x32_bf16 v[88:91], v[48:51], a[72:75], v[88:91]
    ds_read_b64_tr_b16 v[44:45], v4 offset:14336
    v_fma_f32 v21, v21, v10, s35
    v_mfma_f32_16x16x32_bf16 v[88:91], v[52:55], a[88:91], v[88:91]
    v_mul_f32 v116, v116, v20
    v_mfma_f32_16x16x32_bf16 v[92:95], v[48:51], a[76:79], v[92:95]
    s_add_u32 m0, s34, 77824
    ds_read_b64_tr_b16 v[46:47], v4 offset:14592
    v_mul_f32 v21, v21, v101
    v_mfma_f32_16x16x32_bf16 v[92:95], v[52:55], a[92:95], v[92:95]
    s_waitcnt lgkmcnt(4)
    v_exp_f32 v21, v21
    v_mfma_f32_16x16x32_bf16 v[64:67], v[32:35], a[96:99], v[64:67]
    ds_read_b64_tr_b16 v[48:49], v2 offset:16384
    v_mul_f32 v117, v117, v101
    v_mfma_f32_16x16x32_bf16 v[64:67], v[36:39], a[112:115], v[64:67]
    buffer_load_dwordx4 v7, s[4:7], s44 offen offset:0  lds
    v_add_f32 v21, 1.0, v21
    v_mfma_f32_16x16x32_bf16 v[68:71], v[32:35], a[100:103], v[68:71]
    ds_read_b64_tr_b16 v[50:51], v2 offset:16640
    v_mul_f32 v22, v102, v102
    v_mfma_f32_16x16x32_bf16 v[68:71], v[36:39], a[116:119], v[68:71]
    v_rcp_f32 v21, v21
    v_mfma_f32_16x16x32_bf16 v[72:75], v[32:35], a[104:107], v[72:75]
    ds_read_b64_tr_b16 v[52:53], v2 offset:18432
    v_fma_f32 v22, v22, v10, s35
    v_mfma_f32_16x16x32_bf16 v[72:75], v[36:39], a[120:123], v[72:75]
    v_mul_f32 v117, v117, v21
    v_mfma_f32_16x16x32_bf16 v[76:79], v[32:35], a[108:111], v[76:79]
    ds_read_b64_tr_b16 v[54:55], v2 offset:18688
    v_cvt_pk_bf16_f32 v134, v116, v117
    v_mfma_f32_16x16x32_bf16 v[76:79], v[36:39], a[124:127], v[76:79]
    s_waitcnt lgkmcnt(4)
    v_mul_f32 v22, v22, v102
    v_mfma_f32_16x16x32_bf16 v[80:83], v[40:43], a[96:99], v[80:83]
    ds_read_b64_tr_b16 v[32:33], v4 offset:16384
    v_mul_f32 v118, v118, v102
    v_mfma_f32_16x16x32_bf16 v[80:83], v[44:47], a[112:115], v[80:83]
    v_exp_f32 v22, v22
    v_mfma_f32_16x16x32_bf16 v[84:87], v[40:43], a[100:103], v[84:87]
    ds_read_b64_tr_b16 v[34:35], v4 offset:16640
    v_mul_f32 v23, v103, v103
    v_mfma_f32_16x16x32_bf16 v[84:87], v[44:47], a[116:119], v[84:87]
    v_add_f32 v22, 1.0, v22
    v_mfma_f32_16x16x32_bf16 v[88:91], v[40:43], a[104:107], v[88:91]
    ds_read_b64_tr_b16 v[36:37], v4 offset:18432
    v_fma_f32 v23, v23, v10, s35
    v_mfma_f32_16x16x32_bf16 v[88:91], v[44:47], a[120:123], v[88:91]
    v_rcp_f32 v22, v22
    v_mfma_f32_16x16x32_bf16 v[92:95], v[40:43], a[108:111], v[92:95]
    ds_read_b64_tr_b16 v[38:39], v4 offset:18688
    v_mul_f32 v23, v23, v103
    v_mfma_f32_16x16x32_bf16 v[92:95], v[44:47], a[124:127], v[92:95]
    s_waitcnt lgkmcnt(4)
    v_exp_f32 v23, v23
    v_mfma_f32_16x16x32_bf16 v[64:67], v[48:51], a[128:131], v[64:67]
    ds_read_b64_tr_b16 v[40:41], v2 offset:20480
    v_mul_f32 v118, v118, v22
    v_mfma_f32_16x16x32_bf16 v[64:67], v[52:55], a[144:147], v[64:67]
    buffer_load_dwordx4 v7, s[4:7], s45 offen offset:1024  lds
    v_mul_f32 v119, v119, v103
    v_mfma_f32_16x16x32_bf16 v[68:71], v[48:51], a[132:135], v[68:71]
    ds_read_b64_tr_b16 v[42:43], v2 offset:20736
    v_add_f32 v23, 1.0, v23
    v_mfma_f32_16x16x32_bf16 v[68:71], v[52:55], a[148:151], v[68:71]
    v_rcp_f32 v23, v23
    v_mfma_f32_16x16x32_bf16 v[72:75], v[48:51], a[136:139], v[72:75]
    ds_read_b64_tr_b16 v[44:45], v2 offset:22528
    v_mul_f32 v28, v104, v104
    v_mfma_f32_16x16x32_bf16 v[72:75], v[52:55], a[152:155], v[72:75]
    v_mul_f32 v119, v119, v23
    v_mfma_f32_16x16x32_bf16 v[76:79], v[48:51], a[140:143], v[76:79]
    ds_read_b64_tr_b16 v[46:47], v2 offset:22784
    v_cvt_pk_bf16_f32 v135, v118, v119
    v_mfma_f32_16x16x32_bf16 v[76:79], v[52:55], a[156:159], v[76:79]
    s_waitcnt lgkmcnt(4)
    buffer_store_dwordx4 v[132:135], v8, s[16:19], s55 offen sc1
    v_fma_f32 v28, v28, v10, s35
    v_mfma_f32_16x16x32_bf16 v[80:83], v[32:35], a[128:131], v[80:83]
    ds_read_b64_tr_b16 v[48:49], v4 offset:20480
    v_mul_f32 v28, v28, v104
    v_mfma_f32_16x16x32_bf16 v[80:83], v[36:39], a[144:147], v[80:83]
    v_exp_f32 v28, v28
    v_mfma_f32_16x16x32_bf16 v[84:87], v[32:35], a[132:135], v[84:87]
    ds_read_b64_tr_b16 v[50:51], v4 offset:20736
    v_mul_f32 v120, v120, v104
    v_mfma_f32_16x16x32_bf16 v[84:87], v[36:39], a[148:151], v[84:87]
    buffer_load_dwordx4 v7, s[4:7], s46 offen offset:2048  lds
    v_add_f32 v28, 1.0, v28
    v_mfma_f32_16x16x32_bf16 v[88:91], v[32:35], a[136:139], v[88:91]
    ds_read_b64_tr_b16 v[52:53], v4 offset:22528
    v_mul_f32 v29, v105, v105
    v_mfma_f32_16x16x32_bf16 v[88:91], v[36:39], a[152:155], v[88:91]
    v_rcp_f32 v28, v28
    v_mfma_f32_16x16x32_bf16 v[92:95], v[32:35], a[140:143], v[92:95]
    ds_read_b64_tr_b16 v[54:55], v4 offset:22784
    v_fma_f32 v29, v29, v10, s35
    v_mfma_f32_16x16x32_bf16 v[92:95], v[36:39], a[156:159], v[92:95]
    s_waitcnt lgkmcnt(4)
    v_mul_f32 v120, v120, v28
    v_mfma_f32_16x16x32_bf16 v[64:67], v[40:43], a[160:163], v[64:67]
    ds_read_b64_tr_b16 v[32:33], v2 offset:24576
    v_mul_f32 v29, v29, v105
    v_mfma_f32_16x16x32_bf16 v[64:67], v[44:47], a[176:179], v[64:67]
    v_exp_f32 v29, v29
    v_mfma_f32_16x16x32_bf16 v[68:71], v[40:43], a[164:167], v[68:71]
    ds_read_b64_tr_b16 v[34:35], v2 offset:24832
    v_mul_f32 v121, v121, v105
    v_mfma_f32_16x16x32_bf16 v[68:71], v[44:47], a[180:183], v[68:71]
    v_add_f32 v29, 1.0, v29
    v_mfma_f32_16x16x32_bf16 v[72:75], v[40:43], a[168:171], v[72:75]
    ds_read_b64_tr_b16 v[36:37], v2 offset:26624
    v_mul_f32 v30, v106, v106
    v_mfma_f32_16x16x32_bf16 v[72:75], v[44:47], a[184:187], v[72:75]
    v_rcp_f32 v29, v29
    v_mfma_f32_16x16x32_bf16 v[76:79], v[40:43], a[172:175], v[76:79]
    ds_read_b64_tr_b16 v[38:39], v2 offset:26880
    v_fma_f32 v30, v30, v10, s35
    v_mfma_f32_16x16x32_bf16 v[76:79], v[44:47], a[188:191], v[76:79]
    s_waitcnt lgkmcnt(4)
    buffer_load_dwordx4 v7, s[4:7], s47 offen offset:3072  lds
    v_mul_f32 v121, v121, v29
    v_mfma_f32_16x16x32_bf16 v[80:83], v[48:51], a[160:163], v[80:83]
    ds_read_b64_tr_b16 v[40:41], v4 offset:24576
    v_cvt_pk_bf16_f32 v138, v120, v121
    v_mfma_f32_16x16x32_bf16 v[80:83], v[52:55], a[176:179], v[80:83]
    v_mul_f32 v30, v30, v106
    v_mfma_f32_16x16x32_bf16 v[84:87], v[48:51], a[164:167], v[84:87]
    ds_read_b64_tr_b16 v[42:43], v4 offset:24832
    v_mul_f32 v122, v122, v106
    v_mfma_f32_16x16x32_bf16 v[84:87], v[52:55], a[180:183], v[84:87]
    v_exp_f32 v30, v30
    v_mfma_f32_16x16x32_bf16 v[88:91], v[48:51], a[168:171], v[88:91]
    ds_read_b64_tr_b16 v[44:45], v4 offset:26624
    v_mul_f32 v31, v107, v107
    v_mfma_f32_16x16x32_bf16 v[88:91], v[52:55], a[184:187], v[88:91]
    v_add_f32 v30, 1.0, v30
    v_mfma_f32_16x16x32_bf16 v[92:95], v[48:51], a[172:175], v[92:95]
    s_add_u32 m0, s34, 81920
    ds_read_b64_tr_b16 v[46:47], v4 offset:26880
    v_fma_f32 v31, v31, v10, s35
    v_mfma_f32_16x16x32_bf16 v[92:95], v[52:55], a[188:191], v[92:95]
    s_waitcnt lgkmcnt(4)
    v_rcp_f32 v30, v30
    v_mfma_f32_16x16x32_bf16 v[64:67], v[32:35], a[192:195], v[64:67]
    ds_read_b64_tr_b16 v[48:49], v2 offset:28672
    v_mul_f32 v31, v31, v107
    v_mfma_f32_16x16x32_bf16 v[64:67], v[36:39], a[208:211], v[64:67]
    v_exp_f32 v31, v31
    v_mfma_f32_16x16x32_bf16 v[68:71], v[32:35], a[196:199], v[68:71]
    ds_read_b64_tr_b16 v[50:51], v2 offset:28928
    v_mul_f32 v122, v122, v30
    v_mfma_f32_16x16x32_bf16 v[68:71], v[36:39], a[212:215], v[68:71]
    buffer_load_dwordx4 v7, s[4:7], s48 offen offset:0  lds
    v_mul_f32 v123, v123, v107
    v_mfma_f32_16x16x32_bf16 v[72:75], v[32:35], a[200:203], v[72:75]
    s_waitcnt vmcnt(10)
    v_subrev_u32 v11, s70, v11
    v_cmp_lt_u32 vcc, 5, v11
    ds_read_b64_tr_b16 v[52:53], v2 offset:30720
    v_add_f32 v31, 1.0, v31
    v_mfma_f32_16x16x32_bf16 v[72:75], v[36:39], a[216:219], v[72:75]
    v_rcp_f32 v31, v31
    v_mfma_f32_16x16x32_bf16 v[76:79], v[32:35], a[204:207], v[76:79]
    s_cbranch_vccnz adaLN_cond__ssm_conv_h3__glu_gated_geglu__prompt_kernel_slx
adaLN_cond__ssm_conv_h3__glu_gated_geglu__prompt_kernel_slxb:
    ds_read_b64_tr_b16 v[54:55], v2 offset:30976
    v_mul_f32 v16, v108, v108
    v_mfma_f32_16x16x32_bf16 v[76:79], v[36:39], a[220:223], v[76:79]
    s_waitcnt lgkmcnt(4)
    v_mul_f32 v123, v123, v31
    v_mfma_f32_16x16x32_bf16 v[80:83], v[40:43], a[192:195], v[80:83]
    ds_read_b64_tr_b16 v[32:33], v4 offset:28672
    v_cvt_pk_bf16_f32 v139, v122, v123
    v_mfma_f32_16x16x32_bf16 v[80:83], v[44:47], a[208:211], v[80:83]
    buffer_store_dwordx4 v[136:139], v8, s[16:19], s56 offen sc1
    v_fma_f32 v16, v16, v10, s35
    v_mfma_f32_16x16x32_bf16 v[84:87], v[40:43], a[196:199], v[84:87]
    s_add_u32 m0, s34, 110592
    ds_read_b64_tr_b16 v[34:35], v4 offset:28928
    v_mul_f32 v16, v16, v108
    v_mfma_f32_16x16x32_bf16 v[84:87], v[44:47], a[212:215], v[84:87]
    v_exp_f32 v16, v16
    v_mfma_f32_16x16x32_bf16 v[88:91], v[40:43], a[200:203], v[88:91]
    ds_read_b64_tr_b16 v[36:37], v4 offset:30720
    v_mul_f32 v124, v124, v108
    v_mfma_f32_16x16x32_bf16 v[88:91], v[44:47], a[216:219], v[88:91]
    buffer_load_dwordx4 v7, s[8:11], s40 offen offset:0  lds
    v_add_f32 v16, 1.0, v16
    v_mfma_f32_16x16x32_bf16 v[92:95], v[40:43], a[204:207], v[92:95]
    ds_read_b64_tr_b16 v[38:39], v4 offset:30976
    v_mul_f32 v17, v109, v109
    v_mfma_f32_16x16x32_bf16 v[92:95], v[44:47], a[220:223], v[92:95]
    s_waitcnt lgkmcnt(4)
    v_rcp_f32 v16, v16
    v_mfma_f32_16x16x32_bf16 v[64:67], v[48:51], a[224:227], v[64:67]
    ds_read_b64_tr_b16 v[40:41], v2 offset:32768
    v_fma_f32 v17, v17, v10, s35
    v_mfma_f32_16x16x32_bf16 v[64:67], v[52:55], a[240:243], v[64:67]
    v_mul_f32 v124, v124, v16
    v_mfma_f32_16x16x32_bf16 v[68:71], v[48:51], a[228:231], v[68:71]
    ds_read_b64_tr_b16 v[42:43], v2 offset:33024
    v_mul_f32 v17, v17, v109
    v_mfma_f32_16x16x32_bf16 v[68:71], v[52:55], a[244:247], v[68:71]
    v_exp_f32 v17, v17
    v_mfma_f32_16x16x32_bf16 v[72:75], v[48:51], a[232:235], v[72:75]
    ds_read_b64_tr_b16 v[44:45], v2 offset:34816
    v_mul_f32 v125, v125, v109
    v_mfma_f32_16x16x32_bf16 v[72:75], v[52:55], a[248:251], v[72:75]
    v_add_f32 v17, 1.0, v17
    v_mfma_f32_16x16x32_bf16 v[76:79], v[48:51], a[236:239], v[76:79]
    ds_read_b64_tr_b16 v[46:47], v2 offset:35072
    v_mul_f32 v18, v110, v110
    v_mfma_f32_16x16x32_bf16 v[76:79], v[52:55], a[252:255], v[76:79]
    s_waitcnt lgkmcnt(4)
    v_rcp_f32 v17, v17
    v_mfma_f32_16x16x32_bf16 v[80:83], v[32:35], a[224:227], v[80:83]
    ds_read_b64_tr_b16 v[48:49], v4 offset:32768
    v_fma_f32 v18, v18, v10, s35
    v_mfma_f32_16x16x32_bf16 v[80:83], v[36:39], a[240:243], v[80:83]
    buffer_load_dwordx4 v7, s[8:11], s41 offen offset:1024  lds
    v_mul_f32 v125, v125, v17
    v_mfma_f32_16x16x32_bf16 v[84:87], v[32:35], a[228:231], v[84:87]
    ds_read_b64_tr_b16 v[50:51], v4 offset:33024
    v_cvt_pk_bf16_f32 v142, v124, v125
    v_mfma_f32_16x16x32_bf16 v[84:87], v[36:39], a[244:247], v[84:87]
    v_mul_f32 v18, v18, v110
    v_mfma_f32_16x16x32_bf16 v[88:91], v[32:35], a[232:235], v[88:91]
    ds_read_b64_tr_b16 v[52:53], v4 offset:34816
    v_mul_f32 v126, v126, v110
    v_mfma_f32_16x16x32_bf16 v[88:91], v[36:39], a[248:251], v[88:91]
    v_exp_f32 v18, v18
    v_mfma_f32_16x16x32_bf16 v[92:95], v[32:35], a[236:239], v[92:95]
    ds_read_b64_tr_b16 v[54:55], v4 offset:35072
    v_mul_f32 v19, v111, v111
    v_mfma_f32_16x16x32_bf16 v[92:95], v[36:39], a[252:255], v[92:95]
    s_waitcnt lgkmcnt(4)
    v_add_f32 v18, 1.0, v18
    v_mfma_f32_16x16x32_bf16 v[64:67], v[40:43], v[224:227], v[64:67]
    ds_read_b64_tr_b16 v[32:33], v3 offset:0
    v_fma_f32 v19, v19, v10, s35
    v_mfma_f32_16x16x32_bf16 v[64:67], v[44:47], v[240:243], v[64:67]
    v_rcp_f32 v18, v18
    v_mfma_f32_16x16x32_bf16 v[68:71], v[40:43], v[228:231], v[68:71]
    ds_read_b64_tr_b16 v[34:35], v3 offset:256
    v_mul_f32 v19, v19, v111
    v_mfma_f32_16x16x32_bf16 v[68:71], v[44:47], v[244:247], v[68:71]
    v_exp_f32 v19, v19
    v_mfma_f32_16x16x32_bf16 v[72:75], v[40:43], v[232:235], v[72:75]
    ds_read_b64_tr_b16 v[36:37], v3 offset:2048
    v_mul_f32 v126, v126, v18
    v_mfma_f32_16x16x32_bf16 v[72:75], v[44:47], v[248:251], v[72:75]
    buffer_load_dwordx4 v7, s[8:11], s42 offen offset:2048  lds
    v_mul_f32 v127, v127, v111
    v_mfma_f32_16x16x32_bf16 v[76:79], v[40:43], v[236:239], v[76:79]
    ds_read_b64_tr_b16 v[38:39], v3 offset:2304
    v_add_f32 v19, 1.0, v19
    v_mfma_f32_16x16x32_bf16 v[76:79], v[44:47], v[252:255], v[76:79]
    s_waitcnt lgkmcnt(4)
    v_rcp_f32 v19, v19
    v_mfma_f32_16x16x32_bf16 v[80:83], v[48:51], v[224:227], v[80:83]
    ds_read_b64_tr_b16 v[40:41], v5 offset:0
    v_mfma_f32_16x16x32_bf16 v[80:83], v[52:55], v[240:243], v[80:83]
    v_mul_f32 v127, v127, v19
    v_mfma_f32_16x16x32_bf16 v[84:87], v[48:51], v[228:231], v[84:87]
    ds_read_b64_tr_b16 v[42:43], v5 offset:256
    v_cvt_pk_bf16_f32 v143, v126, v127
    v_mfma_f32_16x16x32_bf16 v[84:87], v[52:55], v[244:247], v[84:87]
    buffer_store_dwordx4 v[140:143], v8, s[16:19], s57 offen sc1
    v_mfma_f32_16x16x32_bf16 v[88:91], v[48:51], v[232:235], v[88:91]
    ds_read_b64_tr_b16 v[44:45], v5 offset:2048
    v_mfma_f32_16x16x32_bf16 v[88:91], v[52:55], v[248:251], v[88:91]
    v_mfma_f32_16x16x32_bf16 v[92:95], v[48:51], v[236:239], v[92:95]
    ds_read_b64_tr_b16 v[46:47], v5 offset:2304
    v_mfma_f32_16x16x32_bf16 v[92:95], v[52:55], v[252:255], v[92:95]
    s_waitcnt lgkmcnt(4)
    v_mfma_f32_16x16x32_bf16 v[96:99], v[32:35], a[0:3], 0
    s_lshl_b32 s49, s74, 10
    ds_read_b64_tr_b16 v[48:49], v3 offset:4096
    v_mfma_f32_16x16x32_bf16 v[96:99], v[36:39], a[16:19], v[96:99]
    buffer_load_dwordx4 v7, s[8:11], s43 offen offset:3072  lds
    v_mfma_f32_16x16x32_bf16 v[100:103], v[32:35], a[4:7], 0
    ds_read_b64_tr_b16 v[50:51], v3 offset:4352
    v_add_u32 v8, s49, v9
    v_mfma_f32_16x16x32_bf16 v[100:103], v[36:39], a[20:23], v[100:103]
    v_mul_f32 v16, v64, v64
    v_mfma_f32_16x16x32_bf16 v[104:107], v[32:35], a[8:11], 0
    ds_read_b64_tr_b16 v[52:53], v3 offset:6144
    v_fma_f32 v16, v16, v10, s35
    v_mfma_f32_16x16x32_bf16 v[104:107], v[36:39], a[24:27], v[104:107]
    v_mul_f32 v16, v16, v64
    v_mfma_f32_16x16x32_bf16 v[108:111], v[32:35], a[12:15], 0
    ds_read_b64_tr_b16 v[54:55], v3 offset:6400
    v_mul_f32 v80, v80, v64
    v_mfma_f32_16x16x32_bf16 v[108:111], v[36:39], a[28:31], v[108:111]
    s_waitcnt lgkmcnt(4)
    v_exp_f32 v16, v16
    v_mfma_f32_16x16x32_bf16 v[112:115], v[40:43], a[0:3], 0
    ds_read_b64_tr_b16 v[32:33], v5 offset:4096
    v_mul_f32 v17, v65, v65
    v_mfma_f32_16x16x32_bf16 v[112:115], v[44:47], a[16:19], v[112:115]
    v_add_f32 v16, 1.0, v16
    v_mfma_f32_16x16x32_bf16 v[116:119], v[40:43], a[4:7], 0
    s_add_u32 m0, s34, 114688
    ds_read_b64_tr_b16 v[34:35], v5 offset:4352
    v_fma_f32 v17, v17, v10, s35
    v_mfma_f32_16x16x32_bf16 v[116:119], v[44:47], a[20:23], v[116:119]
    v_rcp_f32 v16, v16
    v_mfma_f32_16x16x32_bf16 v[120:123], v[40:43], a[8:11], 0
    ds_read_b64_tr_b16 v[36:37], v5 offset:6144
    v_mul_f32 v17, v17, v65
    v_mfma_f32_16x16x32_bf16 v[120:123], v[44:47], a[24:27], v[120:123]
    v_exp_f32 v17, v17
    v_mfma_f32_16x16x32_bf16 v[124:127], v[40:43], a[12:15], 0
    ds_read_b64_tr_b16 v[38:39], v5 offset:6400
    v_mul_f32 v80, v80, v16
    v_mfma_f32_16x16x32_bf16 v[124:127], v[44:47], a[28:31], v[124:127]
    s_waitcnt lgkmcnt(4)
    buffer_load_dwordx4 v7, s[8:11], s44 offen offset:0  lds
    v_mul_f32 v81, v81, v65
    v_mfma_f32_16x16x32_bf16 v[96:99], v[48:51], a[32:35], v[96:99]
    ds_read_b64_tr_b16 v[40:41], v3 offset:8192
    v_add_f32 v17, 1.0, v17
    v_mfma_f32_16x16x32_bf16 v[96:99], v[52:55], a[48:51], v[96:99]
    v_rcp_f32 v17, v17
    v_mfma_f32_16x16x32_bf16 v[100:103], v[48:51], a[36:39], v[100:103]
    ds_read_b64_tr_b16 v[42:43], v3 offset:8448
    v_mul_f32 v18, v66, v66
    v_mfma_f32_16x16x32_bf16 v[100:103], v[52:55], a[52:55], v[100:103]
    v_mul_f32 v81, v81, v17
    v_mfma_f32_16x16x32_bf16 v[104:107], v[48:51], a[40:43], v[104:107]
    ds_read_b64_tr_b16 v[44:45], v3 offset:10240
    v_cvt_pk_bf16_f32 v128, v80, v81
    v_mfma_f32_16x16x32_bf16 v[104:107], v[52:55], a[56:59], v[104:107]
    v_fma_f32 v18, v18, v10, s35
    v_mfma_f32_16x16x32_bf16 v[108:111], v[48:51], a[44:47], v[108:111]
    ds_read_b64_tr_b16 v[46:47], v3 offset:10496
    v_mul_f32 v18, v18, v66
    v_mfma_f32_16x16x32_bf16 v[108:111], v[52:55], a[60:63], v[108:111]
    s_waitcnt lgkmcnt(4)
    v_exp_f32 v18, v18
    v_mfma_f32_16x16x32_bf16 v[112:115], v[32:35], a[32:35], v[112:115]
    ds_read_b64_tr_b16 v[48:49], v5 offset:8192
    v_mul_f32 v82, v82, v66
    v_mfma_f32_16x16x32_bf16 v[112:115], v[36:39], a[48:51], v[112:115]
    buffer_load_dwordx4 v7, s[8:11], s45 offen offset:1024  lds
    v_add_f32 v18, 1.0, v18
    v_mfma_f32_16x16x32_bf16 v[116:119], v[32:35], a[36:39], v[116:119]
    ds_read_b64_tr_b16 v[50:51], v5 offset:8448
    v_mul_f32 v19, v67, v67
    v_mfma_f32_16x16x32_bf16 v[116:119], v[36:39], a[52:55], v[116:119]
    v_rcp_f32 v18, v18
    v_mfma_f32_16x16x32_bf16 v[120:123], v[32:35], a[40:43], v[120:123]
    ds_read_b64_tr_b16 v[52:53], v5 offset:10240
    v_fma_f32 v19, v19, v10, s35
    v_mfma_f32_16x16x32_bf16 v[120:123], v[36:39], a[56:59], v[120:123]
    v_mul_f32 v82, v82, v18
    v_mfma_f32_16x16x32_bf16 v[124:127], v[32:35], a[44:47], v[124:127]
    ds_read_b64_tr_b16 v[54:55], v5 offset:10496
    v_mul_f32 v19, v19, v67
    v_mfma_f32_16x16x32_bf16 v[124:127], v[36:39], a[60:63], v[124:127]
    s_waitcnt lgkmcnt(4)
    v_exp_f32 v19, v19
    v_mfma_f32_16x16x32_bf16 v[96:99], v[40:43], a[64:67], v[96:99]
    ds_read_b64_tr_b16 v[32:33], v3 offset:12288
    v_mul_f32 v83, v83, v67
    v_mfma_f32_16x16x32_bf16 v[96:99], v[44:47], a[80:83], v[96:99]
    v_add_f32 v19, 1.0, v19
    v_mfma_f32_16x16x32_bf16 v[100:103], v[40:43], a[68:71], v[100:103]
    ds_read_b64_tr_b16 v[34:35], v3 offset:12544
    v_mul_f32 v20, v68, v68
    v_mfma_f32_16x16x32_bf16 v[100:103], v[44:47], a[84:87], v[100:103]
    v_rcp_f32 v19, v19
    v_mfma_f32_16x16x32_bf16 v[104:107], v[40:43], a[72:75], v[104:107]
    ds_read_b64_tr_b16 v[36:37], v3 offset:14336
    v_fma_f32 v20, v20, v10, s35
    v_mfma_f32_16x16x32_bf16 v[104:107], v[44:47], a[88:91], v[104:107]
    buffer_load_dwordx4 v7, s[8:11], s46 offen offset:2048  lds
    v_mul_f32 v83, v83, v19
    v_mfma_f32_16x16x32_bf16 v[108:111], v[40:43], a[76:79], v[108:111]
    ds_read_b64_tr_b16 v[38:39], v3 offset:14592
    v_cvt_pk_bf16_f32 v129, v82, v83
    v_mfma_f32_16x16x32_bf16 v[108:111], v[44:47], a[92:95], v[108:111]
    s_waitcnt lgkmcnt(4)
    v_mul_f32 v20, v20, v68
    v_mfma_f32_16x16x32_bf16 v[112:115], v[48:51], a[64:67], v[112:115]
    ds_read_b64_tr_b16 v[40:41], v5 offset:12288
    v_mul_f32 v84, v84, v68
    v_mfma_f32_16x16x32_bf16 v[112:115], v[52:55], a[80:83], v[112:115]
    v_exp_f32 v20, v20
    v_mfma_f32_16x16x32_bf16 v[116:119], v[48:51], a[68:71], v[116:119]
    ds_read_b64_tr_b16 v[42:43], v5 offset:12544
    v_mul_f32 v21, v69, v69
    v_mfma_f32_16x16x32_bf16 v[116:119], v[52:55], a[84:87], v[116:119]
    v_add_f32 v20, 1.0, v20
    v_mfma_f32_16x16x32_bf16 v[120:123], v[48:51], a[72:75], v[120:123]
    ds_read_b64_tr_b16 v[44:45], v5 offset:14336
    v_fma_f32 v21, v21, v10, s35
    v_mfma_f32_16x16x32_bf16 v[120:123], v[52:55], a[88:91], v[120:123]
    v_rcp_f32 v20, v20
    v_mfma_f32_16x16x32_bf16 v[124:127], v[48:51], a[76:79], v[124:127]
    ds_read_b64_tr_b16 v[46:47], v5 offset:14592
    v_mul_f32 v21, v21, v69
    v_mfma_f32_16x16x32_bf16 v[124:127], v[52:55], a[92:95], v[124:127]
    s_waitcnt lgkmcnt(4)
    v_exp_f32 v21, v21
    v_mfma_f32_16x16x32_bf16 v[96:99], v[32:35], a[96:99], v[96:99]
    ds_read_b64_tr_b16 v[48:49], v3 offset:16384
    v_mul_f32 v84, v84, v20
    v_mfma_f32_16x16x32_bf16 v[96:99], v[36:39], a[112:115], v[96:99]
    buffer_load_dwordx4 v7, s[8:11], s47 offen offset:3072  lds
    v_mul_f32 v85, v85, v69
    v_mfma_f32_16x16x32_bf16 v[100:103], v[32:35], a[100:103], v[100:103]
    ds_read_b64_tr_b16 v[50:51], v3 offset:16640
    v_add_f32 v21, 1.0, v21
    v_mfma_f32_16x16x32_bf16 v[100:103], v[36:39], a[116:119], v[100:103]
    v_rcp_f32 v21, v21
    v_mfma_f32_16x16x32_bf16 v[104:107], v[32:35], a[104:107], v[104:107]
    ds_read_b64_tr_b16 v[52:53], v3 offset:18432
    v_mul_f32 v22, v70, v70
    v_mfma_f32_16x16x32_bf16 v[104:107], v[36:39], a[120:123], v[104:107]
    v_mul_f32 v85, v85, v21
    v_mfma_f32_16x16x32_bf16 v[108:111], v[32:35], a[108:111], v[108:111]
    ds_read_b64_tr_b16 v[54:55], v3 offset:18688
    v_cvt_pk_bf16_f32 v132, v84, v85
    v_mfma_f32_16x16x32_bf16 v[108:111], v[36:39], a[124:127], v[108:111]
    s_waitcnt lgkmcnt(4)
    v_fma_f32 v22, v22, v10, s35
    v_mfma_f32_16x16x32_bf16 v[112:115], v[40:43], a[96:99], v[112:115]
    ds_read_b64_tr_b16 v[32:33], v5 offset:16384
    v_mul_f32 v22, v22, v70
    v_mfma_f32_16x16x32_bf16 v[112:115], v[44:47], a[112:115], v[112:115]
    v_exp_f32 v22, v22
    v_mfma_f32_16x16x32_bf16 v[116:119], v[40:43], a[100:103], v[116:119]
    s_add_u32 m0, s34, 118784
    ds_read_b64_tr_b16 v[34:35], v5 offset:16640
    v_mul_f32 v86, v86, v70
    v_mfma_f32_16x16x32_bf16 v[116:119], v[44:47], a[116:119], v[116:119]
    v_add_f32 v22, 1.0, v22
    v_mfma_f32_16x16x32_bf16 v[120:123], v[40:43], a[104:107], v[120:123]
    ds_read_b64_tr_b16 v[36:37], v5 offset:18432
    v_mul_f32 v23, v71, v71
    v_mfma_f32_16x16x32_bf16 v[120:123], v[44:47], a[120:123], v[120:123]
    v_rcp_f32 v22, v22
    v_mfma_f32_16x16x32_bf16 v[124:127], v[40:43], a[108:111], v[124:127]
    ds_read_b64_tr_b16 v[38:39], v5 offset:18688
    v_fma_f32 v23, v23, v10, s35
    v_mfma_f32_16x16x32_bf16 v[124:127], v[44:47], a[124:127], v[124:127]
    s_waitcnt lgkmcnt(4)
    buffer_load_dwordx4 v7, s[8:11], s48 offen offset:0  lds
    v_mul_f32 v86, v86, v22
    v_mfma_f32_16x16x32_bf16 v[96:99], v[48:51], a[128:131], v[96:99]
    ds_read_b64_tr_b16 v[40:41], v3 offset:20480
    v_mul_f32 v23, v23, v71
    v_mfma_f32_16x16x32_bf16 v[96:99], v[52:55], a[144:147], v[96:99]
    v_exp_f32 v23, v23
    v_mfma_f32_16x16x32_bf16 v[100:103], v[48:51], a[132:135], v[100:103]
    ds_read_b64_tr_b16 v[42:43], v3 offset:20736
    v_mul_f32 v87, v87, v71
    v_mfma_f32_16x16x32_bf16 v[100:103], v[52:55], a[148:151], v[100:103]
    buffer_load_dword v1, v146, s[4:7], s79 offen
    v_add_f32 v23, 1.0, v23
    v_mfma_f32_16x16x32_bf16 v[104:107], v[48:51], a[136:139], v[104:107]
    ds_read_b64_tr_b16 v[44:45], v3 offset:22528
    v_mul_f32 v28, v72, v72
    v_mfma_f32_16x16x32_bf16 v[104:107], v[52:55], a[152:155], v[104:107]
    v_rcp_f32 v23, v23
    v_mfma_f32_16x16x32_bf16 v[108:111], v[48:51], a[140:143], v[108:111]
    ds_read_b64_tr_b16 v[46:47], v3 offset:22784
    v_fma_f32 v28, v28, v10, s35
    v_mfma_f32_16x16x32_bf16 v[108:111], v[52:55], a[156:159], v[108:111]
    s_waitcnt lgkmcnt(4)
    buffer_load_dword v1, v146, s[8:11], s79 offen
    v_mul_f32 v87, v87, v23
    v_mfma_f32_16x16x32_bf16 v[112:115], v[32:35], a[128:131], v[112:115]
    s_mov_b32 s36, 0
    ds_read_b64_tr_b16 v[48:49], v5 offset:20480
    v_cvt_pk_bf16_f32 v133, v86, v87
    v_mfma_f32_16x16x32_bf16 v[112:115], v[36:39], a[144:147], v[112:115]
    buffer_load_dword v1, v62, s[12:15], s36 offen
    v_mul_f32 v28, v28, v72
    v_mfma_f32_16x16x32_bf16 v[116:119], v[32:35], a[132:135], v[116:119]
    s_mov_b32 s36, 442368
    ds_read_b64_tr_b16 v[50:51], v5 offset:20736
    v_mul_f32 v88, v88, v72
    v_mfma_f32_16x16x32_bf16 v[116:119], v[36:39], a[148:151], v[116:119]
    v_exp_f32 v28, v28
    v_mfma_f32_16x16x32_bf16 v[120:123], v[32:35], a[136:139], v[120:123]
    ds_read_b64_tr_b16 v[52:53], v5 offset:22528
    v_mul_f32 v29, v73, v73
    v_mfma_f32_16x16x32_bf16 v[120:123], v[36:39], a[152:155], v[120:123]
    buffer_load_dword v1, v62, s[12:15], s36 offen
    v_add_f32 v28, 1.0, v28
    v_mfma_f32_16x16x32_bf16 v[124:127], v[32:35], a[140:143], v[124:127]
    ds_read_b64_tr_b16 v[54:55], v5 offset:22784
    v_fma_f32 v29, v29, v10, s35
    v_mfma_f32_16x16x32_bf16 v[124:127], v[36:39], a[156:159], v[124:127]
    s_waitcnt lgkmcnt(4)
    v_rcp_f32 v28, v28
    v_mfma_f32_16x16x32_bf16 v[96:99], v[40:43], a[160:163], v[96:99]
    ds_read_b64_tr_b16 v[32:33], v3 offset:24576
    v_mul_f32 v29, v29, v73
    v_mfma_f32_16x16x32_bf16 v[96:99], v[44:47], a[176:179], v[96:99]
    v_exp_f32 v29, v29
    v_mfma_f32_16x16x32_bf16 v[100:103], v[40:43], a[164:167], v[100:103]
    ds_read_b64_tr_b16 v[34:35], v3 offset:24832
    v_mul_f32 v88, v88, v28
    v_mfma_f32_16x16x32_bf16 v[100:103], v[44:47], a[180:183], v[100:103]
    v_mul_f32 v89, v89, v73
    v_mfma_f32_16x16x32_bf16 v[104:107], v[40:43], a[168:171], v[104:107]
    ds_read_b64_tr_b16 v[36:37], v3 offset:26624
    v_add_f32 v29, 1.0, v29
    v_mfma_f32_16x16x32_bf16 v[104:107], v[44:47], a[184:187], v[104:107]
    v_rcp_f32 v29, v29
    v_mfma_f32_16x16x32_bf16 v[108:111], v[40:43], a[172:175], v[108:111]
    ds_read_b64_tr_b16 v[38:39], v3 offset:26880
    v_mul_f32 v30, v74, v74
    v_mfma_f32_16x16x32_bf16 v[108:111], v[44:47], a[188:191], v[108:111]
    s_waitcnt lgkmcnt(4)
    v_mul_f32 v89, v89, v29
    v_mfma_f32_16x16x32_bf16 v[112:115], v[48:51], a[160:163], v[112:115]
    ds_read_b64_tr_b16 v[40:41], v5 offset:24576
    v_cvt_pk_bf16_f32 v136, v88, v89
    v_mfma_f32_16x16x32_bf16 v[112:115], v[52:55], a[176:179], v[112:115]
    v_fma_f32 v30, v30, v10, s35
    v_mfma_f32_16x16x32_bf16 v[116:119], v[48:51], a[164:167], v[116:119]
    ds_read_b64_tr_b16 v[42:43], v5 offset:24832
    v_mul_f32 v30, v30, v74
    v_mfma_f32_16x16x32_bf16 v[116:119], v[52:55], a[180:183], v[116:119]
    v_exp_f32 v30, v30
    v_mfma_f32_16x16x32_bf16 v[120:123], v[48:51], a[168:171], v[120:123]
    ds_read_b64_tr_b16 v[44:45], v5 offset:26624
    v_mul_f32 v90, v90, v74
    v_mfma_f32_16x16x32_bf16 v[120:123], v[52:55], a[184:187], v[120:123]
    v_add_f32 v30, 1.0, v30
    v_mfma_f32_16x16x32_bf16 v[124:127], v[48:51], a[172:175], v[124:127]
    ds_read_b64_tr_b16 v[46:47], v5 offset:26880
    v_mul_f32 v31, v75, v75
    v_mfma_f32_16x16x32_bf16 v[124:127], v[52:55], a[188:191], v[124:127]
    s_waitcnt lgkmcnt(4)
    v_rcp_f32 v30, v30
    v_mfma_f32_16x16x32_bf16 v[96:99], v[32:35], a[192:195], v[96:99]
    ds_read_b64_tr_b16 v[48:49], v3 offset:28672
    v_fma_f32 v31, v31, v10, s35
    v_mfma_f32_16x16x32_bf16 v[96:99], v[36:39], a[208:211], v[96:99]
    v_mul_f32 v90, v90, v30
    v_mfma_f32_16x16x32_bf16 v[100:103], v[32:35], a[196:199], v[100:103]
    ds_read_b64_tr_b16 v[50:51], v3 offset:28928
    v_mul_f32 v31, v31, v75
    v_mfma_f32_16x16x32_bf16 v[100:103], v[36:39], a[212:215], v[100:103]
    v_exp_f32 v31, v31
    v_mfma_f32_16x16x32_bf16 v[104:107], v[32:35], a[200:203], v[104:107]
    ds_read_b64_tr_b16 v[52:53], v3 offset:30720
    v_mul_f32 v91, v91, v75
    v_mfma_f32_16x16x32_bf16 v[104:107], v[36:39], a[216:219], v[104:107]
    v_add_f32 v31, 1.0, v31
    v_mfma_f32_16x16x32_bf16 v[108:111], v[32:35], a[204:207], v[108:111]
    ds_read_b64_tr_b16 v[54:55], v3 offset:30976
    v_mul_f32 v16, v76, v76
    v_mfma_f32_16x16x32_bf16 v[108:111], v[36:39], a[220:223], v[108:111]
    s_waitcnt lgkmcnt(4)
    v_rcp_f32 v31, v31
    v_mfma_f32_16x16x32_bf16 v[112:115], v[40:43], a[192:195], v[112:115]
    ds_read_b64_tr_b16 v[32:33], v5 offset:28672
    v_fma_f32 v16, v16, v10, s35
    v_mfma_f32_16x16x32_bf16 v[112:115], v[44:47], a[208:211], v[112:115]
    v_mul_f32 v91, v91, v31
    v_mfma_f32_16x16x32_bf16 v[116:119], v[40:43], a[196:199], v[116:119]
    ds_read_b64_tr_b16 v[34:35], v5 offset:28928
    v_cvt_pk_bf16_f32 v137, v90, v91
    v_mfma_f32_16x16x32_bf16 v[116:119], v[44:47], a[212:215], v[116:119]
    v_mul_f32 v16, v16, v76
    v_mfma_f32_16x16x32_bf16 v[120:123], v[40:43], a[200:203], v[120:123]
    ds_read_b64_tr_b16 v[36:37], v5 offset:30720
    v_mul_f32 v92, v92, v76
    v_mfma_f32_16x16x32_bf16 v[120:123], v[44:47], a[216:219], v[120:123]
    v_exp_f32 v16, v16
    v_mfma_f32_16x16x32_bf16 v[124:127], v[40:43], a[204:207], v[124:127]
    ds_read_b64_tr_b16 v[38:39], v5 offset:30976
    v_mul_f32 v17, v77, v77
    v_mfma_f32_16x16x32_bf16 v[124:127], v[44:47], a[220:223], v[124:127]
    s_waitcnt lgkmcnt(4)
    v_add_f32 v16, 1.0, v16
    v_mfma_f32_16x16x32_bf16 v[96:99], v[48:51], a[224:227], v[96:99]
    ds_read_b64_tr_b16 v[40:41], v3 offset:32768
    v_fma_f32 v17, v17, v10, s35
    v_mfma_f32_16x16x32_bf16 v[96:99], v[52:55], a[240:243], v[96:99]
    v_rcp_f32 v16, v16
    v_mfma_f32_16x16x32_bf16 v[100:103], v[48:51], a[228:231], v[100:103]
    ds_read_b64_tr_b16 v[42:43], v3 offset:33024
    v_mul_f32 v17, v17, v77
    v_mfma_f32_16x16x32_bf16 v[100:103], v[52:55], a[244:247], v[100:103]
    v_exp_f32 v17, v17
    v_mfma_f32_16x16x32_bf16 v[104:107], v[48:51], a[232:235], v[104:107]
    ds_read_b64_tr_b16 v[44:45], v3 offset:34816
    v_mul_f32 v92, v92, v16
    v_mfma_f32_16x16x32_bf16 v[104:107], v[52:55], a[248:251], v[104:107]
    v_mul_f32 v93, v93, v77
    v_mfma_f32_16x16x32_bf16 v[108:111], v[48:51], a[236:239], v[108:111]
    ds_read_b64_tr_b16 v[46:47], v3 offset:35072
    v_add_f32 v17, 1.0, v17
    v_mfma_f32_16x16x32_bf16 v[108:111], v[52:55], a[252:255], v[108:111]
    s_waitcnt lgkmcnt(4)
    v_rcp_f32 v17, v17
    v_mfma_f32_16x16x32_bf16 v[112:115], v[32:35], a[224:227], v[112:115]
    ds_read_b64_tr_b16 v[48:49], v5 offset:32768
    v_mul_f32 v18, v78, v78
    v_mfma_f32_16x16x32_bf16 v[112:115], v[36:39], a[240:243], v[112:115]
    ds_read_b64_tr_b16 v[50:51], v5 offset:33024
    v_mul_f32 v93, v93, v17
    v_mfma_f32_16x16x32_bf16 v[116:119], v[32:35], a[228:231], v[116:119]
    ds_read_b64_tr_b16 v[52:53], v5 offset:34816
    v_cvt_pk_bf16_f32 v140, v92, v93
    v_mfma_f32_16x16x32_bf16 v[116:119], v[36:39], a[244:247], v[116:119]
    ds_read_b64_tr_b16 v[54:55], v5 offset:35072
    v_fma_f32 v18, v18, v10, s35
    v_mfma_f32_16x16x32_bf16 v[120:123], v[32:35], a[232:235], v[120:123]
    v_mul_f32 v18, v18, v78
    v_mfma_f32_16x16x32_bf16 v[120:123], v[36:39], a[248:251], v[120:123]
    v_exp_f32 v18, v18
    v_mfma_f32_16x16x32_bf16 v[124:127], v[32:35], a[236:239], v[124:127]
    v_mul_f32 v94, v94, v78
    v_mfma_f32_16x16x32_bf16 v[124:127], v[36:39], a[252:255], v[124:127]
    s_waitcnt vmcnt(4) lgkmcnt(0)
    s_barrier
    v_add_f32 v18, 1.0, v18
    v_mfma_f32_16x16x32_bf16 v[96:99], v[40:43], v[224:227], v[96:99]
    ds_read_b64_tr_b16 v[32:33], v56 offset:0
    v_mul_f32 v19, v79, v79
    v_mfma_f32_16x16x32_bf16 v[96:99], v[44:47], v[240:243], v[96:99]
    v_rcp_f32 v18, v18
    v_mfma_f32_16x16x32_bf16 v[100:103], v[40:43], v[228:231], v[100:103]
    ds_read_b64_tr_b16 v[34:35], v56 offset:256
    v_fma_f32 v19, v19, v10, s35
    v_mfma_f32_16x16x32_bf16 v[100:103], v[44:47], v[244:247], v[100:103]
    v_mul_f32 v94, v94, v18
    v_mfma_f32_16x16x32_bf16 v[104:107], v[40:43], v[232:235], v[104:107]
    ds_read_b64_tr_b16 v[36:37], v56 offset:2048
    v_mul_f32 v19, v19, v79
    v_mfma_f32_16x16x32_bf16 v[104:107], v[44:47], v[248:251], v[104:107]
    v_exp_f32 v19, v19
    v_mfma_f32_16x16x32_bf16 v[108:111], v[40:43], v[236:239], v[108:111]
    ds_read_b64_tr_b16 v[38:39], v56 offset:2304
    v_mul_f32 v95, v95, v79
    v_mfma_f32_16x16x32_bf16 v[108:111], v[44:47], v[252:255], v[108:111]
    s_waitcnt lgkmcnt(4)
    v_add_f32 v19, 1.0, v19
    v_mfma_f32_16x16x32_bf16 v[112:115], v[48:51], v[224:227], v[112:115]
    ds_read_b64_tr_b16 v[40:41], v58 offset:0
    v_mfma_f32_16x16x32_bf16 v[112:115], v[52:55], v[240:243], v[112:115]
    v_rcp_f32 v19, v19
    v_mfma_f32_16x16x32_bf16 v[116:119], v[48:51], v[228:231], v[116:119]
    ds_read_b64_tr_b16 v[42:43], v58 offset:256
    v_mfma_f32_16x16x32_bf16 v[116:119], v[52:55], v[244:247], v[116:119]
    v_mul_f32 v95, v95, v19
    v_mfma_f32_16x16x32_bf16 v[120:123], v[48:51], v[232:235], v[120:123]
    ds_read_b64_tr_b16 v[44:45], v58 offset:2048
    v_cvt_pk_bf16_f32 v141, v94, v95
    v_mfma_f32_16x16x32_bf16 v[120:123], v[52:55], v[248:251], v[120:123]
    v_mfma_f32_16x16x32_bf16 v[124:127], v[48:51], v[236:239], v[124:127]
    ds_read_b64_tr_b16 v[46:47], v58 offset:2304
    v_mfma_f32_16x16x32_bf16 v[124:127], v[52:55], v[252:255], v[124:127]
    s_waitcnt lgkmcnt(4)
    s_lshl_b32 s49, s83, 6
    v_add_u32 v7, s49, v6
    s_add_u32 s36, s36, 0x6c000
    s_add_u32 s49, s67, 4816896
    v_add_u32 v13, 2, v148
    s_mov_b64 exec, 1
    buffer_store_dword v13, off, s[16:19], s49 sc1
    s_mov_b64 exec, -1
    v_mfma_f32_16x16x32_bf16 v[64:67], v[32:35], a[0:3], 0
    s_add_u32 m0, s34, 0
    ds_read_b64_tr_b16 v[48:49], v56 offset:4096
    v_mfma_f32_16x16x32_bf16 v[64:67], v[36:39], a[16:19], v[64:67]
    buffer_load_dwordx4 v7, s[4:7], s40 offen offset:0  lds
    v_mfma_f32_16x16x32_bf16 v[68:71], v[32:35], a[4:7], 0
    ds_read_b64_tr_b16 v[50:51], v56 offset:4352
    v_mul_f32 v16, v96, v96
    v_mfma_f32_16x16x32_bf16 v[68:71], v[36:39], a[20:23], v[68:71]
    v_fma_f32 v16, v16, v10, s35
    v_mfma_f32_16x16x32_bf16 v[72:75], v[32:35], a[8:11], 0
    ds_read_b64_tr_b16 v[52:53], v56 offset:6144
    v_mul_f32 v16, v16, v96
    v_mfma_f32_16x16x32_bf16 v[72:75], v[36:39], a[24:27], v[72:75]
    v_exp_f32 v16, v16
    v_mfma_f32_16x16x32_bf16 v[76:79], v[32:35], a[12:15], 0
    ds_read_b64_tr_b16 v[54:55], v56 offset:6400
    v_mul_f32 v112, v112, v96
    v_mfma_f32_16x16x32_bf16 v[76:79], v[36:39], a[28:31], v[76:79]
    s_waitcnt lgkmcnt(4)
    v_add_f32 v16, 1.0, v16
    v_mfma_f32_16x16x32_bf16 v[80:83], v[40:43], a[0:3], 0
    ds_read_b64_tr_b16 v[32:33], v58 offset:4096
    v_mul_f32 v17, v97, v97
    v_mfma_f32_16x16x32_bf16 v[80:83], v[44:47], a[16:19], v[80:83]
    v_rcp_f32 v16, v16
    v_mfma_f32_16x16x32_bf16 v[84:87], v[40:43], a[4:7], 0
    ds_read_b64_tr_b16 v[34:35], v58 offset:4352
    v_fma_f32 v17, v17, v10, s35
    v_mfma_f32_16x16x32_bf16 v[84:87], v[44:47], a[20:23], v[84:87]
    v_mul_f32 v112, v112, v16
    v_mfma_f32_16x16x32_bf16 v[88:91], v[40:43], a[8:11], 0
    ds_read_b64_tr_b16 v[36:37], v58 offset:6144
    v_mul_f32 v17, v17, v97
    v_mfma_f32_16x16x32_bf16 v[88:91], v[44:47], a[24:27], v[88:91]
    v_exp_f32 v17, v17
    v_mfma_f32_16x16x32_bf16 v[92:95], v[40:43], a[12:15], 0
    ds_read_b64_tr_b16 v[38:39], v58 offset:6400
    v_mul_f32 v113, v113, v97
    v_mfma_f32_16x16x32_bf16 v[92:95], v[44:47], a[28:31], v[92:95]
    s_waitcnt lgkmcnt(4)
    buffer_load_dwordx4 v7, s[4:7], s41 offen offset:1024  lds
    v_add_f32 v17, 1.0, v17
    v_mfma_f32_16x16x32_bf16 v[64:67], v[48:51], a[32:35], v[64:67]
    ds_read_b64_tr_b16 v[40:41], v56 offset:8192
    v_mul_f32 v18, v98, v98
    v_mfma_f32_16x16x32_bf16 v[64:67], v[52:55], a[48:51], v[64:67]
    v_rcp_f32 v17, v17
    v_mfma_f32_16x16x32_bf16 v[68:71], v[48:51], a[36:39], v[68:71]
    ds_read_b64_tr_b16 v[42:43], v56 offset:8448
    v_fma_f32 v18, v18, v10, s35
    v_mfma_f32_16x16x32_bf16 v[68:71], v[52:55], a[52:55], v[68:71]
    v_mul_f32 v113, v113, v17
    v_mfma_f32_16x16x32_bf16 v[72:75], v[48:51], a[40:43], v[72:75]
    ds_read_b64_tr_b16 v[44:45], v56 offset:10240
    v_cvt_pk_bf16_f32 v130, v112, v113
    v_mfma_f32_16x16x32_bf16 v[72:75], v[52:55], a[56:59], v[72:75]
    v_mul_f32 v18, v18, v98
    v_mfma_f32_16x16x32_bf16 v[76:79], v[48:51], a[44:47], v[76:79]
    ds_read_b64_tr_b16 v[46:47], v56 offset:10496
    v_mul_f32 v114, v114, v98
    v_mfma_f32_16x16x32_bf16 v[76:79], v[52:55], a[60:63], v[76:79]
    s_waitcnt lgkmcnt(4)
    v_exp_f32 v18, v18
    v_mfma_f32_16x16x32_bf16 v[80:83], v[32:35], a[32:35], v[80:83]
    ds_read_b64_tr_b16 v[48:49], v58 offset:8192
    v_mul_f32 v19, v99, v99
    v_mfma_f32_16x16x32_bf16 v[80:83], v[36:39], a[48:51], v[80:83]
    buffer_load_dwordx4 v7, s[4:7], s42 offen offset:2048  lds
    v_add_f32 v18, 1.0, v18
    v_mfma_f32_16x16x32_bf16 v[84:87], v[32:35], a[36:39], v[84:87]
    ds_read_b64_tr_b16 v[50:51], v58 offset:8448
    v_fma_f32 v19, v19, v10, s35
    v_mfma_f32_16x16x32_bf16 v[84:87], v[36:39], a[52:55], v[84:87]
    v_rcp_f32 v18, v18
    v_mfma_f32_16x16x32_bf16 v[88:91], v[32:35], a[40:43], v[88:91]
    ds_read_b64_tr_b16 v[52:53], v58 offset:10240
    v_mul_f32 v19, v19, v99
    v_mfma_f32_16x16x32_bf16 v[88:91], v[36:39], a[56:59], v[88:91]
    v_exp_f32 v19, v19
    v_mfma_f32_16x16x32_bf16 v[92:95], v[32:35], a[44:47], v[92:95]
    ds_read_b64_tr_b16 v[54:55], v58 offset:10496
    v_mul_f32 v114, v114, v18
    v_mfma_f32_16x16x32_bf16 v[92:95], v[36:39], a[60:63], v[92:95]
    s_waitcnt lgkmcnt(4)
    v_mul_f32 v115, v115, v99
    v_mfma_f32_16x16x32_bf16 v[64:67], v[40:43], a[64:67], v[64:67]
    ds_read_b64_tr_b16 v[32:33], v56 offset:12288
    v_add_f32 v19, 1.0, v19
    v_mfma_f32_16x16x32_bf16 v[64:67], v[44:47], a[80:83], v[64:67]
    v_rcp_f32 v19, v19
    v_mfma_f32_16x16x32_bf16 v[68:71], v[40:43], a[68:71], v[68:71]
    ds_read_b64_tr_b16 v[34:35], v56 offset:12544
    v_mul_f32 v20, v100, v100
    v_mfma_f32_16x16x32_bf16 v[68:71], v[44:47], a[84:87], v[68:71]
    v_mul_f32 v115, v115, v19
    v_mfma_f32_16x16x32_bf16 v[72:75], v[40:43], a[72:75], v[72:75]
    ds_read_b64_tr_b16 v[36:37], v56 offset:14336
    v_cvt_pk_bf16_f32 v131, v114, v115
    v_mfma_f32_16x16x32_bf16 v[72:75], v[44:47], a[88:91], v[72:75]
    buffer_load_dwordx4 v7, s[4:7], s43 offen offset:3072  lds
    v_fma_f32 v20, v20, v10, s35
    v_mfma_f32_16x16x32_bf16 v[76:79], v[40:43], a[76:79], v[76:79]
    ds_read_b64_tr_b16 v[38:39], v56 offset:14592
    v_mul_f32 v20, v20, v100
    v_mfma_f32_16x16x32_bf16 v[76:79], v[44:47], a[92:95], v[76:79]
    s_waitcnt lgkmcnt(4)
    v_exp_f32 v20, v20
    v_mfma_f32_16x16x32_bf16 v[80:83], v[48:51], a[64:67], v[80:83]
    ds_read_b64_tr_b16 v[40:41], v58 offset:12288
    v_mul_f32 v116, v116, v100
    v_mfma_f32_16x16x32_bf16 v[80:83], v[52:55], a[80:83], v[80:83]
    buffer_store_dwordx4 v[128:131], v8, s[16:19], s54 offen sc1
    v_add_f32 v20, 1.0, v20
    v_mfma_f32_16x16x32_bf16 v[84:87], v[48:51], a[68:71], v[84:87]
    ds_read_b64_tr_b16 v[42:43], v58 offset:12544
    v_mul_f32 v21, v101, v101
    v_mfma_f32_16x16x32_bf16 v[84:87], v[52:55], a[84:87], v[84:87]
    v_rcp_f32 v20, v20
    v_mfma_f32_16x16x32_bf16 v[88:91], v[48:51], a[72:75], v[88:91]
    ds_read_b64_tr_b16 v[44:45], v58 offset:14336
    v_fma_f32 v21, v21, v10, s35
    v_mfma_f32_16x16x32_bf16 v[88:91], v[52:55], a[88:91], v[88:91]
    v_mul_f32 v116, v116, v20
    v_mfma_f32_16x16x32_bf16 v[92:95], v[48:51], a[76:79], v[92:95]
    s_add_u32 m0, s34, 4096
    ds_read_b64_tr_b16 v[46:47], v58 offset:14592
    v_mul_f32 v21, v21, v101
    v_mfma_f32_16x16x32_bf16 v[92:95], v[52:55], a[92:95], v[92:95]
    s_waitcnt lgkmcnt(4)
    v_exp_f32 v21, v21
    v_mfma_f32_16x16x32_bf16 v[64:67], v[32:35], a[96:99], v[64:67]
    ds_read_b64_tr_b16 v[48:49], v56 offset:16384
    v_mul_f32 v117, v117, v101
    v_mfma_f32_16x16x32_bf16 v[64:67], v[36:39], a[112:115], v[64:67]
    buffer_load_dwordx4 v7, s[4:7], s44 offen offset:0  lds
    v_add_f32 v21, 1.0, v21
    v_mfma_f32_16x16x32_bf16 v[68:71], v[32:35], a[100:103], v[68:71]
    ds_read_b64_tr_b16 v[50:51], v56 offset:16640
    v_mul_f32 v22, v102, v102
    v_mfma_f32_16x16x32_bf16 v[68:71], v[36:39], a[116:119], v[68:71]
    v_rcp_f32 v21, v21
    v_mfma_f32_16x16x32_bf16 v[72:75], v[32:35], a[104:107], v[72:75]
    ds_read_b64_tr_b16 v[52:53], v56 offset:18432
    v_fma_f32 v22, v22, v10, s35
    v_mfma_f32_16x16x32_bf16 v[72:75], v[36:39], a[120:123], v[72:75]
    v_mul_f32 v117, v117, v21
    v_mfma_f32_16x16x32_bf16 v[76:79], v[32:35], a[108:111], v[76:79]
    ds_read_b64_tr_b16 v[54:55], v56 offset:18688
    v_cvt_pk_bf16_f32 v134, v116, v117
    v_mfma_f32_16x16x32_bf16 v[76:79], v[36:39], a[124:127], v[76:79]
    s_waitcnt lgkmcnt(4)
    v_mul_f32 v22, v22, v102
    v_mfma_f32_16x16x32_bf16 v[80:83], v[40:43], a[96:99], v[80:83]
    ds_read_b64_tr_b16 v[32:33], v58 offset:16384
    v_mul_f32 v118, v118, v102
    v_mfma_f32_16x16x32_bf16 v[80:83], v[44:47], a[112:115], v[80:83]
    v_exp_f32 v22, v22
    v_mfma_f32_16x16x32_bf16 v[84:87], v[40:43], a[100:103], v[84:87]
    ds_read_b64_tr_b16 v[34:35], v58 offset:16640
    v_mul_f32 v23, v103, v103
    v_mfma_f32_16x16x32_bf16 v[84:87], v[44:47], a[116:119], v[84:87]
    v_add_f32 v22, 1.0, v22
    v_mfma_f32_16x16x32_bf16 v[88:91], v[40:43], a[104:107], v[88:91]
    ds_read_b64_tr_b16 v[36:37], v58 offset:18432
    v_fma_f32 v23, v23, v10, s35
    v_mfma_f32_16x16x32_bf16 v[88:91], v[44:47], a[120:123], v[88:91]
    v_rcp_f32 v22, v22
    v_mfma_f32_16x16x32_bf16 v[92:95], v[40:43], a[108:111], v[92:95]
    ds_read_b64_tr_b16 v[38:39], v58 offset:18688
    v_mul_f32 v23, v23, v103
    v_mfma_f32_16x16x32_bf16 v[92:95], v[44:47], a[124:127], v[92:95]
    s_waitcnt lgkmcnt(4)
    v_exp_f32 v23, v23
    v_mfma_f32_16x16x32_bf16 v[64:67], v[48:51], a[128:131], v[64:67]
    ds_read_b64_tr_b16 v[40:41], v56 offset:20480
    v_mul_f32 v118, v118, v22
    v_mfma_f32_16x16x32_bf16 v[64:67], v[52:55], a[144:147], v[64:67]
    buffer_load_dwordx4 v7, s[4:7], s45 offen offset:1024  lds
    v_mul_f32 v119, v119, v103
    v_mfma_f32_16x16x32_bf16 v[68:71], v[48:51], a[132:135], v[68:71]
    ds_read_b64_tr_b16 v[42:43], v56 offset:20736
    v_add_f32 v23, 1.0, v23
    v_mfma_f32_16x16x32_bf16 v[68:71], v[52:55], a[148:151], v[68:71]
    v_rcp_f32 v23, v23
    v_mfma_f32_16x16x32_bf16 v[72:75], v[48:51], a[136:139], v[72:75]
    ds_read_b64_tr_b16 v[44:45], v56 offset:22528
    v_mul_f32 v28, v104, v104
    v_mfma_f32_16x16x32_bf16 v[72:75], v[52:55], a[152:155], v[72:75]
    v_mul_f32 v119, v119, v23
    v_mfma_f32_16x16x32_bf16 v[76:79], v[48:51], a[140:143], v[76:79]
    ds_read_b64_tr_b16 v[46:47], v56 offset:22784
    v_cvt_pk_bf16_f32 v135, v118, v119
    v_mfma_f32_16x16x32_bf16 v[76:79], v[52:55], a[156:159], v[76:79]
    s_waitcnt lgkmcnt(4)
    buffer_store_dwordx4 v[132:135], v8, s[16:19], s55 offen sc1
    v_fma_f32 v28, v28, v10, s35
    v_mfma_f32_16x16x32_bf16 v[80:83], v[32:35], a[128:131], v[80:83]
    ds_read_b64_tr_b16 v[48:49], v58 offset:20480
    v_mul_f32 v28, v28, v104
    v_mfma_f32_16x16x32_bf16 v[80:83], v[36:39], a[144:147], v[80:83]
    v_exp_f32 v28, v28
    v_mfma_f32_16x16x32_bf16 v[84:87], v[32:35], a[132:135], v[84:87]
    ds_read_b64_tr_b16 v[50:51], v58 offset:20736
    v_mul_f32 v120, v120, v104
    v_mfma_f32_16x16x32_bf16 v[84:87], v[36:39], a[148:151], v[84:87]
    buffer_load_dwordx4 v7, s[4:7], s46 offen offset:2048  lds
    v_add_f32 v28, 1.0, v28
    v_mfma_f32_16x16x32_bf16 v[88:91], v[32:35], a[136:139], v[88:91]
    ds_read_b64_tr_b16 v[52:53], v58 offset:22528
    v_mul_f32 v29, v105, v105
    v_mfma_f32_16x16x32_bf16 v[88:91], v[36:39], a[152:155], v[88:91]
    v_rcp_f32 v28, v28
    v_mfma_f32_16x16x32_bf16 v[92:95], v[32:35], a[140:143], v[92:95]
    ds_read_b64_tr_b16 v[54:55], v58 offset:22784
    v_fma_f32 v29, v29, v10, s35
    v_mfma_f32_16x16x32_bf16 v[92:95], v[36:39], a[156:159], v[92:95]
    s_waitcnt lgkmcnt(4)
    v_mul_f32 v120, v120, v28
    v_mfma_f32_16x16x32_bf16 v[64:67], v[40:43], a[160:163], v[64:67]
    ds_read_b64_tr_b16 v[32:33], v56 offset:24576
    v_mul_f32 v29, v29, v105
    v_mfma_f32_16x16x32_bf16 v[64:67], v[44:47], a[176:179], v[64:67]
    v_exp_f32 v29, v29
    v_mfma_f32_16x16x32_bf16 v[68:71], v[40:43], a[164:167], v[68:71]
    ds_read_b64_tr_b16 v[34:35], v56 offset:24832
    v_mul_f32 v121, v121, v105
    v_mfma_f32_16x16x32_bf16 v[68:71], v[44:47], a[180:183], v[68:71]
    v_add_f32 v29, 1.0, v29
    v_mfma_f32_16x16x32_bf16 v[72:75], v[40:43], a[168:171], v[72:75]
    ds_read_b64_tr_b16 v[36:37], v56 offset:26624
    v_mul_f32 v30, v106, v106
    v_mfma_f32_16x16x32_bf16 v[72:75], v[44:47], a[184:187], v[72:75]
    v_rcp_f32 v29, v29
    v_mfma_f32_16x16x32_bf16 v[76:79], v[40:43], a[172:175], v[76:79]
    ds_read_b64_tr_b16 v[38:39], v56 offset:26880
    v_fma_f32 v30, v30, v10, s35
    v_mfma_f32_16x16x32_bf16 v[76:79], v[44:47], a[188:191], v[76:79]
    s_waitcnt lgkmcnt(4)
    buffer_load_dwordx4 v7, s[4:7], s47 offen offset:3072  lds
    v_mul_f32 v121, v121, v29
    v_mfma_f32_16x16x32_bf16 v[80:83], v[48:51], a[160:163], v[80:83]
    ds_read_b64_tr_b16 v[40:41], v58 offset:24576
    v_cvt_pk_bf16_f32 v138, v120, v121
    v_mfma_f32_16x16x32_bf16 v[80:83], v[52:55], a[176:179], v[80:83]
    v_mul_f32 v30, v30, v106
    v_mfma_f32_16x16x32_bf16 v[84:87], v[48:51], a[164:167], v[84:87]
    ds_read_b64_tr_b16 v[42:43], v58 offset:24832
    v_mul_f32 v122, v122, v106
    v_mfma_f32_16x16x32_bf16 v[84:87], v[52:55], a[180:183], v[84:87]
    v_exp_f32 v30, v30
    v_mfma_f32_16x16x32_bf16 v[88:91], v[48:51], a[168:171], v[88:91]
    ds_read_b64_tr_b16 v[44:45], v58 offset:26624
    v_mul_f32 v31, v107, v107
    v_mfma_f32_16x16x32_bf16 v[88:91], v[52:55], a[184:187], v[88:91]
    v_add_f32 v30, 1.0, v30
    v_mfma_f32_16x16x32_bf16 v[92:95], v[48:51], a[172:175], v[92:95]
    s_add_u32 m0, s34, 8192
    ds_read_b64_tr_b16 v[46:47], v58 offset:26880
    v_fma_f32 v31, v31, v10, s35
    v_mfma_f32_16x16x32_bf16 v[92:95], v[52:55], a[188:191], v[92:95]
    s_waitcnt lgkmcnt(4)
    v_rcp_f32 v30, v30
    v_mfma_f32_16x16x32_bf16 v[64:67], v[32:35], a[192:195], v[64:67]
    ds_read_b64_tr_b16 v[48:49], v56 offset:28672
    v_mul_f32 v31, v31, v107
    v_mfma_f32_16x16x32_bf16 v[64:67], v[36:39], a[208:211], v[64:67]
    v_exp_f32 v31, v31
    v_mfma_f32_16x16x32_bf16 v[68:71], v[32:35], a[196:199], v[68:71]
    ds_read_b64_tr_b16 v[50:51], v56 offset:28928
    v_mul_f32 v122, v122, v30
    v_mfma_f32_16x16x32_bf16 v[68:71], v[36:39], a[212:215], v[68:71]
    buffer_load_dwordx4 v7, s[4:7], s48 offen offset:0  lds
    v_mul_f32 v123, v123, v107
    v_mfma_f32_16x16x32_bf16 v[72:75], v[32:35], a[200:203], v[72:75]
    ds_read_b64_tr_b16 v[52:53], v56 offset:30720
    v_add_f32 v31, 1.0, v31
    v_mfma_f32_16x16x32_bf16 v[72:75], v[36:39], a[216:219], v[72:75]
    v_rcp_f32 v31, v31
    v_mfma_f32_16x16x32_bf16 v[76:79], v[32:35], a[204:207], v[76:79]
    ds_read_b64_tr_b16 v[54:55], v56 offset:30976
    v_mul_f32 v16, v108, v108
    v_mfma_f32_16x16x32_bf16 v[76:79], v[36:39], a[220:223], v[76:79]
    s_waitcnt lgkmcnt(4)
    v_mul_f32 v123, v123, v31
    v_mfma_f32_16x16x32_bf16 v[80:83], v[40:43], a[192:195], v[80:83]
    ds_read_b64_tr_b16 v[32:33], v58 offset:28672
    v_cvt_pk_bf16_f32 v139, v122, v123
    v_mfma_f32_16x16x32_bf16 v[80:83], v[44:47], a[208:211], v[80:83]
    buffer_store_dwordx4 v[136:139], v8, s[16:19], s56 offen sc1
    v_fma_f32 v16, v16, v10, s35
    v_mfma_f32_16x16x32_bf16 v[84:87], v[40:43], a[196:199], v[84:87]
    s_add_u32 m0, s34, 36864
    ds_read_b64_tr_b16 v[34:35], v58 offset:28928
    v_mul_f32 v16, v16, v108
    v_mfma_f32_16x16x32_bf16 v[84:87], v[44:47], a[212:215], v[84:87]
    v_exp_f32 v16, v16
    v_mfma_f32_16x16x32_bf16 v[88:91], v[40:43], a[200:203], v[88:91]
    ds_read_b64_tr_b16 v[36:37], v58 offset:30720
    v_mul_f32 v124, v124, v108
    v_mfma_f32_16x16x32_bf16 v[88:91], v[44:47], a[216:219], v[88:91]
    buffer_load_dwordx4 v7, s[8:11], s40 offen offset:0  lds
    v_add_f32 v16, 1.0, v16
    v_mfma_f32_16x16x32_bf16 v[92:95], v[40:43], a[204:207], v[92:95]
    ds_read_b64_tr_b16 v[38:39], v58 offset:30976
    v_mul_f32 v17, v109, v109
    v_mfma_f32_16x16x32_bf16 v[92:95], v[44:47], a[220:223], v[92:95]
    s_waitcnt lgkmcnt(4)
    v_rcp_f32 v16, v16
    v_mfma_f32_16x16x32_bf16 v[64:67], v[48:51], a[224:227], v[64:67]
    ds_read_b64_tr_b16 v[40:41], v56 offset:32768
    v_fma_f32 v17, v17, v10, s35
    v_mfma_f32_16x16x32_bf16 v[64:67], v[52:55], a[240:243], v[64:67]
    v_mul_f32 v124, v124, v16
    v_mfma_f32_16x16x32_bf16 v[68:71], v[48:51], a[228:231], v[68:71]
    ds_read_b64_tr_b16 v[42:43], v56 offset:33024
    v_mul_f32 v17, v17, v109
    v_mfma_f32_16x16x32_bf16 v[68:71], v[52:55], a[244:247], v[68:71]
    v_exp_f32 v17, v17
    v_mfma_f32_16x16x32_bf16 v[72:75], v[48:51], a[232:235], v[72:75]
    ds_read_b64_tr_b16 v[44:45], v56 offset:34816
    v_mul_f32 v125, v125, v109
    v_mfma_f32_16x16x32_bf16 v[72:75], v[52:55], a[248:251], v[72:75]
    v_add_f32 v17, 1.0, v17
    v_mfma_f32_16x16x32_bf16 v[76:79], v[48:51], a[236:239], v[76:79]
    ds_read_b64_tr_b16 v[46:47], v56 offset:35072
    v_mul_f32 v18, v110, v110
    v_mfma_f32_16x16x32_bf16 v[76:79], v[52:55], a[252:255], v[76:79]
    s_waitcnt lgkmcnt(4)
    v_rcp_f32 v17, v17
    v_mfma_f32_16x16x32_bf16 v[80:83], v[32:35], a[224:227], v[80:83]
    ds_read_b64_tr_b16 v[48:49], v58 offset:32768
    v_fma_f32 v18, v18, v10, s35
    v_mfma_f32_16x16x32_bf16 v[80:83], v[36:39], a[240:243], v[80:83]
    buffer_load_dwordx4 v7, s[8:11], s41 offen offset:1024  lds
    v_mul_f32 v125, v125, v17
    v_mfma_f32_16x16x32_bf16 v[84:87], v[32:35], a[228:231], v[84:87]
    ds_read_b64_tr_b16 v[50:51], v58 offset:33024
    v_cvt_pk_bf16_f32 v142, v124, v125
    v_mfma_f32_16x16x32_bf16 v[84:87], v[36:39], a[244:247], v[84:87]
    v_mul_f32 v18, v18, v110
    v_mfma_f32_16x16x32_bf16 v[88:91], v[32:35], a[232:235], v[88:91]
    ds_read_b64_tr_b16 v[52:53], v58 offset:34816
    v_mul_f32 v126, v126, v110
    v_mfma_f32_16x16x32_bf16 v[88:91], v[36:39], a[248:251], v[88:91]
    v_exp_f32 v18, v18
    v_mfma_f32_16x16x32_bf16 v[92:95], v[32:35], a[236:239], v[92:95]
    ds_read_b64_tr_b16 v[54:55], v58 offset:35072
    v_mul_f32 v19, v111, v111
    v_mfma_f32_16x16x32_bf16 v[92:95], v[36:39], a[252:255], v[92:95]
    s_waitcnt lgkmcnt(4)
    v_add_f32 v18, 1.0, v18
    v_mfma_f32_16x16x32_bf16 v[64:67], v[40:43], v[224:227], v[64:67]
    ds_read_b64_tr_b16 v[32:33], v57 offset:0
    v_fma_f32 v19, v19, v10, s35
    v_mfma_f32_16x16x32_bf16 v[64:67], v[44:47], v[240:243], v[64:67]
    v_rcp_f32 v18, v18
    v_mfma_f32_16x16x32_bf16 v[68:71], v[40:43], v[228:231], v[68:71]
    ds_read_b64_tr_b16 v[34:35], v57 offset:256
    v_mul_f32 v19, v19, v111
    v_mfma_f32_16x16x32_bf16 v[68:71], v[44:47], v[244:247], v[68:71]
    v_exp_f32 v19, v19
    v_mfma_f32_16x16x32_bf16 v[72:75], v[40:43], v[232:235], v[72:75]
    ds_read_b64_tr_b16 v[36:37], v57 offset:2048
    v_mul_f32 v126, v126, v18
    v_mfma_f32_16x16x32_bf16 v[72:75], v[44:47], v[248:251], v[72:75]
    buffer_load_dwordx4 v7, s[8:11], s42 offen offset:2048  lds
    v_mul_f32 v127, v127, v111
    v_mfma_f32_16x16x32_bf16 v[76:79], v[40:43], v[236:239], v[76:79]
    ds_read_b64_tr_b16 v[38:39], v57 offset:2304
    v_add_f32 v19, 1.0, v19
    v_mfma_f32_16x16x32_bf16 v[76:79], v[44:47], v[252:255], v[76:79]
    s_waitcnt lgkmcnt(4)
    v_rcp_f32 v19, v19
    v_mfma_f32_16x16x32_bf16 v[80:83], v[48:51], v[224:227], v[80:83]
    ds_read_b64_tr_b16 v[40:41], v59 offset:0
    v_mfma_f32_16x16x32_bf16 v[80:83], v[52:55], v[240:243], v[80:83]
    v_mul_f32 v127, v127, v19
    v_mfma_f32_16x16x32_bf16 v[84:87], v[48:51], v[228:231], v[84:87]
    ds_read_b64_tr_b16 v[42:43], v59 offset:256
    v_cvt_pk_bf16_f32 v143, v126, v127
    v_mfma_f32_16x16x32_bf16 v[84:87], v[52:55], v[244:247], v[84:87]
    buffer_store_dwordx4 v[140:143], v8, s[16:19], s57 offen sc1
    v_mfma_f32_16x16x32_bf16 v[88:91], v[48:51], v[232:235], v[88:91]
    ds_read_b64_tr_b16 v[44:45], v59 offset:2048
    v_mfma_f32_16x16x32_bf16 v[88:91], v[52:55], v[248:251], v[88:91]
    v_mfma_f32_16x16x32_bf16 v[92:95], v[48:51], v[236:239], v[92:95]
    ds_read_b64_tr_b16 v[46:47], v59 offset:2304
    v_mfma_f32_16x16x32_bf16 v[92:95], v[52:55], v[252:255], v[92:95]
    s_waitcnt lgkmcnt(4)
    v_mfma_f32_16x16x32_bf16 v[96:99], v[32:35], a[0:3], 0
    s_lshl_b32 s49, s82, 10
    ds_read_b64_tr_b16 v[48:49], v57 offset:4096
    v_mfma_f32_16x16x32_bf16 v[96:99], v[36:39], a[16:19], v[96:99]
    buffer_load_dwordx4 v7, s[8:11], s43 offen offset:3072  lds
    v_mfma_f32_16x16x32_bf16 v[100:103], v[32:35], a[4:7], 0
    ds_read_b64_tr_b16 v[50:51], v57 offset:4352
    v_add_u32 v8, s49, v9
    v_mfma_f32_16x16x32_bf16 v[100:103], v[36:39], a[20:23], v[100:103]
    v_mul_f32 v16, v64, v64
    v_mfma_f32_16x16x32_bf16 v[104:107], v[32:35], a[8:11], 0
    ds_read_b64_tr_b16 v[52:53], v57 offset:6144
    v_fma_f32 v16, v16, v10, s35
    v_mfma_f32_16x16x32_bf16 v[104:107], v[36:39], a[24:27], v[104:107]
    v_mul_f32 v16, v16, v64
    v_mfma_f32_16x16x32_bf16 v[108:111], v[32:35], a[12:15], 0
    ds_read_b64_tr_b16 v[54:55], v57 offset:6400
    v_mul_f32 v80, v80, v64
    v_mfma_f32_16x16x32_bf16 v[108:111], v[36:39], a[28:31], v[108:111]
    s_waitcnt lgkmcnt(4)
    v_exp_f32 v16, v16
    v_mfma_f32_16x16x32_bf16 v[112:115], v[40:43], a[0:3], 0
    ds_read_b64_tr_b16 v[32:33], v59 offset:4096
    v_mul_f32 v17, v65, v65
    v_mfma_f32_16x16x32_bf16 v[112:115], v[44:47], a[16:19], v[112:115]
    v_add_f32 v16, 1.0, v16
    v_mfma_f32_16x16x32_bf16 v[116:119], v[40:43], a[4:7], 0
    s_add_u32 m0, s34, 40960
    ds_read_b64_tr_b16 v[34:35], v59 offset:4352
    v_fma_f32 v17, v17, v10, s35
    v_mfma_f32_16x16x32_bf16 v[116:119], v[44:47], a[20:23], v[116:119]
    v_rcp_f32 v16, v16
    v_mfma_f32_16x16x32_bf16 v[120:123], v[40:43], a[8:11], 0
    ds_read_b64_tr_b16 v[36:37], v59 offset:6144
    v_mul_f32 v17, v17, v65
    v_mfma_f32_16x16x32_bf16 v[120:123], v[44:47], a[24:27], v[120:123]
    v_exp_f32 v17, v17
    v_mfma_f32_16x16x32_bf16 v[124:127], v[40:43], a[12:15], 0
    ds_read_b64_tr_b16 v[38:39], v59 offset:6400
    v_mul_f32 v80, v80, v16
    v_mfma_f32_16x16x32_bf16 v[124:127], v[44:47], a[28:31], v[124:127]
    s_waitcnt lgkmcnt(4)
    buffer_load_dwordx4 v7, s[8:11], s44 offen offset:0  lds
    v_mul_f32 v81, v81, v65
    v_mfma_f32_16x16x32_bf16 v[96:99], v[48:51], a[32:35], v[96:99]
    ds_read_b64_tr_b16 v[40:41], v57 offset:8192
    v_add_f32 v17, 1.0, v17
    v_mfma_f32_16x16x32_bf16 v[96:99], v[52:55], a[48:51], v[96:99]
    v_rcp_f32 v17, v17
    v_mfma_f32_16x16x32_bf16 v[100:103], v[48:51], a[36:39], v[100:103]
    ds_read_b64_tr_b16 v[42:43], v57 offset:8448
    v_mul_f32 v18, v66, v66
    v_mfma_f32_16x16x32_bf16 v[100:103], v[52:55], a[52:55], v[100:103]
    v_mul_f32 v81, v81, v17
    v_mfma_f32_16x16x32_bf16 v[104:107], v[48:51], a[40:43], v[104:107]
    ds_read_b64_tr_b16 v[44:45], v57 offset:10240
    v_cvt_pk_bf16_f32 v128, v80, v81
    v_mfma_f32_16x16x32_bf16 v[104:107], v[52:55], a[56:59], v[104:107]
    v_fma_f32 v18, v18, v10, s35
    v_mfma_f32_16x16x32_bf16 v[108:111], v[48:51], a[44:47], v[108:111]
    ds_read_b64_tr_b16 v[46:47], v57 offset:10496
    v_mul_f32 v18, v18, v66
    v_mfma_f32_16x16x32_bf16 v[108:111], v[52:55], a[60:63], v[108:111]
    s_waitcnt lgkmcnt(4)
    v_exp_f32 v18, v18
    v_mfma_f32_16x16x32_bf16 v[112:115], v[32:35], a[32:35], v[112:115]
    ds_read_b64_tr_b16 v[48:49], v59 offset:8192
    v_mul_f32 v82, v82, v66
    v_mfma_f32_16x16x32_bf16 v[112:115], v[36:39], a[48:51], v[112:115]
    buffer_load_dwordx4 v7, s[8:11], s45 offen offset:1024  lds
    v_add_f32 v18, 1.0, v18
    v_mfma_f32_16x16x32_bf16 v[116:119], v[32:35], a[36:39], v[116:119]
    ds_read_b64_tr_b16 v[50:51], v59 offset:8448
    v_mul_f32 v19, v67, v67
    v_mfma_f32_16x16x32_bf16 v[116:119], v[36:39], a[52:55], v[116:119]
    v_rcp_f32 v18, v18
    v_mfma_f32_16x16x32_bf16 v[120:123], v[32:35], a[40:43], v[120:123]
    ds_read_b64_tr_b16 v[52:53], v59 offset:10240
    v_fma_f32 v19, v19, v10, s35
    v_mfma_f32_16x16x32_bf16 v[120:123], v[36:39], a[56:59], v[120:123]
    v_mul_f32 v82, v82, v18
    v_mfma_f32_16x16x32_bf16 v[124:127], v[32:35], a[44:47], v[124:127]
    ds_read_b64_tr_b16 v[54:55], v59 offset:10496
    v_mul_f32 v19, v19, v67
    v_mfma_f32_16x16x32_bf16 v[124:127], v[36:39], a[60:63], v[124:127]
    s_waitcnt lgkmcnt(4)
    v_exp_f32 v19, v19
    v_mfma_f32_16x16x32_bf16 v[96:99], v[40:43], a[64:67], v[96:99]
    ds_read_b64_tr_b16 v[32:33], v57 offset:12288
    v_mul_f32 v83, v83, v67
    v_mfma_f32_16x16x32_bf16 v[96:99], v[44:47], a[80:83], v[96:99]
    v_add_f32 v19, 1.0, v19
    v_mfma_f32_16x16x32_bf16 v[100:103], v[40:43], a[68:71], v[100:103]
    ds_read_b64_tr_b16 v[34:35], v57 offset:12544
    v_mul_f32 v20, v68, v68
    v_mfma_f32_16x16x32_bf16 v[100:103], v[44:47], a[84:87], v[100:103]
    v_rcp_f32 v19, v19
    v_mfma_f32_16x16x32_bf16 v[104:107], v[40:43], a[72:75], v[104:107]
    ds_read_b64_tr_b16 v[36:37], v57 offset:14336
    v_fma_f32 v20, v20, v10, s35
    v_mfma_f32_16x16x32_bf16 v[104:107], v[44:47], a[88:91], v[104:107]
    buffer_load_dwordx4 v7, s[8:11], s46 offen offset:2048  lds
    v_mul_f32 v83, v83, v19
    v_mfma_f32_16x16x32_bf16 v[108:111], v[40:43], a[76:79], v[108:111]
    ds_read_b64_tr_b16 v[38:39], v57 offset:14592
    v_cvt_pk_bf16_f32 v129, v82, v83
    v_mfma_f32_16x16x32_bf16 v[108:111], v[44:47], a[92:95], v[108:111]
    s_waitcnt lgkmcnt(4)
    v_mul_f32 v20, v20, v68
    v_mfma_f32_16x16x32_bf16 v[112:115], v[48:51], a[64:67], v[112:115]
    ds_read_b64_tr_b16 v[40:41], v59 offset:12288
    v_mul_f32 v84, v84, v68
    v_mfma_f32_16x16x32_bf16 v[112:115], v[52:55], a[80:83], v[112:115]
    v_exp_f32 v20, v20
    v_mfma_f32_16x16x32_bf16 v[116:119], v[48:51], a[68:71], v[116:119]
    ds_read_b64_tr_b16 v[42:43], v59 offset:12544
    v_mul_f32 v21, v69, v69
    v_mfma_f32_16x16x32_bf16 v[116:119], v[52:55], a[84:87], v[116:119]
    v_add_f32 v20, 1.0, v20
    v_mfma_f32_16x16x32_bf16 v[120:123], v[48:51], a[72:75], v[120:123]
    ds_read_b64_tr_b16 v[44:45], v59 offset:14336
    v_fma_f32 v21, v21, v10, s35
    v_mfma_f32_16x16x32_bf16 v[120:123], v[52:55], a[88:91], v[120:123]
    v_rcp_f32 v20, v20
    v_mfma_f32_16x16x32_bf16 v[124:127], v[48:51], a[76:79], v[124:127]
    ds_read_b64_tr_b16 v[46:47], v59 offset:14592
    v_mul_f32 v21, v21, v69
    v_mfma_f32_16x16x32_bf16 v[124:127], v[52:55], a[92:95], v[124:127]
    s_waitcnt lgkmcnt(4)
    v_exp_f32 v21, v21
    v_mfma_f32_16x16x32_bf16 v[96:99], v[32:35], a[96:99], v[96:99]
    ds_read_b64_tr_b16 v[48:49], v57 offset:16384
    v_mul_f32 v84, v84, v20
    v_mfma_f32_16x16x32_bf16 v[96:99], v[36:39], a[112:115], v[96:99]
    buffer_load_dwordx4 v7, s[8:11], s47 offen offset:3072  lds
    v_mul_f32 v85, v85, v69
    v_mfma_f32_16x16x32_bf16 v[100:103], v[32:35], a[100:103], v[100:103]
    ds_read_b64_tr_b16 v[50:51], v57 offset:16640
    v_add_f32 v21, 1.0, v21
    v_mfma_f32_16x16x32_bf16 v[100:103], v[36:39], a[116:119], v[100:103]
    v_rcp_f32 v21, v21
    v_mfma_f32_16x16x32_bf16 v[104:107], v[32:35], a[104:107], v[104:107]
    ds_read_b64_tr_b16 v[52:53], v57 offset:18432
    v_mul_f32 v22, v70, v70
    v_mfma_f32_16x16x32_bf16 v[104:107], v[36:39], a[120:123], v[104:107]
    v_mul_f32 v85, v85, v21
    v_mfma_f32_16x16x32_bf16 v[108:111], v[32:35], a[108:111], v[108:111]
    ds_read_b64_tr_b16 v[54:55], v57 offset:18688
    v_cvt_pk_bf16_f32 v132, v84, v85
    v_mfma_f32_16x16x32_bf16 v[108:111], v[36:39], a[124:127], v[108:111]
    s_waitcnt lgkmcnt(4)
    v_fma_f32 v22, v22, v10, s35
    v_mfma_f32_16x16x32_bf16 v[112:115], v[40:43], a[96:99], v[112:115]
    ds_read_b64_tr_b16 v[32:33], v59 offset:16384
    v_mul_f32 v22, v22, v70
    v_mfma_f32_16x16x32_bf16 v[112:115], v[44:47], a[112:115], v[112:115]
    v_exp_f32 v22, v22
    v_mfma_f32_16x16x32_bf16 v[116:119], v[40:43], a[100:103], v[116:119]
    s_add_u32 m0, s34, 45056
    ds_read_b64_tr_b16 v[34:35], v59 offset:16640
    v_mul_f32 v86, v86, v70
    v_mfma_f32_16x16x32_bf16 v[116:119], v[44:47], a[116:119], v[116:119]
    v_add_f32 v22, 1.0, v22
    v_mfma_f32_16x16x32_bf16 v[120:123], v[40:43], a[104:107], v[120:123]
    ds_read_b64_tr_b16 v[36:37], v59 offset:18432
    v_mul_f32 v23, v71, v71
    v_mfma_f32_16x16x32_bf16 v[120:123], v[44:47], a[120:123], v[120:123]
    v_rcp_f32 v22, v22
    v_mfma_f32_16x16x32_bf16 v[124:127], v[40:43], a[108:111], v[124:127]
    ds_read_b64_tr_b16 v[38:39], v59 offset:18688
    v_fma_f32 v23, v23, v10, s35
    v_mfma_f32_16x16x32_bf16 v[124:127], v[44:47], a[124:127], v[124:127]
    s_waitcnt lgkmcnt(4)
    buffer_load_dwordx4 v7, s[8:11], s48 offen offset:0  lds
    v_mul_f32 v86, v86, v22
    v_mfma_f32_16x16x32_bf16 v[96:99], v[48:51], a[128:131], v[96:99]
    s_mov_b32 s36, 884736
    ds_read_b64_tr_b16 v[40:41], v57 offset:20480
    v_mul_f32 v23, v23, v71
    v_mfma_f32_16x16x32_bf16 v[96:99], v[52:55], a[144:147], v[96:99]
    v_exp_f32 v23, v23
    v_mfma_f32_16x16x32_bf16 v[100:103], v[48:51], a[132:135], v[100:103]
    ds_read_b64_tr_b16 v[42:43], v57 offset:20736
    v_mul_f32 v87, v87, v71
    v_mfma_f32_16x16x32_bf16 v[100:103], v[52:55], a[148:151], v[100:103]
    buffer_load_dword v1, v62, s[12:15], s36 offen
    v_add_f32 v23, 1.0, v23
    v_mfma_f32_16x16x32_bf16 v[104:107], v[48:51], a[136:139], v[104:107]
    ds_read_b64_tr_b16 v[44:45], v57 offset:22528
    v_mul_f32 v28, v72, v72
    v_mfma_f32_16x16x32_bf16 v[104:107], v[52:55], a[152:155], v[104:107]
    v_rcp_f32 v23, v23
    v_mfma_f32_16x16x32_bf16 v[108:111], v[48:51], a[140:143], v[108:111]
    ds_read_b64_tr_b16 v[46:47], v57 offset:22784
    v_fma_f32 v28, v28, v10, s35
    v_mfma_f32_16x16x32_bf16 v[108:111], v[52:55], a[156:159], v[108:111]
    s_waitcnt lgkmcnt(4)
    v_mul_f32 v87, v87, v23
    v_mfma_f32_16x16x32_bf16 v[112:115], v[32:35], a[128:131], v[112:115]
    ds_read_b64_tr_b16 v[48:49], v59 offset:20480
    v_cvt_pk_bf16_f32 v133, v86, v87
    v_mfma_f32_16x16x32_bf16 v[112:115], v[36:39], a[144:147], v[112:115]
    v_mul_f32 v28, v28, v72
    v_mfma_f32_16x16x32_bf16 v[116:119], v[32:35], a[132:135], v[116:119]
    ds_read_b64_tr_b16 v[50:51], v59 offset:20736
    v_mul_f32 v88, v88, v72
    v_mfma_f32_16x16x32_bf16 v[116:119], v[36:39], a[148:151], v[116:119]
    v_exp_f32 v28, v28
    v_mfma_f32_16x16x32_bf16 v[120:123], v[32:35], a[136:139], v[120:123]
    ds_read_b64_tr_b16 v[52:53], v59 offset:22528
    v_mul_f32 v29, v73, v73
    v_mfma_f32_16x16x32_bf16 v[120:123], v[36:39], a[152:155], v[120:123]
    v_add_f32 v28, 1.0, v28
    v_mfma_f32_16x16x32_bf16 v[124:127], v[32:35], a[140:143], v[124:127]
    ds_read_b64_tr_b16 v[54:55], v59 offset:22784
    v_fma_f32 v29, v29, v10, s35
    v_mfma_f32_16x16x32_bf16 v[124:127], v[36:39], a[156:159], v[124:127]
    s_waitcnt lgkmcnt(4)
    v_rcp_f32 v28, v28
    v_mfma_f32_16x16x32_bf16 v[96:99], v[40:43], a[160:163], v[96:99]
    ds_read_b64_tr_b16 v[32:33], v57 offset:24576
    v_mul_f32 v29, v29, v73
    v_mfma_f32_16x16x32_bf16 v[96:99], v[44:47], a[176:179], v[96:99]
    v_exp_f32 v29, v29
    v_mfma_f32_16x16x32_bf16 v[100:103], v[40:43], a[164:167], v[100:103]
    ds_read_b64_tr_b16 v[34:35], v57 offset:24832
    v_mul_f32 v88, v88, v28
    v_mfma_f32_16x16x32_bf16 v[100:103], v[44:47], a[180:183], v[100:103]
    v_mul_f32 v89, v89, v73
    v_mfma_f32_16x16x32_bf16 v[104:107], v[40:43], a[168:171], v[104:107]
    ds_read_b64_tr_b16 v[36:37], v57 offset:26624
    v_add_f32 v29, 1.0, v29
    v_mfma_f32_16x16x32_bf16 v[104:107], v[44:47], a[184:187], v[104:107]
    v_rcp_f32 v29, v29
    v_mfma_f32_16x16x32_bf16 v[108:111], v[40:43], a[172:175], v[108:111]
    ds_read_b64_tr_b16 v[38:39], v57 offset:26880
    v_mul_f32 v30, v74, v74
    v_mfma_f32_16x16x32_bf16 v[108:111], v[44:47], a[188:191], v[108:111]
    s_waitcnt lgkmcnt(4)
    v_mul_f32 v89, v89, v29
    v_mfma_f32_16x16x32_bf16 v[112:115], v[48:51], a[160:163], v[112:115]
    ds_read_b64_tr_b16 v[40:41], v59 offset:24576
    v_cvt_pk_bf16_f32 v136, v88, v89
    v_mfma_f32_16x16x32_bf16 v[112:115], v[52:55], a[176:179], v[112:115]
    v_fma_f32 v30, v30, v10, s35
    v_mfma_f32_16x16x32_bf16 v[116:119], v[48:51], a[164:167], v[116:119]
    ds_read_b64_tr_b16 v[42:43], v59 offset:24832
    v_mul_f32 v30, v30, v74
    v_mfma_f32_16x16x32_bf16 v[116:119], v[52:55], a[180:183], v[116:119]
    v_exp_f32 v30, v30
    v_mfma_f32_16x16x32_bf16 v[120:123], v[48:51], a[168:171], v[120:123]
    ds_read_b64_tr_b16 v[44:45], v59 offset:26624
    v_mul_f32 v90, v90, v74
    v_mfma_f32_16x16x32_bf16 v[120:123], v[52:55], a[184:187], v[120:123]
    v_add_f32 v30, 1.0, v30
    v_mfma_f32_16x16x32_bf16 v[124:127], v[48:51], a[172:175], v[124:127]
    ds_read_b64_tr_b16 v[46:47], v59 offset:26880
    v_mul_f32 v31, v75, v75
    v_mfma_f32_16x16x32_bf16 v[124:127], v[52:55], a[188:191], v[124:127]
    s_waitcnt lgkmcnt(4)
    v_rcp_f32 v30, v30
    v_mfma_f32_16x16x32_bf16 v[96:99], v[32:35], a[192:195], v[96:99]
    ds_read_b64_tr_b16 v[48:49], v57 offset:28672
    v_fma_f32 v31, v31, v10, s35
    v_mfma_f32_16x16x32_bf16 v[96:99], v[36:39], a[208:211], v[96:99]
    v_mul_f32 v90, v90, v30
    v_mfma_f32_16x16x32_bf16 v[100:103], v[32:35], a[196:199], v[100:103]
    ds_read_b64_tr_b16 v[50:51], v57 offset:28928
    v_mul_f32 v31, v31, v75
    v_mfma_f32_16x16x32_bf16 v[100:103], v[36:39], a[212:215], v[100:103]
    v_exp_f32 v31, v31
    v_mfma_f32_16x16x32_bf16 v[104:107], v[32:35], a[200:203], v[104:107]
    ds_read_b64_tr_b16 v[52:53], v57 offset:30720
    v_mul_f32 v91, v91, v75
    v_mfma_f32_16x16x32_bf16 v[104:107], v[36:39], a[216:219], v[104:107]
    v_add_f32 v31, 1.0, v31
    v_mfma_f32_16x16x32_bf16 v[108:111], v[32:35], a[204:207], v[108:111]
    ds_read_b64_tr_b16 v[54:55], v57 offset:30976
    v_mul_f32 v16, v76, v76
    v_mfma_f32_16x16x32_bf16 v[108:111], v[36:39], a[220:223], v[108:111]
    s_waitcnt lgkmcnt(4)
    v_rcp_f32 v31, v31
    v_mfma_f32_16x16x32_bf16 v[112:115], v[40:43], a[192:195], v[112:115]
    ds_read_b64_tr_b16 v[32:33], v59 offset:28672
    v_fma_f32 v16, v16, v10, s35
    v_mfma_f32_16x16x32_bf16 v[112:115], v[44:47], a[208:211], v[112:115]
    v_mul_f32 v91, v91, v31
    v_mfma_f32_16x16x32_bf16 v[116:119], v[40:43], a[196:199], v[116:119]
    ds_read_b64_tr_b16 v[34:35], v59 offset:28928
    v_cvt_pk_bf16_f32 v137, v90, v91
    v_mfma_f32_16x16x32_bf16 v[116:119], v[44:47], a[212:215], v[116:119]
    v_mul_f32 v16, v16, v76
    v_mfma_f32_16x16x32_bf16 v[120:123], v[40:43], a[200:203], v[120:123]
    ds_read_b64_tr_b16 v[36:37], v59 offset:30720
    v_mul_f32 v92, v92, v76
    v_mfma_f32_16x16x32_bf16 v[120:123], v[44:47], a[216:219], v[120:123]
    v_exp_f32 v16, v16
    v_mfma_f32_16x16x32_bf16 v[124:127], v[40:43], a[204:207], v[124:127]
    ds_read_b64_tr_b16 v[38:39], v59 offset:30976
    v_mul_f32 v17, v77, v77
    v_mfma_f32_16x16x32_bf16 v[124:127], v[44:47], a[220:223], v[124:127]
    s_waitcnt lgkmcnt(4)
    v_add_f32 v16, 1.0, v16
    v_mfma_f32_16x16x32_bf16 v[96:99], v[48:51], a[224:227], v[96:99]
    ds_read_b64_tr_b16 v[40:41], v57 offset:32768
    v_fma_f32 v17, v17, v10, s35
    v_mfma_f32_16x16x32_bf16 v[96:99], v[52:55], a[240:243], v[96:99]
    v_rcp_f32 v16, v16
    v_mfma_f32_16x16x32_bf16 v[100:103], v[48:51], a[228:231], v[100:103]
    ds_read_b64_tr_b16 v[42:43], v57 offset:33024
    v_mul_f32 v17, v17, v77
    v_mfma_f32_16x16x32_bf16 v[100:103], v[52:55], a[244:247], v[100:103]
    v_exp_f32 v17, v17
    v_mfma_f32_16x16x32_bf16 v[104:107], v[48:51], a[232:235], v[104:107]
    ds_read_b64_tr_b16 v[44:45], v57 offset:34816
    v_mul_f32 v92, v92, v16
    v_mfma_f32_16x16x32_bf16 v[104:107], v[52:55], a[248:251], v[104:107]
    v_mul_f32 v93, v93, v77
    v_mfma_f32_16x16x32_bf16 v[108:111], v[48:51], a[236:239], v[108:111]
    ds_read_b64_tr_b16 v[46:47], v57 offset:35072
    v_add_f32 v17, 1.0, v17
    v_mfma_f32_16x16x32_bf16 v[108:111], v[52:55], a[252:255], v[108:111]
    s_waitcnt lgkmcnt(4)
    v_rcp_f32 v17, v17
    v_mfma_f32_16x16x32_bf16 v[112:115], v[32:35], a[224:227], v[112:115]
    ds_read_b64_tr_b16 v[48:49], v59 offset:32768
    v_mul_f32 v18, v78, v78
    v_mfma_f32_16x16x32_bf16 v[112:115], v[36:39], a[240:243], v[112:115]
    ds_read_b64_tr_b16 v[50:51], v59 offset:33024
    v_mul_f32 v93, v93, v17
    v_mfma_f32_16x16x32_bf16 v[116:119], v[32:35], a[228:231], v[116:119]
    ds_read_b64_tr_b16 v[52:53], v59 offset:34816
    v_cvt_pk_bf16_f32 v140, v92, v93
    v_mfma_f32_16x16x32_bf16 v[116:119], v[36:39], a[244:247], v[116:119]
    ds_read_b64_tr_b16 v[54:55], v59 offset:35072
    v_fma_f32 v18, v18, v10, s35
    v_mfma_f32_16x16x32_bf16 v[120:123], v[32:35], a[232:235], v[120:123]
    v_mul_f32 v18, v18, v78
    v_mfma_f32_16x16x32_bf16 v[120:123], v[36:39], a[248:251], v[120:123]
    v_exp_f32 v18, v18
    v_mfma_f32_16x16x32_bf16 v[124:127], v[32:35], a[236:239], v[124:127]
    v_mul_f32 v94, v94, v78
    v_mfma_f32_16x16x32_bf16 v[124:127], v[36:39], a[252:255], v[124:127]
    s_waitcnt vmcnt(1) lgkmcnt(0)
    s_barrier
    v_add_f32 v18, 1.0, v18
    v_mfma_f32_16x16x32_bf16 v[96:99], v[40:43], v[224:227], v[96:99]
    ds_read_b64_tr_b16 v[32:33], v2 offset:0
    v_mul_f32 v19, v79, v79
    v_mfma_f32_16x16x32_bf16 v[96:99], v[44:47], v[240:243], v[96:99]
    v_rcp_f32 v18, v18
    v_mfma_f32_16x16x32_bf16 v[100:103], v[40:43], v[228:231], v[100:103]
    ds_read_b64_tr_b16 v[34:35], v2 offset:256
    v_fma_f32 v19, v19, v10, s35
    v_mfma_f32_16x16x32_bf16 v[100:103], v[44:47], v[244:247], v[100:103]
    v_mul_f32 v94, v94, v18
    v_mfma_f32_16x16x32_bf16 v[104:107], v[40:43], v[232:235], v[104:107]
    ds_read_b64_tr_b16 v[36:37], v2 offset:2048
    v_mul_f32 v19, v19, v79
    v_mfma_f32_16x16x32_bf16 v[104:107], v[44:47], v[248:251], v[104:107]
    v_exp_f32 v19, v19
    v_mfma_f32_16x16x32_bf16 v[108:111], v[40:43], v[236:239], v[108:111]
    ds_read_b64_tr_b16 v[38:39], v2 offset:2304
    v_mul_f32 v95, v95, v79
    v_mfma_f32_16x16x32_bf16 v[108:111], v[44:47], v[252:255], v[108:111]
    s_waitcnt lgkmcnt(4)
    v_add_f32 v19, 1.0, v19
    v_mfma_f32_16x16x32_bf16 v[112:115], v[48:51], v[224:227], v[112:115]
    ds_read_b64_tr_b16 v[40:41], v4 offset:0
    v_mfma_f32_16x16x32_bf16 v[112:115], v[52:55], v[240:243], v[112:115]
    v_rcp_f32 v19, v19
    v_mfma_f32_16x16x32_bf16 v[116:119], v[48:51], v[228:231], v[116:119]
    ds_read_b64_tr_b16 v[42:43], v4 offset:256
    v_mfma_f32_16x16x32_bf16 v[116:119], v[52:55], v[244:247], v[116:119]
    v_mul_f32 v95, v95, v19
    v_mfma_f32_16x16x32_bf16 v[120:123], v[48:51], v[232:235], v[120:123]
    ds_read_b64_tr_b16 v[44:45], v4 offset:2048
    v_cvt_pk_bf16_f32 v141, v94, v95
    v_mfma_f32_16x16x32_bf16 v[120:123], v[52:55], v[248:251], v[120:123]
    v_mfma_f32_16x16x32_bf16 v[124:127], v[48:51], v[236:239], v[124:127]
    ds_read_b64_tr_b16 v[46:47], v4 offset:2304
    v_mfma_f32_16x16x32_bf16 v[124:127], v[52:55], v[252:255], v[124:127]
    s_waitcnt lgkmcnt(4)
    s_add_u32 s36, s36, 0x6c000
    s_add_u32 s49, s67, 4816896
    v_add_u32 v13, 3, v148
    s_mov_b64 exec, 1
    buffer_store_dword v13, off, s[16:19], s49 sc1
    s_mov_b64 exec, -1
    v_mfma_f32_16x16x32_bf16 v[64:67], v[32:35], a[0:3], 0
    s_mov_b32 s66, 479232
    s_bitcmp1_b32 s24, 0
    s_cselect_b32 s40, s66, 147456
    ds_read_b64_tr_b16 v[48:49], v2 offset:4096
    v_mov_b32 v56, v150
    v_mfma_f32_16x16x32_bf16 v[64:67], v[36:39], a[16:19], v[64:67]
    s_add_u32 s40, s40, s75
    v_mov_b32 v57, v151
    v_mfma_f32_16x16x32_bf16 v[68:71], v[32:35], a[4:7], 0
    s_mov_b32 s66, 368640
    s_bitcmp1_b32 s24, 0
    s_cselect_b32 s41, s66, 0
    ds_read_b64_tr_b16 v[50:51], v2 offset:4352
    v_mov_b32 v58, v152
    v_mfma_f32_16x16x32_bf16 v[68:71], v[36:39], a[20:23], v[68:71]
    s_add_u32 s41, s41, s75
    v_mov_b32 v59, v153
    v_mfma_f32_16x16x32_bf16 v[72:75], v[32:35], a[8:11], 0
    s_mov_b32 s66, 516096
    s_bitcmp1_b32 s24, 0
    s_cselect_b32 s42, s66, 221184
    ds_read_b64_tr_b16 v[52:53], v2 offset:6144
    v_mov_b32 v61, v154
    v_mfma_f32_16x16x32_bf16 v[72:75], v[36:39], a[24:27], v[72:75]
    s_add_u32 s42, s42, s75
    v_mov_b32 v63, v155
    v_mfma_f32_16x16x32_bf16 v[76:79], v[32:35], a[12:15], 0
    s_mov_b32 s66, 405504
    s_bitcmp1_b32 s24, 0
    s_cselect_b32 s43, s66, 36864
    ds_read_b64_tr_b16 v[54:55], v2 offset:6400
    v_mov_b32 v6, v156
    v_mfma_f32_16x16x32_bf16 v[76:79], v[36:39], a[28:31], v[76:79]
    s_waitcnt lgkmcnt(4)
    s_add_u32 s43, s43, s75
    v_mov_b32 v7, v157
    v_mfma_f32_16x16x32_bf16 v[80:83], v[40:43], a[0:3], 0
    s_mov_b32 s66, 552960
    s_bitcmp1_b32 s24, 0
    s_cselect_b32 s44, s66, 258048
    ds_read_b64_tr_b16 v[32:33], v4 offset:4096
    v_mov_b32 v12, v158
    v_mfma_f32_16x16x32_bf16 v[80:83], v[44:47], a[16:19], v[80:83]
    s_add_u32 s44, s44, s75
    v_mul_f32 v16, v96, v96
    v_mfma_f32_16x16x32_bf16 v[84:87], v[40:43], a[4:7], 0
    s_mov_b32 s66, 442368
    s_bitcmp1_b32 s24, 0
    s_cselect_b32 s45, s66, 73728
    ds_read_b64_tr_b16 v[34:35], v4 offset:4352
    v_fma_f32 v16, v16, v10, s35
    v_mfma_f32_16x16x32_bf16 v[84:87], v[44:47], a[20:23], v[84:87]
    s_add_u32 s45, s45, s75
    v_mul_f32 v16, v16, v96
    v_mfma_f32_16x16x32_bf16 v[88:91], v[40:43], a[8:11], 0
    s_mov_b32 s66, 589824
    s_bitcmp1_b32 s24, 0
    s_cselect_b32 s46, s66, 184320
    ds_read_b64_tr_b16 v[36:37], v4 offset:6144
    v_mul_f32 v112, v112, v96
    v_mfma_f32_16x16x32_bf16 v[88:91], v[44:47], a[24:27], v[88:91]
    s_add_u32 s46, s46, s75
    v_exp_f32 v16, v16
    v_mfma_f32_16x16x32_bf16 v[92:95], v[40:43], a[12:15], 0
    s_mov_b32 s66, 331776
    s_bitcmp1_b32 s24, 0
    s_cselect_b32 s47, s66, 110592
    ds_read_b64_tr_b16 v[38:39], v4 offset:6400
    v_mul_f32 v17, v97, v97
    v_mfma_f32_16x16x32_bf16 v[92:95], v[44:47], a[28:31], v[92:95]
    s_waitcnt lgkmcnt(4)
    s_add_u32 s47, s47, s75
    v_add_f32 v16, 1.0, v16
    v_mfma_f32_16x16x32_bf16 v[64:67], v[48:51], a[32:35], v[64:67]
    s_mov_b32 s66, 626688
    s_bitcmp1_b32 s24, 0
    s_cselect_b32 s48, s66, 294912
    ds_read_b64_tr_b16 v[40:41], v2 offset:8192
    v_fma_f32 v17, v17, v10, s35
    v_mfma_f32_16x16x32_bf16 v[64:67], v[52:55], a[48:51], v[64:67]
    s_add_u32 s48, s48, s75
    v_rcp_f32 v16, v16
    v_mfma_f32_16x16x32_bf16 v[68:71], v[48:51], a[36:39], v[68:71]
    s_add_u32 m0, s34, 73728
    ds_read_b64_tr_b16 v[42:43], v2 offset:8448
    v_mul_f32 v17, v17, v97
    v_mfma_f32_16x16x32_bf16 v[68:71], v[52:55], a[52:55], v[68:71]
    v_exp_f32 v17, v17
    v_mfma_f32_16x16x32_bf16 v[72:75], v[48:51], a[40:43], v[72:75]
    ds_read_b64_tr_b16 v[44:45], v2 offset:10240
    v_mul_f32 v112, v112, v16
    v_mfma_f32_16x16x32_bf16 v[72:75], v[52:55], a[56:59], v[72:75]
    buffer_load_dwordx4 v56, s[12:15], s40 offen  lds
    v_mul_f32 v113, v113, v97
    v_mfma_f32_16x16x32_bf16 v[76:79], v[48:51], a[44:47], v[76:79]
    ds_read_b64_tr_b16 v[46:47], v2 offset:10496
    v_add_f32 v17, 1.0, v17
    v_mfma_f32_16x16x32_bf16 v[76:79], v[52:55], a[60:63], v[76:79]
    s_waitcnt lgkmcnt(4)
    v_rcp_f32 v17, v17
    v_mfma_f32_16x16x32_bf16 v[80:83], v[32:35], a[32:35], v[80:83]
    ds_read_b64_tr_b16 v[48:49], v4 offset:8192
    v_mul_f32 v18, v98, v98
    v_mfma_f32_16x16x32_bf16 v[80:83], v[36:39], a[48:51], v[80:83]
    s_add_u32 m0, s34, 74752
    v_mul_f32 v113, v113, v17
    v_mfma_f32_16x16x32_bf16 v[84:87], v[32:35], a[36:39], v[84:87]
    ds_read_b64_tr_b16 v[50:51], v4 offset:8448
    v_cvt_pk_bf16_f32 v130, v112, v113
    v_mfma_f32_16x16x32_bf16 v[84:87], v[36:39], a[52:55], v[84:87]
    buffer_load_dwordx4 v57, s[12:15], s40 offen  lds
    v_fma_f32 v18, v18, v10, s35
    v_mfma_f32_16x16x32_bf16 v[88:91], v[32:35], a[40:43], v[88:91]
    ds_read_b64_tr_b16 v[52:53], v4 offset:10240
    v_mul_f32 v18, v18, v98
    v_mfma_f32_16x16x32_bf16 v[88:91], v[36:39], a[56:59], v[88:91]
    v_exp_f32 v18, v18
    v_mfma_f32_16x16x32_bf16 v[92:95], v[32:35], a[44:47], v[92:95]
    ds_read_b64_tr_b16 v[54:55], v4 offset:10496
    v_mul_f32 v114, v114, v98
    v_mfma_f32_16x16x32_bf16 v[92:95], v[36:39], a[60:63], v[92:95]
    s_waitcnt lgkmcnt(4)
    v_add_f32 v18, 1.0, v18
    v_mfma_f32_16x16x32_bf16 v[64:67], v[40:43], a[64:67], v[64:67]
    s_add_u32 m0, s34, 75776
    ds_read_b64_tr_b16 v[32:33], v2 offset:12288
    v_mul_f32 v19, v99, v99
    v_mfma_f32_16x16x32_bf16 v[64:67], v[44:47], a[80:83], v[64:67]
    v_rcp_f32 v18, v18
    v_mfma_f32_16x16x32_bf16 v[68:71], v[40:43], a[68:71], v[68:71]
    ds_read_b64_tr_b16 v[34:35], v2 offset:12544
    v_fma_f32 v19, v19, v10, s35
    v_mfma_f32_16x16x32_bf16 v[68:71], v[44:47], a[84:87], v[68:71]
    buffer_load_dwordx4 v58, s[12:15], s40 offen  lds
    v_mul_f32 v114, v114, v18
    v_mfma_f32_16x16x32_bf16 v[72:75], v[40:43], a[72:75], v[72:75]
    ds_read_b64_tr_b16 v[36:37], v2 offset:14336
    v_mul_f32 v19, v19, v99
    v_mfma_f32_16x16x32_bf16 v[72:75], v[44:47], a[88:91], v[72:75]
    v_exp_f32 v19, v19
    v_mfma_f32_16x16x32_bf16 v[76:79], v[40:43], a[76:79], v[76:79]
    ds_read_b64_tr_b16 v[38:39], v2 offset:14592
    v_mul_f32 v115, v115, v99
    v_mfma_f32_16x16x32_bf16 v[76:79], v[44:47], a[92:95], v[76:79]
    s_waitcnt lgkmcnt(4)
    v_add_f32 v19, 1.0, v19
    v_mfma_f32_16x16x32_bf16 v[80:83], v[48:51], a[64:67], v[80:83]
    s_add_u32 m0, s34, 76800
    ds_read_b64_tr_b16 v[40:41], v4 offset:12288
    v_mul_f32 v20, v100, v100
    v_mfma_f32_16x16x32_bf16 v[80:83], v[52:55], a[80:83], v[80:83]
    v_rcp_f32 v19, v19
    v_mfma_f32_16x16x32_bf16 v[84:87], v[48:51], a[68:71], v[84:87]
    ds_read_b64_tr_b16 v[42:43], v4 offset:12544
    v_fma_f32 v20, v20, v10, s35
    v_mfma_f32_16x16x32_bf16 v[84:87], v[52:55], a[84:87], v[84:87]
    buffer_load_dwordx4 v59, s[12:15], s40 offen  lds
    v_mul_f32 v115, v115, v19
    v_mfma_f32_16x16x32_bf16 v[88:91], v[48:51], a[72:75], v[88:91]
    ds_read_b64_tr_b16 v[44:45], v4 offset:14336
    v_cvt_pk_bf16_f32 v131, v114, v115
    v_mfma_f32_16x16x32_bf16 v[88:91], v[52:55], a[88:91], v[88:91]
    buffer_store_dwordx4 v[128:131], v8, s[16:19], s54 offen sc1
    v_mul_f32 v20, v20, v100
    v_mfma_f32_16x16x32_bf16 v[92:95], v[48:51], a[76:79], v[92:95]
    s_add_u32 m0, s34, 77824
    ds_read_b64_tr_b16 v[46:47], v4 offset:14592
    v_mul_f32 v116, v116, v100
    v_mfma_f32_16x16x32_bf16 v[92:95], v[52:55], a[92:95], v[92:95]
    s_waitcnt lgkmcnt(4)
    v_exp_f32 v20, v20
    v_mfma_f32_16x16x32_bf16 v[64:67], v[32:35], a[96:99], v[64:67]
    ds_read_b64_tr_b16 v[48:49], v2 offset:16384
    v_mul_f32 v21, v101, v101
    v_mfma_f32_16x16x32_bf16 v[64:67], v[36:39], a[112:115], v[64:67]
    buffer_load_dwordx4 v61, s[12:15], s40 offen  lds
    v_add_f32 v20, 1.0, v20
    v_mfma_f32_16x16x32_bf16 v[68:71], v[32:35], a[100:103], v[68:71]
    ds_read_b64_tr_b16 v[50:51], v2 offset:16640
    v_fma_f32 v21, v21, v10, s35
    v_mfma_f32_16x16x32_bf16 v[68:71], v[36:39], a[116:119], v[68:71]
    v_rcp_f32 v20, v20
    v_mfma_f32_16x16x32_bf16 v[72:75], v[32:35], a[104:107], v[72:75]
    ds_read_b64_tr_b16 v[52:53], v2 offset:18432
    v_mul_f32 v21, v21, v101
    v_mfma_f32_16x16x32_bf16 v[72:75], v[36:39], a[120:123], v[72:75]
    s_add_u32 m0, s34, 78848
    v_exp_f32 v21, v21
    v_mfma_f32_16x16x32_bf16 v[76:79], v[32:35], a[108:111], v[76:79]
    ds_read_b64_tr_b16 v[54:55], v2 offset:18688
    v_mul_f32 v116, v116, v20
    v_mfma_f32_16x16x32_bf16 v[76:79], v[36:39], a[124:127], v[76:79]
    s_waitcnt lgkmcnt(4)
    buffer_load_dwordx4 v63, s[12:15], s40 offen  lds
    v_mul_f32 v117, v117, v101
    v_mfma_f32_16x16x32_bf16 v[80:83], v[40:43], a[96:99], v[80:83]
    ds_read_b64_tr_b16 v[32:33], v4 offset:16384
    v_add_f32 v21, 1.0, v21
    v_mfma_f32_16x16x32_bf16 v[80:83], v[44:47], a[112:115], v[80:83]
    v_rcp_f32 v21, v21
    v_mfma_f32_16x16x32_bf16 v[84:87], v[40:43], a[100:103], v[84:87]
    ds_read_b64_tr_b16 v[34:35], v4 offset:16640
    v_mul_f32 v22, v102, v102
    v_mfma_f32_16x16x32_bf16 v[84:87], v[44:47], a[116:119], v[84:87]
    v_mul_f32 v117, v117, v21
    v_mfma_f32_16x16x32_bf16 v[88:91], v[40:43], a[104:107], v[88:91]
    s_add_u32 m0, s34, 79872
    ds_read_b64_tr_b16 v[36:37], v4 offset:18432
    v_cvt_pk_bf16_f32 v134, v116, v117
    v_mfma_f32_16x16x32_bf16 v[88:91], v[44:47], a[120:123], v[88:91]
    v_fma_f32 v22, v22, v10, s35
    v_mfma_f32_16x16x32_bf16 v[92:95], v[40:43], a[108:111], v[92:95]
    ds_read_b64_tr_b16 v[38:39], v4 offset:18688
    v_mul_f32 v22, v22, v102
    v_mfma_f32_16x16x32_bf16 v[92:95], v[44:47], a[124:127], v[92:95]
    s_waitcnt lgkmcnt(4)
    v_exp_f32 v22, v22
    v_mfma_f32_16x16x32_bf16 v[64:67], v[48:51], a[128:131], v[64:67]
    ds_read_b64_tr_b16 v[40:41], v2 offset:20480
    v_mul_f32 v118, v118, v102
    v_mfma_f32_16x16x32_bf16 v[64:67], v[52:55], a[144:147], v[64:67]
    buffer_load_dwordx4 v6, s[12:15], s40 offen  lds
    v_add_f32 v22, 1.0, v22
    v_mfma_f32_16x16x32_bf16 v[68:71], v[48:51], a[132:135], v[68:71]
    ds_read_b64_tr_b16 v[42:43], v2 offset:20736
    v_mul_f32 v23, v103, v103
    v_mfma_f32_16x16x32_bf16 v[68:71], v[52:55], a[148:151], v[68:71]
    s_add_u32 m0, s34, 80896
    v_rcp_f32 v22, v22
    v_mfma_f32_16x16x32_bf16 v[72:75], v[48:51], a[136:139], v[72:75]
    ds_read_b64_tr_b16 v[44:45], v2 offset:22528
    v_fma_f32 v23, v23, v10, s35
    v_mfma_f32_16x16x32_bf16 v[72:75], v[52:55], a[152:155], v[72:75]
    buffer_load_dwordx4 v7, s[12:15], s40 offen  lds
    v_mul_f32 v118, v118, v22
    v_mfma_f32_16x16x32_bf16 v[76:79], v[48:51], a[140:143], v[76:79]
    ds_read_b64_tr_b16 v[46:47], v2 offset:22784
    v_mul_f32 v23, v23, v103
    v_mfma_f32_16x16x32_bf16 v[76:79], v[52:55], a[156:159], v[76:79]
    s_waitcnt lgkmcnt(4)
    v_exp_f32 v23, v23
    v_mfma_f32_16x16x32_bf16 v[80:83], v[32:35], a[128:131], v[80:83]
    ds_read_b64_tr_b16 v[48:49], v4 offset:20480
    v_mul_f32 v119, v119, v103
    v_mfma_f32_16x16x32_bf16 v[80:83], v[36:39], a[144:147], v[80:83]
    v_add_f32 v23, 1.0, v23
    v_mfma_f32_16x16x32_bf16 v[84:87], v[32:35], a[132:135], v[84:87]
    s_add_u32 m0, s34, 81920
    ds_read_b64_tr_b16 v[50:51], v4 offset:20736
    v_mul_f32 v28, v104, v104
    v_mfma_f32_16x16x32_bf16 v[84:87], v[36:39], a[148:151], v[84:87]
    v_rcp_f32 v23, v23
    v_mfma_f32_16x16x32_bf16 v[88:91], v[32:35], a[136:139], v[88:91]
    ds_read_b64_tr_b16 v[52:53], v4 offset:22528
    v_fma_f32 v28, v28, v10, s35
    v_mfma_f32_16x16x32_bf16 v[88:91], v[36:39], a[152:155], v[88:91]
    buffer_load_dwordx4 v12, s[12:15], s40 offen  lds
    v_mul_f32 v119, v119, v23
    v_mfma_f32_16x16x32_bf16 v[92:95], v[32:35], a[140:143], v[92:95]
    ds_read_b64_tr_b16 v[54:55], v4 offset:22784
    v_cvt_pk_bf16_f32 v135, v118, v119
    v_mfma_f32_16x16x32_bf16 v[92:95], v[36:39], a[156:159], v[92:95]
    s_waitcnt lgkmcnt(4)
    buffer_store_dwordx4 v[132:135], v8, s[16:19], s55 offen sc1
    v_mul_f32 v28, v28, v104
    v_mfma_f32_16x16x32_bf16 v[64:67], v[40:43], a[160:163], v[64:67]
    ds_read_b64_tr_b16 v[32:33], v2 offset:24576
    v_mul_f32 v120, v120, v104
    v_mfma_f32_16x16x32_bf16 v[64:67], v[44:47], a[176:179], v[64:67]
    s_add_u32 m0, s34, 110592
    v_exp_f32 v28, v28
    v_mfma_f32_16x16x32_bf16 v[68:71], v[40:43], a[164:167], v[68:71]
    ds_read_b64_tr_b16 v[34:35], v2 offset:24832
    v_mul_f32 v29, v105, v105
    v_mfma_f32_16x16x32_bf16 v[68:71], v[44:47], a[180:183], v[68:71]
    buffer_load_dwordx4 v56, s[12:15], s41 offen  lds
    v_add_f32 v28, 1.0, v28
    v_mfma_f32_16x16x32_bf16 v[72:75], v[40:43], a[168:171], v[72:75]
    ds_read_b64_tr_b16 v[36:37], v2 offset:26624
    v_fma_f32 v29, v29, v10, s35
    v_mfma_f32_16x16x32_bf16 v[72:75], v[44:47], a[184:187], v[72:75]
    v_rcp_f32 v28, v28
    v_mfma_f32_16x16x32_bf16 v[76:79], v[40:43], a[172:175], v[76:79]
    ds_read_b64_tr_b16 v[38:39], v2 offset:26880
    v_mul_f32 v29, v29, v105
    v_mfma_f32_16x16x32_bf16 v[76:79], v[44:47], a[188:191], v[76:79]
    s_waitcnt lgkmcnt(4)
    v_exp_f32 v29, v29
    v_mfma_f32_16x16x32_bf16 v[80:83], v[48:51], a[160:163], v[80:83]
    s_add_u32 m0, s34, 111616
    ds_read_b64_tr_b16 v[40:41], v4 offset:24576
    v_mul_f32 v120, v120, v28
    v_mfma_f32_16x16x32_bf16 v[80:83], v[52:55], a[176:179], v[80:83]
    v_mul_f32 v121, v121, v105
    v_mfma_f32_16x16x32_bf16 v[84:87], v[48:51], a[164:167], v[84:87]
    ds_read_b64_tr_b16 v[42:43], v4 offset:24832
    v_add_f32 v29, 1.0, v29
    v_mfma_f32_16x16x32_bf16 v[84:87], v[52:55], a[180:183], v[84:87]
    v_rcp_f32 v29, v29
    v_mfma_f32_16x16x32_bf16 v[88:91], v[48:51], a[168:171], v[88:91]
    ds_read_b64_tr_b16 v[44:45], v4 offset:26624
    v_mul_f32 v30, v106, v106
    v_mfma_f32_16x16x32_bf16 v[88:91], v[52:55], a[184:187], v[88:91]
    buffer_load_dwordx4 v57, s[12:15], s41 offen  lds
    v_mul_f32 v121, v121, v29
    v_mfma_f32_16x16x32_bf16 v[92:95], v[48:51], a[172:175], v[92:95]
    ds_read_b64_tr_b16 v[46:47], v4 offset:26880
    v_cvt_pk_bf16_f32 v138, v120, v121
    v_mfma_f32_16x16x32_bf16 v[92:95], v[52:55], a[188:191], v[92:95]
    s_waitcnt lgkmcnt(4)
    v_fma_f32 v30, v30, v10, s35
    v_mfma_f32_16x16x32_bf16 v[64:67], v[32:35], a[192:195], v[64:67]
    s_add_u32 m0, s34, 112640
    ds_read_b64_tr_b16 v[48:49], v2 offset:28672
    v_mul_f32 v30, v30, v106
    v_mfma_f32_16x16x32_bf16 v[64:67], v[36:39], a[208:211], v[64:67]
    v_exp_f32 v30, v30
    v_mfma_f32_16x16x32_bf16 v[68:71], v[32:35], a[196:199], v[68:71]
    ds_read_b64_tr_b16 v[50:51], v2 offset:28928
    v_mul_f32 v122, v122, v106
    v_mfma_f32_16x16x32_bf16 v[68:71], v[36:39], a[212:215], v[68:71]
    buffer_load_dwordx4 v58, s[12:15], s41 offen  lds
    v_add_f32 v30, 1.0, v30
    v_mfma_f32_16x16x32_bf16 v[72:75], v[32:35], a[200:203], v[72:75]
    ds_read_b64_tr_b16 v[52:53], v2 offset:30720
    v_mul_f32 v31, v107, v107
    v_mfma_f32_16x16x32_bf16 v[72:75], v[36:39], a[216:219], v[72:75]
    v_rcp_f32 v30, v30
    v_mfma_f32_16x16x32_bf16 v[76:79], v[32:35], a[204:207], v[76:79]
    s_add_u32 m0, s34, 113664
    ds_read_b64_tr_b16 v[54:55], v2 offset:30976
    v_fma_f32 v31, v31, v10, s35
    v_mfma_f32_16x16x32_bf16 v[76:79], v[36:39], a[220:223], v[76:79]
    s_waitcnt lgkmcnt(4)
    v_mul_f32 v122, v122, v30
    v_mul_f32 v31, v31, v107
    v_mfma_f32_16x16x32_bf16 v[80:83], v[40:43], a[192:195], v[80:83]
    ds_read_b64_tr_b16 v[32:33], v4 offset:28672
    v_mul_f32 v123, v123, v107
    v_mfma_f32_16x16x32_bf16 v[80:83], v[44:47], a[208:211], v[80:83]
    v_exp_f32 v31, v31
    v_mfma_f32_16x16x32_bf16 v[84:87], v[40:43], a[196:199], v[84:87]
    ds_read_b64_tr_b16 v[34:35], v4 offset:28928
    v_mul_f32 v16, v108, v108
    v_mfma_f32_16x16x32_bf16 v[84:87], v[44:47], a[212:215], v[84:87]
    buffer_load_dwordx4 v59, s[12:15], s41 offen  lds
    v_add_f32 v31, 1.0, v31
    v_mfma_f32_16x16x32_bf16 v[88:91], v[40:43], a[200:203], v[88:91]
    ds_read_b64_tr_b16 v[36:37], v4 offset:30720
    v_fma_f32 v16, v16, v10, s35
    v_mfma_f32_16x16x32_bf16 v[88:91], v[44:47], a[216:219], v[88:91]
    s_add_u32 m0, s34, 114688
    v_rcp_f32 v31, v31
    v_mfma_f32_16x16x32_bf16 v[92:95], v[40:43], a[204:207], v[92:95]
    ds_read_b64_tr_b16 v[38:39], v4 offset:30976
    v_mul_f32 v16, v16, v108
    v_mfma_f32_16x16x32_bf16 v[92:95], v[44:47], a[220:223], v[92:95]
    s_waitcnt lgkmcnt(4)
    v_exp_f32 v16, v16
    v_mfma_f32_16x16x32_bf16 v[64:67], v[48:51], a[224:227], v[64:67]
    ds_read_b64_tr_b16 v[40:41], v2 offset:32768
    v_mul_f32 v123, v123, v31
    v_mfma_f32_16x16x32_bf16 v[64:67], v[52:55], a[240:243], v[64:67]
    buffer_load_dwordx4 v61, s[12:15], s41 offen  lds
    v_cvt_pk_bf16_f32 v139, v122, v123
    v_mfma_f32_16x16x32_bf16 v[68:71], v[48:51], a[228:231], v[68:71]
    ds_read_b64_tr_b16 v[42:43], v2 offset:33024
    v_mul_f32 v124, v124, v108
    v_mfma_f32_16x16x32_bf16 v[68:71], v[52:55], a[244:247], v[68:71]
    buffer_store_dwordx4 v[136:139], v8, s[16:19], s56 offen sc1
    v_add_f32 v16, 1.0, v16
    v_mfma_f32_16x16x32_bf16 v[72:75], v[48:51], a[232:235], v[72:75]
    s_add_u32 m0, s34, 115712
    ds_read_b64_tr_b16 v[44:45], v2 offset:34816
    v_mul_f32 v17, v109, v109
    v_mfma_f32_16x16x32_bf16 v[72:75], v[52:55], a[248:251], v[72:75]
    v_rcp_f32 v16, v16
    v_mfma_f32_16x16x32_bf16 v[76:79], v[48:51], a[236:239], v[76:79]
    ds_read_b64_tr_b16 v[46:47], v2 offset:35072
    v_fma_f32 v17, v17, v10, s35
    v_mfma_f32_16x16x32_bf16 v[76:79], v[52:55], a[252:255], v[76:79]
    s_waitcnt lgkmcnt(4)
    buffer_load_dwordx4 v63, s[12:15], s41 offen  lds
    v_mul_f32 v124, v124, v16
    v_mfma_f32_16x16x32_bf16 v[80:83], v[32:35], a[224:227], v[80:83]
    ds_read_b64_tr_b16 v[48:49], v4 offset:32768
    v_mul_f32 v17, v17, v109
    v_mfma_f32_16x16x32_bf16 v[80:83], v[36:39], a[240:243], v[80:83]
    v_exp_f32 v17, v17
    v_mfma_f32_16x16x32_bf16 v[84:87], v[32:35], a[228:231], v[84:87]
    ds_read_b64_tr_b16 v[50:51], v4 offset:33024
    v_mul_f32 v125, v125, v109
    v_mfma_f32_16x16x32_bf16 v[84:87], v[36:39], a[244:247], v[84:87]
    s_add_u32 m0, s34, 116736
    v_add_f32 v17, 1.0, v17
    v_mul_f32 v18, v110, v110
    v_mfma_f32_16x16x32_bf16 v[88:91], v[32:35], a[232:235], v[88:91]
    ds_read_b64_tr_b16 v[52:53], v4 offset:34816
    v_fma_f32 v18, v18, v10, s35
    v_mfma_f32_16x16x32_bf16 v[88:91], v[36:39], a[248:251], v[88:91]
    v_rcp_f32 v17, v17
    v_mfma_f32_16x16x32_bf16 v[92:95], v[32:35], a[236:239], v[92:95]
    ds_read_b64_tr_b16 v[54:55], v4 offset:35072
    v_mul_f32 v18, v18, v110
    v_mfma_f32_16x16x32_bf16 v[92:95], v[36:39], a[252:255], v[92:95]
    s_waitcnt lgkmcnt(4)
    v_exp_f32 v18, v18
    v_mfma_f32_16x16x32_bf16 v[64:67], v[40:43], v[224:227], v[64:67]
    ds_read_b64_tr_b16 v[32:33], v3 offset:0
    v_mul_f32 v125, v125, v17
    v_mfma_f32_16x16x32_bf16 v[64:67], v[44:47], v[240:243], v[64:67]
    buffer_load_dwordx4 v6, s[12:15], s41 offen  lds
    v_cvt_pk_bf16_f32 v142, v124, v125
    v_mfma_f32_16x16x32_bf16 v[68:71], v[40:43], v[228:231], v[68:71]
    s_add_u32 m0, s34, 117760
    ds_read_b64_tr_b16 v[34:35], v3 offset:256
    v_mul_f32 v126, v126, v110
    v_mfma_f32_16x16x32_bf16 v[68:71], v[44:47], v[244:247], v[68:71]
    v_add_f32 v18, 1.0, v18
    v_mul_f32 v19, v111, v111
    v_mfma_f32_16x16x32_bf16 v[72:75], v[40:43], v[232:235], v[72:75]
    ds_read_b64_tr_b16 v[36:37], v3 offset:2048
    v_fma_f32 v19, v19, v10, s35
    v_mfma_f32_16x16x32_bf16 v[72:75], v[44:47], v[248:251], v[72:75]
    v_rcp_f32 v18, v18
    v_mfma_f32_16x16x32_bf16 v[76:79], v[40:43], v[236:239], v[76:79]
    ds_read_b64_tr_b16 v[38:39], v3 offset:2304
    v_mul_f32 v19, v19, v111
    v_mfma_f32_16x16x32_bf16 v[76:79], v[44:47], v[252:255], v[76:79]
    s_waitcnt lgkmcnt(4)
    v_exp_f32 v19, v19
    v_mfma_f32_16x16x32_bf16 v[80:83], v[48:51], v[224:227], v[80:83]
    ds_read_b64_tr_b16 v[40:41], v5 offset:0
    v_mul_f32 v126, v126, v18
    v_mfma_f32_16x16x32_bf16 v[80:83], v[52:55], v[240:243], v[80:83]
    buffer_load_dwordx4 v7, s[12:15], s41 offen  lds
    v_mul_f32 v127, v127, v111
    v_mfma_f32_16x16x32_bf16 v[84:87], v[48:51], v[228:231], v[84:87]
    s_add_u32 m0, s34, 118784
    ds_read_b64_tr_b16 v[42:43], v5 offset:256
    v_add_f32 v19, 1.0, v19
    v_mfma_f32_16x16x32_bf16 v[84:87], v[52:55], v[244:247], v[84:87]
    v_rcp_f32 v19, v19
    v_mfma_f32_16x16x32_bf16 v[88:91], v[48:51], v[232:235], v[88:91]
    ds_read_b64_tr_b16 v[44:45], v5 offset:2048
    v_mfma_f32_16x16x32_bf16 v[88:91], v[52:55], v[248:251], v[88:91]
    buffer_load_dwordx4 v12, s[12:15], s41 offen  lds
    v_mul_f32 v127, v127, v19
    v_mfma_f32_16x16x32_bf16 v[92:95], v[48:51], v[236:239], v[92:95]
    ds_read_b64_tr_b16 v[46:47], v5 offset:2304
    v_cvt_pk_bf16_f32 v143, v126, v127
    v_mfma_f32_16x16x32_bf16 v[92:95], v[52:55], v[252:255], v[92:95]
    s_waitcnt lgkmcnt(4)
    buffer_store_dwordx4 v[140:143], v8, s[16:19], s57 offen sc1
    v_mfma_f32_16x16x32_bf16 v[96:99], v[32:35], a[0:3], 0
    s_lshl_b32 s49, s83, 10
    ds_read_b64_tr_b16 v[48:49], v3 offset:4096
    v_mfma_f32_16x16x32_bf16 v[96:99], v[36:39], a[16:19], v[96:99]
    v_mfma_f32_16x16x32_bf16 v[100:103], v[32:35], a[4:7], 0
    ds_read_b64_tr_b16 v[50:51], v3 offset:4352
    v_add_u32 v8, s49, v9
    v_mfma_f32_16x16x32_bf16 v[100:103], v[36:39], a[20:23], v[100:103]
    v_mul_f32 v16, v64, v64
    v_mfma_f32_16x16x32_bf16 v[104:107], v[32:35], a[8:11], 0
    ds_read_b64_tr_b16 v[52:53], v3 offset:6144
    v_fma_f32 v16, v16, v10, s35
    v_mfma_f32_16x16x32_bf16 v[104:107], v[36:39], a[24:27], v[104:107]
    v_mul_f32 v16, v16, v64
    v_mfma_f32_16x16x32_bf16 v[108:111], v[32:35], a[12:15], 0
    ds_read_b64_tr_b16 v[54:55], v3 offset:6400
    v_mul_f32 v80, v80, v64
    v_mfma_f32_16x16x32_bf16 v[108:111], v[36:39], a[28:31], v[108:111]
    s_waitcnt lgkmcnt(4)
    v_exp_f32 v16, v16
    v_mfma_f32_16x16x32_bf16 v[112:115], v[40:43], a[0:3], 0
    ds_read_b64_tr_b16 v[32:33], v5 offset:4096
    v_mul_f32 v17, v65, v65
    v_mfma_f32_16x16x32_bf16 v[112:115], v[44:47], a[16:19], v[112:115]
    buffer_load_dword v11, v60, s[16:19], s59 offen sc1
    v_add_f32 v16, 1.0, v16
    v_mfma_f32_16x16x32_bf16 v[116:119], v[40:43], a[4:7], 0
    ds_read_b64_tr_b16 v[34:35], v5 offset:4352
    v_fma_f32 v17, v17, v10, s35
    v_mfma_f32_16x16x32_bf16 v[116:119], v[44:47], a[20:23], v[116:119]
    v_rcp_f32 v16, v16
    v_mfma_f32_16x16x32_bf16 v[120:123], v[40:43], a[8:11], 0
    ds_read_b64_tr_b16 v[36:37], v5 offset:6144
    v_mul_f32 v17, v17, v65
    v_mfma_f32_16x16x32_bf16 v[120:123], v[44:47], a[24:27], v[120:123]
    v_exp_f32 v17, v17
    v_mfma_f32_16x16x32_bf16 v[124:127], v[40:43], a[12:15], 0
    ds_read_b64_tr_b16 v[38:39], v5 offset:6400
    v_mul_f32 v80, v80, v16
    v_mfma_f32_16x16x32_bf16 v[124:127], v[44:47], a[28:31], v[124:127]
    s_waitcnt lgkmcnt(4)
    v_mul_f32 v81, v81, v65
    v_mfma_f32_16x16x32_bf16 v[96:99], v[48:51], a[32:35], v[96:99]
    ds_read_b64_tr_b16 v[40:41], v3 offset:8192
    v_add_f32 v17, 1.0, v17
    v_mfma_f32_16x16x32_bf16 v[96:99], v[52:55], a[48:51], v[96:99]
    v_rcp_f32 v17, v17
    v_mfma_f32_16x16x32_bf16 v[100:103], v[48:51], a[36:39], v[100:103]
    ds_read_b64_tr_b16 v[42:43], v3 offset:8448
    v_mul_f32 v18, v66, v66
    v_mfma_f32_16x16x32_bf16 v[100:103], v[52:55], a[52:55], v[100:103]
    v_mul_f32 v81, v81, v17
    v_mfma_f32_16x16x32_bf16 v[104:107], v[48:51], a[40:43], v[104:107]
    ds_read_b64_tr_b16 v[44:45], v3 offset:10240
    v_cvt_pk_bf16_f32 v128, v80, v81
    v_mfma_f32_16x16x32_bf16 v[104:107], v[52:55], a[56:59], v[104:107]
    v_fma_f32 v18, v18, v10, s35
    v_mul_f32 v19, v67, v67
    v_mfma_f32_16x16x32_bf16 v[108:111], v[48:51], a[44:47], v[108:111]
    ds_read_b64_tr_b16 v[46:47], v3 offset:10496
    v_mul_f32 v18, v18, v66
    v_mfma_f32_16x16x32_bf16 v[108:111], v[52:55], a[60:63], v[108:111]
    s_waitcnt lgkmcnt(4)
    v_exp_f32 v18, v18
    v_mfma_f32_16x16x32_bf16 v[112:115], v[32:35], a[32:35], v[112:115]
    ds_read_b64_tr_b16 v[48:49], v5 offset:8192
    v_mul_f32 v82, v82, v66
    v_mfma_f32_16x16x32_bf16 v[112:115], v[36:39], a[48:51], v[112:115]
    v_add_f32 v18, 1.0, v18
    v_fma_f32 v19, v19, v10, s35
    v_mfma_f32_16x16x32_bf16 v[116:119], v[32:35], a[36:39], v[116:119]
    ds_read_b64_tr_b16 v[50:51], v5 offset:8448
    v_mul_f32 v19, v19, v67
    v_mfma_f32_16x16x32_bf16 v[116:119], v[36:39], a[52:55], v[116:119]
    v_rcp_f32 v18, v18
    v_mfma_f32_16x16x32_bf16 v[120:123], v[32:35], a[40:43], v[120:123]
    ds_read_b64_tr_b16 v[52:53], v5 offset:10240
    v_mul_f32 v83, v83, v67
    v_mfma_f32_16x16x32_bf16 v[120:123], v[36:39], a[56:59], v[120:123]
    v_exp_f32 v19, v19
    v_mfma_f32_16x16x32_bf16 v[124:127], v[32:35], a[44:47], v[124:127]
    ds_read_b64_tr_b16 v[54:55], v5 offset:10496
    v_mul_f32 v82, v82, v18
    v_mfma_f32_16x16x32_bf16 v[124:127], v[36:39], a[60:63], v[124:127]
    s_waitcnt lgkmcnt(4)
    v_add_f32 v19, 1.0, v19
    v_mul_f32 v20, v68, v68
    v_mfma_f32_16x16x32_bf16 v[96:99], v[40:43], a[64:67], v[96:99]
    ds_read_b64_tr_b16 v[32:33], v3 offset:12288
    v_fma_f32 v20, v20, v10, s35
    v_mfma_f32_16x16x32_bf16 v[96:99], v[44:47], a[80:83], v[96:99]
    v_rcp_f32 v19, v19
    v_mfma_f32_16x16x32_bf16 v[100:103], v[40:43], a[68:71], v[100:103]
    ds_read_b64_tr_b16 v[34:35], v3 offset:12544
    v_mul_f32 v20, v20, v68
    v_mfma_f32_16x16x32_bf16 v[100:103], v[44:47], a[84:87], v[100:103]
    v_exp_f32 v20, v20
    v_mfma_f32_16x16x32_bf16 v[104:107], v[40:43], a[72:75], v[104:107]
    ds_read_b64_tr_b16 v[36:37], v3 offset:14336
    v_mul_f32 v83, v83, v19
    v_mfma_f32_16x16x32_bf16 v[104:107], v[44:47], a[88:91], v[104:107]
    v_cvt_pk_bf16_f32 v129, v82, v83
    v_mul_f32 v84, v84, v68
    v_mfma_f32_16x16x32_bf16 v[108:111], v[40:43], a[76:79], v[108:111]
    s_waitcnt vmcnt(0)
    v_subrev_u32 v11, s70, v11
    v_subrev_u32 v11, 3, v11
    v_cmp_lt_u32 vcc, 2, v11
    ds_read_b64_tr_b16 v[38:39], v3 offset:14592
    v_add_f32 v20, 1.0, v20
    v_mfma_f32_16x16x32_bf16 v[108:111], v[44:47], a[92:95], v[108:111]
    s_waitcnt lgkmcnt(4)
    v_rcp_f32 v20, v20
    v_mfma_f32_16x16x32_bf16 v[112:115], v[48:51], a[64:67], v[112:115]
    s_cbranch_vccnz adaLN_cond__ssm_conv_h3__glu_gated_geglu__prompt_kernel_sl3
adaLN_cond__ssm_conv_h3__glu_gated_geglu__prompt_kernel_sl3b:
    s_add_u32 s49, s67, 4816896
    v_add_u32 v13, 4, v148
    s_mov_b64 exec, 1
    buffer_store_dword v13, off, s[16:19], s49 sc1
    s_mov_b64 exec, -1
    ds_read_b64_tr_b16 v[40:41], v5 offset:12288
    v_mul_f32 v21, v69, v69
    v_mfma_f32_16x16x32_bf16 v[112:115], v[52:55], a[80:83], v[112:115]
    buffer_load_dwordx4 a[0:3], v24, s[16:19], s62 offen offset:0 sc1
    v_mul_f32 v84, v84, v20
    v_mfma_f32_16x16x32_bf16 v[116:119], v[48:51], a[68:71], v[116:119]
    ds_read_b64_tr_b16 v[42:43], v5 offset:12544
    v_fma_f32 v21, v21, v10, s35
    v_mfma_f32_16x16x32_bf16 v[116:119], v[52:55], a[84:87], v[116:119]
    v_mul_f32 v21, v21, v69
    v_mul_f32 v22, v70, v70
    v_mfma_f32_16x16x32_bf16 v[120:123], v[48:51], a[72:75], v[120:123]
    ds_read_b64_tr_b16 v[44:45], v5 offset:14336
    v_mul_f32 v85, v85, v69
    v_mfma_f32_16x16x32_bf16 v[120:123], v[52:55], a[88:91], v[120:123]
    v_exp_f32 v21, v21
    v_mfma_f32_16x16x32_bf16 v[124:127], v[48:51], a[76:79], v[124:127]
    ds_read_b64_tr_b16 v[46:47], v5 offset:14592
    v_fma_f32 v22, v22, v10, s35
    v_mfma_f32_16x16x32_bf16 v[124:127], v[52:55], a[92:95], v[124:127]
    s_waitcnt lgkmcnt(4)
    buffer_load_dwordx4 a[4:7], v24, s[16:19], s63 offen offset:0 sc1
    v_add_f32 v21, 1.0, v21
    v_mfma_f32_16x16x32_bf16 v[96:99], v[32:35], a[96:99], v[96:99]
    ds_read_b64_tr_b16 v[48:49], v3 offset:16384
    v_mul_f32 v22, v22, v70
    v_mfma_f32_16x16x32_bf16 v[96:99], v[36:39], a[112:115], v[96:99]
    v_rcp_f32 v21, v21
    v_mfma_f32_16x16x32_bf16 v[100:103], v[32:35], a[100:103], v[100:103]
    ds_read_b64_tr_b16 v[50:51], v3 offset:16640
    v_mul_f32 v86, v86, v70
    v_mfma_f32_16x16x32_bf16 v[100:103], v[36:39], a[116:119], v[100:103]
    v_exp_f32 v22, v22
    v_mfma_f32_16x16x32_bf16 v[104:107], v[32:35], a[104:107], v[104:107]
    ds_read_b64_tr_b16 v[52:53], v3 offset:18432
    v_mul_f32 v85, v85, v21
    v_mfma_f32_16x16x32_bf16 v[104:107], v[36:39], a[120:123], v[104:107]
    buffer_load_dwordx4 a[8:11], v26, s[16:19], s62 offen offset:1024 sc1
    v_cvt_pk_bf16_f32 v132, v84, v85
    v_mfma_f32_16x16x32_bf16 v[108:111], v[32:35], a[108:111], v[108:111]
    ds_read_b64_tr_b16 v[54:55], v3 offset:18688
    v_add_f32 v22, 1.0, v22
    v_mfma_f32_16x16x32_bf16 v[108:111], v[36:39], a[124:127], v[108:111]
    s_waitcnt lgkmcnt(4)
    v_rcp_f32 v22, v22
    v_mfma_f32_16x16x32_bf16 v[112:115], v[40:43], a[96:99], v[112:115]
    ds_read_b64_tr_b16 v[32:33], v5 offset:16384
    v_mul_f32 v23, v71, v71
    v_mfma_f32_16x16x32_bf16 v[112:115], v[44:47], a[112:115], v[112:115]
    buffer_load_dwordx4 a[12:15], v26, s[16:19], s63 offen offset:1024 sc1
    v_mul_f32 v86, v86, v22
    v_mfma_f32_16x16x32_bf16 v[116:119], v[40:43], a[100:103], v[116:119]
    ds_read_b64_tr_b16 v[34:35], v5 offset:16640
    v_fma_f32 v23, v23, v10, s35
    v_mfma_f32_16x16x32_bf16 v[116:119], v[44:47], a[116:119], v[116:119]
    v_mul_f32 v23, v23, v71
    v_mul_f32 v28, v72, v72
    v_mfma_f32_16x16x32_bf16 v[120:123], v[40:43], a[104:107], v[120:123]
    ds_read_b64_tr_b16 v[36:37], v5 offset:18432
    v_mul_f32 v87, v87, v71
    v_mfma_f32_16x16x32_bf16 v[120:123], v[44:47], a[120:123], v[120:123]
    v_exp_f32 v23, v23
    v_mfma_f32_16x16x32_bf16 v[124:127], v[40:43], a[108:111], v[124:127]
    ds_read_b64_tr_b16 v[38:39], v5 offset:18688
    v_fma_f32 v28, v28, v10, s35
    v_mfma_f32_16x16x32_bf16 v[124:127], v[44:47], a[124:127], v[124:127]
    s_waitcnt lgkmcnt(4)
    buffer_load_dwordx4 a[16:19], v24, s[16:19], s64 offen offset:0 sc1
    v_add_f32 v23, 1.0, v23
    v_mfma_f32_16x16x32_bf16 v[96:99], v[48:51], a[128:131], v[96:99]
    ds_read_b64_tr_b16 v[40:41], v3 offset:20480
    v_mul_f32 v28, v28, v72
    v_mfma_f32_16x16x32_bf16 v[96:99], v[52:55], a[144:147], v[96:99]
    v_rcp_f32 v23, v23
    v_mfma_f32_16x16x32_bf16 v[100:103], v[48:51], a[132:135], v[100:103]
    ds_read_b64_tr_b16 v[42:43], v3 offset:20736
    v_mul_f32 v88, v88, v72
    v_mfma_f32_16x16x32_bf16 v[100:103], v[52:55], a[148:151], v[100:103]
    v_exp_f32 v28, v28
    v_mfma_f32_16x16x32_bf16 v[104:107], v[48:51], a[136:139], v[104:107]
    ds_read_b64_tr_b16 v[44:45], v3 offset:22528
    v_mul_f32 v87, v87, v23
    v_mfma_f32_16x16x32_bf16 v[104:107], v[52:55], a[152:155], v[104:107]
    buffer_load_dwordx4 a[20:23], v24, s[16:19], s65 offen offset:0 sc1
    v_cvt_pk_bf16_f32 v133, v86, v87
    v_mfma_f32_16x16x32_bf16 v[108:111], v[48:51], a[140:143], v[108:111]
    ds_read_b64_tr_b16 v[46:47], v3 offset:22784
    v_add_f32 v28, 1.0, v28
    v_mfma_f32_16x16x32_bf16 v[108:111], v[52:55], a[156:159], v[108:111]
    s_waitcnt lgkmcnt(4)
    v_rcp_f32 v28, v28
    v_mfma_f32_16x16x32_bf16 v[112:115], v[32:35], a[128:131], v[112:115]
    ds_read_b64_tr_b16 v[48:49], v5 offset:20480
    v_mul_f32 v29, v73, v73
    v_mfma_f32_16x16x32_bf16 v[112:115], v[36:39], a[144:147], v[112:115]
    v_mul_f32 v88, v88, v28
    v_fma_f32 v29, v29, v10, s35
    v_mfma_f32_16x16x32_bf16 v[116:119], v[32:35], a[132:135], v[116:119]
    ds_read_b64_tr_b16 v[50:51], v5 offset:20736
    v_mul_f32 v29, v29, v73
    v_mfma_f32_16x16x32_bf16 v[116:119], v[36:39], a[148:151], v[116:119]
    v_exp_f32 v29, v29
    v_mfma_f32_16x16x32_bf16 v[120:123], v[32:35], a[136:139], v[120:123]
    ds_read_b64_tr_b16 v[52:53], v5 offset:22528
    v_mul_f32 v89, v89, v73
    v_mfma_f32_16x16x32_bf16 v[120:123], v[36:39], a[152:155], v[120:123]
    buffer_load_dwordx4 a[24:27], v26, s[16:19], s64 offen offset:1024 sc1
    v_add_f32 v29, 1.0, v29
    v_mfma_f32_16x16x32_bf16 v[124:127], v[32:35], a[140:143], v[124:127]
    ds_read_b64_tr_b16 v[54:55], v5 offset:22784
    v_mul_f32 v30, v74, v74
    v_mfma_f32_16x16x32_bf16 v[124:127], v[36:39], a[156:159], v[124:127]
    s_waitcnt lgkmcnt(4)
    v_rcp_f32 v29, v29
    v_mfma_f32_16x16x32_bf16 v[96:99], v[40:43], a[160:163], v[96:99]
    ds_read_b64_tr_b16 v[32:33], v3 offset:24576
    v_fma_f32 v30, v30, v10, s35
    v_mfma_f32_16x16x32_bf16 v[96:99], v[44:47], a[176:179], v[96:99]
    buffer_load_dwordx4 a[28:31], v26, s[16:19], s65 offen offset:1024 sc1
    v_mul_f32 v89, v89, v29
    v_mfma_f32_16x16x32_bf16 v[100:103], v[40:43], a[164:167], v[100:103]
    ds_read_b64_tr_b16 v[34:35], v3 offset:24832
    v_cvt_pk_bf16_f32 v136, v88, v89
    v_mfma_f32_16x16x32_bf16 v[100:103], v[44:47], a[180:183], v[100:103]
    v_mul_f32 v30, v30, v74
    v_mul_f32 v31, v75, v75
    v_mfma_f32_16x16x32_bf16 v[104:107], v[40:43], a[168:171], v[104:107]
    ds_read_b64_tr_b16 v[36:37], v3 offset:26624
    v_mul_f32 v90, v90, v74
    v_mfma_f32_16x16x32_bf16 v[104:107], v[44:47], a[184:187], v[104:107]
    v_exp_f32 v30, v30
    v_mfma_f32_16x16x32_bf16 v[108:111], v[40:43], a[172:175], v[108:111]
    ds_read_b64_tr_b16 v[38:39], v3 offset:26880
    v_fma_f32 v31, v31, v10, s35
    v_mfma_f32_16x16x32_bf16 v[108:111], v[44:47], a[188:191], v[108:111]
    s_waitcnt lgkmcnt(4)
    buffer_load_dwordx4 a[32:35], v9, s[16:19], s62 offen offset:0 sc1
    v_add_f32 v30, 1.0, v30
    v_mfma_f32_16x16x32_bf16 v[112:115], v[48:51], a[160:163], v[112:115]
    ds_read_b64_tr_b16 v[40:41], v5 offset:24576
    v_mul_f32 v31, v31, v75
    v_mfma_f32_16x16x32_bf16 v[112:115], v[52:55], a[176:179], v[112:115]
    v_rcp_f32 v30, v30
    v_mfma_f32_16x16x32_bf16 v[116:119], v[48:51], a[164:167], v[116:119]
    ds_read_b64_tr_b16 v[42:43], v5 offset:24832
    v_mul_f32 v91, v91, v75
    v_mfma_f32_16x16x32_bf16 v[116:119], v[52:55], a[180:183], v[116:119]
    v_exp_f32 v31, v31
    v_mfma_f32_16x16x32_bf16 v[120:123], v[48:51], a[168:171], v[120:123]
    ds_read_b64_tr_b16 v[44:45], v5 offset:26624
    v_mul_f32 v90, v90, v30
    v_mfma_f32_16x16x32_bf16 v[120:123], v[52:55], a[184:187], v[120:123]
    buffer_load_dwordx4 a[36:39], v9, s[16:19], s63 offen offset:0 sc1
    v_add_f32 v31, 1.0, v31
    v_mfma_f32_16x16x32_bf16 v[124:127], v[48:51], a[172:175], v[124:127]
    ds_read_b64_tr_b16 v[46:47], v5 offset:26880
    v_mul_f32 v16, v76, v76
    v_mfma_f32_16x16x32_bf16 v[124:127], v[52:55], a[188:191], v[124:127]
    s_waitcnt lgkmcnt(4)
    v_rcp_f32 v31, v31
    v_mfma_f32_16x16x32_bf16 v[96:99], v[32:35], a[192:195], v[96:99]
    ds_read_b64_tr_b16 v[48:49], v3 offset:28672
    v_fma_f32 v16, v16, v10, s35
    v_mfma_f32_16x16x32_bf16 v[96:99], v[36:39], a[208:211], v[96:99]
    buffer_load_dwordx4 a[40:43], v25, s[16:19], s62 offen offset:2048 sc1
    v_mul_f32 v91, v91, v31
    v_mfma_f32_16x16x32_bf16 v[100:103], v[32:35], a[196:199], v[100:103]
    ds_read_b64_tr_b16 v[50:51], v3 offset:28928
    v_cvt_pk_bf16_f32 v137, v90, v91
    v_mfma_f32_16x16x32_bf16 v[100:103], v[36:39], a[212:215], v[100:103]
    v_mul_f32 v16, v16, v76
    v_mul_f32 v17, v77, v77
    v_mfma_f32_16x16x32_bf16 v[104:107], v[32:35], a[200:203], v[104:107]
    ds_read_b64_tr_b16 v[52:53], v3 offset:30720
    v_mul_f32 v92, v92, v76
    v_mfma_f32_16x16x32_bf16 v[104:107], v[36:39], a[216:219], v[104:107]
    v_exp_f32 v16, v16
    v_mfma_f32_16x16x32_bf16 v[108:111], v[32:35], a[204:207], v[108:111]
    ds_read_b64_tr_b16 v[54:55], v3 offset:30976
    v_fma_f32 v17, v17, v10, s35
    v_mfma_f32_16x16x32_bf16 v[108:111], v[36:39], a[220:223], v[108:111]
    s_waitcnt lgkmcnt(4)
    buffer_load_dwordx4 a[44:47], v25, s[16:19], s63 offen offset:2048 sc1
    v_add_f32 v16, 1.0, v16
    v_mfma_f32_16x16x32_bf16 v[112:115], v[40:43], a[192:195], v[112:115]
    ds_read_b64_tr_b16 v[32:33], v5 offset:28672
    v_mul_f32 v17, v17, v77
    v_mfma_f32_16x16x32_bf16 v[112:115], v[44:47], a[208:211], v[112:115]
    v_rcp_f32 v16, v16
    v_mfma_f32_16x16x32_bf16 v[116:119], v[40:43], a[196:199], v[116:119]
    ds_read_b64_tr_b16 v[34:35], v5 offset:28928
    v_mul_f32 v93, v93, v77
    v_mfma_f32_16x16x32_bf16 v[116:119], v[44:47], a[212:215], v[116:119]
    v_exp_f32 v17, v17
    v_mfma_f32_16x16x32_bf16 v[120:123], v[40:43], a[200:203], v[120:123]
    ds_read_b64_tr_b16 v[36:37], v5 offset:30720
    v_mul_f32 v92, v92, v16
    v_mfma_f32_16x16x32_bf16 v[120:123], v[44:47], a[216:219], v[120:123]
    buffer_load_dwordx4 a[48:51], v9, s[16:19], s64 offen offset:0 sc1
    v_add_f32 v17, 1.0, v17
    v_mfma_f32_16x16x32_bf16 v[124:127], v[40:43], a[204:207], v[124:127]
    ds_read_b64_tr_b16 v[38:39], v5 offset:30976
    v_mul_f32 v18, v78, v78
    v_mfma_f32_16x16x32_bf16 v[124:127], v[44:47], a[220:223], v[124:127]
    s_waitcnt lgkmcnt(4)
    v_rcp_f32 v17, v17
    v_mfma_f32_16x16x32_bf16 v[96:99], v[48:51], a[224:227], v[96:99]
    ds_read_b64_tr_b16 v[40:41], v3 offset:32768
    v_fma_f32 v18, v18, v10, s35
    v_mfma_f32_16x16x32_bf16 v[96:99], v[52:55], a[240:243], v[96:99]
    buffer_load_dwordx4 a[52:55], v9, s[16:19], s65 offen offset:0 sc1
    v_mul_f32 v93, v93, v17
    v_mfma_f32_16x16x32_bf16 v[100:103], v[48:51], a[228:231], v[100:103]
    ds_read_b64_tr_b16 v[42:43], v3 offset:33024
    v_cvt_pk_bf16_f32 v140, v92, v93
    v_mfma_f32_16x16x32_bf16 v[100:103], v[52:55], a[244:247], v[100:103]
    v_mul_f32 v18, v18, v78
    v_mul_f32 v19, v79, v79
    v_mfma_f32_16x16x32_bf16 v[104:107], v[48:51], a[232:235], v[104:107]
    ds_read_b64_tr_b16 v[44:45], v3 offset:34816
    v_mul_f32 v94, v94, v78
    v_mfma_f32_16x16x32_bf16 v[104:107], v[52:55], a[248:251], v[104:107]
    v_exp_f32 v18, v18
    v_mfma_f32_16x16x32_bf16 v[108:111], v[48:51], a[236:239], v[108:111]
    ds_read_b64_tr_b16 v[46:47], v3 offset:35072
    v_fma_f32 v19, v19, v10, s35
    v_mfma_f32_16x16x32_bf16 v[108:111], v[52:55], a[252:255], v[108:111]
    s_waitcnt lgkmcnt(4)
    buffer_load_dwordx4 a[56:59], v25, s[16:19], s64 offen offset:2048 sc1
    v_add_f32 v18, 1.0, v18
    v_mfma_f32_16x16x32_bf16 v[112:115], v[32:35], a[224:227], v[112:115]
    ds_read_b64_tr_b16 v[48:49], v5 offset:32768
    v_mul_f32 v19, v19, v79
    v_mfma_f32_16x16x32_bf16 v[112:115], v[36:39], a[240:243], v[112:115]
    ds_read_b64_tr_b16 v[50:51], v5 offset:33024
    v_mul_f32 v95, v95, v79
    v_mfma_f32_16x16x32_bf16 v[116:119], v[32:35], a[228:231], v[116:119]
    ds_read_b64_tr_b16 v[52:53], v5 offset:34816
    v_mfma_f32_16x16x32_bf16 v[116:119], v[36:39], a[244:247], v[116:119]
    ds_read_b64_tr_b16 v[54:55], v5 offset:35072
    v_mfma_f32_16x16x32_bf16 v[120:123], v[32:35], a[232:235], v[120:123]
    v_rcp_f32 v18, v18
    v_mfma_f32_16x16x32_bf16 v[120:123], v[36:39], a[248:251], v[120:123]
    v_exp_f32 v19, v19
    v_mfma_f32_16x16x32_bf16 v[124:127], v[32:35], a[236:239], v[124:127]
    buffer_load_dwordx4 a[60:63], v25, s[16:19], s65 offen offset:2048 sc1
    v_mul_f32 v94, v94, v18
    v_mfma_f32_16x16x32_bf16 v[124:127], v[36:39], a[252:255], v[124:127]
    s_waitcnt vmcnt(19) lgkmcnt(0)
    s_barrier
    v_add_f32 v19, 1.0, v19
    v_mfma_f32_16x16x32_bf16 v[96:99], v[40:43], v[224:227], v[96:99]
    ds_read_b64_tr_b16 v[32:33], v144 offset:0
    v_mfma_f32_16x16x32_bf16 v[96:99], v[44:47], v[240:243], v[96:99]
    ds_read_b64_tr_b16 v[34:35], v144 offset:4608
    v_mfma_f32_16x16x32_bf16 v[100:103], v[40:43], v[228:231], v[100:103]
    ds_read_b64_tr_b16 v[36:37], v144 offset:9216
    v_mfma_f32_16x16x32_bf16 v[100:103], v[44:47], v[244:247], v[100:103]
    ds_read_b64_tr_b16 v[38:39], v144 offset:13824
    v_mfma_f32_16x16x32_bf16 v[104:107], v[40:43], v[232:235], v[104:107]
    ds_read_b64_tr_b16 v[152:153], v144 offset:18432
    v_mfma_f32_16x16x32_bf16 v[104:107], v[44:47], v[248:251], v[104:107]
    ds_read_b64_tr_b16 v[154:155], v144 offset:23040
    v_mfma_f32_16x16x32_bf16 v[108:111], v[40:43], v[236:239], v[108:111]
    ds_read_b64_tr_b16 v[156:157], v144 offset:27648
    v_mfma_f32_16x16x32_bf16 v[108:111], v[44:47], v[252:255], v[108:111]
    s_waitcnt lgkmcnt(7)
    ds_read_b64_tr_b16 v[158:159], v144 offset:32256
    v_mfma_f32_16x16x32_bf16 v[112:115], v[48:51], v[224:227], v[112:115]
    ds_read_b64_tr_b16 v[40:41], v144 offset:32
    v_mfma_f32_16x16x32_bf16 v[112:115], v[52:55], v[240:243], v[112:115]
    ds_read_b64_tr_b16 v[42:43], v144 offset:4640
    v_mfma_f32_16x16x32_bf16 v[116:119], v[48:51], v[228:231], v[116:119]
    ds_read_b64_tr_b16 v[44:45], v144 offset:9248
    v_mfma_f32_16x16x32_bf16 v[116:119], v[52:55], v[244:247], v[116:119]
    ds_read_b64_tr_b16 v[46:47], v144 offset:13856
    v_mfma_f32_16x16x32_bf16 v[120:123], v[48:51], v[232:235], v[120:123]
    ds_read_b64_tr_b16 v[160:161], v144 offset:18464
    v_mfma_f32_16x16x32_bf16 v[120:123], v[52:55], v[248:251], v[120:123]
    ds_read_b64_tr_b16 v[162:163], v144 offset:23072
    v_mfma_f32_16x16x32_bf16 v[124:127], v[48:51], v[236:239], v[124:127]
    ds_read_b64_tr_b16 v[164:165], v144 offset:27680
    v_mfma_f32_16x16x32_bf16 v[124:127], v[52:55], v[252:255], v[124:127]
    s_waitcnt lgkmcnt(7)
    ds_read_b64_tr_b16 v[166:167], v144 offset:32288
    v_rcp_f32 v19, v19
    s_nop 0
    v_mul_f32 v95, v95, v19
    v_cvt_pk_bf16_f32 v141, v94, v95
    v_mov_b32 v2, s70
    s_waitcnt vmcnt(8) lgkmcnt(8)
    v_mfma_f32_16x16x32_bf16 v[64:67], v[32:35], a[0:3], 0
    s_add_u32 m0, s34, 0
    ds_read_b64_tr_b16 v[48:49], v144 offset:64
    v_mfma_f32_16x16x32_bf16 v[64:67], v[36:39], a[8:11], v[64:67]
    s_nop 0
    ds_read_b64_tr_b16 v[50:51], v144 offset:4672
    buffer_load_dwordx4 v56, s[12:15], s42 offen  lds
    v_mfma_f32_16x16x32_bf16 v[64:67], v[152:155], a[16:19], v[64:67]
    s_add_u32 m0, s34, 1024
    ds_read_b64_tr_b16 v[52:53], v144 offset:9280
    v_mul_f32 v16, v96, v96
    v_mul_f32 v17, v97, v97
    v_mfma_f32_16x16x32_bf16 v[64:67], v[156:159], a[24:27], v[64:67]
    ds_read_b64_tr_b16 v[54:55], v144 offset:13888
    v_fma_f32 v16, v16, v10, s35
    v_fma_f32 v17, v17, v10, s35
    v_mfma_f32_16x16x32_bf16 v[68:71], v[32:35], a[4:7], 0
    s_nop 0
    ds_read_b64_tr_b16 v[168:169], v144 offset:18496
    buffer_load_dwordx4 v57, s[12:15], s42 offen  lds
    v_mul_f32 v16, v16, v96
    v_mfma_f32_16x16x32_bf16 v[68:71], v[36:39], a[12:15], v[68:71]
    ds_read_b64_tr_b16 v[170:171], v144 offset:23104
    v_exp_f32 v16, v16
    v_mfma_f32_16x16x32_bf16 v[68:71], v[152:155], a[20:23], v[68:71]
    s_add_u32 m0, s34, 2048
    ds_read_b64_tr_b16 v[172:173], v144 offset:27712
    v_mul_f32 v112, v112, v96
    v_mul_f32 v17, v17, v97
    v_mfma_f32_16x16x32_bf16 v[68:71], v[156:159], a[28:31], v[68:71]
    s_waitcnt lgkmcnt(7)
    ds_read_b64_tr_b16 v[174:175], v144 offset:32320
    v_exp_f32 v17, v17
    v_mfma_f32_16x16x32_bf16 v[72:75], v[40:43], a[0:3], 0
    s_nop 0
    ds_read_b64_tr_b16 v[32:33], v144 offset:96
    buffer_load_dwordx4 v58, s[12:15], s42 offen  lds
    v_add_f32 v16, 1.0, v16
    v_mfma_f32_16x16x32_bf16 v[72:75], v[44:47], a[8:11], v[72:75]
    ds_read_b64_tr_b16 v[34:35], v144 offset:4704
    v_rcp_f32 v16, v16
    v_mfma_f32_16x16x32_bf16 v[72:75], v[160:163], a[16:19], v[72:75]
    s_add_u32 m0, s34, 3072
    ds_read_b64_tr_b16 v[36:37], v144 offset:9312
    v_mul_f32 v113, v113, v97
    v_add_f32 v17, 1.0, v17
    v_mfma_f32_16x16x32_bf16 v[72:75], v[164:167], a[24:27], v[72:75]
    ds_read_b64_tr_b16 v[38:39], v144 offset:13920
    v_rcp_f32 v17, v17
    v_mfma_f32_16x16x32_bf16 v[76:79], v[40:43], a[4:7], 0
    s_nop 0
    ds_read_b64_tr_b16 v[152:153], v144 offset:18528
    buffer_load_dwordx4 v59, s[12:15], s42 offen  lds
    v_mul_f32 v112, v112, v16
    v_mfma_f32_16x16x32_bf16 v[76:79], v[44:47], a[12:15], v[76:79]
    ds_read_b64_tr_b16 v[154:155], v144 offset:23136
    v_mul_f32 v113, v113, v17
    v_mul_f32 v18, v98, v98
    v_mfma_f32_16x16x32_bf16 v[76:79], v[160:163], a[20:23], v[76:79]
    s_add_u32 m0, s34, 4096
    ds_read_b64_tr_b16 v[156:157], v144 offset:27744
    v_cvt_pk_bf16_f32 v130, v112, v113
    v_fma_f32 v18, v18, v10, s35
    v_mfma_f32_16x16x32_bf16 v[76:79], v[164:167], a[28:31], v[76:79]
    s_waitcnt lgkmcnt(7)
    ds_read_b64_tr_b16 v[158:159], v144 offset:32352
    v_mul_f32 v18, v18, v98
    v_mul_f32 v19, v99, v99
    v_mfma_f32_16x16x32_bf16 v[80:83], v[48:51], a[0:3], 0
    s_nop 0
    ds_read_b64_tr_b16 v[40:41], v144 offset:128
    buffer_load_dwordx4 v61, s[12:15], s42 offen  lds
    v_mul_f32 v114, v114, v98
    v_mfma_f32_16x16x32_bf16 v[80:83], v[52:55], a[8:11], v[80:83]
    ds_read_b64_tr_b16 v[42:43], v144 offset:4736
    v_exp_f32 v18, v18
    v_mfma_f32_16x16x32_bf16 v[80:83], v[168:171], a[16:19], v[80:83]
    s_add_u32 m0, s34, 5120
    ds_read_b64_tr_b16 v[44:45], v144 offset:9344
    v_fma_f32 v19, v19, v10, s35
    v_mul_f32 v20, v100, v100
    v_mfma_f32_16x16x32_bf16 v[80:83], v[172:175], a[24:27], v[80:83]
    ds_read_b64_tr_b16 v[46:47], v144 offset:13952
    v_add_f32 v18, 1.0, v18
    v_mul_f32 v19, v19, v99
    v_mfma_f32_16x16x32_bf16 v[84:87], v[48:51], a[4:7], 0
    s_nop 0
    ds_read_b64_tr_b16 v[160:161], v144 offset:18560
    buffer_load_dwordx4 v63, s[12:15], s42 offen  lds
    v_mul_f32 v115, v115, v99
    v_mfma_f32_16x16x32_bf16 v[84:87], v[52:55], a[12:15], v[84:87]
    ds_read_b64_tr_b16 v[162:163], v144 offset:23168
    v_rcp_f32 v18, v18
    v_mfma_f32_16x16x32_bf16 v[84:87], v[168:171], a[20:23], v[84:87]
    s_add_u32 m0, s34, 6144
    ds_read_b64_tr_b16 v[164:165], v144 offset:27776
    v_exp_f32 v19, v19
    v_mfma_f32_16x16x32_bf16 v[84:87], v[172:175], a[28:31], v[84:87]
    s_waitcnt lgkmcnt(7)
    ds_read_b64_tr_b16 v[166:167], v144 offset:32384
    v_mul_f32 v114, v114, v18
    v_fma_f32 v20, v20, v10, s35
    v_mfma_f32_16x16x32_bf16 v[88:91], v[32:35], a[0:3], 0
    s_nop 0
    ds_read_b64_tr_b16 v[48:49], v144 offset:160
    buffer_load_dwordx4 v6, s[12:15], s42 offen  lds
    v_add_f32 v19, 1.0, v19
    v_mfma_f32_16x16x32_bf16 v[88:91], v[36:39], a[8:11], v[88:91]
    ds_read_b64_tr_b16 v[50:51], v144 offset:4768
    v_rcp_f32 v19, v19
    v_mfma_f32_16x16x32_bf16 v[88:91], v[152:155], a[16:19], v[88:91]
    s_add_u32 m0, s34, 7168
    ds_read_b64_tr_b16 v[52:53], v144 offset:9376
    v_mul_f32 v20, v20, v100
    v_mul_f32 v21, v101, v101
    v_mfma_f32_16x16x32_bf16 v[88:91], v[156:159], a[24:27], v[88:91]
    ds_read_b64_tr_b16 v[54:55], v144 offset:13984
    v_exp_f32 v20, v20
    v_mfma_f32_16x16x32_bf16 v[92:95], v[32:35], a[4:7], 0
    s_nop 0
    ds_read_b64_tr_b16 v[168:169], v144 offset:18592
    buffer_load_dwordx4 v7, s[12:15], s42 offen  lds
    v_mul_f32 v115, v115, v19
    v_mfma_f32_16x16x32_bf16 v[92:95], v[36:39], a[12:15], v[92:95]
    ds_read_b64_tr_b16 v[170:171], v144 offset:23200
    v_cvt_pk_bf16_f32 v131, v114, v115
    v_mul_f32 v116, v116, v100
    v_mfma_f32_16x16x32_bf16 v[92:95], v[152:155], a[20:23], v[92:95]
    s_add_u32 m0, s34, 8192
    ds_read_b64_tr_b16 v[172:173], v144 offset:27808
    buffer_store_dwordx4 v[128:131], v8, s[16:19], s54 offen sc1
    v_add_f32 v20, 1.0, v20
    v_mfma_f32_16x16x32_bf16 v[92:95], v[156:159], a[28:31], v[92:95]
    s_waitcnt lgkmcnt(7)
    ds_read_b64_tr_b16 v[174:175], v144 offset:32416
    v_rcp_f32 v20, v20
    v_mfma_f32_16x16x32_bf16 v[176:179], v[40:43], a[0:3], 0
    s_nop 0
    ds_read_b64_tr_b16 v[32:33], v144 offset:192
    buffer_load_dwordx4 v12, s[12:15], s42 offen  lds
    v_fma_f32 v21, v21, v10, s35
    v_mfma_f32_16x16x32_bf16 v[176:179], v[44:47], a[8:11], v[176:179]
    ds_read_b64_tr_b16 v[34:35], v144 offset:4800
    v_mul_f32 v116, v116, v20
    v_mul_f32 v21, v21, v101
    v_mfma_f32_16x16x32_bf16 v[176:179], v[160:163], a[16:19], v[176:179]
    ds_read_b64_tr_b16 v[36:37], v144 offset:9408
    v_exp_f32 v21, v21
    v_mfma_f32_16x16x32_bf16 v[176:179], v[164:167], a[24:27], v[176:179]
    ds_read_b64_tr_b16 v[38:39], v144 offset:14016
    v_mul_f32 v117, v117, v101
    v_mul_f32 v22, v102, v102
    v_mfma_f32_16x16x32_bf16 v[180:183], v[40:43], a[4:7], 0
    s_nop 0
    ds_read_b64_tr_b16 v[152:153], v144 offset:18624
    buffer_load_dwordx4 a[64:67], v24, s[16:19], s62 offen offset:2048 sc1
    v_add_f32 v21, 1.0, v21
    v_mfma_f32_16x16x32_bf16 v[180:183], v[44:47], a[12:15], v[180:183]
    ds_read_b64_tr_b16 v[154:155], v144 offset:23232
    v_rcp_f32 v21, v21
    v_mfma_f32_16x16x32_bf16 v[180:183], v[160:163], a[20:23], v[180:183]
    ds_read_b64_tr_b16 v[156:157], v144 offset:27840
    v_fma_f32 v22, v22, v10, s35
    v_mul_f32 v23, v103, v103
    v_mfma_f32_16x16x32_bf16 v[180:183], v[164:167], a[28:31], v[180:183]
    s_waitcnt lgkmcnt(7)
    ds_read_b64_tr_b16 v[158:159], v144 offset:32448
    v_mul_f32 v117, v117, v21
    v_mul_f32 v22, v22, v102
    v_mfma_f32_16x16x32_bf16 v[184:187], v[48:51], a[0:3], 0
    ds_read_b64_tr_b16 v[40:41], v144 offset:224
    v_exp_f32 v22, v22
    v_mfma_f32_16x16x32_bf16 v[184:187], v[52:55], a[8:11], v[184:187]
    s_nop 0
    ds_read_b64_tr_b16 v[42:43], v144 offset:4832
    buffer_load_dwordx4 a[68:71], v24, s[16:19], s63 offen offset:2048 sc1
    v_cvt_pk_bf16_f32 v134, v116, v117
    v_mfma_f32_16x16x32_bf16 v[184:187], v[168:171], a[16:19], v[184:187]
    ds_read_b64_tr_b16 v[44:45], v144 offset:9440
    v_mul_f32 v118, v118, v102
    v_add_f32 v22, 1.0, v22
    v_mfma_f32_16x16x32_bf16 v[184:187], v[172:175], a[24:27], v[184:187]
    ds_read_b64_tr_b16 v[46:47], v144 offset:14048
    v_rcp_f32 v22, v22
    v_mfma_f32_16x16x32_bf16 v[188:191], v[48:51], a[4:7], 0
    ds_read_b64_tr_b16 v[160:161], v144 offset:18656
    v_fma_f32 v23, v23, v10, s35
    v_mul_f32 v16, v104, v104
    v_mfma_f32_16x16x32_bf16 v[188:191], v[52:55], a[12:15], v[188:191]
    s_nop 0
    ds_read_b64_tr_b16 v[162:163], v144 offset:23264
    buffer_load_dwordx4 a[72:75], v26, s[16:19], s62 offen offset:2048 sc1
    v_mul_f32 v118, v118, v22
    v_mfma_f32_16x16x32_bf16 v[188:191], v[168:171], a[20:23], v[188:191]
    ds_read_b64_tr_b16 v[164:165], v144 offset:27872
    v_mul_f32 v23, v23, v103
    v_fma_f32 v16, v16, v10, s35
    v_mfma_f32_16x16x32_bf16 v[188:191], v[172:175], a[28:31], v[188:191]
    s_waitcnt lgkmcnt(7)
    ds_read_b64_tr_b16 v[166:167], v144 offset:32480
    v_exp_f32 v23, v23
    v_mfma_f32_16x16x32_bf16 v[192:195], v[32:35], a[0:3], 0
    ds_read_b64_tr_b16 v[48:49], v144 offset:256
    v_mul_f32 v119, v119, v103
    v_mul_f32 v16, v16, v104
    v_mfma_f32_16x16x32_bf16 v[192:195], v[36:39], a[8:11], v[192:195]
    s_nop 0
    ds_read_b64_tr_b16 v[50:51], v144 offset:4864
    buffer_load_dwordx4 a[76:79], v26, s[16:19], s63 offen offset:2048 sc1
    v_add_f32 v23, 1.0, v23
    v_mfma_f32_16x16x32_bf16 v[192:195], v[152:155], a[16:19], v[192:195]
    ds_read_b64_tr_b16 v[52:53], v144 offset:9472
    v_rcp_f32 v23, v23
    v_mfma_f32_16x16x32_bf16 v[192:195], v[156:159], a[24:27], v[192:195]
    ds_read_b64_tr_b16 v[54:55], v144 offset:14080
    v_exp_f32 v16, v16
    v_mfma_f32_16x16x32_bf16 v[196:199], v[32:35], a[4:7], 0
    ds_read_b64_tr_b16 v[168:169], v144 offset:18688
    v_mul_f32 v119, v119, v23
    v_mul_f32 v120, v120, v104
    v_mfma_f32_16x16x32_bf16 v[196:199], v[36:39], a[12:15], v[196:199]
    s_nop 0
    ds_read_b64_tr_b16 v[170:171], v144 offset:23296
    buffer_load_dwordx4 a[80:83], v24, s[16:19], s64 offen offset:2048 sc1
    v_cvt_pk_bf16_f32 v135, v118, v119
    v_mfma_f32_16x16x32_bf16 v[196:199], v[152:155], a[20:23], v[196:199]
    s_nop 0
    ds_read_b64_tr_b16 v[172:173], v144 offset:27904
    buffer_store_dwordx4 v[132:135], v8, s[16:19], s55 offen sc1
    v_add_f32 v16, 1.0, v16
    v_mfma_f32_16x16x32_bf16 v[196:199], v[156:159], a[28:31], v[196:199]
    s_waitcnt lgkmcnt(7)
    ds_read_b64_tr_b16 v[174:175], v144 offset:32512
    v_rcp_f32 v16, v16
    v_mfma_f32_16x16x32_bf16 v[200:203], v[40:43], a[0:3], 0
    ds_read_b64_tr_b16 v[32:33], v145 offset:0
    v_mul_f32 v17, v105, v105
    v_mul_f32 v18, v106, v106
    v_mfma_f32_16x16x32_bf16 v[200:203], v[44:47], a[8:11], v[200:203]
    s_nop 0
    ds_read_b64_tr_b16 v[34:35], v145 offset:4608
    buffer_load_dwordx4 a[84:87], v24, s[16:19], s65 offen offset:2048 sc1
    v_mul_f32 v120, v120, v16
    v_mfma_f32_16x16x32_bf16 v[200:203], v[160:163], a[16:19], v[200:203]
    ds_read_b64_tr_b16 v[36:37], v145 offset:9216
    v_fma_f32 v17, v17, v10, s35
    v_fma_f32 v18, v18, v10, s35
    v_mfma_f32_16x16x32_bf16 v[200:203], v[164:167], a[24:27], v[200:203]
    ds_read_b64_tr_b16 v[38:39], v145 offset:13824
    v_mul_f32 v17, v17, v105
    v_mul_f32 v18, v18, v106
    v_mfma_f32_16x16x32_bf16 v[204:207], v[40:43], a[4:7], 0
    ds_read_b64_tr_b16 v[152:153], v145 offset:18432
    v_exp_f32 v17, v17
    v_mfma_f32_16x16x32_bf16 v[204:207], v[44:47], a[12:15], v[204:207]
    s_nop 0
    ds_read_b64_tr_b16 v[154:155], v145 offset:23040
    buffer_load_dwordx4 a[88:91], v26, s[16:19], s64 offen offset:2048 sc1
    v_mul_f32 v121, v121, v105
    v_mfma_f32_16x16x32_bf16 v[204:207], v[160:163], a[20:23], v[204:207]
    buffer_load_dword v11, v60, s[16:19], s59 offen sc1
    ds_read_b64_tr_b16 v[156:157], v145 offset:27648
    v_exp_f32 v18, v18
    v_mfma_f32_16x16x32_bf16 v[204:207], v[164:167], a[28:31], v[204:207]
    s_waitcnt lgkmcnt(7)
    ds_read_b64_tr_b16 v[158:159], v145 offset:32256
    v_add_f32 v17, 1.0, v17
    v_mul_f32 v122, v122, v106
    v_mfma_f32_16x16x32_bf16 v[208:211], v[48:51], a[0:3], 0
    ds_read_b64_tr_b16 v[40:41], v145 offset:32
    v_rcp_f32 v17, v17
    v_mfma_f32_16x16x32_bf16 v[208:211], v[52:55], a[8:11], v[208:211]
    s_nop 0
    ds_read_b64_tr_b16 v[42:43], v145 offset:4640
    buffer_load_dwordx4 a[92:95], v26, s[16:19], s65 offen offset:2048 sc1
    v_add_f32 v18, 1.0, v18
    v_mfma_f32_16x16x32_bf16 v[208:211], v[168:171], a[16:19], v[208:211]
    ds_read_b64_tr_b16 v[44:45], v145 offset:9248
    v_rcp_f32 v18, v18
    v_mfma_f32_16x16x32_bf16 v[208:211], v[172:175], a[24:27], v[208:211]
    s_add_u32 m0, s34, 36864
    ds_read_b64_tr_b16 v[46:47], v145 offset:13856
    v_mul_f32 v121, v121, v17
    v_mul_f32 v19, v107, v107
    v_mfma_f32_16x16x32_bf16 v[212:215], v[48:51], a[4:7], 0
    ds_read_b64_tr_b16 v[160:161], v145 offset:18464
    v_cvt_pk_bf16_f32 v138, v120, v121
    v_mul_f32 v122, v122, v18
    v_mfma_f32_16x16x32_bf16 v[212:215], v[52:55], a[12:15], v[212:215]
    s_waitcnt vmcnt(20)
    ds_read_b64_tr_b16 v[162:163], v145 offset:23072
    buffer_load_dwordx4 v56, s[12:15], s43 offen  lds
    v_fma_f32 v19, v19, v10, s35
    v_mfma_f32_16x16x32_bf16 v[212:215], v[168:171], a[20:23], v[212:215]
    ds_read_b64_tr_b16 v[164:165], v145 offset:27680
    v_mul_f32 v19, v19, v107
    v_mul_f32 v20, v108, v108
    v_mfma_f32_16x16x32_bf16 v[212:215], v[172:175], a[28:31], v[212:215]
    s_waitcnt lgkmcnt(7)
    ds_read_b64_tr_b16 v[166:167], v145 offset:32288
    v_exp_f32 v19, v19
    v_mfma_f32_16x16x32_bf16 v[64:67], v[32:35], a[32:35], v[64:67]
    s_add_u32 m0, s34, 37888
    ds_read_b64_tr_b16 v[48:49], v145 offset:64
    v_mul_f32 v123, v123, v107
    v_fma_f32 v20, v20, v10, s35
    v_mfma_f32_16x16x32_bf16 v[64:67], v[36:39], a[40:43], v[64:67]
    s_nop 0
    ds_read_b64_tr_b16 v[50:51], v145 offset:4672
    buffer_load_dwordx4 v57, s[12:15], s43 offen  lds
    v_add_f32 v19, 1.0, v19
    v_mfma_f32_16x16x32_bf16 v[64:67], v[152:155], a[48:51], v[64:67]
    ds_read_b64_tr_b16 v[52:53], v145 offset:9280
    v_rcp_f32 v19, v19
    v_mfma_f32_16x16x32_bf16 v[64:67], v[156:159], a[56:59], v[64:67]
    s_add_u32 m0, s34, 38912
    ds_read_b64_tr_b16 v[54:55], v145 offset:13888
    v_mul_f32 v20, v20, v108
    v_mul_f32 v21, v109, v109
    v_mfma_f32_16x16x32_bf16 v[68:71], v[32:35], a[36:39], v[68:71]
    ds_read_b64_tr_b16 v[168:169], v145 offset:18496
    v_exp_f32 v20, v20
    v_mfma_f32_16x16x32_bf16 v[68:71], v[36:39], a[44:47], v[68:71]
    s_nop 0
    ds_read_b64_tr_b16 v[170:171], v145 offset:23104
    buffer_load_dwordx4 v58, s[12:15], s43 offen  lds
    v_mul_f32 v123, v123, v19
    v_mfma_f32_16x16x32_bf16 v[68:71], v[152:155], a[52:55], v[68:71]
    ds_read_b64_tr_b16 v[172:173], v145 offset:27712
    v_cvt_pk_bf16_f32 v139, v122, v123
    v_mul_f32 v124, v124, v108
    v_mfma_f32_16x16x32_bf16 v[68:71], v[156:159], a[60:63], v[68:71]
    s_waitcnt lgkmcnt(7)
    ds_read_b64_tr_b16 v[174:175], v145 offset:32320
    buffer_store_dwordx4 v[136:139], v8, s[16:19], s56 offen sc1
    v_add_f32 v20, 1.0, v20
    v_mfma_f32_16x16x32_bf16 v[72:75], v[40:43], a[32:35], v[72:75]
    s_add_u32 m0, s34, 39936
    ds_read_b64_tr_b16 v[32:33], v145 offset:96
    v_rcp_f32 v20, v20
    v_mfma_f32_16x16x32_bf16 v[72:75], v[44:47], a[40:43], v[72:75]
    s_nop 0
    ds_read_b64_tr_b16 v[34:35], v145 offset:4704
    buffer_load_dwordx4 v59, s[12:15], s43 offen  lds
    v_fma_f32 v21, v21, v10, s35
    v_mfma_f32_16x16x32_bf16 v[72:75], v[160:163], a[48:51], v[72:75]
    ds_read_b64_tr_b16 v[36:37], v145 offset:9312
    v_mul_f32 v124, v124, v20
    v_mul_f32 v21, v21, v109
    v_mfma_f32_16x16x32_bf16 v[72:75], v[164:167], a[56:59], v[72:75]
    ds_read_b64_tr_b16 v[38:39], v145 offset:13920
    v_exp_f32 v21, v21
    v_mfma_f32_16x16x32_bf16 v[76:79], v[40:43], a[36:39], v[76:79]
    s_add_u32 m0, s34, 40960
    ds_read_b64_tr_b16 v[152:153], v145 offset:18528
    v_mul_f32 v125, v125, v109
    v_mul_f32 v22, v110, v110
    v_mfma_f32_16x16x32_bf16 v[76:79], v[44:47], a[44:47], v[76:79]
    ds_read_b64_tr_b16 v[154:155], v145 offset:23136
    v_add_f32 v21, 1.0, v21
    v_fma_f32 v22, v22, v10, s35
    v_mfma_f32_16x16x32_bf16 v[76:79], v[160:163], a[52:55], v[76:79]
    s_nop 0
    ds_read_b64_tr_b16 v[156:157], v145 offset:27744
    buffer_load_dwordx4 v61, s[12:15], s43 offen  lds
    v_mul_f32 v22, v22, v110
    v_mfma_f32_16x16x32_bf16 v[76:79], v[164:167], a[60:63], v[76:79]
    s_waitcnt lgkmcnt(7)
    ds_read_b64_tr_b16 v[158:159], v145 offset:32352
    v_rcp_f32 v21, v21
    v_mfma_f32_16x16x32_bf16 v[80:83], v[48:51], a[32:35], v[80:83]
    s_add_u32 m0, s34, 41984
    ds_read_b64_tr_b16 v[40:41], v145 offset:128
    v_exp_f32 v22, v22
    v_mfma_f32_16x16x32_bf16 v[80:83], v[52:55], a[40:43], v[80:83]
    ds_read_b64_tr_b16 v[42:43], v145 offset:4736
    v_mul_f32 v125, v125, v21
    v_mul_f32 v126, v126, v110
    v_mfma_f32_16x16x32_bf16 v[80:83], v[168:171], a[48:51], v[80:83]
    s_nop 0
    ds_read_b64_tr_b16 v[44:45], v145 offset:9344
    buffer_load_dwordx4 v63, s[12:15], s43 offen  lds
    v_cvt_pk_bf16_f32 v142, v124, v125
    v_mfma_f32_16x16x32_bf16 v[80:83], v[172:175], a[56:59], v[80:83]
    ds_read_b64_tr_b16 v[46:47], v145 offset:13952
    v_add_f32 v22, 1.0, v22
    v_mul_f32 v23, v111, v111
    v_mfma_f32_16x16x32_bf16 v[84:87], v[48:51], a[36:39], v[84:87]
    s_add_u32 m0, s34, 43008
    ds_read_b64_tr_b16 v[160:161], v145 offset:18560
    v_rcp_f32 v22, v22
    v_mfma_f32_16x16x32_bf16 v[84:87], v[52:55], a[44:47], v[84:87]
    ds_read_b64_tr_b16 v[162:163], v145 offset:23168
    v_fma_f32 v23, v23, v10, s35
    v_mfma_f32_16x16x32_bf16 v[84:87], v[168:171], a[52:55], v[84:87]
    s_nop 0
    ds_read_b64_tr_b16 v[164:165], v145 offset:27776
    buffer_load_dwordx4 v6, s[12:15], s43 offen  lds
    v_mul_f32 v126, v126, v22
    v_mfma_f32_16x16x32_bf16 v[84:87], v[172:175], a[60:63], v[84:87]
    s_waitcnt lgkmcnt(7)
    ds_read_b64_tr_b16 v[166:167], v145 offset:32384
    v_mul_f32 v23, v23, v111
    v_mfma_f32_16x16x32_bf16 v[88:91], v[32:35], a[32:35], v[88:91]
    s_add_u32 m0, s34, 44032
    ds_read_b64_tr_b16 v[48:49], v145 offset:160
    v_exp_f32 v23, v23
    v_mfma_f32_16x16x32_bf16 v[88:91], v[36:39], a[40:43], v[88:91]
    ds_read_b64_tr_b16 v[50:51], v145 offset:4768
    v_mul_f32 v127, v127, v111
    v_mfma_f32_16x16x32_bf16 v[88:91], v[152:155], a[48:51], v[88:91]
    s_nop 0
    ds_read_b64_tr_b16 v[52:53], v145 offset:9376
    buffer_load_dwordx4 v7, s[12:15], s43 offen  lds
    v_add_f32 v23, 1.0, v23
    v_mfma_f32_16x16x32_bf16 v[88:91], v[156:159], a[56:59], v[88:91]
    ds_read_b64_tr_b16 v[54:55], v145 offset:13984
    v_rcp_f32 v23, v23
    v_mfma_f32_16x16x32_bf16 v[92:95], v[32:35], a[36:39], v[92:95]
    s_add_u32 m0, s34, 45056
    ds_read_b64_tr_b16 v[168:169], v145 offset:18592
    v_mfma_f32_16x16x32_bf16 v[92:95], v[36:39], a[44:47], v[92:95]
    ds_read_b64_tr_b16 v[170:171], v145 offset:23200
    v_mul_f32 v127, v127, v23
    v_mfma_f32_16x16x32_bf16 v[92:95], v[152:155], a[52:55], v[92:95]
    s_nop 0
    ds_read_b64_tr_b16 v[172:173], v145 offset:27808
    buffer_load_dwordx4 v12, s[12:15], s43 offen  lds
    v_cvt_pk_bf16_f32 v143, v126, v127
    v_mfma_f32_16x16x32_bf16 v[92:95], v[156:159], a[60:63], v[92:95]
    s_waitcnt lgkmcnt(7)
    ds_read_b64_tr_b16 v[174:175], v145 offset:32416
    buffer_store_dwordx4 v[140:143], v8, s[16:19], s57 offen sc1
    v_mfma_f32_16x16x32_bf16 v[176:179], v[40:43], a[32:35], v[176:179]
    ds_read_b64_tr_b16 v[32:33], v145 offset:192
    v_mfma_f32_16x16x32_bf16 v[176:179], v[44:47], a[40:43], v[176:179]
    ds_read_b64_tr_b16 v[34:35], v145 offset:4800
    v_mfma_f32_16x16x32_bf16 v[176:179], v[160:163], a[48:51], v[176:179]
    s_nop 0
    ds_read_b64_tr_b16 v[36:37], v145 offset:9408
    buffer_load_dwordx4 a[96:99], v9, s[16:19], s62 offen offset:1024 sc1
    v_mfma_f32_16x16x32_bf16 v[176:179], v[164:167], a[56:59], v[176:179]
    ds_read_b64_tr_b16 v[38:39], v145 offset:14016
    v_mfma_f32_16x16x32_bf16 v[180:183], v[40:43], a[36:39], v[180:183]
    ds_read_b64_tr_b16 v[152:153], v145 offset:18624
    v_mfma_f32_16x16x32_bf16 v[180:183], v[44:47], a[44:47], v[180:183]
    ds_read_b64_tr_b16 v[154:155], v145 offset:23232
    v_mfma_f32_16x16x32_bf16 v[180:183], v[160:163], a[52:55], v[180:183]
    s_nop 0
    ds_read_b64_tr_b16 v[156:157], v145 offset:27840
    buffer_load_dwordx4 a[100:103], v9, s[16:19], s63 offen offset:1024 sc1
    v_mfma_f32_16x16x32_bf16 v[180:183], v[164:167], a[60:63], v[180:183]
    s_waitcnt lgkmcnt(7)
    ds_read_b64_tr_b16 v[158:159], v145 offset:32448
    v_mfma_f32_16x16x32_bf16 v[184:187], v[48:51], a[32:35], v[184:187]
    ds_read_b64_tr_b16 v[40:41], v145 offset:224
    v_mfma_f32_16x16x32_bf16 v[184:187], v[52:55], a[40:43], v[184:187]
    ds_read_b64_tr_b16 v[42:43], v145 offset:4832
    v_mfma_f32_16x16x32_bf16 v[184:187], v[168:171], a[48:51], v[184:187]
    s_nop 0
    ds_read_b64_tr_b16 v[44:45], v145 offset:9440
    buffer_load_dwordx4 a[104:107], v25, s[16:19], s62 offen offset:3072 sc1
    v_mfma_f32_16x16x32_bf16 v[184:187], v[172:175], a[56:59], v[184:187]
    ds_read_b64_tr_b16 v[46:47], v145 offset:14048
    v_mfma_f32_16x16x32_bf16 v[188:191], v[48:51], a[36:39], v[188:191]
    ds_read_b64_tr_b16 v[160:161], v145 offset:18656
    v_mfma_f32_16x16x32_bf16 v[188:191], v[52:55], a[44:47], v[188:191]
    ds_read_b64_tr_b16 v[162:163], v145 offset:23264
    v_mfma_f32_16x16x32_bf16 v[188:191], v[168:171], a[52:55], v[188:191]
    s_nop 0
    ds_read_b64_tr_b16 v[164:165], v145 offset:27872
    buffer_load_dwordx4 a[108:111], v25, s[16:19], s63 offen offset:3072 sc1
    v_mfma_f32_16x16x32_bf16 v[188:191], v[172:175], a[60:63], v[188:191]
    s_waitcnt lgkmcnt(7)
    ds_read_b64_tr_b16 v[166:167], v145 offset:32480
    v_mfma_f32_16x16x32_bf16 v[192:195], v[32:35], a[32:35], v[192:195]
    ds_read_b64_tr_b16 v[48:49], v145 offset:256
    v_mfma_f32_16x16x32_bf16 v[192:195], v[36:39], a[40:43], v[192:195]
    ds_read_b64_tr_b16 v[50:51], v145 offset:4864
    v_mfma_f32_16x16x32_bf16 v[192:195], v[152:155], a[48:51], v[192:195]
    s_nop 0
    ds_read_b64_tr_b16 v[52:53], v145 offset:9472
    buffer_load_dwordx4 a[112:115], v9, s[16:19], s64 offen offset:1024 sc1
    v_mfma_f32_16x16x32_bf16 v[192:195], v[156:159], a[56:59], v[192:195]
    ds_read_b64_tr_b16 v[54:55], v145 offset:14080
    v_mfma_f32_16x16x32_bf16 v[196:199], v[32:35], a[36:39], v[196:199]
    ds_read_b64_tr_b16 v[168:169], v145 offset:18688
    v_mfma_f32_16x16x32_bf16 v[196:199], v[36:39], a[44:47], v[196:199]
    ds_read_b64_tr_b16 v[170:171], v145 offset:23296
    v_mfma_f32_16x16x32_bf16 v[196:199], v[152:155], a[52:55], v[196:199]
    ds_read_b64_tr_b16 v[172:173], v145 offset:27904
    v_mfma_f32_16x16x32_bf16 v[196:199], v[156:159], a[60:63], v[196:199]
    s_waitcnt vmcnt(26) lgkmcnt(7)
    s_barrier
    ds_read_b64_tr_b16 v[174:175], v145 offset:32512
    buffer_load_dwordx4 a[116:119], v9, s[16:19], s65 offen offset:1024 sc1
    v_mfma_f32_16x16x32_bf16 v[200:203], v[40:43], a[32:35], v[200:203]
    ds_read_b64_tr_b16 v[32:33], v14 offset:0
    v_mfma_f32_16x16x32_bf16 v[200:203], v[44:47], a[40:43], v[200:203]
    ds_read_b64_tr_b16 v[34:35], v14 offset:4608
    v_mfma_f32_16x16x32_bf16 v[200:203], v[160:163], a[48:51], v[200:203]
    ds_read_b64_tr_b16 v[36:37], v14 offset:9216
    v_mfma_f32_16x16x32_bf16 v[200:203], v[164:167], a[56:59], v[200:203]
    s_nop 0
    ds_read_b64_tr_b16 v[38:39], v14 offset:13824
    buffer_load_dwordx4 a[120:123], v25, s[16:19], s64 offen offset:3072 sc1
    v_mfma_f32_16x16x32_bf16 v[204:207], v[40:43], a[36:39], v[204:207]
    ds_read_b64_tr_b16 v[152:153], v14 offset:18432
    v_mfma_f32_16x16x32_bf16 v[204:207], v[44:47], a[44:47], v[204:207]
    ds_read_b64_tr_b16 v[154:155], v14 offset:23040
    v_mfma_f32_16x16x32_bf16 v[204:207], v[160:163], a[52:55], v[204:207]
    ds_read_b64_tr_b16 v[156:157], v14 offset:27648
    v_mfma_f32_16x16x32_bf16 v[204:207], v[164:167], a[60:63], v[204:207]
    s_waitcnt lgkmcnt(7)
    ds_read_b64_tr_b16 v[158:159], v14 offset:32256
    buffer_load_dwordx4 a[124:127], v25, s[16:19], s65 offen offset:3072 sc1
    v_mfma_f32_16x16x32_bf16 v[208:211], v[48:51], a[32:35], v[208:211]
    ds_read_b64_tr_b16 v[40:41], v14 offset:32
    v_mfma_f32_16x16x32_bf16 v[208:211], v[52:55], a[40:43], v[208:211]
    s_add_u32 m0, s34, 73728
    ds_read_b64_tr_b16 v[42:43], v14 offset:4640
    v_mfma_f32_16x16x32_bf16 v[208:211], v[168:171], a[48:51], v[208:211]
    ds_read_b64_tr_b16 v[44:45], v14 offset:9248
    v_mfma_f32_16x16x32_bf16 v[208:211], v[172:175], a[56:59], v[208:211]
    s_nop 0
    ds_read_b64_tr_b16 v[46:47], v14 offset:13856
    buffer_load_dwordx4 v56, s[12:15], s44 offen  lds
    v_mfma_f32_16x16x32_bf16 v[212:215], v[48:51], a[36:39], v[212:215]
    ds_read_b64_tr_b16 v[160:161], v14 offset:18464
    v_mfma_f32_16x16x32_bf16 v[212:215], v[52:55], a[44:47], v[212:215]
    s_waitcnt vmcnt(20)
    ds_read_b64_tr_b16 v[162:163], v14 offset:23072
    v_mfma_f32_16x16x32_bf16 v[212:215], v[168:171], a[52:55], v[212:215]
    s_waitcnt vmcnt(21)
    v_subrev_u32 v11, s70, v11
    v_subrev_u32 v11, 4, v11
    v_cmp_lt_u32 vcc, 1, v11
    ds_read_b64_tr_b16 v[164:165], v14 offset:27680
    v_mfma_f32_16x16x32_bf16 v[212:215], v[172:175], a[60:63], v[212:215]
    s_waitcnt lgkmcnt(7)
    ds_read_b64_tr_b16 v[166:167], v14 offset:32288
    v_mfma_f32_16x16x32_bf16 v[64:67], v[32:35], a[64:67], v[64:67]
    s_cbranch_vccnz adaLN_cond__ssm_conv_h3__glu_gated_geglu__prompt_kernel_sl4
adaLN_cond__ssm_conv_h3__glu_gated_geglu__prompt_kernel_sl4b:
    ds_read_b64_tr_b16 v[48:49], v14 offset:64
    v_mfma_f32_16x16x32_bf16 v[64:67], v[36:39], a[72:75], v[64:67]
    s_add_u32 m0, s34, 74752
    ds_read_b64_tr_b16 v[50:51], v14 offset:4672
    v_mfma_f32_16x16x32_bf16 v[64:67], v[152:155], a[80:83], v[64:67]
    s_nop 0
    ds_read_b64_tr_b16 v[52:53], v14 offset:9280
    buffer_load_dwordx4 v57, s[12:15], s44 offen  lds
    v_mfma_f32_16x16x32_bf16 v[64:67], v[156:159], a[88:91], v[64:67]
    s_add_u32 m0, s34, 75776
    ds_read_b64_tr_b16 v[54:55], v14 offset:13888
    v_mfma_f32_16x16x32_bf16 v[68:71], v[32:35], a[68:71], v[68:71]
    s_nop 0
    ds_read_b64_tr_b16 v[168:169], v14 offset:18496
    buffer_load_dwordx4 v58, s[12:15], s44 offen  lds
    v_mfma_f32_16x16x32_bf16 v[68:71], v[36:39], a[76:79], v[68:71]
    s_add_u32 m0, s34, 76800
    ds_read_b64_tr_b16 v[170:171], v14 offset:23104
    v_mfma_f32_16x16x32_bf16 v[68:71], v[152:155], a[84:87], v[68:71]
    ds_read_b64_tr_b16 v[172:173], v14 offset:27712
    v_mfma_f32_16x16x32_bf16 v[68:71], v[156:159], a[92:95], v[68:71]
    s_waitcnt lgkmcnt(7)
    ds_read_b64_tr_b16 v[174:175], v14 offset:32320
    buffer_load_dwordx4 v59, s[12:15], s44 offen  lds
    v_mfma_f32_16x16x32_bf16 v[72:75], v[40:43], a[64:67], v[72:75]
    ds_read_b64_tr_b16 v[32:33], v14 offset:96
    v_mfma_f32_16x16x32_bf16 v[72:75], v[44:47], a[72:75], v[72:75]
    s_add_u32 m0, s34, 77824
    ds_read_b64_tr_b16 v[34:35], v14 offset:4704
    v_mfma_f32_16x16x32_bf16 v[72:75], v[160:163], a[80:83], v[72:75]
    ds_read_b64_tr_b16 v[36:37], v14 offset:9312
    v_mfma_f32_16x16x32_bf16 v[72:75], v[164:167], a[88:91], v[72:75]
    s_nop 0
    ds_read_b64_tr_b16 v[38:39], v14 offset:13920
    buffer_load_dwordx4 v61, s[12:15], s44 offen  lds
    v_mfma_f32_16x16x32_bf16 v[76:79], v[40:43], a[68:71], v[76:79]
    ds_read_b64_tr_b16 v[152:153], v14 offset:18528
    v_mfma_f32_16x16x32_bf16 v[76:79], v[44:47], a[76:79], v[76:79]
    s_add_u32 m0, s34, 78848
    ds_read_b64_tr_b16 v[154:155], v14 offset:23136
    v_mfma_f32_16x16x32_bf16 v[76:79], v[160:163], a[84:87], v[76:79]
    ds_read_b64_tr_b16 v[156:157], v14 offset:27744
    v_mfma_f32_16x16x32_bf16 v[76:79], v[164:167], a[92:95], v[76:79]
    s_waitcnt lgkmcnt(7)
    ds_read_b64_tr_b16 v[158:159], v14 offset:32352
    buffer_load_dwordx4 v63, s[12:15], s44 offen  lds
    v_mfma_f32_16x16x32_bf16 v[80:83], v[48:51], a[64:67], v[80:83]
    ds_read_b64_tr_b16 v[40:41], v14 offset:128
    v_mfma_f32_16x16x32_bf16 v[80:83], v[52:55], a[72:75], v[80:83]
    s_add_u32 m0, s34, 79872
    ds_read_b64_tr_b16 v[42:43], v14 offset:4736
    v_mfma_f32_16x16x32_bf16 v[80:83], v[168:171], a[80:83], v[80:83]
    ds_read_b64_tr_b16 v[44:45], v14 offset:9344
    v_mfma_f32_16x16x32_bf16 v[80:83], v[172:175], a[88:91], v[80:83]
    s_nop 0
    ds_read_b64_tr_b16 v[46:47], v14 offset:13952
    buffer_load_dwordx4 v6, s[12:15], s44 offen  lds
    v_mfma_f32_16x16x32_bf16 v[84:87], v[48:51], a[68:71], v[84:87]
    ds_read_b64_tr_b16 v[160:161], v14 offset:18560
    v_mfma_f32_16x16x32_bf16 v[84:87], v[52:55], a[76:79], v[84:87]
    ds_read_b64_tr_b16 v[162:163], v14 offset:23168
    v_mfma_f32_16x16x32_bf16 v[84:87], v[168:171], a[84:87], v[84:87]
    s_add_u32 m0, s34, 80896
    ds_read_b64_tr_b16 v[164:165], v14 offset:27776
    v_mfma_f32_16x16x32_bf16 v[84:87], v[172:175], a[92:95], v[84:87]
    s_waitcnt lgkmcnt(7)
    ds_read_b64_tr_b16 v[166:167], v14 offset:32384
    v_mfma_f32_16x16x32_bf16 v[88:91], v[32:35], a[64:67], v[88:91]
    s_nop 0
    ds_read_b64_tr_b16 v[48:49], v14 offset:160
    buffer_load_dwordx4 v7, s[12:15], s44 offen  lds
    v_mfma_f32_16x16x32_bf16 v[88:91], v[36:39], a[72:75], v[88:91]
    ds_read_b64_tr_b16 v[50:51], v14 offset:4768
    v_mfma_f32_16x16x32_bf16 v[88:91], v[152:155], a[80:83], v[88:91]
    s_add_u32 m0, s34, 81920
    ds_read_b64_tr_b16 v[52:53], v14 offset:9376
    v_mfma_f32_16x16x32_bf16 v[88:91], v[156:159], a[88:91], v[88:91]
    ds_read_b64_tr_b16 v[54:55], v14 offset:13984
    v_mfma_f32_16x16x32_bf16 v[92:95], v[32:35], a[68:71], v[92:95]
    s_nop 0
    ds_read_b64_tr_b16 v[168:169], v14 offset:18592
    buffer_load_dwordx4 v12, s[12:15], s44 offen  lds
    v_mfma_f32_16x16x32_bf16 v[92:95], v[36:39], a[76:79], v[92:95]
    ds_read_b64_tr_b16 v[170:171], v14 offset:23200
    v_mfma_f32_16x16x32_bf16 v[92:95], v[152:155], a[84:87], v[92:95]
    ds_read_b64_tr_b16 v[172:173], v14 offset:27808
    v_mfma_f32_16x16x32_bf16 v[92:95], v[156:159], a[92:95], v[92:95]
    s_waitcnt lgkmcnt(7)
    ds_read_b64_tr_b16 v[174:175], v14 offset:32416
    v_mfma_f32_16x16x32_bf16 v[176:179], v[40:43], a[64:67], v[176:179]
    s_nop 0
    ds_read_b64_tr_b16 v[32:33], v14 offset:192
    buffer_load_dwordx4 a[128:131], v24, s[16:19], s62 offen offset:3072 sc1
    v_mfma_f32_16x16x32_bf16 v[176:179], v[44:47], a[72:75], v[176:179]
    ds_read_b64_tr_b16 v[34:35], v14 offset:4800
    v_mfma_f32_16x16x32_bf16 v[176:179], v[160:163], a[80:83], v[176:179]
    ds_read_b64_tr_b16 v[36:37], v14 offset:9408
    v_mfma_f32_16x16x32_bf16 v[176:179], v[164:167], a[88:91], v[176:179]
    ds_read_b64_tr_b16 v[38:39], v14 offset:14016
    v_mfma_f32_16x16x32_bf16 v[180:183], v[40:43], a[68:71], v[180:183]
    s_nop 0
    ds_read_b64_tr_b16 v[152:153], v14 offset:18624
    buffer_load_dwordx4 a[132:135], v24, s[16:19], s63 offen offset:3072 sc1
    v_mfma_f32_16x16x32_bf16 v[180:183], v[44:47], a[76:79], v[180:183]
    ds_read_b64_tr_b16 v[154:155], v14 offset:23232
    v_mfma_f32_16x16x32_bf16 v[180:183], v[160:163], a[84:87], v[180:183]
    ds_read_b64_tr_b16 v[156:157], v14 offset:27840
    v_mfma_f32_16x16x32_bf16 v[180:183], v[164:167], a[92:95], v[180:183]
    s_waitcnt lgkmcnt(7)
    ds_read_b64_tr_b16 v[158:159], v14 offset:32448
    v_mfma_f32_16x16x32_bf16 v[184:187], v[48:51], a[64:67], v[184:187]
    s_nop 0
    ds_read_b64_tr_b16 v[40:41], v14 offset:224
    buffer_load_dwordx4 a[136:139], v26, s[16:19], s62 offen offset:3072 sc1
    v_mfma_f32_16x16x32_bf16 v[184:187], v[52:55], a[72:75], v[184:187]
    ds_read_b64_tr_b16 v[42:43], v14 offset:4832
    v_mfma_f32_16x16x32_bf16 v[184:187], v[168:171], a[80:83], v[184:187]
    ds_read_b64_tr_b16 v[44:45], v14 offset:9440
    v_mfma_f32_16x16x32_bf16 v[184:187], v[172:175], a[88:91], v[184:187]
    ds_read_b64_tr_b16 v[46:47], v14 offset:14048
    v_mfma_f32_16x16x32_bf16 v[188:191], v[48:51], a[68:71], v[188:191]
    s_nop 0
    ds_read_b64_tr_b16 v[160:161], v14 offset:18656
    buffer_load_dwordx4 a[140:143], v26, s[16:19], s63 offen offset:3072 sc1
    v_mfma_f32_16x16x32_bf16 v[188:191], v[52:55], a[76:79], v[188:191]
    ds_read_b64_tr_b16 v[162:163], v14 offset:23264
    v_mfma_f32_16x16x32_bf16 v[188:191], v[168:171], a[84:87], v[188:191]
    ds_read_b64_tr_b16 v[164:165], v14 offset:27872
    v_mfma_f32_16x16x32_bf16 v[188:191], v[172:175], a[92:95], v[188:191]
    s_waitcnt lgkmcnt(7)
    ds_read_b64_tr_b16 v[166:167], v14 offset:32480
    v_mfma_f32_16x16x32_bf16 v[192:195], v[32:35], a[64:67], v[192:195]
    s_nop 0
    ds_read_b64_tr_b16 v[48:49], v14 offset:256
    buffer_load_dwordx4 a[144:147], v24, s[16:19], s64 offen offset:3072 sc1
    v_mfma_f32_16x16x32_bf16 v[192:195], v[36:39], a[72:75], v[192:195]
    ds_read_b64_tr_b16 v[50:51], v14 offset:4864
    v_mfma_f32_16x16x32_bf16 v[192:195], v[152:155], a[80:83], v[192:195]
    ds_read_b64_tr_b16 v[52:53], v14 offset:9472
    v_mfma_f32_16x16x32_bf16 v[192:195], v[156:159], a[88:91], v[192:195]
    ds_read_b64_tr_b16 v[54:55], v14 offset:14080
    v_mfma_f32_16x16x32_bf16 v[196:199], v[32:35], a[68:71], v[196:199]
    s_nop 0
    ds_read_b64_tr_b16 v[168:169], v14 offset:18688
    buffer_load_dwordx4 a[148:151], v24, s[16:19], s65 offen offset:3072 sc1
    v_mfma_f32_16x16x32_bf16 v[196:199], v[36:39], a[76:79], v[196:199]
    ds_read_b64_tr_b16 v[170:171], v14 offset:23296
    v_mfma_f32_16x16x32_bf16 v[196:199], v[152:155], a[84:87], v[196:199]
    ds_read_b64_tr_b16 v[172:173], v14 offset:27904
    v_mfma_f32_16x16x32_bf16 v[196:199], v[156:159], a[92:95], v[196:199]
    s_waitcnt vmcnt(24) lgkmcnt(7)
    s_barrier
    ds_read_b64_tr_b16 v[174:175], v14 offset:32512
    v_mfma_f32_16x16x32_bf16 v[200:203], v[40:43], a[64:67], v[200:203]
    s_nop 0
    ds_read_b64_tr_b16 v[32:33], v15 offset:0
    buffer_load_dwordx4 a[152:155], v26, s[16:19], s64 offen offset:3072 sc1
    v_mfma_f32_16x16x32_bf16 v[200:203], v[44:47], a[72:75], v[200:203]
    ds_read_b64_tr_b16 v[34:35], v15 offset:4608
    v_mfma_f32_16x16x32_bf16 v[200:203], v[160:163], a[80:83], v[200:203]
    ds_read_b64_tr_b16 v[36:37], v15 offset:9216
    v_mfma_f32_16x16x32_bf16 v[200:203], v[164:167], a[88:91], v[200:203]
    ds_read_b64_tr_b16 v[38:39], v15 offset:13824
    v_mfma_f32_16x16x32_bf16 v[204:207], v[40:43], a[68:71], v[204:207]
    s_nop 0
    ds_read_b64_tr_b16 v[152:153], v15 offset:18432
    buffer_load_dwordx4 a[156:159], v26, s[16:19], s65 offen offset:3072 sc1
    v_mfma_f32_16x16x32_bf16 v[204:207], v[44:47], a[76:79], v[204:207]
    ds_read_b64_tr_b16 v[154:155], v15 offset:23040
    v_mfma_f32_16x16x32_bf16 v[204:207], v[160:163], a[84:87], v[204:207]
    ds_read_b64_tr_b16 v[156:157], v15 offset:27648
    v_mfma_f32_16x16x32_bf16 v[204:207], v[164:167], a[92:95], v[204:207]
    s_waitcnt lgkmcnt(7)
    ds_read_b64_tr_b16 v[158:159], v15 offset:32256
    v_mfma_f32_16x16x32_bf16 v[208:211], v[48:51], a[64:67], v[208:211]
    s_add_u32 m0, s34, 110592
    ds_read_b64_tr_b16 v[40:41], v15 offset:32
    v_mfma_f32_16x16x32_bf16 v[208:211], v[52:55], a[72:75], v[208:211]
    s_nop 0
    ds_read_b64_tr_b16 v[42:43], v15 offset:4640
    buffer_load_dwordx4 v56, s[12:15], s45 offen  lds
    v_mfma_f32_16x16x32_bf16 v[208:211], v[168:171], a[80:83], v[208:211]
    ds_read_b64_tr_b16 v[44:45], v15 offset:9248
    v_mfma_f32_16x16x32_bf16 v[208:211], v[172:175], a[88:91], v[208:211]
    s_add_u32 m0, s34, 111616
    ds_read_b64_tr_b16 v[46:47], v15 offset:13856
    v_mfma_f32_16x16x32_bf16 v[212:215], v[48:51], a[68:71], v[212:215]
    ds_read_b64_tr_b16 v[160:161], v15 offset:18464
    v_mfma_f32_16x16x32_bf16 v[212:215], v[52:55], a[76:79], v[212:215]
    s_waitcnt vmcnt(18)
    ds_read_b64_tr_b16 v[162:163], v15 offset:23072
    buffer_load_dwordx4 v57, s[12:15], s45 offen  lds
    v_mfma_f32_16x16x32_bf16 v[212:215], v[168:171], a[84:87], v[212:215]
    ds_read_b64_tr_b16 v[164:165], v15 offset:27680
    v_mfma_f32_16x16x32_bf16 v[212:215], v[172:175], a[92:95], v[212:215]
    s_waitcnt lgkmcnt(7)
    ds_read_b64_tr_b16 v[166:167], v15 offset:32288
    v_mfma_f32_16x16x32_bf16 v[64:67], v[32:35], a[96:99], v[64:67]
    s_waitcnt vmcnt(27)
    s_add_u32 s49, s67, 4816896
    v_add_u32 v13, 5, v2
    s_mov_b64 exec, 1
    buffer_store_dword v13, off, s[16:19], s49 sc1
    s_mov_b64 exec, -1
    ds_read_b64_tr_b16 v[48:49], v15 offset:64
    v_mfma_f32_16x16x32_bf16 v[64:67], v[36:39], a[104:107], v[64:67]
    s_add_u32 m0, s34, 112640
    ds_read_b64_tr_b16 v[50:51], v15 offset:4672
    v_mfma_f32_16x16x32_bf16 v[64:67], v[152:155], a[112:115], v[64:67]
    s_nop 0
    ds_read_b64_tr_b16 v[52:53], v15 offset:9280
    buffer_load_dwordx4 v58, s[12:15], s45 offen  lds
    v_mfma_f32_16x16x32_bf16 v[64:67], v[156:159], a[120:123], v[64:67]
    s_add_u32 m0, s34, 113664
    ds_read_b64_tr_b16 v[54:55], v15 offset:13888
    v_mfma_f32_16x16x32_bf16 v[68:71], v[32:35], a[100:103], v[68:71]
    ds_read_b64_tr_b16 v[168:169], v15 offset:18496
    v_mfma_f32_16x16x32_bf16 v[68:71], v[36:39], a[108:111], v[68:71]
    s_nop 0
    ds_read_b64_tr_b16 v[170:171], v15 offset:23104
    buffer_load_dwordx4 v59, s[12:15], s45 offen  lds
    v_mfma_f32_16x16x32_bf16 v[68:71], v[152:155], a[116:119], v[68:71]
    ds_read_b64_tr_b16 v[172:173], v15 offset:27712
    v_mfma_f32_16x16x32_bf16 v[68:71], v[156:159], a[124:127], v[68:71]
    s_waitcnt lgkmcnt(7)
    ds_read_b64_tr_b16 v[174:175], v15 offset:32320
    v_mfma_f32_16x16x32_bf16 v[72:75], v[40:43], a[96:99], v[72:75]
    s_add_u32 m0, s34, 114688
    ds_read_b64_tr_b16 v[32:33], v15 offset:96
    v_mfma_f32_16x16x32_bf16 v[72:75], v[44:47], a[104:107], v[72:75]
    s_nop 0
    ds_read_b64_tr_b16 v[34:35], v15 offset:4704
    buffer_load_dwordx4 v61, s[12:15], s45 offen  lds
    v_mfma_f32_16x16x32_bf16 v[72:75], v[160:163], a[112:115], v[72:75]
    s_mov_b32 s20, s60
    ds_read_b64_tr_b16 v[36:37], v15 offset:9312
    v_mfma_f32_16x16x32_bf16 v[72:75], v[164:167], a[120:123], v[72:75]
    s_and_b32 s21, s61, 0xffff
    ds_read_b64_tr_b16 v[38:39], v15 offset:13920
    v_mfma_f32_16x16x32_bf16 v[76:79], v[40:43], a[100:103], v[76:79]
    s_add_u32 m0, s34, 115712
    ds_read_b64_tr_b16 v[152:153], v15 offset:18528
    v_mfma_f32_16x16x32_bf16 v[76:79], v[44:47], a[108:111], v[76:79]
    s_nop 0
    ds_read_b64_tr_b16 v[154:155], v15 offset:23136
    buffer_load_dwordx4 v63, s[12:15], s45 offen  lds
    v_mfma_f32_16x16x32_bf16 v[76:79], v[160:163], a[116:119], v[76:79]
    ds_read_b64_tr_b16 v[156:157], v15 offset:27744
    v_and_b32 v22, 63, v0
    v_mfma_f32_16x16x32_bf16 v[76:79], v[164:167], a[124:127], v[76:79]
    s_waitcnt lgkmcnt(7)
    ds_read_b64_tr_b16 v[158:159], v15 offset:32352
    v_and_b32 v17, 15, v22
    v_mfma_f32_16x16x32_bf16 v[80:83], v[48:51], a[96:99], v[80:83]
    s_add_u32 m0, s34, 116736
    ds_read_b64_tr_b16 v[40:41], v15 offset:128
    v_mfma_f32_16x16x32_bf16 v[80:83], v[52:55], a[104:107], v[80:83]
    s_nop 0
    ds_read_b64_tr_b16 v[42:43], v15 offset:4736
    buffer_load_dwordx4 v6, s[12:15], s45 offen  lds
    v_mfma_f32_16x16x32_bf16 v[80:83], v[168:171], a[112:115], v[80:83]
    ds_read_b64_tr_b16 v[44:45], v15 offset:9344
    v_lshrrev_b32 v18, 4, v22
    v_mfma_f32_16x16x32_bf16 v[80:83], v[172:175], a[120:123], v[80:83]
    s_add_u32 m0, s34, 117760
    ds_read_b64_tr_b16 v[46:47], v15 offset:13952
    v_lshlrev_b32 v19, 7, v18
    v_mfma_f32_16x16x32_bf16 v[84:87], v[48:51], a[100:103], v[84:87]
    ds_read_b64_tr_b16 v[160:161], v15 offset:18560
    v_mfma_f32_16x16x32_bf16 v[84:87], v[52:55], a[108:111], v[84:87]
    s_nop 0
    ds_read_b64_tr_b16 v[162:163], v15 offset:23168
    buffer_load_dwordx4 v7, s[12:15], s45 offen  lds
    v_mfma_f32_16x16x32_bf16 v[84:87], v[168:171], a[116:119], v[84:87]
    ds_read_b64_tr_b16 v[164:165], v15 offset:27776
    v_lshl_add_u32 v19, v17, 3, v19
    v_mfma_f32_16x16x32_bf16 v[84:87], v[172:175], a[124:127], v[84:87]
    s_waitcnt lgkmcnt(7)
    ds_read_b64_tr_b16 v[166:167], v15 offset:32384
    v_lshlrev_b32 v20, 4, v18
    v_mfma_f32_16x16x32_bf16 v[88:91], v[32:35], a[96:99], v[88:91]
    s_lshl_b32 s3, s31, 4
    ds_read_b64_tr_b16 v[48:49], v15 offset:160
    v_mfma_f32_16x16x32_bf16 v[88:91], v[36:39], a[104:107], v[88:91]
    s_add_u32 m0, s34, 118784
    ds_read_b64_tr_b16 v[50:51], v15 offset:4768
    v_mfma_f32_16x16x32_bf16 v[88:91], v[152:155], a[112:115], v[88:91]
    s_nop 0
    ds_read_b64_tr_b16 v[52:53], v15 offset:9376
    buffer_load_dwordx4 v12, s[12:15], s45 offen  lds
    v_mfma_f32_16x16x32_bf16 v[88:91], v[156:159], a[120:123], v[88:91]
    ds_read_b64_tr_b16 v[54:55], v15 offset:13984
    v_add_u32 v21, s3, v17
    v_mfma_f32_16x16x32_bf16 v[92:95], v[32:35], a[100:103], v[92:95]
    ds_read_b64_tr_b16 v[168:169], v15 offset:18592
    v_mul_u32_u24 v21, 1152, v21
    v_mfma_f32_16x16x32_bf16 v[92:95], v[36:39], a[108:111], v[92:95]
    s_nop 0
    ds_read_b64_tr_b16 v[170:171], v15 offset:23200
    buffer_load_dwordx4 a[160:163], v9, s[16:19], s62 offen offset:2048 sc1
    v_mfma_f32_16x16x32_bf16 v[92:95], v[152:155], a[116:119], v[92:95]
    ds_read_b64_tr_b16 v[172:173], v15 offset:27808
    v_lshl_add_u32 v21, v18, 3, v21
    v_mfma_f32_16x16x32_bf16 v[92:95], v[156:159], a[124:127], v[92:95]
    s_waitcnt lgkmcnt(7)
    ds_read_b64_tr_b16 v[174:175], v15 offset:32416
    v_mfma_f32_16x16x32_bf16 v[176:179], v[40:43], a[96:99], v[176:179]
    s_mul_i32 s50, s31, 18432
    ds_read_b64_tr_b16 v[32:33], v15 offset:192
    v_mfma_f32_16x16x32_bf16 v[176:179], v[44:47], a[104:107], v[176:179]
    s_mul_i32 s3, s33, 4608
    ds_read_b64_tr_b16 v[34:35], v15 offset:4800
    buffer_load_dwordx4 a[164:167], v9, s[16:19], s63 offen offset:2048 sc1
    v_mfma_f32_16x16x32_bf16 v[176:179], v[160:163], a[112:115], v[176:179]
    s_add_u32 s50, s50, s3
    ds_read_b64_tr_b16 v[36:37], v15 offset:9408
    v_mfma_f32_16x16x32_bf16 v[176:179], v[164:167], a[120:123], v[176:179]
    s_add_u32 s50, s50, 7340032
    ds_read_b64_tr_b16 v[38:39], v15 offset:14016
    v_mfma_f32_16x16x32_bf16 v[180:183], v[40:43], a[100:103], v[180:183]
    s_add_u32 s36, s50, 4096
    ds_read_b64_tr_b16 v[152:153], v15 offset:18624
    v_mfma_f32_16x16x32_bf16 v[180:183], v[44:47], a[108:111], v[180:183]
    s_nop 0
    ds_read_b64_tr_b16 v[154:155], v15 offset:23232
    buffer_load_dwordx4 a[168:171], v26, s[16:19], s62 offen offset:0 sc1
    v_mfma_f32_16x16x32_bf16 v[180:183], v[160:163], a[116:119], v[180:183]
    s_add_u32 s37, s36, 18432
    ds_read_b64_tr_b16 v[156:157], v15 offset:27840
    v_mfma_f32_16x16x32_bf16 v[180:183], v[164:167], a[124:127], v[180:183]
    s_waitcnt lgkmcnt(7)
    ds_read_b64_tr_b16 v[158:159], v15 offset:32448
    v_mfma_f32_16x16x32_bf16 v[184:187], v[48:51], a[96:99], v[184:187]
    s_lshl_b32 s3, s30, 10
    ds_read_b64_tr_b16 v[40:41], v15 offset:224
    v_mfma_f32_16x16x32_bf16 v[184:187], v[52:55], a[104:107], v[184:187]
    s_add_u32 s50, s50, s3
    ds_read_b64_tr_b16 v[42:43], v15 offset:4832
    buffer_load_dwordx4 a[172:175], v26, s[16:19], s63 offen offset:0 sc1
    v_mfma_f32_16x16x32_bf16 v[184:187], v[168:171], a[112:115], v[184:187]
    s_add_u32 s51, s50, 18432
    ds_read_b64_tr_b16 v[44:45], v15 offset:9440
    v_mfma_f32_16x16x32_bf16 v[184:187], v[172:175], a[120:123], v[184:187]
    s_mul_i32 s52, s33, 576
    ds_read_b64_tr_b16 v[46:47], v15 offset:14048
    v_mfma_f32_16x16x32_bf16 v[188:191], v[48:51], a[100:103], v[188:191]
    s_add_u32 s52, s52, 4730112
    ds_read_b64_tr_b16 v[160:161], v15 offset:18656
    v_mfma_f32_16x16x32_bf16 v[188:191], v[52:55], a[108:111], v[188:191]
    s_nop 0
    ds_read_b64_tr_b16 v[162:163], v15 offset:23264
    buffer_load_dwordx4 a[176:179], v9, s[16:19], s64 offen offset:2048 sc1
    v_mfma_f32_16x16x32_bf16 v[188:191], v[168:171], a[116:119], v[188:191]
    s_lshl_b32 s3, s30, 7
    ds_read_b64_tr_b16 v[164:165], v15 offset:27872
    v_mfma_f32_16x16x32_bf16 v[188:191], v[172:175], a[124:127], v[188:191]
    s_waitcnt lgkmcnt(7)
    ds_read_b64_tr_b16 v[166:167], v15 offset:32480
    v_mfma_f32_16x16x32_bf16 v[192:195], v[32:35], a[96:99], v[192:195]
    s_add_u32 s53, s52, s3
    ds_read_b64_tr_b16 v[48:49], v15 offset:256
    v_mfma_f32_16x16x32_bf16 v[192:195], v[36:39], a[104:107], v[192:195]
    s_mul_i32 s73, s33, 288
    ds_read_b64_tr_b16 v[50:51], v15 offset:4864
    buffer_load_dwordx4 a[180:183], v9, s[16:19], s65 offen offset:2048 sc1
    v_mfma_f32_16x16x32_bf16 v[192:195], v[152:155], a[112:115], v[192:195]
    s_lshl_b32 s3, s30, 6
    ds_read_b64_tr_b16 v[52:53], v15 offset:9472
    v_mfma_f32_16x16x32_bf16 v[192:195], v[156:159], a[120:123], v[192:195]
    s_add_u32 s72, s73, s3
    ds_read_b64_tr_b16 v[54:55], v15 offset:14080
    v_mfma_f32_16x16x32_bf16 v[196:199], v[32:35], a[100:103], v[196:199]
    s_xor_b32 s32, s24, s30
    ds_read_b64_tr_b16 v[168:169], v15 offset:18688
    v_mfma_f32_16x16x32_bf16 v[196:199], v[36:39], a[108:111], v[196:199]
    s_nop 0
    ds_read_b64_tr_b16 v[170:171], v15 offset:23296
    buffer_load_dwordx4 a[184:187], v26, s[16:19], s64 offen offset:0 sc1
    v_mfma_f32_16x16x32_bf16 v[196:199], v[152:155], a[116:119], v[196:199]
    s_xor_b32 s3, s2, 2
    ds_read_b64_tr_b16 v[172:173], v15 offset:27904
    v_mfma_f32_16x16x32_bf16 v[196:199], v[156:159], a[124:127], v[196:199]
    s_waitcnt vmcnt(25) lgkmcnt(7)
    s_barrier
    ds_read_b64_tr_b16 v[174:175], v15 offset:32512
    v_mfma_f32_16x16x32_bf16 v[200:203], v[40:43], a[96:99], v[200:203]
    s_lshl_b32 s3, s3, 2
    ds_read_b64_tr_b16 v[32:33], v144 offset:0
    v_mfma_f32_16x16x32_bf16 v[200:203], v[44:47], a[104:107], v[200:203]
    s_add_u32 s3, s3, s24
    ds_read_b64_tr_b16 v[34:35], v144 offset:4608
    buffer_load_dwordx4 a[188:191], v26, s[16:19], s65 offen offset:0 sc1
    v_mfma_f32_16x16x32_bf16 v[200:203], v[160:163], a[112:115], v[200:203]
    s_mul_i32 s3, s3, 12288
    ds_read_b64_tr_b16 v[36:37], v144 offset:9216
    v_mfma_f32_16x16x32_bf16 v[200:203], v[164:167], a[120:123], v[200:203]
    s_add_u32 s55, s3, 28573696
    ds_read_b64_tr_b16 v[38:39], v144 offset:13824
    v_mfma_f32_16x16x32_bf16 v[204:207], v[40:43], a[100:103], v[204:207]
    s_add_u32 s77, s58, 0
    ds_read_b64_tr_b16 v[152:153], v144 offset:18432
    v_mfma_f32_16x16x32_bf16 v[204:207], v[44:47], a[108:111], v[204:207]
    s_add_u32 m0, s34, 0
    ds_read_b64_tr_b16 v[154:155], v144 offset:23040
    v_mfma_f32_16x16x32_bf16 v[204:207], v[160:163], a[116:119], v[204:207]
    s_cmp_eq_u32 s32, 1
    s_cselect_b32 s81, s77, 0x7ff00000
    ds_read_b64_tr_b16 v[156:157], v144 offset:27648
    buffer_load_dwordx4 v56, s[12:15], s46 offen  lds
    v_mfma_f32_16x16x32_bf16 v[204:207], v[164:167], a[124:127], v[204:207]
    s_waitcnt lgkmcnt(7)
    ds_read_b64_tr_b16 v[158:159], v144 offset:32256
    v_mfma_f32_16x16x32_bf16 v[208:211], v[48:51], a[96:99], v[208:211]
    s_xor_b32 s3, s2, 4
    ds_read_b64_tr_b16 v[40:41], v144 offset:32
    v_mfma_f32_16x16x32_bf16 v[208:211], v[52:55], a[104:107], v[208:211]
    s_lshl_b32 s3, s3, 2
    ds_read_b64_tr_b16 v[42:43], v144 offset:4640
    v_mfma_f32_16x16x32_bf16 v[208:211], v[168:171], a[112:115], v[208:211]
    s_add_u32 s3, s3, s24
    ds_read_b64_tr_b16 v[44:45], v144 offset:9248
    v_mfma_f32_16x16x32_bf16 v[208:211], v[172:175], a[120:123], v[208:211]
    s_mul_i32 s3, s3, 12288
    ds_read_b64_tr_b16 v[46:47], v144 offset:13856
    v_mfma_f32_16x16x32_bf16 v[212:215], v[48:51], a[100:103], v[212:215]
    s_add_u32 s56, s3, 28577792
    ds_read_b64_tr_b16 v[160:161], v144 offset:18464
    v_mfma_f32_16x16x32_bf16 v[212:215], v[52:55], a[108:111], v[212:215]
    s_waitcnt vmcnt(19)
    ds_read_b64_tr_b16 v[162:163], v144 offset:23072
    v_mfma_f32_16x16x32_bf16 v[212:215], v[168:171], a[116:119], v[212:215]
    s_add_u32 s78, s58, 4096
    ds_read_b64_tr_b16 v[164:165], v144 offset:27680
    v_mfma_f32_16x16x32_bf16 v[212:215], v[172:175], a[124:127], v[212:215]
    s_waitcnt lgkmcnt(7)
    ds_read_b64_tr_b16 v[166:167], v144 offset:32288
    v_mfma_f32_16x16x32_bf16 v[64:67], v[32:35], a[128:131], v[64:67]
    s_cmp_eq_u32 s32, 2
    s_cselect_b32 s82, s78, 0x7ff00000
    ds_read_b64_tr_b16 v[48:49], v144 offset:64
    v_mfma_f32_16x16x32_bf16 v[64:67], v[36:39], a[136:139], v[64:67]
    s_xor_b32 s3, s2, 6
    ds_read_b64_tr_b16 v[50:51], v144 offset:4672
    v_mfma_f32_16x16x32_bf16 v[64:67], v[152:155], a[144:147], v[64:67]
    s_lshl_b32 s3, s3, 2
    ds_read_b64_tr_b16 v[52:53], v144 offset:9280
    v_mfma_f32_16x16x32_bf16 v[64:67], v[156:159], a[152:155], v[64:67]
    s_add_u32 s3, s3, s24
    ds_read_b64_tr_b16 v[54:55], v144 offset:13888
    v_mfma_f32_16x16x32_bf16 v[68:71], v[32:35], a[132:135], v[68:71]
    s_mul_i32 s3, s3, 12288
    ds_read_b64_tr_b16 v[168:169], v144 offset:18496
    v_mfma_f32_16x16x32_bf16 v[68:71], v[36:39], a[140:143], v[68:71]
    s_add_u32 m0, s34, 1024
    ds_read_b64_tr_b16 v[170:171], v144 offset:23104
    v_mfma_f32_16x16x32_bf16 v[68:71], v[152:155], a[148:151], v[68:71]
    s_add_u32 s57, s3, 28581888
    ds_read_b64_tr_b16 v[172:173], v144 offset:27712
    buffer_load_dwordx4 v57, s[12:15], s46 offen  lds
    v_mfma_f32_16x16x32_bf16 v[68:71], v[156:159], a[156:159], v[68:71]
    s_waitcnt lgkmcnt(7)
    ds_read_b64_tr_b16 v[174:175], v144 offset:32320
    v_mfma_f32_16x16x32_bf16 v[72:75], v[40:43], a[128:131], v[72:75]
    s_add_u32 s79, s58, 8192
    ds_read_b64_tr_b16 v[32:33], v144 offset:96
    v_mfma_f32_16x16x32_bf16 v[72:75], v[44:47], a[136:139], v[72:75]
    s_cmp_eq_u32 s32, 3
    s_cselect_b32 s83, s79, 0x7ff00000
    ds_read_b64_tr_b16 v[34:35], v144 offset:4704
    v_mfma_f32_16x16x32_bf16 v[72:75], v[160:163], a[144:147], v[72:75]
    s_add_u32 m0, s34, 2048
    ds_read_b64_tr_b16 v[36:37], v144 offset:9312
    v_mfma_f32_16x16x32_bf16 v[72:75], v[164:167], a[152:155], v[72:75]
    s_nop 0
    ds_read_b64_tr_b16 v[38:39], v144 offset:13920
    buffer_load_dwordx4 v58, s[12:15], s46 offen  lds
    v_mfma_f32_16x16x32_bf16 v[76:79], v[40:43], a[132:135], v[76:79]
    s_add_u32 m0, s34, 3072
    ds_read_b64_tr_b16 v[152:153], v144 offset:18528
    v_mov_b32 v227, s70
    v_mfma_f32_16x16x32_bf16 v[76:79], v[44:47], a[140:143], v[76:79]
    s_nop 0
    ds_read_b64_tr_b16 v[154:155], v144 offset:23136
    buffer_load_dwordx4 v59, s[12:15], s46 offen  lds
    v_mfma_f32_16x16x32_bf16 v[76:79], v[160:163], a[148:151], v[76:79]
    s_add_u32 m0, s34, 4096
    ds_read_b64_tr_b16 v[156:157], v144 offset:27744
    v_mov_b32 v231, s70
    v_mfma_f32_16x16x32_bf16 v[76:79], v[164:167], a[156:159], v[76:79]
    s_waitcnt lgkmcnt(7)
    ds_read_b64_tr_b16 v[158:159], v144 offset:32352
    buffer_load_dwordx4 v61, s[12:15], s46 offen  lds
    v_mfma_f32_16x16x32_bf16 v[80:83], v[48:51], a[128:131], v[80:83]
    s_add_u32 m0, s34, 5120
    ds_read_b64_tr_b16 v[40:41], v144 offset:128
    v_mov_b32 v235, s70
    v_mfma_f32_16x16x32_bf16 v[80:83], v[52:55], a[136:139], v[80:83]
    s_nop 0
    ds_read_b64_tr_b16 v[42:43], v144 offset:4736
    buffer_load_dwordx4 v63, s[12:15], s46 offen  lds
    v_mfma_f32_16x16x32_bf16 v[80:83], v[168:171], a[144:147], v[80:83]
    s_add_u32 m0, s34, 6144
    ds_read_b64_tr_b16 v[44:45], v144 offset:9344
    v_mov_b32 v239, s70
    v_mfma_f32_16x16x32_bf16 v[80:83], v[172:175], a[152:155], v[80:83]
    s_nop 0
    ds_read_b64_tr_b16 v[46:47], v144 offset:13952
    buffer_load_dwordx4 v6, s[12:15], s46 offen  lds
    v_mfma_f32_16x16x32_bf16 v[84:87], v[48:51], a[132:135], v[84:87]
    s_add_u32 m0, s34, 7168
    ds_read_b64_tr_b16 v[160:161], v144 offset:18560
    v_mov_b32 v243, s70
    v_mfma_f32_16x16x32_bf16 v[84:87], v[52:55], a[140:143], v[84:87]
    s_nop 0
    ds_read_b64_tr_b16 v[162:163], v144 offset:23168
    buffer_load_dwordx4 v7, s[12:15], s46 offen  lds
    v_mfma_f32_16x16x32_bf16 v[84:87], v[168:171], a[148:151], v[84:87]
    s_add_u32 m0, s34, 8192
    ds_read_b64_tr_b16 v[164:165], v144 offset:27776
    v_mov_b32 v247, s70
    v_mfma_f32_16x16x32_bf16 v[84:87], v[172:175], a[156:159], v[84:87]
    s_waitcnt lgkmcnt(7)
    ds_read_b64_tr_b16 v[166:167], v144 offset:32384
    buffer_load_dwordx4 v12, s[12:15], s46 offen  lds
    v_mfma_f32_16x16x32_bf16 v[88:91], v[32:35], a[128:131], v[88:91]
    ds_read_b64_tr_b16 v[48:49], v144 offset:160
    v_mov_b32 v251, s70
    v_mfma_f32_16x16x32_bf16 v[88:91], v[36:39], a[136:139], v[88:91]
    ds_read_b64_tr_b16 v[50:51], v144 offset:4768
    v_mov_b32 v255, s70
    v_mfma_f32_16x16x32_bf16 v[88:91], v[152:155], a[144:147], v[88:91]
    buffer_load_dword v11, v60, s[16:19], s59 offen sc1
    ds_read_b64_tr_b16 v[52:53], v144 offset:9376
    buffer_load_dwordx4 a[192:195], v24, s[16:19], s62 offen offset:1024 sc1
    v_mfma_f32_16x16x32_bf16 v[88:91], v[156:159], a[152:155], v[88:91]
    ds_read_b64_tr_b16 v[54:55], v144 offset:13984
    v_mfma_f32_16x16x32_bf16 v[92:95], v[32:35], a[132:135], v[92:95]
    ds_read_b64_tr_b16 v[168:169], v144 offset:18592
    v_mfma_f32_16x16x32_bf16 v[92:95], v[36:39], a[140:143], v[92:95]
    ds_read_b64_tr_b16 v[170:171], v144 offset:23200
    v_mfma_f32_16x16x32_bf16 v[92:95], v[152:155], a[148:151], v[92:95]
    s_nop 0
    ds_read_b64_tr_b16 v[172:173], v144 offset:27808
    buffer_load_dwordx4 a[196:199], v24, s[16:19], s63 offen offset:1024 sc1
    v_mfma_f32_16x16x32_bf16 v[92:95], v[156:159], a[156:159], v[92:95]
    s_waitcnt lgkmcnt(7)
    ds_read_b64_tr_b16 v[174:175], v144 offset:32416
    v_mfma_f32_16x16x32_bf16 v[176:179], v[40:43], a[128:131], v[176:179]
    ds_read_b64_tr_b16 v[32:33], v144 offset:192
    v_mfma_f32_16x16x32_bf16 v[176:179], v[44:47], a[136:139], v[176:179]
    ds_read_b64_tr_b16 v[34:35], v144 offset:4800
    v_mfma_f32_16x16x32_bf16 v[176:179], v[160:163], a[144:147], v[176:179]
    s_nop 0
    ds_read_b64_tr_b16 v[36:37], v144 offset:9408
    buffer_load_dwordx4 a[200:203], v27, s[16:19], s62 offen offset:0 sc1
    v_mfma_f32_16x16x32_bf16 v[176:179], v[164:167], a[152:155], v[176:179]
    ds_read_b64_tr_b16 v[38:39], v144 offset:14016
    v_mfma_f32_16x16x32_bf16 v[180:183], v[40:43], a[132:135], v[180:183]
    ds_read_b64_tr_b16 v[152:153], v144 offset:18624
    v_mfma_f32_16x16x32_bf16 v[180:183], v[44:47], a[140:143], v[180:183]
    ds_read_b64_tr_b16 v[154:155], v144 offset:23232
    v_mfma_f32_16x16x32_bf16 v[180:183], v[160:163], a[148:151], v[180:183]
    ds_read_b64_tr_b16 v[156:157], v144 offset:27840
    v_mfma_f32_16x16x32_bf16 v[180:183], v[164:167], a[156:159], v[180:183]
    s_waitcnt lgkmcnt(7)
    ds_read_b64_tr_b16 v[158:159], v144 offset:32448
    buffer_load_dwordx4 a[204:207], v27, s[16:19], s63 offen offset:0 sc1
    v_mfma_f32_16x16x32_bf16 v[184:187], v[48:51], a[128:131], v[184:187]
    ds_read_b64_tr_b16 v[40:41], v144 offset:224
    v_mfma_f32_16x16x32_bf16 v[184:187], v[52:55], a[136:139], v[184:187]
    ds_read_b64_tr_b16 v[42:43], v144 offset:4832
    v_mfma_f32_16x16x32_bf16 v[184:187], v[168:171], a[144:147], v[184:187]
    ds_read_b64_tr_b16 v[44:45], v144 offset:9440
    v_mfma_f32_16x16x32_bf16 v[184:187], v[172:175], a[152:155], v[184:187]
    s_nop 0
    ds_read_b64_tr_b16 v[46:47], v144 offset:14048
    buffer_load_dwordx4 a[208:211], v24, s[16:19], s64 offen offset:1024 sc1
    v_mfma_f32_16x16x32_bf16 v[188:191], v[48:51], a[132:135], v[188:191]
    ds_read_b64_tr_b16 v[160:161], v144 offset:18656
    v_mfma_f32_16x16x32_bf16 v[188:191], v[52:55], a[140:143], v[188:191]
    ds_read_b64_tr_b16 v[162:163], v144 offset:23264
    v_mfma_f32_16x16x32_bf16 v[188:191], v[168:171], a[148:151], v[188:191]
    ds_read_b64_tr_b16 v[164:165], v144 offset:27872
    v_mfma_f32_16x16x32_bf16 v[188:191], v[172:175], a[156:159], v[188:191]
    s_waitcnt lgkmcnt(7)
    ds_read_b64_tr_b16 v[166:167], v144 offset:32480
    buffer_load_dwordx4 a[212:215], v24, s[16:19], s65 offen offset:1024 sc1
    v_mfma_f32_16x16x32_bf16 v[192:195], v[32:35], a[128:131], v[192:195]
    ds_read_b64_tr_b16 v[48:49], v144 offset:256
    v_mfma_f32_16x16x32_bf16 v[192:195], v[36:39], a[136:139], v[192:195]
    ds_read_b64_tr_b16 v[50:51], v144 offset:4864
    v_mfma_f32_16x16x32_bf16 v[192:195], v[152:155], a[144:147], v[192:195]
    ds_read_b64_tr_b16 v[52:53], v144 offset:9472
    v_mfma_f32_16x16x32_bf16 v[192:195], v[156:159], a[152:155], v[192:195]
    s_nop 0
    ds_read_b64_tr_b16 v[54:55], v144 offset:14080
    buffer_load_dwordx4 a[216:219], v27, s[16:19], s64 offen offset:0 sc1
    v_mfma_f32_16x16x32_bf16 v[196:199], v[32:35], a[132:135], v[196:199]
    ds_read_b64_tr_b16 v[168:169], v144 offset:18688
    v_mfma_f32_16x16x32_bf16 v[196:199], v[36:39], a[140:143], v[196:199]
    ds_read_b64_tr_b16 v[170:171], v144 offset:23296
    v_mfma_f32_16x16x32_bf16 v[196:199], v[152:155], a[148:151], v[196:199]
    ds_read_b64_tr_b16 v[172:173], v144 offset:27904
    v_mfma_f32_16x16x32_bf16 v[196:199], v[156:159], a[156:159], v[196:199]
    s_waitcnt vmcnt(25) lgkmcnt(7)
    s_barrier
    ds_read_b64_tr_b16 v[174:175], v144 offset:32512
    buffer_load_dwordx4 a[220:223], v27, s[16:19], s65 offen offset:0 sc1
    v_mfma_f32_16x16x32_bf16 v[200:203], v[40:43], a[128:131], v[200:203]
    ds_read_b64_tr_b16 v[32:33], v145 offset:256
    v_mfma_f32_16x16x32_bf16 v[200:203], v[44:47], a[136:139], v[200:203]
    s_add_u32 m0, s34, 36864
    ds_read_b64_tr_b16 v[34:35], v145 offset:4864
    v_mfma_f32_16x16x32_bf16 v[200:203], v[160:163], a[144:147], v[200:203]
    ds_read_b64_tr_b16 v[36:37], v145 offset:9472
    v_mfma_f32_16x16x32_bf16 v[200:203], v[164:167], a[152:155], v[200:203]
    s_nop 0
    ds_read_b64_tr_b16 v[38:39], v145 offset:14080
    buffer_load_dwordx4 v56, s[12:15], s47 offen  lds
    v_mfma_f32_16x16x32_bf16 v[204:207], v[40:43], a[132:135], v[204:207]
    ds_read_b64_tr_b16 v[152:153], v145 offset:18688
    v_mfma_f32_16x16x32_bf16 v[204:207], v[44:47], a[140:143], v[204:207]
    s_add_u32 m0, s34, 37888
    ds_read_b64_tr_b16 v[154:155], v145 offset:23296
    v_mfma_f32_16x16x32_bf16 v[204:207], v[160:163], a[148:151], v[204:207]
    ds_read_b64_tr_b16 v[156:157], v145 offset:27904
    v_mfma_f32_16x16x32_bf16 v[204:207], v[164:167], a[156:159], v[204:207]
    s_waitcnt lgkmcnt(7)
    ds_read_b64_tr_b16 v[158:159], v145 offset:32512
    buffer_load_dwordx4 v57, s[12:15], s47 offen  lds
    v_mfma_f32_16x16x32_bf16 v[208:211], v[48:51], a[128:131], v[208:211]
    ds_read_b64_tr_b16 v[40:41], v145 offset:192
    v_mfma_f32_16x16x32_bf16 v[208:211], v[52:55], a[136:139], v[208:211]
    s_add_u32 m0, s34, 38912
    ds_read_b64_tr_b16 v[42:43], v145 offset:4800
    v_mfma_f32_16x16x32_bf16 v[208:211], v[168:171], a[144:147], v[208:211]
    ds_read_b64_tr_b16 v[44:45], v145 offset:9408
    v_mfma_f32_16x16x32_bf16 v[208:211], v[172:175], a[152:155], v[208:211]
    s_nop 0
    ds_read_b64_tr_b16 v[46:47], v145 offset:14016
    buffer_load_dwordx4 v58, s[12:15], s47 offen  lds
    v_mfma_f32_16x16x32_bf16 v[212:215], v[48:51], a[132:135], v[212:215]
    ds_read_b64_tr_b16 v[160:161], v145 offset:18624
    v_mfma_f32_16x16x32_bf16 v[212:215], v[52:55], a[140:143], v[212:215]
    s_waitcnt vmcnt(21)
    ds_read_b64_tr_b16 v[162:163], v145 offset:23232
    v_mfma_f32_16x16x32_bf16 v[212:215], v[168:171], a[148:151], v[212:215]
    s_add_u32 m0, s34, 39936
    ds_read_b64_tr_b16 v[164:165], v145 offset:27840
    v_mfma_f32_16x16x32_bf16 v[212:215], v[172:175], a[156:159], v[212:215]
    s_waitcnt lgkmcnt(7)
    ds_read_b64_tr_b16 v[166:167], v145 offset:32448
    buffer_load_dwordx4 v59, s[12:15], s47 offen  lds
    v_mfma_f32_16x16x32_bf16 v[208:211], v[32:35], a[160:163], v[208:211]
    ds_read_b64_tr_b16 v[48:49], v145 offset:224
    v_mfma_f32_16x16x32_bf16 v[208:211], v[36:39], a[168:171], v[208:211]
    s_add_u32 m0, s34, 40960
    ds_read_b64_tr_b16 v[50:51], v145 offset:4832
    v_mfma_f32_16x16x32_bf16 v[208:211], v[152:155], a[176:179], v[208:211]
    ds_read_b64_tr_b16 v[52:53], v145 offset:9440
    v_mfma_f32_16x16x32_bf16 v[208:211], v[156:159], a[184:187], v[208:211]
    s_nop 0
    ds_read_b64_tr_b16 v[54:55], v145 offset:14048
    buffer_load_dwordx4 v61, s[12:15], s47 offen  lds
    v_mfma_f32_16x16x32_bf16 v[212:215], v[32:35], a[164:167], v[212:215]
    ds_read_b64_tr_b16 v[168:169], v145 offset:18656
    v_mfma_f32_16x16x32_bf16 v[212:215], v[36:39], a[172:175], v[212:215]
    ds_read_b64_tr_b16 v[170:171], v145 offset:23264
    v_mfma_f32_16x16x32_bf16 v[212:215], v[152:155], a[180:183], v[212:215]
    s_add_u32 m0, s34, 41984
    ds_read_b64_tr_b16 v[172:173], v145 offset:27872
    v_mfma_f32_16x16x32_bf16 v[212:215], v[156:159], a[188:191], v[212:215]
    s_waitcnt lgkmcnt(7)
    ds_read_b64_tr_b16 v[174:175], v145 offset:32480
    v_mfma_f32_16x16x32_bf16 v[192:195], v[40:43], a[160:163], v[192:195]
    s_nop 0
    ds_read_b64_tr_b16 v[32:33], v145 offset:128
    buffer_load_dwordx4 v63, s[12:15], s47 offen  lds
    v_mfma_f32_16x16x32_bf16 v[192:195], v[44:47], a[168:171], v[192:195]
    ds_read_b64_tr_b16 v[34:35], v145 offset:4736
    v_mfma_f32_16x16x32_bf16 v[192:195], v[160:163], a[176:179], v[192:195]
    s_add_u32 m0, s34, 43008
    ds_read_b64_tr_b16 v[36:37], v145 offset:9344
    v_mfma_f32_16x16x32_bf16 v[192:195], v[164:167], a[184:187], v[192:195]
    ds_read_b64_tr_b16 v[38:39], v145 offset:13952
    v_mfma_f32_16x16x32_bf16 v[196:199], v[40:43], a[164:167], v[196:199]
    s_nop 0
    ds_read_b64_tr_b16 v[152:153], v145 offset:18560
    buffer_load_dwordx4 v6, s[12:15], s47 offen  lds
    v_mfma_f32_16x16x32_bf16 v[196:199], v[44:47], a[172:175], v[196:199]
    ds_read_b64_tr_b16 v[154:155], v145 offset:23168
    v_mfma_f32_16x16x32_bf16 v[196:199], v[160:163], a[180:183], v[196:199]
    s_add_u32 m0, s34, 44032
    ds_read_b64_tr_b16 v[156:157], v145 offset:27776
    v_mfma_f32_16x16x32_bf16 v[196:199], v[164:167], a[188:191], v[196:199]
    s_waitcnt lgkmcnt(7)
    ds_read_b64_tr_b16 v[158:159], v145 offset:32384
    v_mfma_f32_16x16x32_bf16 v[200:203], v[48:51], a[160:163], v[200:203]
    s_nop 0
    ds_read_b64_tr_b16 v[40:41], v145 offset:160
    buffer_load_dwordx4 v7, s[12:15], s47 offen  lds
    v_mfma_f32_16x16x32_bf16 v[200:203], v[52:55], a[168:171], v[200:203]
    ds_read_b64_tr_b16 v[42:43], v145 offset:4768
    v_mfma_f32_16x16x32_bf16 v[200:203], v[168:171], a[176:179], v[200:203]
    s_add_u32 m0, s34, 45056
    ds_read_b64_tr_b16 v[44:45], v145 offset:9376
    v_mfma_f32_16x16x32_bf16 v[200:203], v[172:175], a[184:187], v[200:203]
    ds_read_b64_tr_b16 v[46:47], v145 offset:13984
    v_mfma_f32_16x16x32_bf16 v[204:207], v[48:51], a[164:167], v[204:207]
    s_nop 0
    ds_read_b64_tr_b16 v[160:161], v145 offset:18592
    buffer_load_dwordx4 v12, s[12:15], s47 offen  lds
    v_mfma_f32_16x16x32_bf16 v[204:207], v[52:55], a[172:175], v[204:207]
    ds_read_b64_tr_b16 v[162:163], v145 offset:23200
    v_mfma_f32_16x16x32_bf16 v[204:207], v[168:171], a[180:183], v[204:207]
    s_waitcnt vmcnt(17)
    v_subrev_u32 v11, s70, v11
    v_subrev_u32 v11, 5, v11
    v_cmp_lt_u32 vcc, 0, v11
    ds_read_b64_tr_b16 v[164:165], v145 offset:27808
    v_mfma_f32_16x16x32_bf16 v[204:207], v[172:175], a[188:191], v[204:207]
    s_waitcnt lgkmcnt(7)
    ds_read_b64_tr_b16 v[166:167], v145 offset:32416
    v_mfma_f32_16x16x32_bf16 v[176:179], v[32:35], a[160:163], v[176:179]
    s_cbranch_vccnz adaLN_cond__ssm_conv_h3__glu_gated_geglu__prompt_kernel_sl5
adaLN_cond__ssm_conv_h3__glu_gated_geglu__prompt_kernel_sl5b:
    ds_read_b64_tr_b16 v[48:49], v145 offset:64
    v_mfma_f32_16x16x32_bf16 v[176:179], v[36:39], a[168:171], v[176:179]
    s_nop 0
    ds_read_b64_tr_b16 v[50:51], v145 offset:4672
    buffer_load_dwordx4 a[224:227], v9, s[16:19], s62 offen offset:3072 sc1
    v_mfma_f32_16x16x32_bf16 v[176:179], v[152:155], a[176:179], v[176:179]
    ds_read_b64_tr_b16 v[52:53], v145 offset:9280
    v_mfma_f32_16x16x32_bf16 v[176:179], v[156:159], a[184:187], v[176:179]
    ds_read_b64_tr_b16 v[54:55], v145 offset:13888
    v_mfma_f32_16x16x32_bf16 v[180:183], v[32:35], a[164:167], v[180:183]
    ds_read_b64_tr_b16 v[168:169], v145 offset:18496
    v_mfma_f32_16x16x32_bf16 v[180:183], v[36:39], a[172:175], v[180:183]
    s_nop 0
    ds_read_b64_tr_b16 v[170:171], v145 offset:23104
    buffer_load_dwordx4 a[228:231], v9, s[16:19], s63 offen offset:3072 sc1
    v_mfma_f32_16x16x32_bf16 v[180:183], v[152:155], a[180:183], v[180:183]
    ds_read_b64_tr_b16 v[172:173], v145 offset:27712
    v_mfma_f32_16x16x32_bf16 v[180:183], v[156:159], a[188:191], v[180:183]
    s_waitcnt lgkmcnt(7)
    ds_read_b64_tr_b16 v[174:175], v145 offset:32320
    v_mfma_f32_16x16x32_bf16 v[184:187], v[40:43], a[160:163], v[184:187]
    ds_read_b64_tr_b16 v[32:33], v145 offset:96
    v_mfma_f32_16x16x32_bf16 v[184:187], v[44:47], a[168:171], v[184:187]
    s_nop 0
    ds_read_b64_tr_b16 v[34:35], v145 offset:4704
    buffer_load_dwordx4 a[232:235], v25, s[16:19], s62 offen offset:1024 sc1
    v_mfma_f32_16x16x32_bf16 v[184:187], v[160:163], a[176:179], v[184:187]
    ds_read_b64_tr_b16 v[36:37], v145 offset:9312
    v_mfma_f32_16x16x32_bf16 v[184:187], v[164:167], a[184:187], v[184:187]
    ds_read_b64_tr_b16 v[38:39], v145 offset:13920
    v_mfma_f32_16x16x32_bf16 v[188:191], v[40:43], a[164:167], v[188:191]
    ds_read_b64_tr_b16 v[152:153], v145 offset:18528
    v_mfma_f32_16x16x32_bf16 v[188:191], v[44:47], a[172:175], v[188:191]
    s_nop 0
    ds_read_b64_tr_b16 v[154:155], v145 offset:23136
    buffer_load_dwordx4 a[236:239], v25, s[16:19], s63 offen offset:1024 sc1
    v_mfma_f32_16x16x32_bf16 v[188:191], v[160:163], a[180:183], v[188:191]
    ds_read_b64_tr_b16 v[156:157], v145 offset:27744
    v_mfma_f32_16x16x32_bf16 v[188:191], v[164:167], a[188:191], v[188:191]
    s_waitcnt vmcnt(22) lgkmcnt(7)
    s_barrier
    ds_read_b64_tr_b16 v[158:159], v145 offset:32352
    v_mfma_f32_16x16x32_bf16 v[80:83], v[48:51], a[160:163], v[80:83]
    ds_read_b64_tr_b16 v[40:41], v14 offset:256
    v_mfma_f32_16x16x32_bf16 v[80:83], v[52:55], a[168:171], v[80:83]
    s_nop 0
    ds_read_b64_tr_b16 v[42:43], v14 offset:4864
    buffer_load_dwordx4 a[240:243], v9, s[16:19], s64 offen offset:3072 sc1
    v_mfma_f32_16x16x32_bf16 v[80:83], v[168:171], a[176:179], v[80:83]
    ds_read_b64_tr_b16 v[44:45], v14 offset:9472
    v_mfma_f32_16x16x32_bf16 v[80:83], v[172:175], a[184:187], v[80:83]
    ds_read_b64_tr_b16 v[46:47], v14 offset:14080
    v_mfma_f32_16x16x32_bf16 v[84:87], v[48:51], a[164:167], v[84:87]
    ds_read_b64_tr_b16 v[160:161], v14 offset:18688
    v_mfma_f32_16x16x32_bf16 v[84:87], v[52:55], a[172:175], v[84:87]
    s_nop 0
    ds_read_b64_tr_b16 v[162:163], v14 offset:23296
    buffer_load_dwordx4 a[244:247], v9, s[16:19], s65 offen offset:3072 sc1
    v_mfma_f32_16x16x32_bf16 v[84:87], v[168:171], a[180:183], v[84:87]
    ds_read_b64_tr_b16 v[164:165], v14 offset:27904
    v_mfma_f32_16x16x32_bf16 v[84:87], v[172:175], a[188:191], v[84:87]
    s_waitcnt lgkmcnt(7)
    ds_read_b64_tr_b16 v[166:167], v14 offset:32512
    v_mfma_f32_16x16x32_bf16 v[88:91], v[32:35], a[160:163], v[88:91]
    ds_read_b64_tr_b16 v[48:49], v14 offset:192
    v_mfma_f32_16x16x32_bf16 v[88:91], v[36:39], a[168:171], v[88:91]
    s_nop 0
    ds_read_b64_tr_b16 v[50:51], v14 offset:4800
    buffer_load_dwordx4 a[248:251], v25, s[16:19], s64 offen offset:1024 sc1
    v_mfma_f32_16x16x32_bf16 v[88:91], v[152:155], a[176:179], v[88:91]
    ds_read_b64_tr_b16 v[52:53], v14 offset:9408
    v_mfma_f32_16x16x32_bf16 v[88:91], v[156:159], a[184:187], v[88:91]
    ds_read_b64_tr_b16 v[54:55], v14 offset:14016
    v_mfma_f32_16x16x32_bf16 v[92:95], v[32:35], a[164:167], v[92:95]
    ds_read_b64_tr_b16 v[168:169], v14 offset:18624
    v_mfma_f32_16x16x32_bf16 v[92:95], v[36:39], a[172:175], v[92:95]
    s_waitcnt vmcnt(16)
    ds_read_b64_tr_b16 v[170:171], v14 offset:23232
    buffer_load_dwordx4 a[252:255], v25, s[16:19], s65 offen offset:1024 sc1
    v_mfma_f32_16x16x32_bf16 v[92:95], v[152:155], a[180:183], v[92:95]
    ds_read_b64_tr_b16 v[172:173], v14 offset:27840
    v_mfma_f32_16x16x32_bf16 v[92:95], v[156:159], a[188:191], v[92:95]
    s_waitcnt lgkmcnt(7)
    ds_read_b64_tr_b16 v[174:175], v14 offset:32448
    v_mfma_f32_16x16x32_bf16 v[208:211], v[40:43], a[192:195], v[208:211]
    s_add_u32 m0, s34, 73728
    ds_read_b64_tr_b16 v[32:33], v14 offset:224
    v_mfma_f32_16x16x32_bf16 v[208:211], v[44:47], a[200:203], v[208:211]
    s_nop 0
    ds_read_b64_tr_b16 v[34:35], v14 offset:4832
    buffer_load_dwordx4 v56, s[12:15], s48 offen  lds
    v_mfma_f32_16x16x32_bf16 v[208:211], v[160:163], a[208:211], v[208:211]
    ds_read_b64_tr_b16 v[36:37], v14 offset:9440
    v_mfma_f32_16x16x32_bf16 v[208:211], v[164:167], a[216:219], v[208:211]
    s_add_u32 m0, s34, 74752
    ds_read_b64_tr_b16 v[38:39], v14 offset:14048
    v_mfma_f32_16x16x32_bf16 v[212:215], v[40:43], a[196:199], v[212:215]
    ds_read_b64_tr_b16 v[152:153], v14 offset:18656
    v_mfma_f32_16x16x32_bf16 v[212:215], v[44:47], a[204:207], v[212:215]
    s_nop 0
    ds_read_b64_tr_b16 v[154:155], v14 offset:23264
    buffer_load_dwordx4 v57, s[12:15], s48 offen  lds
    v_mfma_f32_16x16x32_bf16 v[212:215], v[160:163], a[212:215], v[212:215]
    ds_read_b64_tr_b16 v[156:157], v14 offset:27872
    v_mfma_f32_16x16x32_bf16 v[212:215], v[164:167], a[220:223], v[212:215]
    s_waitcnt lgkmcnt(7)
    ds_read_b64_tr_b16 v[158:159], v14 offset:32480
    v_mfma_f32_16x16x32_bf16 v[192:195], v[48:51], a[192:195], v[192:195]
    s_add_u32 m0, s34, 75776
    ds_read_b64_tr_b16 v[40:41], v14 offset:128
    v_mfma_f32_16x16x32_bf16 v[192:195], v[52:55], a[200:203], v[192:195]
    ds_read_b64_tr_b16 v[42:43], v14 offset:4736
    v_mfma_f32_16x16x32_bf16 v[192:195], v[168:171], a[208:211], v[192:195]
    s_nop 0
    ds_read_b64_tr_b16 v[44:45], v14 offset:9344
    buffer_load_dwordx4 v58, s[12:15], s48 offen  lds
    v_mfma_f32_16x16x32_bf16 v[192:195], v[172:175], a[216:219], v[192:195]
    ds_read_b64_tr_b16 v[46:47], v14 offset:13952
    v_mfma_f32_16x16x32_bf16 v[196:199], v[48:51], a[196:199], v[196:199]
    s_add_u32 m0, s34, 76800
    ds_read_b64_tr_b16 v[160:161], v14 offset:18560
    v_mfma_f32_16x16x32_bf16 v[196:199], v[52:55], a[204:207], v[196:199]
    ds_read_b64_tr_b16 v[162:163], v14 offset:23168
    v_mfma_f32_16x16x32_bf16 v[196:199], v[168:171], a[212:215], v[196:199]
    s_nop 0
    ds_read_b64_tr_b16 v[164:165], v14 offset:27776
    buffer_load_dwordx4 v59, s[12:15], s48 offen  lds
    v_mfma_f32_16x16x32_bf16 v[196:199], v[172:175], a[220:223], v[196:199]
    s_waitcnt lgkmcnt(7)
    ds_read_b64_tr_b16 v[166:167], v14 offset:32384
    v_mfma_f32_16x16x32_bf16 v[200:203], v[32:35], a[192:195], v[200:203]
    s_add_u32 m0, s34, 77824
    ds_read_b64_tr_b16 v[48:49], v14 offset:160
    v_mfma_f32_16x16x32_bf16 v[200:203], v[36:39], a[200:203], v[200:203]
    ds_read_b64_tr_b16 v[50:51], v14 offset:4768
    v_mfma_f32_16x16x32_bf16 v[200:203], v[152:155], a[208:211], v[200:203]
    s_nop 0
    ds_read_b64_tr_b16 v[52:53], v14 offset:9376
    buffer_load_dwordx4 v61, s[12:15], s48 offen  lds
    v_mfma_f32_16x16x32_bf16 v[200:203], v[156:159], a[216:219], v[200:203]
    ds_read_b64_tr_b16 v[54:55], v14 offset:13984
    v_mfma_f32_16x16x32_bf16 v[204:207], v[32:35], a[196:199], v[204:207]
    s_add_u32 m0, s34, 78848
    ds_read_b64_tr_b16 v[168:169], v14 offset:18592
    v_mfma_f32_16x16x32_bf16 v[204:207], v[36:39], a[204:207], v[204:207]
    ds_read_b64_tr_b16 v[170:171], v14 offset:23200
    v_mfma_f32_16x16x32_bf16 v[204:207], v[152:155], a[212:215], v[204:207]
    s_nop 0
    ds_read_b64_tr_b16 v[172:173], v14 offset:27808
    buffer_load_dwordx4 v63, s[12:15], s48 offen  lds
    v_mfma_f32_16x16x32_bf16 v[204:207], v[156:159], a[220:223], v[204:207]
    s_waitcnt lgkmcnt(7)
    ds_read_b64_tr_b16 v[174:175], v14 offset:32416
    v_mfma_f32_16x16x32_bf16 v[176:179], v[40:43], a[192:195], v[176:179]
    s_add_u32 m0, s34, 79872
    ds_read_b64_tr_b16 v[32:33], v14 offset:64
    v_mfma_f32_16x16x32_bf16 v[176:179], v[44:47], a[200:203], v[176:179]
    ds_read_b64_tr_b16 v[34:35], v14 offset:4672
    v_mfma_f32_16x16x32_bf16 v[176:179], v[160:163], a[208:211], v[176:179]
    s_nop 0
    ds_read_b64_tr_b16 v[36:37], v14 offset:9280
    buffer_load_dwordx4 v6, s[12:15], s48 offen  lds
    v_mfma_f32_16x16x32_bf16 v[176:179], v[164:167], a[216:219], v[176:179]
    ds_read_b64_tr_b16 v[38:39], v14 offset:13888
    v_mfma_f32_16x16x32_bf16 v[180:183], v[40:43], a[196:199], v[180:183]
    s_add_u32 m0, s34, 80896
    ds_read_b64_tr_b16 v[152:153], v14 offset:18496
    v_mfma_f32_16x16x32_bf16 v[180:183], v[44:47], a[204:207], v[180:183]
    ds_read_b64_tr_b16 v[154:155], v14 offset:23104
    v_mfma_f32_16x16x32_bf16 v[180:183], v[160:163], a[212:215], v[180:183]
    s_nop 0
    ds_read_b64_tr_b16 v[156:157], v14 offset:27712
    buffer_load_dwordx4 v7, s[12:15], s48 offen  lds
    v_mfma_f32_16x16x32_bf16 v[180:183], v[164:167], a[220:223], v[180:183]
    s_waitcnt lgkmcnt(7)
    ds_read_b64_tr_b16 v[158:159], v14 offset:32320
    v_mfma_f32_16x16x32_bf16 v[184:187], v[48:51], a[192:195], v[184:187]
    s_add_u32 m0, s34, 81920
    ds_read_b64_tr_b16 v[40:41], v14 offset:96
    v_mfma_f32_16x16x32_bf16 v[184:187], v[52:55], a[200:203], v[184:187]
    ds_read_b64_tr_b16 v[42:43], v14 offset:4704
    v_mfma_f32_16x16x32_bf16 v[184:187], v[168:171], a[208:211], v[184:187]
    s_nop 0
    ds_read_b64_tr_b16 v[44:45], v14 offset:9312
    buffer_load_dwordx4 v12, s[12:15], s48 offen  lds
    v_mfma_f32_16x16x32_bf16 v[184:187], v[172:175], a[216:219], v[184:187]
    ds_read_b64_tr_b16 v[46:47], v14 offset:13920
    v_mfma_f32_16x16x32_bf16 v[188:191], v[48:51], a[196:199], v[188:191]
    ds_read_b64_tr_b16 v[160:161], v14 offset:18528
    v_mfma_f32_16x16x32_bf16 v[188:191], v[52:55], a[204:207], v[188:191]
    ds_read_b64_tr_b16 v[162:163], v14 offset:23136
    v_mfma_f32_16x16x32_bf16 v[188:191], v[168:171], a[212:215], v[188:191]
    s_nop 0
    ds_read_b64_tr_b16 v[164:165], v14 offset:27744
    buffer_load_dwordx4 v[96:99], v25, s[16:19], s62 offen offset:0 sc1
    v_mfma_f32_16x16x32_bf16 v[188:191], v[172:175], a[220:223], v[188:191]
    s_waitcnt vmcnt(18) lgkmcnt(7)
    s_barrier
    ds_read_b64_tr_b16 v[166:167], v14 offset:32352
    v_mfma_f32_16x16x32_bf16 v[80:83], v[32:35], a[192:195], v[80:83]
    ds_read_b64_tr_b16 v[48:49], v15 offset:256
    v_mfma_f32_16x16x32_bf16 v[80:83], v[36:39], a[200:203], v[80:83]
    ds_read_b64_tr_b16 v[50:51], v15 offset:4864
    v_mfma_f32_16x16x32_bf16 v[80:83], v[152:155], a[208:211], v[80:83]
    s_nop 0
    ds_read_b64_tr_b16 v[52:53], v15 offset:9472
    buffer_load_dwordx4 v[100:103], v25, s[16:19], s63 offen offset:0 sc1
    v_mfma_f32_16x16x32_bf16 v[80:83], v[156:159], a[216:219], v[80:83]
    ds_read_b64_tr_b16 v[54:55], v15 offset:14080
    v_mfma_f32_16x16x32_bf16 v[84:87], v[32:35], a[196:199], v[84:87]
    ds_read_b64_tr_b16 v[168:169], v15 offset:18688
    v_mfma_f32_16x16x32_bf16 v[84:87], v[36:39], a[204:207], v[84:87]
    ds_read_b64_tr_b16 v[170:171], v15 offset:23296
    v_mfma_f32_16x16x32_bf16 v[84:87], v[152:155], a[212:215], v[84:87]
    s_nop 0
    ds_read_b64_tr_b16 v[172:173], v15 offset:27904
    buffer_load_dwordx4 v[104:107], v27, s[16:19], s62 offen offset:1024 sc1
    v_mfma_f32_16x16x32_bf16 v[84:87], v[156:159], a[220:223], v[84:87]
    s_waitcnt lgkmcnt(7)
    ds_read_b64_tr_b16 v[174:175], v15 offset:32512
    v_mfma_f32_16x16x32_bf16 v[88:91], v[40:43], a[192:195], v[88:91]
    ds_read_b64_tr_b16 v[32:33], v15 offset:192
    v_mfma_f32_16x16x32_bf16 v[88:91], v[44:47], a[200:203], v[88:91]
    ds_read_b64_tr_b16 v[34:35], v15 offset:4800
    v_mfma_f32_16x16x32_bf16 v[88:91], v[160:163], a[208:211], v[88:91]
    ds_read_b64_tr_b16 v[36:37], v15 offset:9408
    v_mfma_f32_16x16x32_bf16 v[88:91], v[164:167], a[216:219], v[88:91]
    s_nop 0
    ds_read_b64_tr_b16 v[38:39], v15 offset:14016
    buffer_load_dwordx4 v[108:111], v27, s[16:19], s63 offen offset:1024 sc1
    v_mfma_f32_16x16x32_bf16 v[92:95], v[40:43], a[196:199], v[92:95]
    ds_read_b64_tr_b16 v[152:153], v15 offset:18624
    v_mfma_f32_16x16x32_bf16 v[92:95], v[44:47], a[204:207], v[92:95]
    s_waitcnt vmcnt(13)
    ds_read_b64_tr_b16 v[154:155], v15 offset:23232
    v_mfma_f32_16x16x32_bf16 v[92:95], v[160:163], a[212:215], v[92:95]
    ds_read_b64_tr_b16 v[156:157], v15 offset:27840
    v_mfma_f32_16x16x32_bf16 v[92:95], v[164:167], a[220:223], v[92:95]
    s_waitcnt lgkmcnt(7)
    ds_read_b64_tr_b16 v[158:159], v15 offset:32448
    buffer_load_dwordx4 v[112:115], v25, s[16:19], s64 offen offset:0 sc1
    v_mfma_f32_16x16x32_bf16 v[208:211], v[48:51], a[224:227], v[208:211]
    ds_read_b64_tr_b16 v[40:41], v15 offset:224
    v_mfma_f32_16x16x32_bf16 v[208:211], v[52:55], a[232:235], v[208:211]
    ds_read_b64_tr_b16 v[42:43], v15 offset:4832
    v_mfma_f32_16x16x32_bf16 v[208:211], v[168:171], a[240:243], v[208:211]
    ds_read_b64_tr_b16 v[44:45], v15 offset:9440
    v_mfma_f32_16x16x32_bf16 v[208:211], v[172:175], a[248:251], v[208:211]
    s_nop 0
    ds_read_b64_tr_b16 v[46:47], v15 offset:14048
    buffer_load_dwordx4 v[116:119], v25, s[16:19], s65 offen offset:0 sc1
    v_mfma_f32_16x16x32_bf16 v[212:215], v[48:51], a[228:231], v[212:215]
    ds_read_b64_tr_b16 v[160:161], v15 offset:18656
    v_mfma_f32_16x16x32_bf16 v[212:215], v[52:55], a[236:239], v[212:215]
    ds_read_b64_tr_b16 v[162:163], v15 offset:23264
    v_mfma_f32_16x16x32_bf16 v[212:215], v[168:171], a[244:247], v[212:215]
    ds_read_b64_tr_b16 v[164:165], v15 offset:27872
    v_mfma_f32_16x16x32_bf16 v[212:215], v[172:175], a[252:255], v[212:215]
    s_waitcnt lgkmcnt(7)
    ds_read_b64_tr_b16 v[166:167], v15 offset:32480
    buffer_load_dwordx4 v[120:123], v27, s[16:19], s64 offen offset:1024 sc1
    v_mfma_f32_16x16x32_bf16 v[192:195], v[32:35], a[224:227], v[192:195]
    ds_read_b64_tr_b16 v[48:49], v15 offset:128
    v_mfma_f32_16x16x32_bf16 v[192:195], v[36:39], a[232:235], v[192:195]
    ds_read_b64_tr_b16 v[50:51], v15 offset:4736
    v_mfma_f32_16x16x32_bf16 v[192:195], v[152:155], a[240:243], v[192:195]
    ds_read_b64_tr_b16 v[52:53], v15 offset:9344
    v_mfma_f32_16x16x32_bf16 v[192:195], v[156:159], a[248:251], v[192:195]
    s_nop 0
    ds_read_b64_tr_b16 v[54:55], v15 offset:13952
    buffer_load_dwordx4 v[124:127], v27, s[16:19], s65 offen offset:1024 sc1
    v_mfma_f32_16x16x32_bf16 v[196:199], v[32:35], a[228:231], v[196:199]
    ds_read_b64_tr_b16 v[168:169], v15 offset:18560
    v_mfma_f32_16x16x32_bf16 v[196:199], v[36:39], a[236:239], v[196:199]
    ds_read_b64_tr_b16 v[170:171], v15 offset:23168
    v_mfma_f32_16x16x32_bf16 v[196:199], v[152:155], a[244:247], v[196:199]
    ds_read_b64_tr_b16 v[172:173], v15 offset:27776
    v_mfma_f32_16x16x32_bf16 v[196:199], v[156:159], a[252:255], v[196:199]
    s_waitcnt lgkmcnt(7)
    ds_read_b64_tr_b16 v[174:175], v15 offset:32384
    v_mfma_f32_16x16x32_bf16 v[200:203], v[40:43], a[224:227], v[200:203]
    ds_read_b64_tr_b16 v[32:33], v15 offset:160
    v_mfma_f32_16x16x32_bf16 v[200:203], v[44:47], a[232:235], v[200:203]
    ds_read_b64_tr_b16 v[34:35], v15 offset:4768
    v_mfma_f32_16x16x32_bf16 v[200:203], v[160:163], a[240:243], v[200:203]
    ds_read_b64_tr_b16 v[36:37], v15 offset:9376
    v_mfma_f32_16x16x32_bf16 v[200:203], v[164:167], a[248:251], v[200:203]
    s_nop 0
    ds_read_b64_tr_b16 v[38:39], v15 offset:13984
    buffer_load_dwordx2 v[128:129], v19, s[16:19], s50 offen offset:0 sc1
    v_mfma_f32_16x16x32_bf16 v[204:207], v[40:43], a[228:231], v[204:207]
    s_nop 0
    ds_read_b64_tr_b16 v[152:153], v15 offset:18592
    buffer_load_dwordx2 v[130:131], v19, s[16:19], s51 offen offset:0 sc1
    v_mfma_f32_16x16x32_bf16 v[204:207], v[44:47], a[236:239], v[204:207]
    s_nop 0
    ds_read_b64_tr_b16 v[154:155], v15 offset:23200
    buffer_load_dwordx2 v[132:133], v19, s[16:19], s50 offen offset:512 sc1
    v_mfma_f32_16x16x32_bf16 v[204:207], v[160:163], a[244:247], v[204:207]
    s_nop 0
    ds_read_b64_tr_b16 v[156:157], v15 offset:27808
    buffer_load_dwordx2 v[134:135], v19, s[16:19], s51 offen offset:512 sc1
    v_mfma_f32_16x16x32_bf16 v[204:207], v[164:167], a[252:255], v[204:207]
    s_waitcnt lgkmcnt(7)
    ds_read_b64_tr_b16 v[158:159], v15 offset:32416
    buffer_load_dwordx2 v[136:137], v19, s[16:19], s36 offen sc1
    v_mfma_f32_16x16x32_bf16 v[176:179], v[48:51], a[224:227], v[176:179]
    s_nop 0
    ds_read_b64_tr_b16 v[40:41], v15 offset:64
    buffer_load_dwordx2 v[138:139], v19, s[16:19], s37 offen sc1
    v_mfma_f32_16x16x32_bf16 v[176:179], v[52:55], a[232:235], v[176:179]
    s_nop 0
    ds_read_b64_tr_b16 v[42:43], v15 offset:4672
    buffer_load_dwordx4 v[216:219], v20, s[16:19], s53 offen offset:0 sc1
    v_mfma_f32_16x16x32_bf16 v[176:179], v[168:171], a[240:243], v[176:179]
    s_nop 0
    ds_read_b64_tr_b16 v[44:45], v15 offset:9280
    buffer_load_dwordx4 v[220:223], v20, s[16:19], s53 offen offset:64 sc1
    v_mfma_f32_16x16x32_bf16 v[176:179], v[172:175], a[248:251], v[176:179]
    s_nop 0
    ds_read_b64_tr_b16 v[46:47], v15 offset:13888
    buffer_load_dwordx4 v[140:143], v20, s[16:19], s52 offen offset:512 sc1
    v_mfma_f32_16x16x32_bf16 v[180:183], v[48:51], a[228:231], v[180:183]
    ds_read_b64_tr_b16 v[160:161], v15 offset:18496
    v_mfma_f32_16x16x32_bf16 v[180:183], v[52:55], a[236:239], v[180:183]
    ds_read_b64_tr_b16 v[162:163], v15 offset:23104
    v_mfma_f32_16x16x32_bf16 v[180:183], v[168:171], a[244:247], v[180:183]
    ds_read_b64_tr_b16 v[164:165], v15 offset:27712
    v_mfma_f32_16x16x32_bf16 v[180:183], v[172:175], a[252:255], v[180:183]
    s_waitcnt lgkmcnt(7)
    ds_read_b64_tr_b16 v[166:167], v15 offset:32320
    v_mfma_f32_16x16x32_bf16 v[184:187], v[32:35], a[224:227], v[184:187]
    ds_read_b64_tr_b16 v[48:49], v15 offset:96
    v_mfma_f32_16x16x32_bf16 v[184:187], v[36:39], a[232:235], v[184:187]
    ds_read_b64_tr_b16 v[50:51], v15 offset:4704
    v_mfma_f32_16x16x32_bf16 v[184:187], v[152:155], a[240:243], v[184:187]
    ds_read_b64_tr_b16 v[52:53], v15 offset:9312
    v_mfma_f32_16x16x32_bf16 v[184:187], v[156:159], a[248:251], v[184:187]
    ds_read_b64_tr_b16 v[54:55], v15 offset:13920
    v_mfma_f32_16x16x32_bf16 v[188:191], v[32:35], a[228:231], v[188:191]
    ds_read_b64_tr_b16 v[168:169], v15 offset:18528
    v_mfma_f32_16x16x32_bf16 v[188:191], v[36:39], a[236:239], v[188:191]
    ds_read_b64_tr_b16 v[170:171], v15 offset:23136
    v_mfma_f32_16x16x32_bf16 v[188:191], v[152:155], a[244:247], v[188:191]
    ds_read_b64_tr_b16 v[172:173], v15 offset:27744
    v_mfma_f32_16x16x32_bf16 v[188:191], v[156:159], a[252:255], v[188:191]
    s_waitcnt vmcnt(17) lgkmcnt(7)
    s_barrier
    ds_read_b64_tr_b16 v[174:175], v15 offset:32352
    v_mfma_f32_16x16x32_bf16 v[80:83], v[40:43], a[224:227], v[80:83]
    ds_read_b64_tr_b16 v[32:33], v144 offset:256
    v_mfma_f32_16x16x32_bf16 v[80:83], v[44:47], a[232:235], v[80:83]
    ds_read_b64_tr_b16 v[34:35], v144 offset:4864
    v_mfma_f32_16x16x32_bf16 v[80:83], v[160:163], a[240:243], v[80:83]
    ds_read_b64_tr_b16 v[36:37], v144 offset:9472
    v_mfma_f32_16x16x32_bf16 v[80:83], v[164:167], a[248:251], v[80:83]
    ds_read_b64_tr_b16 v[38:39], v144 offset:14080
    v_mfma_f32_16x16x32_bf16 v[84:87], v[40:43], a[228:231], v[84:87]
    ds_read_b64_tr_b16 v[152:153], v144 offset:18688
    v_mfma_f32_16x16x32_bf16 v[84:87], v[44:47], a[236:239], v[84:87]
    ds_read_b64_tr_b16 v[154:155], v144 offset:23296
    v_mfma_f32_16x16x32_bf16 v[84:87], v[160:163], a[244:247], v[84:87]
    ds_read_b64_tr_b16 v[156:157], v144 offset:27904
    v_mfma_f32_16x16x32_bf16 v[84:87], v[164:167], a[252:255], v[84:87]
    s_waitcnt lgkmcnt(7)
    ds_read_b64_tr_b16 v[158:159], v144 offset:32512
    v_mfma_f32_16x16x32_bf16 v[88:91], v[48:51], a[224:227], v[88:91]
    ds_read_b64_tr_b16 v[40:41], v144 offset:192
    v_mfma_f32_16x16x32_bf16 v[88:91], v[52:55], a[232:235], v[88:91]
    ds_read_b64_tr_b16 v[42:43], v144 offset:4800
    v_mfma_f32_16x16x32_bf16 v[88:91], v[168:171], a[240:243], v[88:91]
    ds_read_b64_tr_b16 v[44:45], v144 offset:9408
    v_mfma_f32_16x16x32_bf16 v[88:91], v[172:175], a[248:251], v[88:91]
    ds_read_b64_tr_b16 v[46:47], v144 offset:14016
    v_mfma_f32_16x16x32_bf16 v[92:95], v[48:51], a[228:231], v[92:95]
    ds_read_b64_tr_b16 v[160:161], v144 offset:18624
    v_mfma_f32_16x16x32_bf16 v[92:95], v[52:55], a[236:239], v[92:95]
    s_waitcnt vmcnt(9)
    ds_read_b64_tr_b16 v[162:163], v144 offset:23232
    v_mfma_f32_16x16x32_bf16 v[92:95], v[168:171], a[244:247], v[92:95]
    ds_read_b64_tr_b16 v[164:165], v144 offset:27840
    v_mfma_f32_16x16x32_bf16 v[92:95], v[172:175], a[252:255], v[92:95]
    s_waitcnt lgkmcnt(7)
    ds_read_b64_tr_b16 v[166:167], v144 offset:32448
    v_mfma_f32_16x16x32_bf16 v[208:211], v[32:35], v[96:99], v[208:211]
    ds_read_b64_tr_b16 v[48:49], v144 offset:224
    v_mfma_f32_16x16x32_bf16 v[208:211], v[36:39], v[104:107], v[208:211]
    ds_read_b64_tr_b16 v[50:51], v144 offset:4832
    v_mfma_f32_16x16x32_bf16 v[208:211], v[152:155], v[112:115], v[208:211]
    ds_read_b64_tr_b16 v[52:53], v144 offset:9440
    v_mfma_f32_16x16x32_bf16 v[208:211], v[156:159], v[120:123], v[208:211]
    ds_read_b64_tr_b16 v[54:55], v144 offset:14048
    v_mfma_f32_16x16x32_bf16 v[212:215], v[32:35], v[100:103], v[212:215]
    ds_read_b64_tr_b16 v[168:169], v144 offset:18656
    v_mfma_f32_16x16x32_bf16 v[212:215], v[36:39], v[108:111], v[212:215]
    ds_read_b64_tr_b16 v[170:171], v144 offset:23264
    v_mfma_f32_16x16x32_bf16 v[212:215], v[152:155], v[116:119], v[212:215]
    ds_read_b64_tr_b16 v[172:173], v144 offset:27872
    v_mfma_f32_16x16x32_bf16 v[212:215], v[156:159], v[124:127], v[212:215]
    s_waitcnt lgkmcnt(7)
    ds_read_b64_tr_b16 v[174:175], v144 offset:32480
    v_mfma_f32_16x16x32_bf16 v[192:195], v[40:43], v[96:99], v[192:195]
    ds_read_b64_tr_b16 v[32:33], v144 offset:128
    v_mfma_f32_16x16x32_bf16 v[192:195], v[44:47], v[104:107], v[192:195]
    ds_read_b64_tr_b16 v[34:35], v144 offset:4736
    v_mfma_f32_16x16x32_bf16 v[192:195], v[160:163], v[112:115], v[192:195]
    ds_read_b64_tr_b16 v[36:37], v144 offset:9344
    v_cvt_pk_bf16_f32 v28, v208, v209
    v_mfma_f32_16x16x32_bf16 v[192:195], v[164:167], v[120:123], v[192:195]
    ds_read_b64_tr_b16 v[38:39], v144 offset:13952
    v_cvt_pk_bf16_f32 v29, v210, v211
    v_mfma_f32_16x16x32_bf16 v[196:199], v[40:43], v[100:103], v[196:199]
    ds_read_b64_tr_b16 v[152:153], v144 offset:18560
    v_cvt_pk_bf16_f32 v30, v212, v213
    v_mfma_f32_16x16x32_bf16 v[196:199], v[44:47], v[108:111], v[196:199]
    ds_read_b64_tr_b16 v[154:155], v144 offset:23168
    v_cvt_pk_bf16_f32 v31, v214, v215
    v_mfma_f32_16x16x32_bf16 v[196:199], v[160:163], v[116:119], v[196:199]
    ds_read_b64_tr_b16 v[156:157], v144 offset:27776
    v_mov_b32 v234, v28
    v_mfma_f32_16x16x32_bf16 v[196:199], v[164:167], v[124:127], v[196:199]
    s_waitcnt lgkmcnt(7)
    ds_read_b64_tr_b16 v[158:159], v144 offset:32384
    v_mov_b32 v236, v29
    v_mfma_f32_16x16x32_bf16 v[200:203], v[48:51], v[96:99], v[200:203]
    ds_read_b64_tr_b16 v[40:41], v144 offset:160
    v_mov_b32 v237, v30
    v_mfma_f32_16x16x32_bf16 v[200:203], v[52:55], v[104:107], v[200:203]
    ds_read_b64_tr_b16 v[42:43], v144 offset:4768
    v_mov_b32 v238, v31
    v_mfma_f32_16x16x32_bf16 v[200:203], v[168:171], v[112:115], v[200:203]
    ds_read_b64_tr_b16 v[44:45], v144 offset:9376
    v_cvt_pk_bf16_f32 v224, v192, v193
    v_mfma_f32_16x16x32_bf16 v[200:203], v[172:175], v[120:123], v[200:203]
    ds_read_b64_tr_b16 v[46:47], v144 offset:13984
    v_cvt_pk_bf16_f32 v225, v194, v195
    v_mfma_f32_16x16x32_bf16 v[204:207], v[48:51], v[100:103], v[204:207]
    ds_read_b64_tr_b16 v[160:161], v144 offset:18592
    v_cvt_pk_bf16_f32 v226, v196, v197
    v_mfma_f32_16x16x32_bf16 v[204:207], v[52:55], v[108:111], v[204:207]
    s_nop 0
    ds_read_b64_tr_b16 v[162:163], v144 offset:23200
    buffer_store_dwordx4 v[224:227], v9, s[16:19], s79 offen offset:0 sc1
    v_mfma_f32_16x16x32_bf16 v[204:207], v[168:171], v[116:119], v[204:207]
    ds_read_b64_tr_b16 v[164:165], v144 offset:27808
    v_cvt_pk_bf16_f32 v228, v198, v199
    v_mfma_f32_16x16x32_bf16 v[204:207], v[172:175], v[124:127], v[204:207]
    s_waitcnt lgkmcnt(7)
    ds_read_b64_tr_b16 v[166:167], v144 offset:32416
    v_mov_b32 v250, v28
    v_mfma_f32_16x16x32_bf16 v[176:179], v[32:35], v[96:99], v[176:179]
    ds_read_b64_tr_b16 v[48:49], v144 offset:64
    v_mov_b32 v252, v29
    v_mfma_f32_16x16x32_bf16 v[176:179], v[36:39], v[104:107], v[176:179]
    ds_read_b64_tr_b16 v[50:51], v144 offset:4672
    v_mov_b32 v253, v30
    v_mfma_f32_16x16x32_bf16 v[176:179], v[152:155], v[112:115], v[176:179]
    ds_read_b64_tr_b16 v[52:53], v144 offset:9280
    v_cvt_pk_bf16_f32 v229, v200, v201
    v_mfma_f32_16x16x32_bf16 v[176:179], v[156:159], v[120:123], v[176:179]
    ds_read_b64_tr_b16 v[54:55], v144 offset:13888
    v_cvt_pk_bf16_f32 v230, v202, v203
    v_mfma_f32_16x16x32_bf16 v[180:183], v[32:35], v[100:103], v[180:183]
    s_nop 0
    ds_read_b64_tr_b16 v[168:169], v144 offset:18496
    buffer_store_dwordx4 v[228:231], v9, s[16:19], s79 offen offset:1024 sc1
    v_mfma_f32_16x16x32_bf16 v[180:183], v[36:39], v[108:111], v[180:183]
    ds_read_b64_tr_b16 v[170:171], v144 offset:23104
    v_cvt_pk_bf16_f32 v232, v204, v205
    v_mfma_f32_16x16x32_bf16 v[180:183], v[152:155], v[116:119], v[180:183]
    ds_read_b64_tr_b16 v[172:173], v144 offset:27712
    v_cvt_pk_bf16_f32 v233, v206, v207
    v_mfma_f32_16x16x32_bf16 v[180:183], v[156:159], v[124:127], v[180:183]
    s_waitcnt lgkmcnt(7)
    ds_read_b64_tr_b16 v[174:175], v144 offset:32320
    buffer_store_dwordx4 v[232:235], v9, s[16:19], s79 offen offset:2048 sc1
    v_mfma_f32_16x16x32_bf16 v[184:187], v[40:43], v[96:99], v[184:187]
    s_nop 0
    ds_read_b64_tr_b16 v[32:33], v144 offset:96
    buffer_store_dwordx4 v[236:239], v9, s[16:19], s83 offen offset:3072 sc1
    v_mfma_f32_16x16x32_bf16 v[184:187], v[44:47], v[104:107], v[184:187]
    ds_read_b64_tr_b16 v[34:35], v144 offset:4704
    v_mov_b32 v254, v31
    v_mfma_f32_16x16x32_bf16 v[184:187], v[160:163], v[112:115], v[184:187]
    ds_read_b64_tr_b16 v[36:37], v144 offset:9312
    v_cvt_pk_bf16_f32 v240, v176, v177
    v_mfma_f32_16x16x32_bf16 v[184:187], v[164:167], v[120:123], v[184:187]
    ds_read_b64_tr_b16 v[38:39], v144 offset:13920
    v_cvt_pk_bf16_f32 v241, v178, v179
    v_mfma_f32_16x16x32_bf16 v[188:191], v[40:43], v[100:103], v[188:191]
    ds_read_b64_tr_b16 v[152:153], v144 offset:18528
    v_cvt_pk_bf16_f32 v242, v180, v181
    v_mfma_f32_16x16x32_bf16 v[188:191], v[44:47], v[108:111], v[188:191]
    s_nop 0
    ds_read_b64_tr_b16 v[154:155], v144 offset:23136
    buffer_store_dwordx4 v[240:243], v9, s[16:19], s78 offen offset:0 sc1
    v_mfma_f32_16x16x32_bf16 v[188:191], v[160:163], v[116:119], v[188:191]
    ds_read_b64_tr_b16 v[156:157], v144 offset:27744
    v_cvt_pk_bf16_f32 v244, v182, v183
    v_mfma_f32_16x16x32_bf16 v[188:191], v[164:167], v[124:127], v[188:191]
    s_waitcnt lgkmcnt(7)
    ds_read_b64_tr_b16 v[158:159], v144 offset:32352
    v_mov_b32 v234, v28
    v_mfma_f32_16x16x32_bf16 v[80:83], v[48:51], v[96:99], v[80:83]
    ds_read_b64_tr_b16 v[40:41], v145 offset:0
    v_mov_b32 v236, v29
    v_mfma_f32_16x16x32_bf16 v[80:83], v[52:55], v[104:107], v[80:83]
    ds_read_b64_tr_b16 v[42:43], v145 offset:4608
    v_mov_b32 v237, v30
    v_mfma_f32_16x16x32_bf16 v[80:83], v[168:171], v[112:115], v[80:83]
    ds_read_b64_tr_b16 v[44:45], v145 offset:9216
    v_cvt_pk_bf16_f32 v245, v184, v185
    v_mfma_f32_16x16x32_bf16 v[80:83], v[172:175], v[120:123], v[80:83]
    ds_read_b64_tr_b16 v[46:47], v145 offset:13824
    v_cvt_pk_bf16_f32 v246, v186, v187
    v_mfma_f32_16x16x32_bf16 v[84:87], v[48:51], v[100:103], v[84:87]
    s_nop 0
    ds_read_b64_tr_b16 v[160:161], v145 offset:18432
    buffer_store_dwordx4 v[244:247], v9, s[16:19], s78 offen offset:1024 sc1
    v_mfma_f32_16x16x32_bf16 v[84:87], v[52:55], v[108:111], v[84:87]
    ds_read_b64_tr_b16 v[162:163], v145 offset:23040
    v_cvt_pk_bf16_f32 v248, v188, v189
    v_mfma_f32_16x16x32_bf16 v[84:87], v[168:171], v[116:119], v[84:87]
    ds_read_b64_tr_b16 v[164:165], v145 offset:27648
    v_cvt_pk_bf16_f32 v249, v190, v191
    v_mfma_f32_16x16x32_bf16 v[84:87], v[172:175], v[124:127], v[84:87]
    s_waitcnt lgkmcnt(7)
    ds_read_b64_tr_b16 v[166:167], v145 offset:32256
    buffer_store_dwordx4 v[248:251], v9, s[16:19], s78 offen offset:2048 sc1
    v_mfma_f32_16x16x32_bf16 v[88:91], v[32:35], v[96:99], v[88:91]
    s_nop 0
    ds_read_b64_tr_b16 v[48:49], v14 offset:0
    buffer_store_dwordx4 v[252:255], v9, s[16:19], s82 offen offset:3072 sc1
    v_mfma_f32_16x16x32_bf16 v[88:91], v[36:39], v[104:107], v[88:91]
    ds_read_b64_tr_b16 v[50:51], v14 offset:4608
    v_mov_b32 v238, v31
    v_mfma_f32_16x16x32_bf16 v[88:91], v[152:155], v[112:115], v[88:91]
    ds_read_b64_tr_b16 v[52:53], v14 offset:9216
    v_cvt_pk_bf16_f32 v224, v80, v81
    v_mfma_f32_16x16x32_bf16 v[88:91], v[156:159], v[120:123], v[88:91]
    ds_read_b64_tr_b16 v[54:55], v14 offset:13824
    v_cvt_pk_bf16_f32 v225, v82, v83
    v_mfma_f32_16x16x32_bf16 v[92:95], v[32:35], v[100:103], v[92:95]
    ds_read_b64_tr_b16 v[168:169], v14 offset:18432
    v_cvt_pk_bf16_f32 v226, v84, v85
    v_mfma_f32_16x16x32_bf16 v[92:95], v[36:39], v[108:111], v[92:95]
    s_nop 0
    ds_read_b64_tr_b16 v[170:171], v14 offset:23040
    buffer_store_dwordx4 v[224:227], v9, s[16:19], s77 offen offset:0 sc1
    v_mfma_f32_16x16x32_bf16 v[92:95], v[152:155], v[116:119], v[92:95]
    ds_read_b64_tr_b16 v[172:173], v14 offset:27648
    v_cvt_pk_bf16_f32 v228, v86, v87
    v_mfma_f32_16x16x32_bf16 v[92:95], v[156:159], v[124:127], v[92:95]
    s_waitcnt lgkmcnt(7)
    ds_read_b64_tr_b16 v[174:175], v14 offset:32256
    v_mfma_f32_16x16x32_bf16 v[64:67], v[40:43], a[160:163], v[64:67]
    ds_read_b64_tr_b16 v[32:33], v15 offset:0
    v_mfma_f32_16x16x32_bf16 v[64:67], v[44:47], a[168:171], v[64:67]
    ds_read_b64_tr_b16 v[34:35], v15 offset:4608
    v_mfma_f32_16x16x32_bf16 v[64:67], v[160:163], a[176:179], v[64:67]
    ds_read_b64_tr_b16 v[36:37], v15 offset:9216
    v_cvt_pk_bf16_f32 v229, v88, v89
    v_mfma_f32_16x16x32_bf16 v[64:67], v[164:167], a[184:187], v[64:67]
    ds_read_b64_tr_b16 v[38:39], v15 offset:13824
    v_cvt_pk_bf16_f32 v230, v90, v91
    v_mfma_f32_16x16x32_bf16 v[68:71], v[40:43], a[164:167], v[68:71]
    s_nop 0
    ds_read_b64_tr_b16 v[152:153], v15 offset:18432
    buffer_store_dwordx4 v[228:231], v9, s[16:19], s77 offen offset:1024 sc1
    v_mfma_f32_16x16x32_bf16 v[68:71], v[44:47], a[172:175], v[68:71]
    ds_read_b64_tr_b16 v[154:155], v15 offset:23040
    v_cvt_pk_bf16_f32 v232, v92, v93
    v_mfma_f32_16x16x32_bf16 v[68:71], v[160:163], a[180:183], v[68:71]
    ds_read_b64_tr_b16 v[156:157], v15 offset:27648
    v_cvt_pk_bf16_f32 v233, v94, v95
    v_mfma_f32_16x16x32_bf16 v[68:71], v[164:167], a[188:191], v[68:71]
    s_waitcnt lgkmcnt(7)
    ds_read_b64_tr_b16 v[158:159], v15 offset:32256
    buffer_store_dwordx4 v[232:235], v9, s[16:19], s77 offen offset:2048 sc1
    v_mfma_f32_16x16x32_bf16 v[64:67], v[48:51], a[192:195], v[64:67]
    s_nop 0
    ds_read_b64_tr_b16 v[40:41], v144 offset:0
    buffer_store_dwordx4 v[236:239], v9, s[16:19], s81 offen offset:3072 sc1
    v_mfma_f32_16x16x32_bf16 v[64:67], v[52:55], a[200:203], v[64:67]
    ds_read_b64_tr_b16 v[42:43], v144 offset:4608
    v_mfma_f32_16x16x32_bf16 v[64:67], v[168:171], a[208:211], v[64:67]
    ds_read_b64_tr_b16 v[44:45], v144 offset:9216
    v_mfma_f32_16x16x32_bf16 v[64:67], v[172:175], a[216:219], v[64:67]
    ds_read_b64_tr_b16 v[46:47], v144 offset:13824
    v_mfma_f32_16x16x32_bf16 v[68:71], v[48:51], a[196:199], v[68:71]
    ds_read_b64_tr_b16 v[160:161], v144 offset:18432
    v_mfma_f32_16x16x32_bf16 v[68:71], v[52:55], a[204:207], v[68:71]
    ds_read_b64_tr_b16 v[162:163], v144 offset:23040
    v_mfma_f32_16x16x32_bf16 v[68:71], v[168:171], a[212:215], v[68:71]
    ds_read_b64_tr_b16 v[164:165], v144 offset:27648
    v_mfma_f32_16x16x32_bf16 v[68:71], v[172:175], a[220:223], v[68:71]
    s_waitcnt lgkmcnt(7)
    ds_read_b64_tr_b16 v[166:167], v144 offset:32256
    v_mfma_f32_16x16x32_bf16 v[64:67], v[32:35], a[224:227], v[64:67]
    ds_read_b64_tr_b16 v[48:49], v145 offset:32
    v_mfma_f32_16x16x32_bf16 v[64:67], v[36:39], a[232:235], v[64:67]
    ds_read_b64_tr_b16 v[50:51], v145 offset:4640
    v_mfma_f32_16x16x32_bf16 v[64:67], v[152:155], a[240:243], v[64:67]
    ds_read_b64_tr_b16 v[52:53], v145 offset:9248
    v_mfma_f32_16x16x32_bf16 v[64:67], v[156:159], a[248:251], v[64:67]
    ds_read_b64_tr_b16 v[54:55], v145 offset:13856
    v_mfma_f32_16x16x32_bf16 v[68:71], v[32:35], a[228:231], v[68:71]
    ds_read_b64_tr_b16 v[168:169], v145 offset:18464
    v_mfma_f32_16x16x32_bf16 v[68:71], v[36:39], a[236:239], v[68:71]
    ds_read_b64_tr_b16 v[170:171], v145 offset:23072
    v_mfma_f32_16x16x32_bf16 v[68:71], v[152:155], a[244:247], v[68:71]
    ds_read_b64_tr_b16 v[172:173], v145 offset:27680
    v_mfma_f32_16x16x32_bf16 v[68:71], v[156:159], a[252:255], v[68:71]
    s_waitcnt lgkmcnt(7)
    ds_read_b64_tr_b16 v[174:175], v145 offset:32288
    v_mfma_f32_16x16x32_bf16 v[64:67], v[40:43], v[96:99], v[64:67]
    ds_read_b64_tr_b16 v[32:33], v14 offset:32
    v_mfma_f32_16x16x32_bf16 v[64:67], v[44:47], v[104:107], v[64:67]
    ds_read_b64_tr_b16 v[34:35], v14 offset:4640
    v_mfma_f32_16x16x32_bf16 v[64:67], v[160:163], v[112:115], v[64:67]
    ds_read_b64_tr_b16 v[36:37], v14 offset:9248
    v_mfma_f32_16x16x32_bf16 v[64:67], v[164:167], v[120:123], v[64:67]
    ds_read_b64_tr_b16 v[38:39], v14 offset:13856
    v_mfma_f32_16x16x32_bf16 v[68:71], v[40:43], v[100:103], v[68:71]
    ds_read_b64_tr_b16 v[152:153], v14 offset:18464
    v_mfma_f32_16x16x32_bf16 v[68:71], v[44:47], v[108:111], v[68:71]
    ds_read_b64_tr_b16 v[154:155], v14 offset:23072
    v_mfma_f32_16x16x32_bf16 v[68:71], v[160:163], v[116:119], v[68:71]
    ds_read_b64_tr_b16 v[156:157], v14 offset:27680
    v_mfma_f32_16x16x32_bf16 v[68:71], v[164:167], v[124:127], v[68:71]
    s_waitcnt lgkmcnt(7)
    ds_read_b64_tr_b16 v[158:159], v14 offset:32288
    v_mfma_f32_16x16x32_bf16 v[72:75], v[48:51], a[160:163], v[72:75]
    ds_read_b64_tr_b16 v[40:41], v15 offset:32
    v_mfma_f32_16x16x32_bf16 v[72:75], v[52:55], a[168:171], v[72:75]
    ds_read_b64_tr_b16 v[42:43], v15 offset:4640
    v_mfma_f32_16x16x32_bf16 v[72:75], v[168:171], a[176:179], v[72:75]
    ds_read_b64_tr_b16 v[44:45], v15 offset:9248
    v_mfma_f32_16x16x32_bf16 v[72:75], v[172:175], a[184:187], v[72:75]
    ds_read_b64_tr_b16 v[46:47], v15 offset:13856
    v_mfma_f32_16x16x32_bf16 v[76:79], v[48:51], a[164:167], v[76:79]
    ds_read_b64_tr_b16 v[160:161], v15 offset:18464
    v_mfma_f32_16x16x32_bf16 v[76:79], v[52:55], a[172:175], v[76:79]
    ds_read_b64_tr_b16 v[162:163], v15 offset:23072
    v_mfma_f32_16x16x32_bf16 v[76:79], v[168:171], a[180:183], v[76:79]
    ds_read_b64_tr_b16 v[164:165], v15 offset:27680
    v_mfma_f32_16x16x32_bf16 v[76:79], v[172:175], a[188:191], v[76:79]
    s_waitcnt lgkmcnt(7)
    ds_read_b64_tr_b16 v[166:167], v15 offset:32288
    v_mfma_f32_16x16x32_bf16 v[72:75], v[32:35], a[192:195], v[72:75]
    ds_read_b64_tr_b16 v[48:49], v144 offset:32
    v_mfma_f32_16x16x32_bf16 v[72:75], v[36:39], a[200:203], v[72:75]
    ds_read_b64_tr_b16 v[50:51], v144 offset:4640
    v_mfma_f32_16x16x32_bf16 v[72:75], v[152:155], a[208:211], v[72:75]
    ds_read_b64_tr_b16 v[52:53], v144 offset:9248
    v_mfma_f32_16x16x32_bf16 v[72:75], v[156:159], a[216:219], v[72:75]
    ds_read_b64_tr_b16 v[54:55], v144 offset:13856
    v_mfma_f32_16x16x32_bf16 v[76:79], v[32:35], a[196:199], v[76:79]
    ds_read_b64_tr_b16 v[168:169], v144 offset:18464
    v_mfma_f32_16x16x32_bf16 v[76:79], v[36:39], a[204:207], v[76:79]
    ds_read_b64_tr_b16 v[170:171], v144 offset:23072
    v_mfma_f32_16x16x32_bf16 v[76:79], v[152:155], a[212:215], v[76:79]
    ds_read_b64_tr_b16 v[172:173], v144 offset:27680
    v_mfma_f32_16x16x32_bf16 v[76:79], v[156:159], a[220:223], v[76:79]
    s_waitcnt lgkmcnt(7)
    ds_read_b64_tr_b16 v[174:175], v144 offset:32288
    v_mfma_f32_16x16x32_bf16 v[72:75], v[40:43], a[224:227], v[72:75]
    v_mfma_f32_16x16x32_bf16 v[72:75], v[44:47], a[232:235], v[72:75]
    v_mfma_f32_16x16x32_bf16 v[72:75], v[160:163], a[240:243], v[72:75]
    v_mfma_f32_16x16x32_bf16 v[72:75], v[164:167], a[248:251], v[72:75]
    v_mfma_f32_16x16x32_bf16 v[76:79], v[40:43], a[228:231], v[76:79]
    v_mfma_f32_16x16x32_bf16 v[76:79], v[44:47], a[236:239], v[76:79]
    v_mfma_f32_16x16x32_bf16 v[76:79], v[160:163], a[244:247], v[76:79]
    v_mfma_f32_16x16x32_bf16 v[76:79], v[164:167], a[252:255], v[76:79]
    s_waitcnt lgkmcnt(0)
    v_mfma_f32_16x16x32_bf16 v[72:75], v[48:51], v[96:99], v[72:75]
    v_mfma_f32_16x16x32_bf16 v[72:75], v[52:55], v[104:107], v[72:75]
    v_mfma_f32_16x16x32_bf16 v[72:75], v[168:171], v[112:115], v[72:75]
    v_mfma_f32_16x16x32_bf16 v[72:75], v[172:175], v[120:123], v[72:75]
    v_mfma_f32_16x16x32_bf16 v[76:79], v[48:51], v[100:103], v[76:79]
    v_mfma_f32_16x16x32_bf16 v[76:79], v[52:55], v[108:111], v[76:79]
    v_mfma_f32_16x16x32_bf16 v[76:79], v[168:171], v[116:119], v[76:79]
    v_mfma_f32_16x16x32_bf16 v[76:79], v[172:175], v[124:127], v[76:79]
    s_waitcnt lgkmcnt(0)
    s_mov_b32 s66, 0xffff0000
    s_cmp_eq_u32 s32, 0
    s_cbranch_scc1 adaLN_cond__ssm_conv_h3__glu_gated_geglu__prompt_kernel_own8
    s_movk_i32 s84, 256
    buffer_load_dwordx4 v[32:35], v9, s[16:19], s55 offen offset:0 sc1
    buffer_load_dwordx4 v[36:39], v9, s[16:19], s55 offen offset:1024 sc1
    buffer_load_dwordx4 v[40:43], v9, s[16:19], s55 offen offset:2048 sc1
    buffer_load_dwordx4 v[44:47], v9, s[16:19], s56 offen offset:0 sc1
    buffer_load_dwordx4 v[48:51], v9, s[16:19], s56 offen offset:1024 sc1
    buffer_load_dwordx4 v[52:55], v9, s[16:19], s56 offen offset:2048 sc1
    buffer_load_dwordx4 v[56:59], v9, s[16:19], s57 offen offset:0 sc1
    buffer_load_dwordx4 v[60:63], v9, s[16:19], s57 offen offset:1024 sc1
    buffer_load_dwordx4 v[96:99], v9, s[16:19], s57 offen offset:2048 sc1
    s_waitcnt vmcnt(9)
    v_lshlrev_b32 v224, 16, v128
    v_and_b32 v225, s66, v128
    v_lshlrev_b32 v226, 16, v129
    v_and_b32 v227, s66, v129
    v_lshlrev_b32 v228, 16, v130
    v_and_b32 v229, s66, v130
    v_lshlrev_b32 v230, 16, v131
    v_and_b32 v231, s66, v131
    v_lshlrev_b32 v232, 16, v132
    v_and_b32 v233, s66, v132
    v_lshlrev_b32 v234, 16, v133
    v_and_b32 v235, s66, v133
    v_lshlrev_b32 v236, 16, v134
    v_and_b32 v237, s66, v134
    v_lshlrev_b32 v238, 16, v135
    v_and_b32 v239, s66, v135
    v_bfe_u32 v16, v0, 4, 2
    v_lshlrev_b32 v19, 3, v16
    v_sub_u32 v19, v21, v19
    v_lshrrev_b32 v20, 1, v16
    v_lshl_add_u32 v19, v20, 4, v19
    v_and_b32 v16, 1, v16
    v_lshl_add_u32 v22, v16, 5, v19
    v_add_u32 v23, 18432, v22
    v_mul_u32_u24 v16, 18432, v16
    v_add3_u32 v19, v19, v16, s84
    s_waitcnt vmcnt(0)
    v_min3_u32 v17, v35, v39, v43
    v_max3_u32 v18, v35, v39, v43
    v_min3_u32 v17, v17, v47, v51
    v_max3_u32 v18, v18, v47, v51
    v_min3_u32 v17, v17, v55, v59
    v_max3_u32 v18, v18, v55, v59
    v_min3_u32 v17, v17, v63, v99
    v_max3_u32 v18, v18, v63, v99
    v_xor_b32 v17, s70, v17
    v_xor_b32 v18, s70, v18
    v_or_b32 v17, v17, v18
    v_cmp_ne_u32 vcc, 0, v17
    s_nop 1
    s_cbranch_vccz adaLN_cond__ssm_conv_h3__glu_gated_geglu__prompt_kernel_p5ax
    s_mov_b32 s69, 0
adaLN_cond__ssm_conv_h3__glu_gated_geglu__prompt_kernel_p5a:
    buffer_load_dwordx4 v[32:35], v9, s[16:19], s55 offen offset:0 sc1
    buffer_load_dwordx4 v[36:39], v9, s[16:19], s55 offen offset:1024 sc1
    buffer_load_dwordx4 v[40:43], v9, s[16:19], s55 offen offset:2048 sc1
    buffer_load_dwordx4 v[44:47], v9, s[16:19], s56 offen offset:0 sc1
    buffer_load_dwordx4 v[48:51], v9, s[16:19], s56 offen offset:1024 sc1
    buffer_load_dwordx4 v[52:55], v9, s[16:19], s56 offen offset:2048 sc1
    buffer_load_dwordx4 v[56:59], v9, s[16:19], s57 offen offset:0 sc1
    buffer_load_dwordx4 v[60:63], v9, s[16:19], s57 offen offset:1024 sc1
    buffer_load_dwordx4 v[96:99], v9, s[16:19], s57 offen offset:2048 sc1
    s_add_u32 s69, s69, 1
    s_waitcnt vmcnt(0)
    v_min3_u32 v17, v35, v39, v43
    v_max3_u32 v18, v35, v39, v43
    v_min3_u32 v17, v17, v47, v51
    v_max3_u32 v18, v18, v47, v51
    v_min3_u32 v17, v17, v55, v59
    v_max3_u32 v18, v18, v55, v59
    v_min3_u32 v17, v17, v63, v99
    v_max3_u32 v18, v18, v63, v99
    v_xor_b32 v17, s70, v17
    v_xor_b32 v18, s70, v18
    v_or_b32 v17, v17, v18
    v_cmp_ne_u32 vcc, 0, v17
    s_cmp_ge_u32 s69, 400000
    s_cbranch_scc1 adaLN_cond__ssm_conv_h3__glu_gated_geglu__prompt_kernel_p5ax
    s_nop 1
    s_cbranch_vccnz adaLN_cond__ssm_conv_h3__glu_gated_geglu__prompt_kernel_p5a
adaLN_cond__ssm_conv_h3__glu_gated_geglu__prompt_kernel_p5ax:
    v_lshlrev_b32 v152, 16, v32
    v_and_b32 v153, s66, v32
    v_lshlrev_b32 v154, 16, v33
    v_and_b32 v155, s66, v33
    v_pk_add_f32 v[64:65], v[64:65], v[152:153]
    v_pk_add_f32 v[66:67], v[66:67], v[154:155]
    v_lshlrev_b32 v156, 16, v34
    v_and_b32 v157, s66, v34
    v_lshlrev_b32 v158, 16, v36
    v_and_b32 v159, s66, v36
    v_pk_add_f32 v[68:69], v[68:69], v[156:157]
    v_pk_add_f32 v[70:71], v[70:71], v[158:159]
    v_lshlrev_b32 v160, 16, v37
    v_and_b32 v161, s66, v37
    v_lshlrev_b32 v162, 16, v38
    v_and_b32 v163, s66, v38
    v_pk_add_f32 v[72:73], v[72:73], v[160:161]
    v_pk_add_f32 v[74:75], v[74:75], v[162:163]
    v_lshlrev_b32 v164, 16, v40
    v_and_b32 v165, s66, v40
    v_lshlrev_b32 v166, 16, v41
    v_and_b32 v167, s66, v41
    v_pk_add_f32 v[76:77], v[76:77], v[164:165]
    v_pk_add_f32 v[78:79], v[78:79], v[166:167]
    v_lshlrev_b32 v152, 16, v44
    v_and_b32 v153, s66, v44
    v_lshlrev_b32 v154, 16, v45
    v_and_b32 v155, s66, v45
    v_pk_add_f32 v[64:65], v[64:65], v[152:153]
    v_pk_add_f32 v[66:67], v[66:67], v[154:155]
    v_lshlrev_b32 v156, 16, v46
    v_and_b32 v157, s66, v46
    v_lshlrev_b32 v158, 16, v48
    v_and_b32 v159, s66, v48
    v_pk_add_f32 v[68:69], v[68:69], v[156:157]
    v_pk_add_f32 v[70:71], v[70:71], v[158:159]
    v_lshlrev_b32 v160, 16, v49
    v_and_b32 v161, s66, v49
    v_lshlrev_b32 v162, 16, v50
    v_and_b32 v163, s66, v50
    v_pk_add_f32 v[72:73], v[72:73], v[160:161]
    v_pk_add_f32 v[74:75], v[74:75], v[162:163]
    v_lshlrev_b32 v164, 16, v52
    v_and_b32 v165, s66, v52
    v_lshlrev_b32 v166, 16, v53
    v_and_b32 v167, s66, v53
    v_pk_add_f32 v[76:77], v[76:77], v[164:165]
    v_pk_add_f32 v[78:79], v[78:79], v[166:167]
    v_lshlrev_b32 v152, 16, v56
    v_and_b32 v153, s66, v56
    v_lshlrev_b32 v154, 16, v57
    v_and_b32 v155, s66, v57
    v_pk_add_f32 v[64:65], v[64:65], v[152:153]
    v_pk_add_f32 v[66:67], v[66:67], v[154:155]
    v_lshlrev_b32 v156, 16, v58
    v_and_b32 v157, s66, v58
    v_lshlrev_b32 v158, 16, v60
    v_and_b32 v159, s66, v60
    v_pk_add_f32 v[68:69], v[68:69], v[156:157]
    v_pk_add_f32 v[70:71], v[70:71], v[158:159]
    v_lshlrev_b32 v160, 16, v61
    v_and_b32 v161, s66, v61
    v_lshlrev_b32 v162, 16, v62
    v_and_b32 v163, s66, v62
    v_pk_add_f32 v[72:73], v[72:73], v[160:161]
    v_pk_add_f32 v[74:75], v[74:75], v[162:163]
    v_lshlrev_b32 v164, 16, v96
    v_and_b32 v165, s66, v96
    v_lshlrev_b32 v166, 16, v97
    v_and_b32 v167, s66, v97
    v_pk_add_f32 v[76:77], v[76:77], v[164:165]
    v_pk_add_f32 v[78:79], v[78:79], v[166:167]
    v_pk_fma_f32 v[152:153], v[64:65], v[216:217], v[224:225]
    v_pk_fma_f32 v[154:155], v[66:67], v[218:219], v[226:227]
    v_cvt_pk_bf16_f32 v32, v152, v153
    v_cvt_pk_bf16_f32 v33, v154, v155
    v_pk_fma_f32 v[156:157], v[68:69], v[216:217], v[228:229]
    v_pk_fma_f32 v[158:159], v[70:71], v[218:219], v[230:231]
    v_cvt_pk_bf16_f32 v36, v156, v157
    v_cvt_pk_bf16_f32 v37, v158, v159
    v_pk_fma_f32 v[160:161], v[72:73], v[220:221], v[232:233]
    v_pk_fma_f32 v[162:163], v[74:75], v[222:223], v[234:235]
    v_cvt_pk_bf16_f32 v34, v160, v161
    v_cvt_pk_bf16_f32 v35, v162, v163
    v_pk_fma_f32 v[164:165], v[76:77], v[220:221], v[236:237]
    v_pk_fma_f32 v[166:167], v[78:79], v[222:223], v[238:239]
    v_cvt_pk_bf16_f32 v38, v164, v165
    v_cvt_pk_bf16_f32 v39, v166, v167
    v_permlane16_swap_b32 v32, v34
    v_permlane16_swap_b32 v33, v35
    buffer_store_dwordx4 v[32:35], v22, s[20:23], s72 offen sc1
    v_permlane16_swap_b32 v36, v38
    v_permlane16_swap_b32 v37, v39
    buffer_store_dwordx4 v[36:39], v23, s[20:23], s72 offen sc1
    s_endpgm
adaLN_cond__ssm_conv_h3__glu_gated_geglu__prompt_kernel_own8:
    s_movk_i32 s84, 256
    buffer_load_dwordx4 v[32:35], v9, s[16:19], s55 offen offset:0 sc1
    buffer_load_dwordx4 v[36:39], v9, s[16:19], s55 offen offset:1024 sc1
    buffer_load_dwordx4 v[40:43], v9, s[16:19], s55 offen offset:2048 sc1
    buffer_load_dwordx4 v[44:47], v9, s[16:19], s55 offen offset:3072 sc1
    buffer_load_dwordx4 v[48:51], v9, s[16:19], s56 offen offset:0 sc1
    buffer_load_dwordx4 v[52:55], v9, s[16:19], s56 offen offset:1024 sc1
    buffer_load_dwordx4 v[56:59], v9, s[16:19], s56 offen offset:2048 sc1
    buffer_load_dwordx4 v[60:63], v9, s[16:19], s56 offen offset:3072 sc1
    buffer_load_dwordx4 v[96:99], v9, s[16:19], s57 offen offset:0 sc1
    buffer_load_dwordx4 v[100:103], v9, s[16:19], s57 offen offset:1024 sc1
    buffer_load_dwordx4 v[104:107], v9, s[16:19], s57 offen offset:2048 sc1
    buffer_load_dwordx4 v[108:111], v9, s[16:19], s57 offen offset:3072 sc1
    s_waitcnt vmcnt(12)
    v_lshlrev_b32 v224, 16, v128
    v_and_b32 v225, s66, v128
    v_lshlrev_b32 v226, 16, v129
    v_and_b32 v227, s66, v129
    v_lshlrev_b32 v228, 16, v130
    v_and_b32 v229, s66, v130
    v_lshlrev_b32 v230, 16, v131
    v_and_b32 v231, s66, v131
    v_lshlrev_b32 v232, 16, v132
    v_and_b32 v233, s66, v132
    v_lshlrev_b32 v234, 16, v133
    v_and_b32 v235, s66, v133
    v_lshlrev_b32 v236, 16, v134
    v_and_b32 v237, s66, v134
    v_lshlrev_b32 v238, 16, v135
    v_and_b32 v239, s66, v135
    v_lshlrev_b32 v240, 16, v136
    v_and_b32 v241, s66, v136
    v_lshlrev_b32 v242, 16, v137
    v_and_b32 v243, s66, v137
    v_lshlrev_b32 v244, 16, v138
    v_and_b32 v245, s66, v138
    v_lshlrev_b32 v246, 16, v139
    v_and_b32 v247, s66, v139
    v_bfe_u32 v16, v0, 4, 2
    v_lshlrev_b32 v19, 3, v16
    v_sub_u32 v19, v21, v19
    v_lshrrev_b32 v20, 1, v16
    v_lshl_add_u32 v19, v20, 4, v19
    v_and_b32 v16, 1, v16
    v_lshl_add_u32 v22, v16, 5, v19
    v_add_u32 v23, 18432, v22
    v_mul_u32_u24 v16, 18432, v16
    v_add3_u32 v19, v19, v16, s84
    s_waitcnt vmcnt(0)
    v_min3_u32 v17, v35, v39, v43
    v_max3_u32 v18, v35, v39, v43
    v_min3_u32 v17, v17, v47, v51
    v_max3_u32 v18, v18, v47, v51
    v_min3_u32 v17, v17, v55, v59
    v_max3_u32 v18, v18, v55, v59
    v_min3_u32 v17, v17, v63, v99
    v_max3_u32 v18, v18, v63, v99
    v_min3_u32 v17, v17, v103, v107
    v_max3_u32 v18, v18, v103, v107
    v_min3_u32 v17, v17, v111, v111
    v_max3_u32 v18, v18, v111, v111
    v_xor_b32 v17, s70, v17
    v_xor_b32 v18, s70, v18
    v_or_b32 v17, v17, v18
    v_cmp_ne_u32 vcc, 0, v17
    s_nop 1
    s_cbranch_vccz adaLN_cond__ssm_conv_h3__glu_gated_geglu__prompt_kernel_p5bx
    s_mov_b32 s69, 0
adaLN_cond__ssm_conv_h3__glu_gated_geglu__prompt_kernel_p5b:
    buffer_load_dwordx4 v[32:35], v9, s[16:19], s55 offen offset:0 sc1
    buffer_load_dwordx4 v[36:39], v9, s[16:19], s55 offen offset:1024 sc1
    buffer_load_dwordx4 v[40:43], v9, s[16:19], s55 offen offset:2048 sc1
    buffer_load_dwordx4 v[44:47], v9, s[16:19], s55 offen offset:3072 sc1
    buffer_load_dwordx4 v[48:51], v9, s[16:19], s56 offen offset:0 sc1
    buffer_load_dwordx4 v[52:55], v9, s[16:19], s56 offen offset:1024 sc1
    buffer_load_dwordx4 v[56:59], v9, s[16:19], s56 offen offset:2048 sc1
    buffer_load_dwordx4 v[60:63], v9, s[16:19], s56 offen offset:3072 sc1
    buffer_load_dwordx4 v[96:99], v9, s[16:19], s57 offen offset:0 sc1
    buffer_load_dwordx4 v[100:103], v9, s[16:19], s57 offen offset:1024 sc1
    buffer_load_dwordx4 v[104:107], v9, s[16:19], s57 offen offset:2048 sc1
    buffer_load_dwordx4 v[108:111], v9, s[16:19], s57 offen offset:3072 sc1
    s_add_u32 s69, s69, 1
    s_waitcnt vmcnt(0)
    v_min3_u32 v17, v35, v39, v43
    v_max3_u32 v18, v35, v39, v43
    v_min3_u32 v17, v17, v47, v51
    v_max3_u32 v18, v18, v47, v51
    v_min3_u32 v17, v17, v55, v59
    v_max3_u32 v18, v18, v55, v59
    v_min3_u32 v17, v17, v63, v99
    v_max3_u32 v18, v18, v63, v99
    v_min3_u32 v17, v17, v103, v107
    v_max3_u32 v18, v18, v103, v107
    v_min3_u32 v17, v17, v111, v111
    v_max3_u32 v18, v18, v111, v111
    v_xor_b32 v17, s70, v17
    v_xor_b32 v18, s70, v18
    v_or_b32 v17, v17, v18
    v_cmp_ne_u32 vcc, 0, v17
    s_cmp_ge_u32 s69, 400000
    s_cbranch_scc1 adaLN_cond__ssm_conv_h3__glu_gated_geglu__prompt_kernel_p5bx
    s_nop 1
    s_cbranch_vccnz adaLN_cond__ssm_conv_h3__glu_gated_geglu__prompt_kernel_p5b
adaLN_cond__ssm_conv_h3__glu_gated_geglu__prompt_kernel_p5bx:
    v_lshlrev_b32 v152, 16, v32
    v_and_b32 v153, s66, v32
    v_lshlrev_b32 v154, 16, v33
    v_and_b32 v155, s66, v33
    v_pk_add_f32 v[64:65], v[64:65], v[152:153]
    v_pk_add_f32 v[66:67], v[66:67], v[154:155]
    v_lshlrev_b32 v156, 16, v34
    v_and_b32 v157, s66, v34
    v_lshlrev_b32 v158, 16, v36
    v_and_b32 v159, s66, v36
    v_pk_add_f32 v[68:69], v[68:69], v[156:157]
    v_pk_add_f32 v[70:71], v[70:71], v[158:159]
    v_lshlrev_b32 v160, 16, v37
    v_and_b32 v161, s66, v37
    v_lshlrev_b32 v162, 16, v38
    v_and_b32 v163, s66, v38
    v_pk_add_f32 v[72:73], v[72:73], v[160:161]
    v_pk_add_f32 v[74:75], v[74:75], v[162:163]
    v_lshlrev_b32 v164, 16, v40
    v_and_b32 v165, s66, v40
    v_lshlrev_b32 v166, 16, v41
    v_and_b32 v167, s66, v41
    v_pk_add_f32 v[76:77], v[76:77], v[164:165]
    v_pk_add_f32 v[78:79], v[78:79], v[166:167]
    v_lshlrev_b32 v168, 16, v42
    v_and_b32 v169, s66, v42
    v_lshlrev_b32 v170, 16, v44
    v_and_b32 v171, s66, v44
    v_pk_add_f32 v[208:209], v[208:209], v[168:169]
    v_pk_add_f32 v[210:211], v[210:211], v[170:171]
    v_lshlrev_b32 v172, 16, v45
    v_and_b32 v173, s66, v45
    v_lshlrev_b32 v174, 16, v46
    v_and_b32 v175, s66, v46
    v_pk_add_f32 v[212:213], v[212:213], v[172:173]
    v_pk_add_f32 v[214:215], v[214:215], v[174:175]
    v_lshlrev_b32 v152, 16, v48
    v_and_b32 v153, s66, v48
    v_lshlrev_b32 v154, 16, v49
    v_and_b32 v155, s66, v49
    v_pk_add_f32 v[64:65], v[64:65], v[152:153]
    v_pk_add_f32 v[66:67], v[66:67], v[154:155]
    v_lshlrev_b32 v156, 16, v50
    v_and_b32 v157, s66, v50
    v_lshlrev_b32 v158, 16, v52
    v_and_b32 v159, s66, v52
    v_pk_add_f32 v[68:69], v[68:69], v[156:157]
    v_pk_add_f32 v[70:71], v[70:71], v[158:159]
    v_lshlrev_b32 v160, 16, v53
    v_and_b32 v161, s66, v53
    v_lshlrev_b32 v162, 16, v54
    v_and_b32 v163, s66, v54
    v_pk_add_f32 v[72:73], v[72:73], v[160:161]
    v_pk_add_f32 v[74:75], v[74:75], v[162:163]
    v_lshlrev_b32 v164, 16, v56
    v_and_b32 v165, s66, v56
    v_lshlrev_b32 v166, 16, v57
    v_and_b32 v167, s66, v57
    v_pk_add_f32 v[76:77], v[76:77], v[164:165]
    v_pk_add_f32 v[78:79], v[78:79], v[166:167]
    v_lshlrev_b32 v168, 16, v58
    v_and_b32 v169, s66, v58
    v_lshlrev_b32 v170, 16, v60
    v_and_b32 v171, s66, v60
    v_pk_add_f32 v[208:209], v[208:209], v[168:169]
    v_pk_add_f32 v[210:211], v[210:211], v[170:171]
    v_lshlrev_b32 v172, 16, v61
    v_and_b32 v173, s66, v61
    v_lshlrev_b32 v174, 16, v62
    v_and_b32 v175, s66, v62
    v_pk_add_f32 v[212:213], v[212:213], v[172:173]
    v_pk_add_f32 v[214:215], v[214:215], v[174:175]
    v_lshlrev_b32 v152, 16, v96
    v_and_b32 v153, s66, v96
    v_lshlrev_b32 v154, 16, v97
    v_and_b32 v155, s66, v97
    v_pk_add_f32 v[64:65], v[64:65], v[152:153]
    v_pk_add_f32 v[66:67], v[66:67], v[154:155]
    v_lshlrev_b32 v156, 16, v98
    v_and_b32 v157, s66, v98
    v_lshlrev_b32 v158, 16, v100
    v_and_b32 v159, s66, v100
    v_pk_add_f32 v[68:69], v[68:69], v[156:157]
    v_pk_add_f32 v[70:71], v[70:71], v[158:159]
    v_lshlrev_b32 v160, 16, v101
    v_and_b32 v161, s66, v101
    v_lshlrev_b32 v162, 16, v102
    v_and_b32 v163, s66, v102
    v_pk_add_f32 v[72:73], v[72:73], v[160:161]
    v_pk_add_f32 v[74:75], v[74:75], v[162:163]
    v_lshlrev_b32 v164, 16, v104
    v_and_b32 v165, s66, v104
    v_lshlrev_b32 v166, 16, v105
    v_and_b32 v167, s66, v105
    v_pk_add_f32 v[76:77], v[76:77], v[164:165]
    v_pk_add_f32 v[78:79], v[78:79], v[166:167]
    v_lshlrev_b32 v168, 16, v106
    v_and_b32 v169, s66, v106
    v_lshlrev_b32 v170, 16, v108
    v_and_b32 v171, s66, v108
    v_pk_add_f32 v[208:209], v[208:209], v[168:169]
    v_pk_add_f32 v[210:211], v[210:211], v[170:171]
    v_lshlrev_b32 v172, 16, v109
    v_and_b32 v173, s66, v109
    v_lshlrev_b32 v174, 16, v110
    v_and_b32 v175, s66, v110
    v_pk_add_f32 v[212:213], v[212:213], v[172:173]
    v_pk_add_f32 v[214:215], v[214:215], v[174:175]
    v_pk_fma_f32 v[152:153], v[64:65], v[216:217], v[224:225]
    v_pk_fma_f32 v[154:155], v[66:67], v[218:219], v[226:227]
    v_cvt_pk_bf16_f32 v32, v152, v153
    v_cvt_pk_bf16_f32 v33, v154, v155
    v_pk_fma_f32 v[156:157], v[68:69], v[216:217], v[228:229]
    v_pk_fma_f32 v[158:159], v[70:71], v[218:219], v[230:231]
    v_cvt_pk_bf16_f32 v36, v156, v157
    v_cvt_pk_bf16_f32 v37, v158, v159
    v_pk_fma_f32 v[160:161], v[72:73], v[220:221], v[232:233]
    v_pk_fma_f32 v[162:163], v[74:75], v[222:223], v[234:235]
    v_cvt_pk_bf16_f32 v34, v160, v161
    v_cvt_pk_bf16_f32 v35, v162, v163
    v_pk_fma_f32 v[164:165], v[76:77], v[220:221], v[236:237]
    v_pk_fma_f32 v[166:167], v[78:79], v[222:223], v[238:239]
    v_cvt_pk_bf16_f32 v38, v164, v165
    v_cvt_pk_bf16_f32 v39, v166, v167
    v_pk_fma_f32 v[168:169], v[208:209], v[140:141], v[240:241]
    v_pk_fma_f32 v[170:171], v[210:211], v[142:143], v[242:243]
    v_cvt_pk_bf16_f32 v40, v168, v169
    v_cvt_pk_bf16_f32 v41, v170, v171
    v_pk_fma_f32 v[172:173], v[212:213], v[140:141], v[244:245]
    v_pk_fma_f32 v[174:175], v[214:215], v[142:143], v[246:247]
    v_cvt_pk_bf16_f32 v42, v172, v173
    v_cvt_pk_bf16_f32 v43, v174, v175
    v_permlane16_swap_b32 v32, v34
    v_permlane16_swap_b32 v33, v35
    buffer_store_dwordx4 v[32:35], v22, s[20:23], s72 offen sc1
    v_permlane16_swap_b32 v36, v38
    v_permlane16_swap_b32 v37, v39
    buffer_store_dwordx4 v[36:39], v23, s[20:23], s72 offen sc1
    v_permlane16_swap_b32 v40, v42
    v_permlane16_swap_b32 v41, v43
    buffer_store_dwordx4 v[40:43], v19, s[20:23], s73 offen sc1
    s_endpgm
adaLN_cond__ssm_conv_h3__glu_gated_geglu__prompt_kernel_bc0_0:
    s_mov_b32 s69, 0
adaLN_cond__ssm_conv_h3__glu_gated_geglu__prompt_kernel_bc0_0l:
    buffer_load_dwordx4 a[0:3], v9, s[16:19], s50 offen offset:0 sc1
    buffer_load_dwordx4 a[4:7], v9, s[16:19], s51 offen offset:0 sc1
    buffer_load_dwordx4 a[16:19], v9, s[16:19], s50 offen offset:1024 sc1
    buffer_load_dwordx4 a[20:23], v9, s[16:19], s51 offen offset:1024 sc1
    s_add_u32 s69, s69, 1
    s_waitcnt vmcnt(0)
    v_accvgpr_read_b32 v176, a0
    v_accvgpr_read_b32 v177, a4
    v_accvgpr_read_b32 v178, a16
    v_accvgpr_read_b32 v179, a20
    v_max3_u32 v176, v176, v177, v178
    v_max_u32 v176, v176, v179
    v_cmp_eq_u32 vcc, -1, v176
    s_cmp_ge_u32 s69, 400000
    s_cbranch_scc1 adaLN_cond__ssm_conv_h3__glu_gated_geglu__prompt_kernel_bc0_0lx
    s_nop 1
    s_cbranch_vccnz adaLN_cond__ssm_conv_h3__glu_gated_geglu__prompt_kernel_bc0_0l
adaLN_cond__ssm_conv_h3__glu_gated_geglu__prompt_kernel_bc0_0lx:
    s_branch adaLN_cond__ssm_conv_h3__glu_gated_geglu__prompt_kernel_bc0_0b
adaLN_cond__ssm_conv_h3__glu_gated_geglu__prompt_kernel_bc0_1:
    s_mov_b32 s69, 0
adaLN_cond__ssm_conv_h3__glu_gated_geglu__prompt_kernel_bc0_1l:
    buffer_load_dwordx4 a[32:35], v9, s[16:19], s50 offen offset:2048 sc1
    buffer_load_dwordx4 a[36:39], v9, s[16:19], s51 offen offset:2048 sc1
    buffer_load_dwordx4 a[48:51], v9, s[16:19], s50 offen offset:3072 sc1
    buffer_load_dwordx4 a[52:55], v9, s[16:19], s51 offen offset:3072 sc1
    s_add_u32 s69, s69, 1
    s_waitcnt vmcnt(0)
    v_accvgpr_read_b32 v176, a32
    v_accvgpr_read_b32 v177, a36
    v_accvgpr_read_b32 v178, a48
    v_accvgpr_read_b32 v179, a52
    v_max3_u32 v176, v176, v177, v178
    v_max_u32 v176, v176, v179
    v_cmp_eq_u32 vcc, -1, v176
    s_cmp_ge_u32 s69, 400000
    s_cbranch_scc1 adaLN_cond__ssm_conv_h3__glu_gated_geglu__prompt_kernel_bc0_1lx
    s_nop 1
    s_cbranch_vccnz adaLN_cond__ssm_conv_h3__glu_gated_geglu__prompt_kernel_bc0_1l
adaLN_cond__ssm_conv_h3__glu_gated_geglu__prompt_kernel_bc0_1lx:
    s_branch adaLN_cond__ssm_conv_h3__glu_gated_geglu__prompt_kernel_bc0_1b
adaLN_cond__ssm_conv_h3__glu_gated_geglu__prompt_kernel_bc0_2:
    s_mov_b32 s69, 0
adaLN_cond__ssm_conv_h3__glu_gated_geglu__prompt_kernel_bc0_2l:
    buffer_load_dwordx4 a[64:67], v24, s[16:19], s50 offen offset:0 sc1
    buffer_load_dwordx4 a[68:71], v24, s[16:19], s51 offen offset:0 sc1
    buffer_load_dwordx4 a[80:83], v24, s[16:19], s50 offen offset:1024 sc1
    buffer_load_dwordx4 a[84:87], v24, s[16:19], s51 offen offset:1024 sc1
    s_add_u32 s69, s69, 1
    s_waitcnt vmcnt(0)
    v_accvgpr_read_b32 v176, a64
    v_accvgpr_read_b32 v177, a68
    v_accvgpr_read_b32 v178, a80
    v_accvgpr_read_b32 v179, a84
    v_max3_u32 v176, v176, v177, v178
    v_max_u32 v176, v176, v179
    v_cmp_eq_u32 vcc, -1, v176
    s_cmp_ge_u32 s69, 400000
    s_cbranch_scc1 adaLN_cond__ssm_conv_h3__glu_gated_geglu__prompt_kernel_bc0_2lx
    s_nop 1
    s_cbranch_vccnz adaLN_cond__ssm_conv_h3__glu_gated_geglu__prompt_kernel_bc0_2l
adaLN_cond__ssm_conv_h3__glu_gated_geglu__prompt_kernel_bc0_2lx:
    s_branch adaLN_cond__ssm_conv_h3__glu_gated_geglu__prompt_kernel_bc0_2b
adaLN_cond__ssm_conv_h3__glu_gated_geglu__prompt_kernel_bc0_3:
    s_mov_b32 s69, 0
adaLN_cond__ssm_conv_h3__glu_gated_geglu__prompt_kernel_bc0_3l:
    buffer_load_dwordx4 a[96:99], v24, s[16:19], s50 offen offset:2048 sc1
    buffer_load_dwordx4 a[100:103], v24, s[16:19], s51 offen offset:2048 sc1
    buffer_load_dwordx4 a[112:115], v24, s[16:19], s50 offen offset:3072 sc1
    buffer_load_dwordx4 a[116:119], v24, s[16:19], s51 offen offset:3072 sc1
    s_add_u32 s69, s69, 1
    s_waitcnt vmcnt(0)
    v_accvgpr_read_b32 v176, a96
    v_accvgpr_read_b32 v177, a100
    v_accvgpr_read_b32 v178, a112
    v_accvgpr_read_b32 v179, a116
    v_max3_u32 v176, v176, v177, v178
    v_max_u32 v176, v176, v179
    v_cmp_eq_u32 vcc, -1, v176
    s_cmp_ge_u32 s69, 400000
    s_cbranch_scc1 adaLN_cond__ssm_conv_h3__glu_gated_geglu__prompt_kernel_bc0_3lx
    s_nop 1
    s_cbranch_vccnz adaLN_cond__ssm_conv_h3__glu_gated_geglu__prompt_kernel_bc0_3l
adaLN_cond__ssm_conv_h3__glu_gated_geglu__prompt_kernel_bc0_3lx:
    s_branch adaLN_cond__ssm_conv_h3__glu_gated_geglu__prompt_kernel_bc0_3b
adaLN_cond__ssm_conv_h3__glu_gated_geglu__prompt_kernel_bc0_4:
    s_mov_b32 s69, 0
adaLN_cond__ssm_conv_h3__glu_gated_geglu__prompt_kernel_bc0_4l:
    buffer_load_dwordx4 a[128:131], v25, s[16:19], s50 offen offset:0 sc1
    buffer_load_dwordx4 a[132:135], v25, s[16:19], s51 offen offset:0 sc1
    buffer_load_dwordx4 a[144:147], v25, s[16:19], s50 offen offset:1024 sc1
    buffer_load_dwordx4 a[148:151], v25, s[16:19], s51 offen offset:1024 sc1
    s_add_u32 s69, s69, 1
    s_waitcnt vmcnt(0)
    v_accvgpr_read_b32 v176, a128
    v_accvgpr_read_b32 v177, a132
    v_accvgpr_read_b32 v178, a144
    v_accvgpr_read_b32 v179, a148
    v_max3_u32 v176, v176, v177, v178
    v_max_u32 v176, v176, v179
    v_cmp_eq_u32 vcc, -1, v176
    s_cmp_ge_u32 s69, 400000
    s_cbranch_scc1 adaLN_cond__ssm_conv_h3__glu_gated_geglu__prompt_kernel_bc0_4lx
    s_nop 1
    s_cbranch_vccnz adaLN_cond__ssm_conv_h3__glu_gated_geglu__prompt_kernel_bc0_4l
adaLN_cond__ssm_conv_h3__glu_gated_geglu__prompt_kernel_bc0_4lx:
    s_branch adaLN_cond__ssm_conv_h3__glu_gated_geglu__prompt_kernel_bc0_4b
adaLN_cond__ssm_conv_h3__glu_gated_geglu__prompt_kernel_bc0_5:
    s_mov_b32 s69, 0
adaLN_cond__ssm_conv_h3__glu_gated_geglu__prompt_kernel_bc0_5l:
    buffer_load_dwordx4 a[160:163], v25, s[16:19], s50 offen offset:2048 sc1
    buffer_load_dwordx4 a[164:167], v25, s[16:19], s51 offen offset:2048 sc1
    buffer_load_dwordx4 a[176:179], v25, s[16:19], s50 offen offset:3072 sc1
    buffer_load_dwordx4 a[180:183], v25, s[16:19], s51 offen offset:3072 sc1
    s_add_u32 s69, s69, 1
    s_waitcnt vmcnt(0)
    v_accvgpr_read_b32 v176, a160
    v_accvgpr_read_b32 v177, a164
    v_accvgpr_read_b32 v178, a176
    v_accvgpr_read_b32 v179, a180
    v_max3_u32 v176, v176, v177, v178
    v_max_u32 v176, v176, v179
    v_cmp_eq_u32 vcc, -1, v176
    s_cmp_ge_u32 s69, 400000
    s_cbranch_scc1 adaLN_cond__ssm_conv_h3__glu_gated_geglu__prompt_kernel_bc0_5lx
    s_nop 1
    s_cbranch_vccnz adaLN_cond__ssm_conv_h3__glu_gated_geglu__prompt_kernel_bc0_5l
adaLN_cond__ssm_conv_h3__glu_gated_geglu__prompt_kernel_bc0_5lx:
    s_branch adaLN_cond__ssm_conv_h3__glu_gated_geglu__prompt_kernel_bc0_5b
adaLN_cond__ssm_conv_h3__glu_gated_geglu__prompt_kernel_bc0_6:
    s_mov_b32 s69, 0
adaLN_cond__ssm_conv_h3__glu_gated_geglu__prompt_kernel_bc0_6l:
    buffer_load_dwordx4 a[192:195], v26, s[16:19], s50 offen offset:0 sc1
    buffer_load_dwordx4 a[196:199], v26, s[16:19], s51 offen offset:0 sc1
    buffer_load_dwordx4 a[208:211], v26, s[16:19], s50 offen offset:1024 sc1
    buffer_load_dwordx4 a[212:215], v26, s[16:19], s51 offen offset:1024 sc1
    s_add_u32 s69, s69, 1
    s_waitcnt vmcnt(0)
    v_accvgpr_read_b32 v176, a192
    v_accvgpr_read_b32 v177, a196
    v_accvgpr_read_b32 v178, a208
    v_accvgpr_read_b32 v179, a212
    v_max3_u32 v176, v176, v177, v178
    v_max_u32 v176, v176, v179
    v_cmp_eq_u32 vcc, -1, v176
    s_cmp_ge_u32 s69, 400000
    s_cbranch_scc1 adaLN_cond__ssm_conv_h3__glu_gated_geglu__prompt_kernel_bc0_6lx
    s_nop 1
    s_cbranch_vccnz adaLN_cond__ssm_conv_h3__glu_gated_geglu__prompt_kernel_bc0_6l
adaLN_cond__ssm_conv_h3__glu_gated_geglu__prompt_kernel_bc0_6lx:
    s_branch adaLN_cond__ssm_conv_h3__glu_gated_geglu__prompt_kernel_bc0_6b
adaLN_cond__ssm_conv_h3__glu_gated_geglu__prompt_kernel_bc0_7:
    s_mov_b32 s69, 0
adaLN_cond__ssm_conv_h3__glu_gated_geglu__prompt_kernel_bc0_7l:
    buffer_load_dwordx4 a[224:227], v26, s[16:19], s50 offen offset:2048 sc1
    buffer_load_dwordx4 a[228:231], v26, s[16:19], s51 offen offset:2048 sc1
    buffer_load_dwordx4 a[240:243], v26, s[16:19], s50 offen offset:3072 sc1
    buffer_load_dwordx4 a[244:247], v26, s[16:19], s51 offen offset:3072 sc1
    s_add_u32 s69, s69, 1
    s_waitcnt vmcnt(0)
    v_accvgpr_read_b32 v176, a224
    v_accvgpr_read_b32 v177, a228
    v_accvgpr_read_b32 v178, a240
    v_accvgpr_read_b32 v179, a244
    v_max3_u32 v176, v176, v177, v178
    v_max_u32 v176, v176, v179
    v_cmp_eq_u32 vcc, -1, v176
    s_cmp_ge_u32 s69, 400000
    s_cbranch_scc1 adaLN_cond__ssm_conv_h3__glu_gated_geglu__prompt_kernel_bc0_7lx
    s_nop 1
    s_cbranch_vccnz adaLN_cond__ssm_conv_h3__glu_gated_geglu__prompt_kernel_bc0_7l
adaLN_cond__ssm_conv_h3__glu_gated_geglu__prompt_kernel_bc0_7lx:
    s_branch adaLN_cond__ssm_conv_h3__glu_gated_geglu__prompt_kernel_bc0_7b
adaLN_cond__ssm_conv_h3__glu_gated_geglu__prompt_kernel_bc0_8:
    s_mov_b32 s69, 0
adaLN_cond__ssm_conv_h3__glu_gated_geglu__prompt_kernel_bc0_8l:
    buffer_load_dwordx4 v[224:227], v27, s[16:19], s50 offen offset:0 sc1
    buffer_load_dwordx4 v[228:231], v27, s[16:19], s51 offen offset:0 sc1
    buffer_load_dwordx4 v[240:243], v27, s[16:19], s50 offen offset:1024 sc1
    buffer_load_dwordx4 v[244:247], v27, s[16:19], s51 offen offset:1024 sc1
    s_add_u32 s69, s69, 1
    s_waitcnt vmcnt(0)
    v_max3_u32 v176, v224, v228, v240
    v_max_u32 v176, v176, v244
    v_cmp_eq_u32 vcc, -1, v176
    s_cmp_ge_u32 s69, 400000
    s_cbranch_scc1 adaLN_cond__ssm_conv_h3__glu_gated_geglu__prompt_kernel_bc0_8lx
    s_nop 1
    s_cbranch_vccnz adaLN_cond__ssm_conv_h3__glu_gated_geglu__prompt_kernel_bc0_8l
adaLN_cond__ssm_conv_h3__glu_gated_geglu__prompt_kernel_bc0_8lx:
    s_branch adaLN_cond__ssm_conv_h3__glu_gated_geglu__prompt_kernel_bc0_8b
adaLN_cond__ssm_conv_h3__glu_gated_geglu__prompt_kernel_bc1_0:
    s_mov_b32 s69, 0
adaLN_cond__ssm_conv_h3__glu_gated_geglu__prompt_kernel_bc1_0l:
    buffer_load_dwordx4 a[8:11], v9, s[16:19], s52 offen offset:0 sc1
    buffer_load_dwordx4 a[12:15], v9, s[16:19], s53 offen offset:0 sc1
    buffer_load_dwordx4 a[24:27], v9, s[16:19], s52 offen offset:1024 sc1
    buffer_load_dwordx4 a[28:31], v9, s[16:19], s53 offen offset:1024 sc1
    s_add_u32 s69, s69, 1
    s_waitcnt vmcnt(0)
    v_accvgpr_read_b32 v176, a8
    v_accvgpr_read_b32 v177, a12
    v_accvgpr_read_b32 v178, a24
    v_accvgpr_read_b32 v179, a28
    v_max3_u32 v176, v176, v177, v178
    v_max_u32 v176, v176, v179
    v_cmp_eq_u32 vcc, -1, v176
    s_cmp_ge_u32 s69, 400000
    s_cbranch_scc1 adaLN_cond__ssm_conv_h3__glu_gated_geglu__prompt_kernel_bc1_0lx
    s_nop 1
    s_cbranch_vccnz adaLN_cond__ssm_conv_h3__glu_gated_geglu__prompt_kernel_bc1_0l
adaLN_cond__ssm_conv_h3__glu_gated_geglu__prompt_kernel_bc1_0lx:
    s_branch adaLN_cond__ssm_conv_h3__glu_gated_geglu__prompt_kernel_bc1_0b
adaLN_cond__ssm_conv_h3__glu_gated_geglu__prompt_kernel_bc1_1:
    s_mov_b32 s69, 0
adaLN_cond__ssm_conv_h3__glu_gated_geglu__prompt_kernel_bc1_1l:
    buffer_load_dwordx4 a[40:43], v9, s[16:19], s52 offen offset:2048 sc1
    buffer_load_dwordx4 a[44:47], v9, s[16:19], s53 offen offset:2048 sc1
    buffer_load_dwordx4 a[56:59], v9, s[16:19], s52 offen offset:3072 sc1
    buffer_load_dwordx4 a[60:63], v9, s[16:19], s53 offen offset:3072 sc1
    s_add_u32 s69, s69, 1
    s_waitcnt vmcnt(0)
    v_accvgpr_read_b32 v176, a40
    v_accvgpr_read_b32 v177, a44
    v_accvgpr_read_b32 v178, a56
    v_accvgpr_read_b32 v179, a60
    v_max3_u32 v176, v176, v177, v178
    v_max_u32 v176, v176, v179
    v_cmp_eq_u32 vcc, -1, v176
    s_cmp_ge_u32 s69, 400000
    s_cbranch_scc1 adaLN_cond__ssm_conv_h3__glu_gated_geglu__prompt_kernel_bc1_1lx
    s_nop 1
    s_cbranch_vccnz adaLN_cond__ssm_conv_h3__glu_gated_geglu__prompt_kernel_bc1_1l
adaLN_cond__ssm_conv_h3__glu_gated_geglu__prompt_kernel_bc1_1lx:
    s_branch adaLN_cond__ssm_conv_h3__glu_gated_geglu__prompt_kernel_bc1_1b
adaLN_cond__ssm_conv_h3__glu_gated_geglu__prompt_kernel_bc1_2:
    s_mov_b32 s69, 0
adaLN_cond__ssm_conv_h3__glu_gated_geglu__prompt_kernel_bc1_2l:
    buffer_load_dwordx4 a[72:75], v24, s[16:19], s52 offen offset:0 sc1
    buffer_load_dwordx4 a[76:79], v24, s[16:19], s53 offen offset:0 sc1
    buffer_load_dwordx4 a[88:91], v24, s[16:19], s52 offen offset:1024 sc1
    buffer_load_dwordx4 a[92:95], v24, s[16:19], s53 offen offset:1024 sc1
    s_add_u32 s69, s69, 1
    s_waitcnt vmcnt(0)
    v_accvgpr_read_b32 v176, a72
    v_accvgpr_read_b32 v177, a76
    v_accvgpr_read_b32 v178, a88
    v_accvgpr_read_b32 v179, a92
    v_max3_u32 v176, v176, v177, v178
    v_max_u32 v176, v176, v179
    v_cmp_eq_u32 vcc, -1, v176
    s_cmp_ge_u32 s69, 400000
    s_cbranch_scc1 adaLN_cond__ssm_conv_h3__glu_gated_geglu__prompt_kernel_bc1_2lx
    s_nop 1
    s_cbranch_vccnz adaLN_cond__ssm_conv_h3__glu_gated_geglu__prompt_kernel_bc1_2l
adaLN_cond__ssm_conv_h3__glu_gated_geglu__prompt_kernel_bc1_2lx:
    s_branch adaLN_cond__ssm_conv_h3__glu_gated_geglu__prompt_kernel_bc1_2b
adaLN_cond__ssm_conv_h3__glu_gated_geglu__prompt_kernel_bc1_3:
    s_mov_b32 s69, 0
adaLN_cond__ssm_conv_h3__glu_gated_geglu__prompt_kernel_bc1_3l:
    buffer_load_dwordx4 a[104:107], v24, s[16:19], s52 offen offset:2048 sc1
    buffer_load_dwordx4 a[108:111], v24, s[16:19], s53 offen offset:2048 sc1
    buffer_load_dwordx4 a[120:123], v24, s[16:19], s52 offen offset:3072 sc1
    buffer_load_dwordx4 a[124:127], v24, s[16:19], s53 offen offset:3072 sc1
    s_add_u32 s69, s69, 1
    s_waitcnt vmcnt(0)
    v_accvgpr_read_b32 v176, a104
    v_accvgpr_read_b32 v177, a108
    v_accvgpr_read_b32 v178, a120
    v_accvgpr_read_b32 v179, a124
    v_max3_u32 v176, v176, v177, v178
    v_max_u32 v176, v176, v179
    v_cmp_eq_u32 vcc, -1, v176
    s_cmp_ge_u32 s69, 400000
    s_cbranch_scc1 adaLN_cond__ssm_conv_h3__glu_gated_geglu__prompt_kernel_bc1_3lx
    s_nop 1
    s_cbranch_vccnz adaLN_cond__ssm_conv_h3__glu_gated_geglu__prompt_kernel_bc1_3l
adaLN_cond__ssm_conv_h3__glu_gated_geglu__prompt_kernel_bc1_3lx:
    s_branch adaLN_cond__ssm_conv_h3__glu_gated_geglu__prompt_kernel_bc1_3b
adaLN_cond__ssm_conv_h3__glu_gated_geglu__prompt_kernel_bc1_4:
    s_mov_b32 s69, 0
adaLN_cond__ssm_conv_h3__glu_gated_geglu__prompt_kernel_bc1_4l:
    buffer_load_dwordx4 a[136:139], v25, s[16:19], s52 offen offset:0 sc1
    buffer_load_dwordx4 a[140:143], v25, s[16:19], s53 offen offset:0 sc1
    buffer_load_dwordx4 a[152:155], v25, s[16:19], s52 offen offset:1024 sc1
    buffer_load_dwordx4 a[156:159], v25, s[16:19], s53 offen offset:1024 sc1
    s_add_u32 s69, s69, 1
    s_waitcnt vmcnt(0)
    v_accvgpr_read_b32 v176, a136
    v_accvgpr_read_b32 v177, a140
    v_accvgpr_read_b32 v178, a152
    v_accvgpr_read_b32 v179, a156
    v_max3_u32 v176, v176, v177, v178
    v_max_u32 v176, v176, v179
    v_cmp_eq_u32 vcc, -1, v176
    s_cmp_ge_u32 s69, 400000
    s_cbranch_scc1 adaLN_cond__ssm_conv_h3__glu_gated_geglu__prompt_kernel_bc1_4lx
    s_nop 1
    s_cbranch_vccnz adaLN_cond__ssm_conv_h3__glu_gated_geglu__prompt_kernel_bc1_4l
adaLN_cond__ssm_conv_h3__glu_gated_geglu__prompt_kernel_bc1_4lx:
    s_branch adaLN_cond__ssm_conv_h3__glu_gated_geglu__prompt_kernel_bc1_4b
adaLN_cond__ssm_conv_h3__glu_gated_geglu__prompt_kernel_bc1_5:
    s_mov_b32 s69, 0
adaLN_cond__ssm_conv_h3__glu_gated_geglu__prompt_kernel_bc1_5l:
    buffer_load_dwordx4 a[168:171], v25, s[16:19], s52 offen offset:2048 sc1
    buffer_load_dwordx4 a[172:175], v25, s[16:19], s53 offen offset:2048 sc1
    buffer_load_dwordx4 a[184:187], v25, s[16:19], s52 offen offset:3072 sc1
    buffer_load_dwordx4 a[188:191], v25, s[16:19], s53 offen offset:3072 sc1
    s_add_u32 s69, s69, 1
    s_waitcnt vmcnt(0)
    v_accvgpr_read_b32 v176, a168
    v_accvgpr_read_b32 v177, a172
    v_accvgpr_read_b32 v178, a184
    v_accvgpr_read_b32 v179, a188
    v_max3_u32 v176, v176, v177, v178
    v_max_u32 v176, v176, v179
    v_cmp_eq_u32 vcc, -1, v176
    s_cmp_ge_u32 s69, 400000
    s_cbranch_scc1 adaLN_cond__ssm_conv_h3__glu_gated_geglu__prompt_kernel_bc1_5lx
    s_nop 1
    s_cbranch_vccnz adaLN_cond__ssm_conv_h3__glu_gated_geglu__prompt_kernel_bc1_5l
adaLN_cond__ssm_conv_h3__glu_gated_geglu__prompt_kernel_bc1_5lx:
    s_branch adaLN_cond__ssm_conv_h3__glu_gated_geglu__prompt_kernel_bc1_5b
adaLN_cond__ssm_conv_h3__glu_gated_geglu__prompt_kernel_bc1_6:
    s_mov_b32 s69, 0
adaLN_cond__ssm_conv_h3__glu_gated_geglu__prompt_kernel_bc1_6l:
    buffer_load_dwordx4 a[200:203], v26, s[16:19], s52 offen offset:0 sc1
    buffer_load_dwordx4 a[204:207], v26, s[16:19], s53 offen offset:0 sc1
    buffer_load_dwordx4 a[216:219], v26, s[16:19], s52 offen offset:1024 sc1
    buffer_load_dwordx4 a[220:223], v26, s[16:19], s53 offen offset:1024 sc1
    s_add_u32 s69, s69, 1
    s_waitcnt vmcnt(0)
    v_accvgpr_read_b32 v176, a200
    v_accvgpr_read_b32 v177, a204
    v_accvgpr_read_b32 v178, a216
    v_accvgpr_read_b32 v179, a220
    v_max3_u32 v176, v176, v177, v178
    v_max_u32 v176, v176, v179
    v_cmp_eq_u32 vcc, -1, v176
    s_cmp_ge_u32 s69, 400000
    s_cbranch_scc1 adaLN_cond__ssm_conv_h3__glu_gated_geglu__prompt_kernel_bc1_6lx
    s_nop 1
    s_cbranch_vccnz adaLN_cond__ssm_conv_h3__glu_gated_geglu__prompt_kernel_bc1_6l
adaLN_cond__ssm_conv_h3__glu_gated_geglu__prompt_kernel_bc1_6lx:
    s_branch adaLN_cond__ssm_conv_h3__glu_gated_geglu__prompt_kernel_bc1_6b
adaLN_cond__ssm_conv_h3__glu_gated_geglu__prompt_kernel_bc1_7:
    s_mov_b32 s69, 0
adaLN_cond__ssm_conv_h3__glu_gated_geglu__prompt_kernel_bc1_7l:
    buffer_load_dwordx4 a[232:235], v26, s[16:19], s52 offen offset:2048 sc1
    buffer_load_dwordx4 a[236:239], v26, s[16:19], s53 offen offset:2048 sc1
    buffer_load_dwordx4 a[248:251], v26, s[16:19], s52 offen offset:3072 sc1
    buffer_load_dwordx4 a[252:255], v26, s[16:19], s53 offen offset:3072 sc1
    s_add_u32 s69, s69, 1
    s_waitcnt vmcnt(0)
    v_accvgpr_read_b32 v176, a232
    v_accvgpr_read_b32 v177, a236
    v_accvgpr_read_b32 v178, a248
    v_accvgpr_read_b32 v179, a252
    v_max3_u32 v176, v176, v177, v178
    v_max_u32 v176, v176, v179
    v_cmp_eq_u32 vcc, -1, v176
    s_cmp_ge_u32 s69, 400000
    s_cbranch_scc1 adaLN_cond__ssm_conv_h3__glu_gated_geglu__prompt_kernel_bc1_7lx
    s_nop 1
    s_cbranch_vccnz adaLN_cond__ssm_conv_h3__glu_gated_geglu__prompt_kernel_bc1_7l
adaLN_cond__ssm_conv_h3__glu_gated_geglu__prompt_kernel_bc1_7lx:
    s_branch adaLN_cond__ssm_conv_h3__glu_gated_geglu__prompt_kernel_bc1_7b
adaLN_cond__ssm_conv_h3__glu_gated_geglu__prompt_kernel_bc1_8:
    s_mov_b32 s69, 0
adaLN_cond__ssm_conv_h3__glu_gated_geglu__prompt_kernel_bc1_8l:
    buffer_load_dwordx4 v[232:235], v27, s[16:19], s52 offen offset:0 sc1
    buffer_load_dwordx4 v[236:239], v27, s[16:19], s53 offen offset:0 sc1
    buffer_load_dwordx4 v[248:251], v27, s[16:19], s52 offen offset:1024 sc1
    buffer_load_dwordx4 v[252:255], v27, s[16:19], s53 offen offset:1024 sc1
    s_add_u32 s69, s69, 1
    s_waitcnt vmcnt(0)
    v_max3_u32 v176, v232, v236, v248
    v_max_u32 v176, v176, v252
    v_cmp_eq_u32 vcc, -1, v176
    s_cmp_ge_u32 s69, 400000
    s_cbranch_scc1 adaLN_cond__ssm_conv_h3__glu_gated_geglu__prompt_kernel_bc1_8lx
    s_nop 1
    s_cbranch_vccnz adaLN_cond__ssm_conv_h3__glu_gated_geglu__prompt_kernel_bc1_8l
adaLN_cond__ssm_conv_h3__glu_gated_geglu__prompt_kernel_bc1_8lx:
    s_branch adaLN_cond__ssm_conv_h3__glu_gated_geglu__prompt_kernel_bc1_8b
adaLN_cond__ssm_conv_h3__glu_gated_geglu__prompt_kernel_slm:
    s_mov_b32 s69, 0
adaLN_cond__ssm_conv_h3__glu_gated_geglu__prompt_kernel_slml:
    buffer_load_dword v11, v246, s[16:19], s59 offen sc1
    s_add_u32 s69, s69, 1
    s_waitcnt vmcnt(0)
    v_subrev_u32 v11, s70, v11
    v_cmp_lt_u32 vcc, 5, v11
    s_cmp_ge_u32 s69, 400000
    s_cbranch_scc1 adaLN_cond__ssm_conv_h3__glu_gated_geglu__prompt_kernel_slmlx
    s_cbranch_vccz adaLN_cond__ssm_conv_h3__glu_gated_geglu__prompt_kernel_slmlx
    s_sleep 1
    s_branch adaLN_cond__ssm_conv_h3__glu_gated_geglu__prompt_kernel_slml
adaLN_cond__ssm_conv_h3__glu_gated_geglu__prompt_kernel_slmlx:
    s_branch adaLN_cond__ssm_conv_h3__glu_gated_geglu__prompt_kernel_slmb
adaLN_cond__ssm_conv_h3__glu_gated_geglu__prompt_kernel_slo:
    s_mov_b32 s69, 0
adaLN_cond__ssm_conv_h3__glu_gated_geglu__prompt_kernel_slol:
    buffer_load_dword v11, v246, s[16:19], s59 offen sc1
    s_add_u32 s69, s69, 1
    s_waitcnt vmcnt(0)
    v_subrev_u32 v11, s70, v11
    v_cmp_lt_u32 vcc, 5, v11
    s_cmp_ge_u32 s69, 400000
    s_cbranch_scc1 adaLN_cond__ssm_conv_h3__glu_gated_geglu__prompt_kernel_slolx
    s_cbranch_vccz adaLN_cond__ssm_conv_h3__glu_gated_geglu__prompt_kernel_slolx
    s_sleep 1
    s_branch adaLN_cond__ssm_conv_h3__glu_gated_geglu__prompt_kernel_slol
adaLN_cond__ssm_conv_h3__glu_gated_geglu__prompt_kernel_slolx:
    s_branch adaLN_cond__ssm_conv_h3__glu_gated_geglu__prompt_kernel_slob
adaLN_cond__ssm_conv_h3__glu_gated_geglu__prompt_kernel_slx:
    s_mov_b32 s69, 0
adaLN_cond__ssm_conv_h3__glu_gated_geglu__prompt_kernel_slxl:
    buffer_load_dword v11, v12, s[16:19], s3 offen sc1
    s_add_u32 s69, s69, 1
    s_waitcnt vmcnt(0)
    v_subrev_u32 v11, s70, v11
    v_cmp_lt_u32 vcc, 5, v11
    s_cmp_ge_u32 s69, 400000
    s_cbranch_scc1 adaLN_cond__ssm_conv_h3__glu_gated_geglu__prompt_kernel_slxlx
    s_nop 1
    s_cbranch_vccnz adaLN_cond__ssm_conv_h3__glu_gated_geglu__prompt_kernel_slxl
adaLN_cond__ssm_conv_h3__glu_gated_geglu__prompt_kernel_slxlx:
    s_branch adaLN_cond__ssm_conv_h3__glu_gated_geglu__prompt_kernel_slxb
adaLN_cond__ssm_conv_h3__glu_gated_geglu__prompt_kernel_sl3:
    s_mov_b32 s69, 0
adaLN_cond__ssm_conv_h3__glu_gated_geglu__prompt_kernel_sl3l:
    buffer_load_dword v11, v60, s[16:19], s59 offen sc1
    s_add_u32 s69, s69, 1
    s_waitcnt vmcnt(0)
    v_subrev_u32 v11, s70, v11
    v_subrev_u32 v11, 3, v11
    v_cmp_lt_u32 vcc, 2, v11
    s_cmp_ge_u32 s69, 400000
    s_cbranch_scc1 adaLN_cond__ssm_conv_h3__glu_gated_geglu__prompt_kernel_sl3lx
    s_nop 1
    s_cbranch_vccnz adaLN_cond__ssm_conv_h3__glu_gated_geglu__prompt_kernel_sl3l
adaLN_cond__ssm_conv_h3__glu_gated_geglu__prompt_kernel_sl3lx:
    s_branch adaLN_cond__ssm_conv_h3__glu_gated_geglu__prompt_kernel_sl3b
adaLN_cond__ssm_conv_h3__glu_gated_geglu__prompt_kernel_sl4:
    s_mov_b32 s69, 0
adaLN_cond__ssm_conv_h3__glu_gated_geglu__prompt_kernel_sl4l:
    buffer_load_dword v11, v60, s[16:19], s59 offen sc1
    s_add_u32 s69, s69, 1
    s_waitcnt vmcnt(0)
    v_subrev_u32 v11, s70, v11
    v_subrev_u32 v11, 4, v11
    v_cmp_lt_u32 vcc, 1, v11
    s_cmp_ge_u32 s69, 400000
    s_cbranch_scc1 adaLN_cond__ssm_conv_h3__glu_gated_geglu__prompt_kernel_sl4lx
    s_nop 1
    s_cbranch_vccnz adaLN_cond__ssm_conv_h3__glu_gated_geglu__prompt_kernel_sl4l
adaLN_cond__ssm_conv_h3__glu_gated_geglu__prompt_kernel_sl4lx:
    s_branch adaLN_cond__ssm_conv_h3__glu_gated_geglu__prompt_kernel_sl4b
adaLN_cond__ssm_conv_h3__glu_gated_geglu__prompt_kernel_sl5:
    s_mov_b32 s69, 0
adaLN_cond__ssm_conv_h3__glu_gated_geglu__prompt_kernel_sl5l:
    buffer_load_dword v11, v60, s[16:19], s59 offen sc1
    s_add_u32 s69, s69, 1
    s_waitcnt vmcnt(0)
    v_subrev_u32 v11, s70, v11
    v_subrev_u32 v11, 5, v11
    v_cmp_lt_u32 vcc, 0, v11
    s_cmp_ge_u32 s69, 400000
    s_cbranch_scc1 adaLN_cond__ssm_conv_h3__glu_gated_geglu__prompt_kernel_sl5lx
    s_nop 1
    s_cbranch_vccnz adaLN_cond__ssm_conv_h3__glu_gated_geglu__prompt_kernel_sl5l
adaLN_cond__ssm_conv_h3__glu_gated_geglu__prompt_kernel_sl5lx:
    s_branch adaLN_cond__ssm_conv_h3__glu_gated_geglu__prompt_kernel_sl5b
adaLN_cond__ssm_conv_h3__glu_gated_geglu__prompt_kernel_end:
    s_endpgm
.section .rodata,"a"
.p2align 6
.amdhsa_kernel adaLN_cond__ssm_conv_h3__glu_gated_geglu__prompt_kernel
  .amdhsa_next_free_vgpr 512
  .amdhsa_next_free_sgpr 86
  .amdhsa_accum_offset 256
  .amdhsa_group_segment_fixed_size 0
  .amdhsa_kernarg_size 120
  .amdhsa_user_sgpr_count 2
  .amdhsa_user_sgpr_kernarg_segment_ptr 1
  .amdhsa_system_sgpr_workgroup_id_x 1
  .amdhsa_float_denorm_mode_32 3
.end_amdhsa_kernel
```
